```python
import torch

def _softmax(x, axis=-1):
    return torch.softmax(x, dim=axis)
def _gelu(x):
    return torch.nn.functional.gelu(x, approximate="tanh")
def _silu(x):
    return torch.nn.functional.silu(x)
def _sigmoid(x):
    return torch.sigmoid(x)
def _layernorm(x, axis=-1, eps=1e-5):
    m = x.mean(dim=axis, keepdim=True)
    v = x.var(dim=axis, keepdim=True, unbiased=False)
    return (x - m) / torch.sqrt(v + eps)
def _scatter_add(tgt, idx, src, axis=0):
    return tgt.clone().index_add_(axis, idx, src)
def _segment_sum(src, seg, n):
    out = torch.zeros((n,) + src.shape[1:], dtype=src.dtype)
    return out.index_add_(0, seg, src)
def _pad(x, pw):
    flat = tuple(v for pair in reversed(pw) for v in pair)
    return torch.nn.functional.pad(x, flat)

kernel_name = 'gated_mix__sliding_local_dilated__compressed_kv_cla__prompt'

def setup_inputs():

    _w = (lambda a: (lambda t: t.to(torch.bfloat16) if t.is_floating_point() else t)(torch.as_tensor(a)))
    def _A_setup():
        B, S, D = 1, 2048, 512
        return {
            "x": _w((lambda *s: torch.randn(*s, dtype=torch.bfloat16) * 0.05)(B, S, D)),
            "wqkv": _w((lambda *s: torch.randn(*s, dtype=torch.bfloat16) * 1.6)(D, 3 * D)),
            "wo": _w((lambda *s: torch.randn(*s, dtype=torch.bfloat16) * 0.05)(D, D)),
        }
    _A_in = _A_setup()

    def _B_setup():
        B, H, Sq, Sk, D, M = 1, 32, 2048, 2048, 128, 512
        Dc = 4 * D
        return {
            "x": _w((lambda *s: torch.randn(*s, dtype=torch.bfloat16) * 0.05)(B, Sq, M)),
            "c_kv": _w((lambda *s: torch.randn(*s, dtype=torch.bfloat16) * 1.6)(B, Sk, Dc)),
            "w_q": _w((lambda *s: torch.randn(*s, dtype=torch.bfloat16) * 6.4)(M, H, D) * (M ** -0.5)),
            "w_uk": _w((lambda *s: torch.randn(*s, dtype=torch.bfloat16) * 6.4)(Dc, H, D) * (Dc ** -0.5)),
            "w_uv": _w((lambda *s: torch.randn(*s, dtype=torch.bfloat16) * 1.6)(Dc, H, D) * (Dc ** -0.5)),
            "w_o": _w((lambda *s: torch.randn(*s, dtype=torch.bfloat16) * 1.6)(H, D, M) * ((H * D) ** -0.5)),
        }
    _B_in = _B_setup()

    return {
        "A_x": _A_in["x"],
        "A_wqkv": _A_in["wqkv"],
        "A_wo": _A_in["wo"],
        "B_x": _B_in["x"],
        "B_c_kv": _B_in["c_kv"],
        "B_w_q": _B_in["w_q"],
        "B_w_uk": _B_in["w_uk"],
        "B_w_uv": _B_in["w_uv"],
        "B_w_o": _B_in["w_o"],
        "gate_w": _w((lambda *s: torch.randn(*s, dtype=torch.bfloat16) * 0.05)(512) * 16.0),
    }

def reference(A_x, A_wqkv, A_wo, B_x, B_c_kv, B_w_q, B_w_uk, B_w_uv, B_w_o, gate_w):
    def _A_ref(x, wqkv, wo):
        B, S, D = x.shape
        H = 32; Dh = D // H
        W, dil = 8, 2
        qkv = (lambda x, *d: x.permute(*d))((x @ wqkv).reshape(B, S, 3, H, Dh), 2, 0, 3, 1, 4)
        q, k, v = qkv[0], qkv[1], qkv[2]
        scale = Dh ** -0.5
        pos = torch.arange(S)
        off = torch.arange(W) * dil
        idx = pos[:, None] - off[None, :]
        mask = idx >= 0
        idx_c = torch.where(mask, idx, 0).reshape(-1)
        kg = k[:, :, idx_c, :].reshape(B, H, S, W, Dh)
        vg = v[:, :, idx_c, :].reshape(B, H, S, W, Dh)
        logits = torch.einsum("bhsd,bhswd->bhsw", q, kg) * scale
        logits = torch.where(mask[None, None, :, :], logits, -1e9)
        attn = _softmax(logits, axis=-1)
        o = torch.einsum("bhsw,bhswd->bhsd", attn, vg)
        return (lambda x, *d: x.permute(*d))(o, 0, 2, 1, 3).reshape(B, S, D) @ wo

    def _B_ref(x, c_kv, w_q, w_uk, w_uv, w_o):
        B, Sq, M = x.shape[0], x.shape[1], x.shape[2]
        Sk = c_kv.shape[1]
        H, D = w_q.shape[1], w_q.shape[2]
        q = torch.einsum("bqm,mhd->bhqd", x, w_q)
        k = torch.einsum("bkc,chd->bhkd", c_kv, w_uk)
        v = torch.einsum("bkc,chd->bhkd", c_kv, w_uv)
        scores = torch.einsum("bhqd,bhkd->bhqk", q, k) * (D ** -0.5)
        off = Sk - Sq
        qi = torch.arange(Sq)[:, None]
        kj = torch.arange(Sk)[None, :]
        cmask = kj <= (qi + off)
        scores = torch.where(cmask[None, None], scores, -1e9)
        p = _softmax(scores, axis=-1)
        ctx = torch.einsum("bhqk,bhkd->bhqd", p, v)
        return torch.einsum("bhqd,hdm->bqm", ctx, w_o)

    x = A_x
    g = _sigmoid((x * gate_w).sum(-1, keepdims=True))
    a = _A_ref(x, A_wqkv, A_wo)
    b = _B_ref(x, B_c_kv, B_w_q, B_w_uk, B_w_uv, B_w_o)
    return g * a + (1 - g) * b
```

```asm
; @launch grid=(256,1,1) block=(256,1,1) lds=163840
.amdgcn_target "amdgcn-amd-amdhsa--gfx950"
.text
.globl gated_mix__sliding_local_dilated__compressed_kv_cla__prompt_kernel
.p2align 8
.type gated_mix__sliding_local_dilated__compressed_kv_cla__prompt_kernel,@function
gated_mix__sliding_local_dilated__compressed_kv_cla__prompt_kernel:
    s_cmp_ge_u32 s2, 256
    s_cbranch_scc1 L_A_end
    s_load_dwordx16 s[36:51], s[0:1], 0
    s_load_dwordx8 s[52:59], s[0:1], 64
    s_load_dwordx2 s[60:61], s[0:1], 96
    v_lshrrev_b32 v16, 6, v0
    v_and_b32 v0, 63, v0
    v_readfirstlane_b32 s3, v16
L_cpf:
    s_getpc_b64 s[18:19]
    s_lshr_b32 s34, s2, 3
    s_lshl_b32 s34, s34, 2
    s_add_u32 s34, s34, s3
    s_mul_i32 s34, s34, 640
    v_min_u32 v18, 4, v0
    v_lshlrev_b32 v18, 7, v18
    v_add_u32 v18, s34, v18
    v_min_u32 v18, 0x11bcc, v18
    global_load_dword v23, v18, s[18:19]
    s_and_b32 s32, s2, 7
    s_lshl_b32 s32, s32, 2
    s_lshr_b32 s34, s2, 6
    s_add_u32 s32, s32, s34
    s_lshr_b32 s33, s2, 3
    s_and_b32 s33, s33, 7
    v_lshlrev_b32 v1, 4, v0
    v_lshrrev_b32 v16, 4, v0
    v_and_b32 v18, 7, v0
    v_xor_b32 v18, v18, v16
    v_lshlrev_b32 v18, 4, v18
    v_lshrrev_b32 v19, 3, v0
    v_lshl_add_u32 v2, v19, 10, v18
    v_xor_b32 v3, 64, v2
    v_add_u32 v4, 0x3800, v2
    v_add_u32 v5, 0x5400, v3
    v_add_u32 v3, 0x1c00, v3
    s_and_b32 s34, s3, 1
    s_lshl_b32 s35, s34, 2
    v_or_b32 v18, s35, v16
    v_bfe_u32 v19, v0, 1, 3
    v_xor_b32 v18, v18, v19
    v_lshlrev_b32 v18, 5, v18
    v_lshl_add_u32 v18, v16, 13, v18
    v_and_b32 v19, 1, v0
    v_lshl_add_u32 v6, v19, 4, v18
    v_add_u32 v7, 0x7c00, v6
    v_mov_b32 v8, v6
    v_add_u32 v9, 0x8000, v6
    s_lshl_b32 s75, s34, 5
    s_add_u32 s75, s75, s33
    s_lshr_b32 s76, s3, 1
    s_lshl_b32 s76, s76, 3
    s_add_u32 s75, s75, s76
    s_lshl_b32 s75, s75, 15
    s_mov_b32 s94, 524288
    s_lshl_b32 s65, s3, 13
    s_add_u32 s65, s65, 65536
    s_lshl_b32 s76, s3, 16
    s_lshl_b32 s35, s32, 8
    s_add_u32 s76, s76, s35
    s_mov_b32 s70, 0
    s_lshl_b32 s71, s3, 11
    s_add_u32 s72, s71, 8192
    s_add_u32 s73, s71, 9216
    s_lshr_b32 s92, s2, 5
    s_and_b32 s92, s92, 4
    s_add_u32 s92, s92, s33
    s_and_b32 s92, s92, 7
    s_and_b32 s90, s92, 0
    s_and_b32 s100, s33, 1
    s_lshl_b32 s101, s100, 19
    s_lshl_b32 s100, s100, 7
    s_add_u32 s90, s90, s2
    s_and_b32 s90, s90, 4
    s_add_u32 s92, s92, s2
    s_and_b32 s92, s92, 7
    s_lshl_b32 s91, s90, 1
    s_waitcnt lgkmcnt(0)
    s_add_u32 s82, s44, s75
    s_addc_u32 s83, s45, 0
    s_add_u32 s84, s48, s76
    s_addc_u32 s85, s49, 0
    s_add_u32 s86, s50, s76
    s_addc_u32 s87, s51, 0
    s_lshl_b32 s75, s90, 7
    s_xor_b32 s75, s75, s100
    s_add_u32 s4, s82, s75
    s_addc_u32 s5, s83, 0
    s_lshl_b32 s75, s91, 18
    s_xor_b32 s75, s75, s101
    s_add_u32 s6, s84, s75
    s_addc_u32 s7, s85, 0
    s_add_u32 s8, s86, s75
    s_addc_u32 s9, s87, 0
    s_mov_b64 s[10:11], s[8:9]
    s_add_u32 m0, s65, 0
    s_nop 0
    global_load_lds_dwordx4 v2, s[4:5] offset:0
    global_load_lds_dwordx4 v3, s[4:5] offset:1024
    global_load_lds_dwordx4 v4, s[4:5] offset:2048
    global_load_lds_dwordx4 v5, s[4:5] offset:3072
    s_add_u32 s4, s4, s94
    s_addc_u32 s5, s5, 0
    s_add_u32 m0, s70, s71
    s_nop 0
    global_load_lds_dwordx4 v6, s[6:7]
    global_load_lds_dwordx4 v7, s[6:7] offset:1024
    s_add_u32 m0, s70, s72
    s_nop 0
    global_load_lds_dwordx4 v8, s[8:9]
    s_add_u32 m0, s70, s73
    s_nop 0
    global_load_lds_dwordx4 v9, s[10:11]
    s_add_u32 s91, s91, 1
    s_and_b32 s91, s91, 15
    s_lshl_b32 s75, s91, 18
    s_xor_b32 s75, s75, s101
    s_add_u32 s6, s84, s75
    s_addc_u32 s7, s85, 0
    s_add_u32 s8, s86, s75
    s_addc_u32 s9, s87, 0
    s_mov_b64 s[10:11], s[8:9]
    s_add_u32 s70, s70, 16384
    s_and_b32 s70, s70, 0xffff
    s_cmp_eq_u32 s3, 3
    s_cselect_b32 s62, 0, -1
    s_cmp_ge_u32 s3, 2
    s_cselect_b32 s63, 0, -1
    s_and_b32 s67, s3, 1
    s_lshl_b32 s66, s67, 14
    s_lshl_b32 s77, s3, 11
    s_sub_u32 s66, s77, s66
    s_lshl_b32 s67, s67, 10
    s_lshr_b32 s64, s3, 1
    s_lshl_b32 s77, s64, 11
    s_lshl_b32 s64, s64, 12
    s_add_u32 s64, s64, 8192
    s_lshl_b32 s78, s33, 1
    s_sub_u32 s79, 30, s78
    s_cmp_ge_u32 s3, 2
    s_cselect_b32 s78, s79, s78
    s_and_b32 s79, s3, 1
    s_add_u32 s78, s78, s79
    s_lshl_b32 s78, s78, 16
    s_add_u32 s44, s60, 60817408
    s_addc_u32 s45, s61, 0
    s_add_u32 s12, s36, s78
    s_addc_u32 s13, s37, 0
    s_lshl_b32 s34, s32, 3
    s_add_u32 s34, s34, s33
    s_lshl_b32 s34, s34, 8
    s_add_u32 s48, s44, s34
    s_addc_u32 s49, s45, 0
    s_getreg_b32 s35, hwreg(HW_REG_XCC_ID, 0, 4)
    s_cmp_eq_u32 s3, 0
    s_cselect_b32 s50, 0x80, 0
    s_mov_b32 s51, 0x20000
    s_mov_b32 s95, s35
    s_min_u32 s34, s3, 2
    s_lshl_b32 s34, s34, 10
    s_lshr_b32 s96, s32, 2
    s_and_b32 s97, s32, 3
    s_lshl_b32 s35, s33, 2
    s_add_u32 s97, s97, s35
    s_mul_i32 s35, s97, 49152
    s_lshl_b32 s76, s96, 7
    s_add_u32 s35, s35, s76
    s_add_u32 s35, s35, s34
    s_add_u32 s98, s38, s35
    s_addc_u32 s99, s39, 0
    s_add_u32 s34, s34, 52428800
    s_mul_i32 s35, s32, 49152
    s_add_u32 s35, s35, s34
    s_add_u32 s16, s60, s35
    s_addc_u32 s17, s61, 0
    s_mul_i32 s35, s96, 196608
    s_add_u32 s34, s34, s35
    s_lshr_b32 s35, s97, 1
    s_mul_i32 s35, s35, 3072
    s_add_u32 s34, s34, s35
    s_and_b32 s35, s97, 1
    s_lshl_b32 s35, s35, 8
    s_add_u32 s34, s34, s35
    s_add_u32 s24, s60, s34
    s_addc_u32 s25, s61, 0
    s_and_b32 s26, s62, 148224
    s_mov_b32 s27, 0x20000
    v_lshrrev_b32 v18, 3, v0
    v_mul_u32_u24 v18, 0xc00, v18
    v_and_b32 v19, 7, v0
    v_lshl_add_u32 v18, v19, 4, v18
    s_and_b32 s34, s3, 1
    s_lshl_b32 s34, s34, 14
    v_and_b32 v20, 15, v0
    v_lshrrev_b32 v19, 1, v20
    v_xor_b32 v19, v19, v16
    v_lshlrev_b32 v19, 4, v19
    v_lshl_add_u32 v10, v20, 7, v19
    v_add_u32 v10, s34, v10
    v_lshrrev_b32 v20, 2, v20
    v_lshl_add_u32 v17, v16, 3, v20
    v_lshlrev_b32 v17, 8, v17
    v_and_b32 v19, 1, v16
    v_lshl_add_u32 v20, v19, 2, v20
    v_lshl_add_u32 v17, v20, 5, v17
    v_and_b32 v20, 3, v0
    v_lshl_add_u32 v17, v20, 3, v17
    s_lshr_b32 s34, s3, 1
    s_lshl_b32 s34, s34, 7
    v_xor_b32 v12, s34, v17
    v_xor_b32 v13, 32, v12
    v_xor_b32 v14, 64, v12
    v_xor_b32 v15, 0x60, v12
    v_add_u32 v11, 65536, v10
    s_mov_b32 s28, s58
    s_mov_b32 s29, s59
    s_mov_b32 s30, 0
    s_mov_b32 s31, 0x20000
    v_mov_b32 v22, 1
    s_add_u32 m0, s65, 4096
    s_nop 0
    global_load_lds_dwordx4 v2, s[4:5] offset:0
    global_load_lds_dwordx4 v3, s[4:5] offset:1024
    global_load_lds_dwordx4 v4, s[4:5] offset:2048
    global_load_lds_dwordx4 v5, s[4:5] offset:3072
    s_add_u32 s90, s90, 1
    s_and_b32 s90, s90, 7
    s_lshl_b32 s75, s90, 7
    s_xor_b32 s75, s75, s100
    s_add_u32 s4, s82, s75
    s_addc_u32 s5, s83, 0
    s_add_u32 s65, s65, 32768
    s_cmp_ge_u32 s65, 163840
    s_cselect_b32 s75, 98304, 0
    s_sub_u32 s65, s65, s75
    s_add_u32 m0, s70, s71
    s_nop 0
    global_load_lds_dwordx4 v6, s[6:7]
    global_load_lds_dwordx4 v7, s[6:7] offset:1024
    s_add_u32 m0, s70, s72
    s_nop 0
    global_load_lds_dwordx4 v8, s[8:9]
    s_add_u32 m0, s70, s73
    s_nop 0
    global_load_lds_dwordx4 v9, s[10:11]
    s_add_u32 s91, s91, 1
    s_and_b32 s91, s91, 15
    s_lshl_b32 s75, s91, 18
    s_xor_b32 s75, s75, s101
    s_add_u32 s6, s84, s75
    s_addc_u32 s7, s85, 0
    s_add_u32 s8, s86, s75
    s_addc_u32 s9, s87, 0
    s_mov_b64 s[10:11], s[8:9]
    s_add_u32 s70, s70, 16384
    s_and_b32 s70, s70, 0xffff
    s_waitcnt vmcnt(16)
    s_mov_b64 exec, 0
    s_cmp_eq_u32 s3, 0
    s_cbranch_scc1 L_wk0
    s_cmp_eq_u32 s3, 1
    s_cbranch_scc1 L_wk1
    s_cmp_eq_u32 s3, 2
    s_cbranch_scc1 L_wk2
    s_branch L_wk3
L_wkpad:
.p2align 12
L_wkret:
    s_mov_b64 exec, -1
    s_add_u32 m0, s65, 0
    s_nop 0
    global_load_lds_dwordx4 v2, s[4:5] offset:0
    global_load_lds_dwordx4 v3, s[4:5] offset:1024
    global_load_lds_dwordx4 v4, s[4:5] offset:2048
    global_load_lds_dwordx4 v5, s[4:5] offset:3072
    s_add_u32 s4, s4, s94
    s_addc_u32 s5, s5, 0
    s_add_u32 m0, s70, s71
    s_nop 0
    global_load_lds_dwordx4 v6, s[6:7]
    global_load_lds_dwordx4 v7, s[6:7] offset:1024
    s_add_u32 m0, s70, s72
    s_nop 0
    global_load_lds_dwordx4 v8, s[8:9]
    s_add_u32 m0, s70, s73
    s_nop 0
    global_load_lds_dwordx4 v9, s[10:11]
    s_add_u32 s91, s91, 1
    s_and_b32 s91, s91, 15
    s_lshl_b32 s75, s91, 18
    s_xor_b32 s75, s75, s101
    s_add_u32 s6, s84, s75
    s_addc_u32 s7, s85, 0
    s_add_u32 s8, s86, s75
    s_addc_u32 s9, s87, 0
    s_mov_b64 s[10:11], s[8:9]
    s_add_u32 s70, s70, 16384
    s_and_b32 s70, s70, 0xffff
    s_add_u32 m0, s65, 4096
    s_nop 0
    global_load_lds_dwordx4 v2, s[4:5] offset:0
    global_load_lds_dwordx4 v3, s[4:5] offset:1024
    global_load_lds_dwordx4 v4, s[4:5] offset:2048
    global_load_lds_dwordx4 v5, s[4:5] offset:3072
    s_add_u32 s90, s90, 1
    s_and_b32 s90, s90, 7
    s_lshl_b32 s75, s90, 7
    s_xor_b32 s75, s75, s100
    s_add_u32 s4, s82, s75
    s_addc_u32 s5, s83, 0
    s_add_u32 s65, s65, 32768
    s_cmp_ge_u32 s65, 163840
    s_cselect_b32 s75, 98304, 0
    s_sub_u32 s65, s65, s75
    s_waitcnt vmcnt(16)
    s_barrier
    ds_read_b64_tr_b16 a[128:129], v12 offset:0
    ds_read_b64_tr_b16 a[130:131], v12 offset:1024
    ds_read_b64_tr_b16 a[132:133], v13 offset:0
    ds_read_b64_tr_b16 a[134:135], v13 offset:1024
    ds_read_b64_tr_b16 a[136:137], v14 offset:0
    ds_read_b64_tr_b16 a[138:139], v14 offset:1024
    ds_read_b64_tr_b16 a[140:141], v15 offset:0
    ds_read_b64_tr_b16 a[142:143], v15 offset:1024
    ds_read_b128 a[64:67], v11 offset:0
    ds_read_b64_tr_b16 a[144:145], v12 offset:8192
    ds_read_b64_tr_b16 a[146:147], v12 offset:9216
    ds_read_b64_tr_b16 a[148:149], v13 offset:8192
    ds_read_b64_tr_b16 a[150:151], v13 offset:9216
    ds_read_b64_tr_b16 a[152:153], v14 offset:8192
    ds_read_b64_tr_b16 a[154:155], v14 offset:9216
    ds_read_b64_tr_b16 a[156:157], v15 offset:8192
    ds_read_b64_tr_b16 a[158:159], v15 offset:9216
    ds_read_b128 a[72:75], v11 offset:2048
    ds_read_b128 a[80:83], v11 offset:4096
    ds_read_b128 a[88:91], v11 offset:6144
    ds_read_b128 a[96:99], v11 offset:8192
    ds_read_b128 a[104:107], v11 offset:10240
    ds_read_b128 a[112:115], v11 offset:12288
    ds_read_b128 a[120:123], v11 offset:14336
    v_xor_b32 v21, 64, v11
    s_waitcnt lgkmcnt(0)
    v_mfma_f32_16x16x32_bf16 v[128:131], a[128:131], a[64:67], 0
    s_waitcnt vmcnt(12)
    v_mfma_f32_16x16x32_bf16 v[132:135], a[132:135], a[64:67], 0
    s_barrier
    v_mfma_f32_16x16x32_bf16 v[80:83], a[136:139], a[64:67], 0
    s_add_u32 m0, s70, s71
    ds_read_b64_tr_b16 a[160:161], v12 offset:16384
    global_load_lds_dwordx4 v6, s[6:7]
    v_mfma_f32_16x16x32_bf16 v[84:87], a[140:143], a[64:67], 0
    ds_read_b64_tr_b16 a[162:163], v12 offset:17408
    v_mfma_f32_16x16x32_bf16 v[192:195], a[64:67], a[144:147], 0
    ds_read_b64_tr_b16 a[164:165], v13 offset:16384
    v_mfma_f32_16x16x32_bf16 v[200:203], a[64:67], a[148:151], 0
    ds_read_b64_tr_b16 a[166:167], v13 offset:17408
    global_load_lds_dwordx4 v7, s[6:7] offset:1024
    v_mfma_f32_16x16x32_bf16 a[232:235], a[64:67], a[152:155], 0
    ds_read_b64_tr_b16 a[168:169], v14 offset:16384
    v_mfma_f32_16x16x32_bf16 a[240:243], a[64:67], a[156:159], 0
    ds_read_b64_tr_b16 a[170:171], v14 offset:17408
    v_mfma_f32_16x16x32_bf16 v[136:139], a[128:131], a[72:75], 0
    s_add_u32 m0, s70, s72
    ds_read_b64_tr_b16 a[172:173], v15 offset:16384
    global_load_lds_dwordx4 v8, s[8:9]
    v_mfma_f32_16x16x32_bf16 v[140:143], a[132:135], a[72:75], 0
    ds_read_b64_tr_b16 a[174:175], v15 offset:17408
    v_mfma_f32_16x16x32_bf16 v[24:27], a[136:139], a[72:75], 0
    ds_read_b64_tr_b16 a[176:177], v12 offset:24576
    v_mfma_f32_16x16x32_bf16 v[28:31], a[140:143], a[72:75], 0
    s_add_u32 m0, s70, s73
    ds_read_b64_tr_b16 a[178:179], v12 offset:25600
    global_load_lds_dwordx4 v9, s[10:11]
    v_mfma_f32_16x16x32_bf16 v[196:199], a[72:75], a[144:147], 0
    s_add_u32 m0, s65, 0
    ds_read_b64_tr_b16 a[180:181], v13 offset:24576
    v_mfma_f32_16x16x32_bf16 v[204:207], a[72:75], a[148:151], 0
    s_add_u32 s91, s91, 1
    ds_read_b64_tr_b16 a[182:183], v13 offset:25600
    v_mfma_f32_16x16x32_bf16 a[236:239], a[72:75], a[152:155], 0
    s_and_b32 s91, s91, 15
    ds_read_b64_tr_b16 a[184:185], v14 offset:24576
    global_load_lds_dwordx4 v2, s[4:5] offset:0
    v_mfma_f32_16x16x32_bf16 a[244:247], a[72:75], a[156:159], 0
    s_lshl_b32 s75, s91, 18
    ds_read_b64_tr_b16 a[186:187], v14 offset:25600
    v_mfma_f32_16x16x32_bf16 v[144:147], a[128:131], a[80:83], 0
    s_xor_b32 s75, s75, s101
    ds_read_b64_tr_b16 a[188:189], v15 offset:24576
    v_mfma_f32_16x16x32_bf16 v[148:151], a[132:135], a[80:83], 0
    s_add_u32 s6, s84, s75
    ds_read_b64_tr_b16 a[190:191], v15 offset:25600
    global_load_lds_dwordx4 v3, s[4:5] offset:1024
    v_mfma_f32_16x16x32_bf16 v[32:35], a[136:139], a[80:83], 0
    s_addc_u32 s7, s85, 0
    ds_read_b128 a[68:71], v21 offset:0
    v_mfma_f32_16x16x32_bf16 v[36:39], a[140:143], a[80:83], 0
    s_add_u32 s8, s86, s75
    ds_read_b128 a[76:79], v21 offset:2048
    v_mfma_f32_16x16x32_bf16 v[208:211], a[80:83], a[144:147], 0
    s_addc_u32 s9, s87, 0
    ds_read_b128 a[84:87], v21 offset:4096
    global_load_lds_dwordx4 v4, s[4:5] offset:2048
    v_mfma_f32_16x16x32_bf16 v[216:219], a[80:83], a[148:151], 0
    s_mov_b64 s[10:11], s[8:9]
    ds_read_b128 a[92:95], v21 offset:6144
    v_mfma_f32_16x16x32_bf16 a[248:251], a[80:83], a[152:155], 0
    s_add_u32 s70, s70, 16384
    ds_read_b128 a[100:103], v21 offset:8192
    v_mfma_f32_16x16x32_bf16 v[40:43], a[80:83], a[156:159], 0
    s_and_b32 s70, s70, 0xffff
    ds_read_b128 a[108:111], v21 offset:10240
    global_load_lds_dwordx4 v5, s[4:5] offset:3072
    v_mfma_f32_16x16x32_bf16 v[152:155], a[128:131], a[88:91], 0
    s_add_u32 s4, s4, s94
    ds_read_b128 a[116:119], v21 offset:12288
    v_mfma_f32_16x16x32_bf16 v[156:159], a[132:135], a[88:91], 0
    s_addc_u32 s5, s5, 0
    ds_read_b128 a[124:127], v21 offset:14336
    v_mfma_f32_16x16x32_bf16 v[88:91], a[136:139], a[88:91], 0
    v_mfma_f32_16x16x32_bf16 v[92:95], a[140:143], a[88:91], 0
    v_mfma_f32_16x16x32_bf16 v[212:215], a[88:91], a[144:147], 0
    s_add_u32 m0, s70, s71
    v_mfma_f32_16x16x32_bf16 v[220:223], a[88:91], a[148:151], 0
    global_load_lds_dwordx4 v6, s[6:7]
    v_mfma_f32_16x16x32_bf16 a[252:255], a[88:91], a[152:155], 0
    v_add_u32 v11, 98304, v10
    v_mfma_f32_16x16x32_bf16 v[44:47], a[88:91], a[156:159], 0
    v_mfma_f32_16x16x32_bf16 v[160:163], a[128:131], a[96:99], 0
    global_load_lds_dwordx4 v7, s[6:7] offset:1024
    v_mfma_f32_16x16x32_bf16 v[164:167], a[132:135], a[96:99], 0
    v_mfma_f32_16x16x32_bf16 v[96:99], a[136:139], a[96:99], 0
    v_mfma_f32_16x16x32_bf16 v[100:103], a[140:143], a[96:99], 0
    s_add_u32 m0, s70, s72
    v_mfma_f32_16x16x32_bf16 v[224:227], a[96:99], a[144:147], 0
    global_load_lds_dwordx4 v8, s[8:9]
    v_mfma_f32_16x16x32_bf16 v[232:235], a[96:99], a[148:151], 0
    v_mfma_f32_16x16x32_bf16 v[48:51], a[96:99], a[152:155], 0
    v_mfma_f32_16x16x32_bf16 v[56:59], a[96:99], a[156:159], 0
    s_add_u32 m0, s70, s73
    v_mfma_f32_16x16x32_bf16 v[168:171], a[128:131], a[104:107], 0
    global_load_lds_dwordx4 v9, s[10:11]
    v_mfma_f32_16x16x32_bf16 v[172:175], a[132:135], a[104:107], 0
    s_add_u32 m0, s65, 4096
    v_mfma_f32_16x16x32_bf16 v[104:107], a[136:139], a[104:107], 0
    s_add_u32 s91, s91, 1
    v_mfma_f32_16x16x32_bf16 v[108:111], a[140:143], a[104:107], 0
    s_and_b32 s91, s91, 15
    global_load_lds_dwordx4 v2, s[4:5] offset:0
    v_mfma_f32_16x16x32_bf16 v[228:231], a[104:107], a[144:147], 0
    s_lshl_b32 s75, s91, 18
    v_mfma_f32_16x16x32_bf16 v[236:239], a[104:107], a[148:151], 0
    s_xor_b32 s75, s75, s101
    v_mfma_f32_16x16x32_bf16 v[52:55], a[104:107], a[152:155], 0
    s_add_u32 s6, s84, s75
    global_load_lds_dwordx4 v3, s[4:5] offset:1024
    v_mfma_f32_16x16x32_bf16 v[60:63], a[104:107], a[156:159], 0
    s_addc_u32 s7, s85, 0
    v_mfma_f32_16x16x32_bf16 v[176:179], a[128:131], a[112:115], 0
    s_add_u32 s8, s86, s75
    v_mfma_f32_16x16x32_bf16 v[180:183], a[132:135], a[112:115], 0
    s_addc_u32 s9, s87, 0
    global_load_lds_dwordx4 v4, s[4:5] offset:2048
    v_mfma_f32_16x16x32_bf16 v[112:115], a[136:139], a[112:115], 0
    s_mov_b64 s[10:11], s[8:9]
    v_mfma_f32_16x16x32_bf16 v[116:119], a[140:143], a[112:115], 0
    s_add_u32 s70, s70, 16384
    v_mfma_f32_16x16x32_bf16 v[240:243], a[112:115], a[144:147], 0
    s_and_b32 s70, s70, 0xffff
    global_load_lds_dwordx4 v5, s[4:5] offset:3072
    v_mfma_f32_16x16x32_bf16 v[248:251], a[112:115], a[148:151], 0
    s_add_u32 s90, s90, 1
    v_mfma_f32_16x16x32_bf16 v[64:67], a[112:115], a[152:155], 0
    s_and_b32 s90, s90, 7
    v_mfma_f32_16x16x32_bf16 v[72:75], a[112:115], a[156:159], 0
    s_lshl_b32 s75, s90, 7
    v_mfma_f32_16x16x32_bf16 v[184:187], a[128:131], a[120:123], 0
    s_xor_b32 s75, s75, s100
    v_mfma_f32_16x16x32_bf16 v[188:191], a[132:135], a[120:123], 0
    s_add_u32 s4, s82, s75
    v_mfma_f32_16x16x32_bf16 v[120:123], a[136:139], a[120:123], 0
    s_addc_u32 s5, s83, 0
    v_mfma_f32_16x16x32_bf16 v[124:127], a[140:143], a[120:123], 0
    s_add_u32 s65, s65, 32768
    v_mfma_f32_16x16x32_bf16 v[244:247], a[120:123], a[144:147], 0
    s_cmp_ge_u32 s65, 163840
    v_mfma_f32_16x16x32_bf16 v[252:255], a[120:123], a[148:151], 0
    s_cselect_b32 s75, 98304, 0
    v_mfma_f32_16x16x32_bf16 v[68:71], a[120:123], a[152:155], 0
    s_sub_u32 s65, s65, s75
    v_mfma_f32_16x16x32_bf16 v[76:79], a[120:123], a[156:159], 0
    s_waitcnt lgkmcnt(0)
    v_mfma_f32_16x16x32_bf16 v[128:131], a[160:163], a[68:71], v[128:131]
    s_waitcnt vmcnt(16)
    v_mfma_f32_16x16x32_bf16 v[132:135], a[164:167], a[68:71], v[132:135]
    s_barrier
    v_mfma_f32_16x16x32_bf16 v[80:83], a[168:171], a[68:71], v[80:83]
    s_add_u32 m0, s70, s71
    ds_read_b64_tr_b16 a[0:1], v12 offset:32768
    global_load_lds_dwordx4 v6, s[6:7]
    v_mfma_f32_16x16x32_bf16 v[84:87], a[172:175], a[68:71], v[84:87]
    ds_read_b64_tr_b16 a[2:3], v12 offset:33792
    v_mfma_f32_16x16x32_bf16 v[192:195], a[68:71], a[176:179], v[192:195]
    ds_read_b64_tr_b16 a[4:5], v13 offset:32768
    v_mfma_f32_16x16x32_bf16 v[200:203], a[68:71], a[180:183], v[200:203]
    ds_read_b64_tr_b16 a[6:7], v13 offset:33792
    v_mfma_f32_16x16x32_bf16 a[232:235], a[68:71], a[184:187], a[232:235]
    ds_read_b64_tr_b16 a[8:9], v14 offset:32768
    v_mfma_f32_16x16x32_bf16 a[240:243], a[68:71], a[188:191], a[240:243]
    ds_read_b64_tr_b16 a[10:11], v14 offset:33792
    v_mfma_f32_16x16x32_bf16 v[136:139], a[160:163], a[76:79], v[136:139]
    ds_read_b64_tr_b16 a[12:13], v15 offset:32768
    global_load_lds_dwordx4 v7, s[6:7] offset:1024
    v_mfma_f32_16x16x32_bf16 v[140:143], a[164:167], a[76:79], v[140:143]
    ds_read_b64_tr_b16 a[14:15], v15 offset:33792
    v_mfma_f32_16x16x32_bf16 v[24:27], a[168:171], a[76:79], v[24:27]
    ds_read_b64_tr_b16 a[16:17], v12 offset:40960
    v_mfma_f32_16x16x32_bf16 v[28:31], a[172:175], a[76:79], v[28:31]
    ds_read_b64_tr_b16 a[18:19], v12 offset:41984
    v_mfma_f32_16x16x32_bf16 v[196:199], a[76:79], a[176:179], v[196:199]
    ds_read_b64_tr_b16 a[20:21], v13 offset:40960
    v_mfma_f32_16x16x32_bf16 v[204:207], a[76:79], a[180:183], v[204:207]
    ds_read_b64_tr_b16 a[22:23], v13 offset:41984
    v_mfma_f32_16x16x32_bf16 a[236:239], a[76:79], a[184:187], a[236:239]
    s_add_u32 m0, s70, s72
    ds_read_b64_tr_b16 a[24:25], v14 offset:40960
    global_load_lds_dwordx4 v8, s[8:9]
    v_mfma_f32_16x16x32_bf16 a[244:247], a[76:79], a[188:191], a[244:247]
    ds_read_b64_tr_b16 a[26:27], v14 offset:41984
    v_mfma_f32_16x16x32_bf16 v[144:147], a[160:163], a[84:87], v[144:147]
    ds_read_b64_tr_b16 a[28:29], v15 offset:40960
    v_mfma_f32_16x16x32_bf16 v[148:151], a[164:167], a[84:87], v[148:151]
    ds_read_b64_tr_b16 a[30:31], v15 offset:41984
    v_mfma_f32_16x16x32_bf16 v[32:35], a[168:171], a[84:87], v[32:35]
    ds_read_b128 a[64:67], v11 offset:0
    v_mfma_f32_16x16x32_bf16 v[36:39], a[172:175], a[84:87], v[36:39]
    ds_read_b128 a[72:75], v11 offset:2048
    v_mfma_f32_16x16x32_bf16 v[208:211], a[84:87], a[176:179], v[208:211]
    s_add_u32 m0, s70, s73
    ds_read_b128 a[80:83], v11 offset:4096
    global_load_lds_dwordx4 v9, s[10:11]
    v_mfma_f32_16x16x32_bf16 v[216:219], a[84:87], a[180:183], v[216:219]
    s_add_u32 m0, s65, 0
    ds_read_b128 a[88:91], v11 offset:6144
    v_mfma_f32_16x16x32_bf16 a[248:251], a[84:87], a[184:187], a[248:251]
    s_add_u32 s91, s91, 1
    ds_read_b128 a[96:99], v11 offset:8192
    v_mfma_f32_16x16x32_bf16 v[40:43], a[84:87], a[188:191], v[40:43]
    s_and_b32 s91, s91, 15
    ds_read_b128 a[104:107], v11 offset:10240
    v_mfma_f32_16x16x32_bf16 v[152:155], a[160:163], a[92:95], v[152:155]
    s_lshl_b32 s75, s91, 18
    ds_read_b128 a[112:115], v11 offset:12288
    v_mfma_f32_16x16x32_bf16 v[156:159], a[164:167], a[92:95], v[156:159]
    s_xor_b32 s75, s75, s101
    ds_read_b128 a[192:195], v11 offset:14336
    v_mfma_f32_16x16x32_bf16 v[88:91], a[168:171], a[92:95], v[88:91]
    s_add_u32 s6, s84, s75
    global_load_lds_dwordx4 v2, s[4:5] offset:0
    v_mfma_f32_16x16x32_bf16 v[92:95], a[172:175], a[92:95], v[92:95]
    s_addc_u32 s7, s85, 0
    v_mfma_f32_16x16x32_bf16 v[212:215], a[92:95], a[176:179], v[212:215]
    s_add_u32 s8, s86, s75
    v_mfma_f32_16x16x32_bf16 v[220:223], a[92:95], a[180:183], v[220:223]
    s_addc_u32 s9, s87, 0
    global_load_dwordx4 a[200:203], v18, s[98:99]
    v_mfma_f32_16x16x32_bf16 a[252:255], a[92:95], a[184:187], a[252:255]
    s_mov_b64 s[10:11], s[8:9]
    v_xor_b32 v21, 64, v11
    v_add_u32 v18, 24576, v18
    v_mfma_f32_16x16x32_bf16 v[44:47], a[92:95], a[188:191], v[44:47]
    s_add_u32 s70, s70, 16384
    v_mfma_f32_16x16x32_bf16 v[160:163], a[160:163], a[100:103], v[160:163]
    s_and_b32 s70, s70, 0xffff
    global_load_lds_dwordx4 v3, s[4:5] offset:1024
    v_mfma_f32_16x16x32_bf16 v[164:167], a[164:167], a[100:103], v[164:167]
    v_mfma_f32_16x16x32_bf16 v[96:99], a[168:171], a[100:103], v[96:99]
    v_mfma_f32_16x16x32_bf16 v[100:103], a[172:175], a[100:103], v[100:103]
    global_load_dwordx4 a[204:207], v18, s[98:99]
    v_mfma_f32_16x16x32_bf16 v[224:227], a[100:103], a[176:179], v[224:227]
    v_mfma_f32_16x16x32_bf16 v[232:235], a[100:103], a[180:183], v[232:235]
    v_mfma_f32_16x16x32_bf16 v[48:51], a[100:103], a[184:187], v[48:51]
    global_load_lds_dwordx4 v4, s[4:5] offset:2048
    v_mfma_f32_16x16x32_bf16 v[56:59], a[100:103], a[188:191], v[56:59]
    v_mfma_f32_16x16x32_bf16 v[168:171], a[160:163], a[108:111], v[168:171]
    v_mfma_f32_16x16x32_bf16 v[172:175], a[164:167], a[108:111], v[172:175]
    v_mfma_f32_16x16x32_bf16 v[104:107], a[168:171], a[108:111], v[104:107]
    v_mfma_f32_16x16x32_bf16 v[108:111], a[172:175], a[108:111], v[108:111]
    v_mfma_f32_16x16x32_bf16 v[228:231], a[108:111], a[176:179], v[228:231]
    global_load_lds_dwordx4 v5, s[4:5] offset:3072
    v_mfma_f32_16x16x32_bf16 v[236:239], a[108:111], a[180:183], v[236:239]
    s_add_u32 s4, s4, s94
    v_mfma_f32_16x16x32_bf16 v[52:55], a[108:111], a[184:187], v[52:55]
    s_addc_u32 s5, s5, 0
    v_mfma_f32_16x16x32_bf16 v[60:63], a[108:111], a[188:191], v[60:63]
    s_and_b32 s34, s32, 15
    v_mfma_f32_16x16x32_bf16 v[176:179], a[160:163], a[116:119], v[176:179]
    s_lshl_b32 s34, s34, 2
    v_mfma_f32_16x16x32_bf16 v[180:183], a[164:167], a[116:119], v[180:183]
    s_add_u32 s34, s34, s3
    v_mfma_f32_16x16x32_bf16 v[112:115], a[168:171], a[116:119], v[112:115]
    s_lshl_b32 s34, s34, 13
    v_mfma_f32_16x16x32_bf16 v[116:119], a[172:175], a[116:119], v[116:119]
    s_lshl_b32 s35, s33, 7
    v_mfma_f32_16x16x32_bf16 v[240:243], a[116:119], a[176:179], v[240:243]
    s_add_u32 s34, s34, s35
    v_mfma_f32_16x16x32_bf16 v[248:251], a[116:119], a[180:183], v[248:251]
    v_and_b32 v19, 7, v0
    v_lshl_add_u32 v20, v19, 10, s34
    v_mfma_f32_16x16x32_bf16 v[64:67], a[116:119], a[184:187], v[64:67]
    v_lshlrev_b32 v19, 7, v19
    v_mfma_f32_16x16x32_bf16 v[72:75], a[116:119], a[188:191], v[72:75]
    v_mfma_f32_16x16x32_bf16 v[184:187], a[160:163], a[124:127], v[184:187]
    global_load_dword v23, v20, s[40:41]
    v_mfma_f32_16x16x32_bf16 v[188:191], a[164:167], a[124:127], v[188:191]
    global_load_dword v23, v19, s[54:55]
    v_mfma_f32_16x16x32_bf16 v[120:123], a[168:171], a[124:127], v[120:123]
    v_mfma_f32_16x16x32_bf16 v[124:127], a[172:175], a[124:127], v[124:127]
    v_mfma_f32_16x16x32_bf16 v[244:247], a[124:127], a[176:179], v[244:247]
    v_mfma_f32_16x16x32_bf16 v[252:255], a[124:127], a[180:183], v[252:255]
    v_mfma_f32_16x16x32_bf16 v[68:71], a[124:127], a[184:187], v[68:71]
    v_mfma_f32_16x16x32_bf16 v[76:79], a[124:127], a[188:191], v[76:79]
    s_waitcnt lgkmcnt(0)
    v_mfma_f32_16x16x32_bf16 v[128:131], a[0:3], a[64:67], v[128:131]
    s_waitcnt vmcnt(24)
    v_mfma_f32_16x16x32_bf16 v[132:135], a[4:7], a[64:67], v[132:135]
    s_barrier
    v_mfma_f32_16x16x32_bf16 v[80:83], a[8:11], a[64:67], v[80:83]
    s_add_u32 m0, s70, s71
    ds_read_b64_tr_b16 a[32:33], v12 offset:49152
    global_load_lds_dwordx4 v6, s[6:7]
    v_mfma_f32_16x16x32_bf16 v[84:87], a[12:15], a[64:67], v[84:87]
    ds_read_b64_tr_b16 a[34:35], v12 offset:50176
    v_mfma_f32_16x16x32_bf16 v[192:195], a[64:67], a[16:19], v[192:195]
    ds_read_b64_tr_b16 a[36:37], v13 offset:49152
    v_mfma_f32_16x16x32_bf16 v[200:203], a[64:67], a[20:23], v[200:203]
    ds_read_b64_tr_b16 a[38:39], v13 offset:50176
    v_mfma_f32_16x16x32_bf16 a[232:235], a[64:67], a[24:27], a[232:235]
    ds_read_b64_tr_b16 a[40:41], v14 offset:49152
    v_mfma_f32_16x16x32_bf16 a[240:243], a[64:67], a[28:31], a[240:243]
    ds_read_b64_tr_b16 a[42:43], v14 offset:50176
    v_mfma_f32_16x16x32_bf16 v[136:139], a[0:3], a[72:75], v[136:139]
    ds_read_b64_tr_b16 a[44:45], v15 offset:49152
    global_load_lds_dwordx4 v7, s[6:7] offset:1024
    v_mfma_f32_16x16x32_bf16 v[140:143], a[4:7], a[72:75], v[140:143]
    ds_read_b64_tr_b16 a[46:47], v15 offset:50176
    v_mfma_f32_16x16x32_bf16 v[24:27], a[8:11], a[72:75], v[24:27]
    ds_read_b64_tr_b16 a[48:49], v12 offset:57344
    v_mfma_f32_16x16x32_bf16 v[28:31], a[12:15], a[72:75], v[28:31]
    ds_read_b64_tr_b16 a[50:51], v12 offset:58368
    v_mfma_f32_16x16x32_bf16 v[196:199], a[72:75], a[16:19], v[196:199]
    ds_read_b64_tr_b16 a[52:53], v13 offset:57344
    v_mfma_f32_16x16x32_bf16 v[204:207], a[72:75], a[20:23], v[204:207]
    ds_read_b64_tr_b16 a[54:55], v13 offset:58368
    v_mfma_f32_16x16x32_bf16 a[236:239], a[72:75], a[24:27], a[236:239]
    s_add_u32 m0, s70, s72
    ds_read_b64_tr_b16 a[56:57], v14 offset:57344
    global_load_lds_dwordx4 v8, s[8:9]
    v_mfma_f32_16x16x32_bf16 a[244:247], a[72:75], a[28:31], a[244:247]
    ds_read_b64_tr_b16 a[58:59], v14 offset:58368
    v_mfma_f32_16x16x32_bf16 v[144:147], a[0:3], a[80:83], v[144:147]
    ds_read_b64_tr_b16 a[60:61], v15 offset:57344
    v_mfma_f32_16x16x32_bf16 v[148:151], a[4:7], a[80:83], v[148:151]
    ds_read_b64_tr_b16 a[62:63], v15 offset:58368
    v_mfma_f32_16x16x32_bf16 v[32:35], a[8:11], a[80:83], v[32:35]
    ds_read_b128 a[68:71], v21 offset:0
    v_mfma_f32_16x16x32_bf16 v[36:39], a[12:15], a[80:83], v[36:39]
    ds_read_b128 a[76:79], v21 offset:2048
    v_mfma_f32_16x16x32_bf16 v[208:211], a[80:83], a[16:19], v[208:211]
    s_add_u32 m0, s70, s73
    ds_read_b128 a[84:87], v21 offset:4096
    global_load_lds_dwordx4 v9, s[10:11]
    v_mfma_f32_16x16x32_bf16 v[216:219], a[80:83], a[20:23], v[216:219]
    s_add_u32 m0, s65, 4096
    ds_read_b128 a[92:95], v21 offset:6144
    v_mfma_f32_16x16x32_bf16 a[248:251], a[80:83], a[24:27], a[248:251]
    s_add_u32 s91, s91, 1
    ds_read_b128 a[100:103], v21 offset:8192
    v_mfma_f32_16x16x32_bf16 v[40:43], a[80:83], a[28:31], v[40:43]
    s_and_b32 s91, s91, 15
    ds_read_b128 a[108:111], v21 offset:10240
    v_mfma_f32_16x16x32_bf16 v[152:155], a[0:3], a[88:91], v[152:155]
    s_lshl_b32 s75, s91, 18
    ds_read_b128 a[116:119], v21 offset:12288
    v_mfma_f32_16x16x32_bf16 v[156:159], a[4:7], a[88:91], v[156:159]
    s_xor_b32 s75, s75, s101
    ds_read_b128 a[196:199], v21 offset:14336
    v_mfma_f32_16x16x32_bf16 v[88:91], a[8:11], a[88:91], v[88:91]
    s_add_u32 s6, s84, s75
    global_load_lds_dwordx4 v2, s[4:5] offset:0
    v_mfma_f32_16x16x32_bf16 v[92:95], a[12:15], a[88:91], v[92:95]
    s_addc_u32 s7, s85, 0
    v_mfma_f32_16x16x32_bf16 v[212:215], a[88:91], a[16:19], v[212:215]
    s_add_u32 s8, s86, s75
    v_mfma_f32_16x16x32_bf16 v[220:223], a[88:91], a[20:23], v[220:223]
    s_addc_u32 s9, s87, 0
    v_mfma_f32_16x16x32_bf16 a[252:255], a[88:91], a[24:27], a[252:255]
    s_mov_b64 s[10:11], s[8:9]
    v_add_u32 v11, 131072, v10
    v_mfma_f32_16x16x32_bf16 v[44:47], a[88:91], a[28:31], v[44:47]
    s_add_u32 s70, s70, 16384
    v_mfma_f32_16x16x32_bf16 v[160:163], a[0:3], a[96:99], v[160:163]
    s_and_b32 s70, s70, 0xffff
    global_load_lds_dwordx4 v3, s[4:5] offset:1024
    v_mfma_f32_16x16x32_bf16 v[164:167], a[4:7], a[96:99], v[164:167]
    v_mfma_f32_16x16x32_bf16 v[96:99], a[8:11], a[96:99], v[96:99]
    v_mfma_f32_16x16x32_bf16 v[100:103], a[12:15], a[96:99], v[100:103]
    v_mfma_f32_16x16x32_bf16 v[224:227], a[96:99], a[16:19], v[224:227]
    v_mfma_f32_16x16x32_bf16 v[232:235], a[96:99], a[20:23], v[232:235]
    v_mfma_f32_16x16x32_bf16 v[48:51], a[96:99], a[24:27], v[48:51]
    global_load_lds_dwordx4 v4, s[4:5] offset:2048
    v_mfma_f32_16x16x32_bf16 v[56:59], a[96:99], a[28:31], v[56:59]
    v_mfma_f32_16x16x32_bf16 v[168:171], a[0:3], a[104:107], v[168:171]
    v_mfma_f32_16x16x32_bf16 v[172:175], a[4:7], a[104:107], v[172:175]
    v_mfma_f32_16x16x32_bf16 v[104:107], a[8:11], a[104:107], v[104:107]
    v_mfma_f32_16x16x32_bf16 v[108:111], a[12:15], a[104:107], v[108:111]
    v_mfma_f32_16x16x32_bf16 v[228:231], a[104:107], a[16:19], v[228:231]
    global_load_lds_dwordx4 v5, s[4:5] offset:3072
    v_mfma_f32_16x16x32_bf16 v[236:239], a[104:107], a[20:23], v[236:239]
    s_add_u32 s90, s90, 1
    v_mfma_f32_16x16x32_bf16 v[52:55], a[104:107], a[24:27], v[52:55]
    s_and_b32 s90, s90, 7
    v_mfma_f32_16x16x32_bf16 v[60:63], a[104:107], a[28:31], v[60:63]
    s_lshl_b32 s75, s90, 7
    v_mfma_f32_16x16x32_bf16 v[176:179], a[0:3], a[112:115], v[176:179]
    s_xor_b32 s75, s75, s100
    v_mfma_f32_16x16x32_bf16 v[180:183], a[4:7], a[112:115], v[180:183]
    s_add_u32 s4, s82, s75
    v_mfma_f32_16x16x32_bf16 v[112:115], a[8:11], a[112:115], v[112:115]
    s_addc_u32 s5, s83, 0
    v_mfma_f32_16x16x32_bf16 v[116:119], a[12:15], a[112:115], v[116:119]
    s_add_u32 s65, s65, 32768
    v_mfma_f32_16x16x32_bf16 v[240:243], a[112:115], a[16:19], v[240:243]
    s_cmp_ge_u32 s65, 163840
    v_mfma_f32_16x16x32_bf16 v[248:251], a[112:115], a[20:23], v[248:251]
    s_cselect_b32 s75, 98304, 0
    v_mfma_f32_16x16x32_bf16 v[64:67], a[112:115], a[24:27], v[64:67]
    s_sub_u32 s65, s65, s75
    v_mfma_f32_16x16x32_bf16 v[72:75], a[112:115], a[28:31], v[72:75]
    v_mfma_f32_16x16x32_bf16 v[184:187], a[0:3], a[192:195], v[184:187]
    v_mfma_f32_16x16x32_bf16 v[188:191], a[4:7], a[192:195], v[188:191]
    v_mfma_f32_16x16x32_bf16 v[120:123], a[8:11], a[192:195], v[120:123]
    v_mfma_f32_16x16x32_bf16 v[124:127], a[12:15], a[192:195], v[124:127]
    v_mfma_f32_16x16x32_bf16 v[244:247], a[192:195], a[16:19], v[244:247]
    v_mfma_f32_16x16x32_bf16 v[252:255], a[192:195], a[20:23], v[252:255]
    v_mfma_f32_16x16x32_bf16 v[68:71], a[192:195], a[24:27], v[68:71]
    v_mfma_f32_16x16x32_bf16 v[76:79], a[192:195], a[28:31], v[76:79]
    s_waitcnt lgkmcnt(0)
    v_mfma_f32_16x16x32_bf16 v[128:131], a[32:35], a[68:71], v[128:131]
    s_waitcnt vmcnt(20)
    v_mfma_f32_16x16x32_bf16 v[132:135], a[36:39], a[68:71], v[132:135]
    s_barrier
    v_mfma_f32_16x16x32_bf16 v[80:83], a[40:43], a[68:71], v[80:83]
    s_add_u32 m0, s70, s71
    ds_read_b64_tr_b16 a[128:129], v12 offset:0
    global_load_lds_dwordx4 v6, s[6:7]
    v_mfma_f32_16x16x32_bf16 v[84:87], a[44:47], a[68:71], v[84:87]
    ds_read_b64_tr_b16 a[130:131], v12 offset:1024
    v_mfma_f32_16x16x32_bf16 v[192:195], a[68:71], a[48:51], v[192:195]
    ds_read_b64_tr_b16 a[132:133], v13 offset:0
    v_mfma_f32_16x16x32_bf16 v[200:203], a[68:71], a[52:55], v[200:203]
    ds_read_b64_tr_b16 a[134:135], v13 offset:1024
    v_mfma_f32_16x16x32_bf16 a[232:235], a[68:71], a[56:59], a[232:235]
    ds_read_b64_tr_b16 a[136:137], v14 offset:0
    v_mfma_f32_16x16x32_bf16 a[240:243], a[68:71], a[60:63], a[240:243]
    ds_read_b64_tr_b16 a[138:139], v14 offset:1024
    v_mfma_f32_16x16x32_bf16 v[136:139], a[32:35], a[76:79], v[136:139]
    ds_read_b64_tr_b16 a[140:141], v15 offset:0
    global_load_lds_dwordx4 v7, s[6:7] offset:1024
    v_mfma_f32_16x16x32_bf16 v[140:143], a[36:39], a[76:79], v[140:143]
    ds_read_b64_tr_b16 a[142:143], v15 offset:1024
    v_mfma_f32_16x16x32_bf16 v[24:27], a[40:43], a[76:79], v[24:27]
    ds_read_b64_tr_b16 a[144:145], v12 offset:8192
    v_mfma_f32_16x16x32_bf16 v[28:31], a[44:47], a[76:79], v[28:31]
    ds_read_b64_tr_b16 a[146:147], v12 offset:9216
    v_mfma_f32_16x16x32_bf16 v[196:199], a[76:79], a[48:51], v[196:199]
    ds_read_b64_tr_b16 a[148:149], v13 offset:8192
    v_mfma_f32_16x16x32_bf16 v[204:207], a[76:79], a[52:55], v[204:207]
    ds_read_b64_tr_b16 a[150:151], v13 offset:9216
    v_mfma_f32_16x16x32_bf16 a[236:239], a[76:79], a[56:59], a[236:239]
    s_add_u32 m0, s70, s72
    ds_read_b64_tr_b16 a[152:153], v14 offset:8192
    global_load_lds_dwordx4 v8, s[8:9]
    v_mfma_f32_16x16x32_bf16 a[244:247], a[76:79], a[60:63], a[244:247]
    ds_read_b64_tr_b16 a[154:155], v14 offset:9216
    v_mfma_f32_16x16x32_bf16 v[144:147], a[32:35], a[84:87], v[144:147]
    ds_read_b64_tr_b16 a[156:157], v15 offset:8192
    v_mfma_f32_16x16x32_bf16 v[148:151], a[36:39], a[84:87], v[148:151]
    ds_read_b64_tr_b16 a[158:159], v15 offset:9216
    v_mfma_f32_16x16x32_bf16 v[32:35], a[40:43], a[84:87], v[32:35]
    ds_read_b128 a[64:67], v11 offset:0
    v_mfma_f32_16x16x32_bf16 v[36:39], a[44:47], a[84:87], v[36:39]
    ds_read_b128 a[72:75], v11 offset:2048
    v_mfma_f32_16x16x32_bf16 v[208:211], a[84:87], a[48:51], v[208:211]
    s_add_u32 m0, s70, s73
    ds_read_b128 a[80:83], v11 offset:4096
    global_load_lds_dwordx4 v9, s[10:11]
    v_mfma_f32_16x16x32_bf16 v[216:219], a[84:87], a[52:55], v[216:219]
    s_add_u32 m0, s65, 0
    ds_read_b128 a[88:91], v11 offset:6144
    v_mfma_f32_16x16x32_bf16 a[248:251], a[84:87], a[56:59], a[248:251]
    s_add_u32 s91, s91, 1
    ds_read_b128 a[96:99], v11 offset:8192
    v_mfma_f32_16x16x32_bf16 v[40:43], a[84:87], a[60:63], v[40:43]
    s_and_b32 s91, s91, 15
    ds_read_b128 a[104:107], v11 offset:10240
    v_mfma_f32_16x16x32_bf16 v[152:155], a[32:35], a[92:95], v[152:155]
    s_lshl_b32 s75, s91, 18
    ds_read_b128 a[112:115], v11 offset:12288
    v_mfma_f32_16x16x32_bf16 v[156:159], a[36:39], a[92:95], v[156:159]
    s_xor_b32 s75, s75, s101
    ds_read_b128 a[120:123], v11 offset:14336
    v_mfma_f32_16x16x32_bf16 v[88:91], a[40:43], a[92:95], v[88:91]
    s_add_u32 s6, s84, s75
    global_load_lds_dwordx4 v2, s[4:5] offset:0
    v_mfma_f32_16x16x32_bf16 v[92:95], a[44:47], a[92:95], v[92:95]
    s_addc_u32 s7, s85, 0
    v_mfma_f32_16x16x32_bf16 v[212:215], a[92:95], a[48:51], v[212:215]
    s_add_u32 s8, s86, s75
    v_mfma_f32_16x16x32_bf16 v[220:223], a[92:95], a[52:55], v[220:223]
    s_addc_u32 s9, s87, 0
    v_mfma_f32_16x16x32_bf16 a[252:255], a[92:95], a[56:59], a[252:255]
    s_mov_b64 s[10:11], s[8:9]
    v_xor_b32 v21, 64, v11
    v_mfma_f32_16x16x32_bf16 v[44:47], a[92:95], a[60:63], v[44:47]
    s_add_u32 s70, s70, 16384
    v_mfma_f32_16x16x32_bf16 v[160:163], a[32:35], a[100:103], v[160:163]
    s_and_b32 s70, s70, 0xffff
    global_load_lds_dwordx4 v3, s[4:5] offset:1024
    v_mfma_f32_16x16x32_bf16 v[164:167], a[36:39], a[100:103], v[164:167]
    v_mfma_f32_16x16x32_bf16 v[96:99], a[40:43], a[100:103], v[96:99]
    v_mfma_f32_16x16x32_bf16 v[100:103], a[44:47], a[100:103], v[100:103]
    v_mfma_f32_16x16x32_bf16 v[224:227], a[100:103], a[48:51], v[224:227]
    v_mfma_f32_16x16x32_bf16 v[232:235], a[100:103], a[52:55], v[232:235]
    v_mfma_f32_16x16x32_bf16 v[48:51], a[100:103], a[56:59], v[48:51]
    global_load_lds_dwordx4 v4, s[4:5] offset:2048
    v_mfma_f32_16x16x32_bf16 v[56:59], a[100:103], a[60:63], v[56:59]
    v_mfma_f32_16x16x32_bf16 v[168:171], a[32:35], a[108:111], v[168:171]
    v_mfma_f32_16x16x32_bf16 v[172:175], a[36:39], a[108:111], v[172:175]
    v_mfma_f32_16x16x32_bf16 v[104:107], a[40:43], a[108:111], v[104:107]
    v_mfma_f32_16x16x32_bf16 v[108:111], a[44:47], a[108:111], v[108:111]
    v_mfma_f32_16x16x32_bf16 v[228:231], a[108:111], a[48:51], v[228:231]
    global_load_lds_dwordx4 v5, s[4:5] offset:3072
    v_mfma_f32_16x16x32_bf16 v[236:239], a[108:111], a[52:55], v[236:239]
    s_add_u32 s4, s4, s94
    v_mfma_f32_16x16x32_bf16 v[52:55], a[108:111], a[56:59], v[52:55]
    s_addc_u32 s5, s5, 0
    v_mfma_f32_16x16x32_bf16 v[60:63], a[108:111], a[60:63], v[60:63]
L_wk0:
    s_cbranch_execz L_wk4
    s_lshl_b32 s34, s32, 3
    v_mfma_f32_16x16x32_bf16 v[176:179], a[32:35], a[116:119], v[176:179]
    s_add_u32 s34, s34, s33
    v_mfma_f32_16x16x32_bf16 v[180:183], a[36:39], a[116:119], v[180:183]
    s_lshl_b32 s34, s34, 2
    v_mfma_f32_16x16x32_bf16 v[112:115], a[40:43], a[116:119], v[112:115]
    s_add_u32 s34, s34, s3
    v_mfma_f32_16x16x32_bf16 v[116:119], a[44:47], a[116:119], v[116:119]
    s_mul_i32 s35, s34, 1024
    v_mfma_f32_16x16x32_bf16 v[240:243], a[116:119], a[48:51], v[240:243]
    s_lshl_b32 s34, s34, 12
    v_mfma_f32_16x16x32_bf16 v[248:251], a[116:119], a[52:55], v[248:251]
    s_add_u32 s96, s52, s34
    v_mfma_f32_16x16x32_bf16 v[64:67], a[116:119], a[56:59], v[64:67]
    s_addc_u32 s97, s53, 0
    v_mfma_f32_16x16x32_bf16 v[72:75], a[116:119], a[60:63], v[72:75]
    v_and_b32 v20, 7, v0
    v_lshl_add_u32 v20, v20, 7, s35
    v_mfma_f32_16x16x32_bf16 v[184:187], a[32:35], a[196:199], v[184:187]
    v_and_b32 v20, 0xfff, v20
    v_mfma_f32_16x16x32_bf16 v[188:191], a[36:39], a[196:199], v[188:191]
    v_mfma_f32_16x16x32_bf16 v[120:123], a[40:43], a[196:199], v[120:123]
    v_mfma_f32_16x16x32_bf16 v[124:127], a[44:47], a[196:199], v[124:127]
    v_mfma_f32_16x16x32_bf16 v[244:247], a[196:199], a[48:51], v[244:247]
    v_mfma_f32_16x16x32_bf16 v[252:255], a[196:199], a[52:55], v[252:255]
    v_mfma_f32_16x16x32_bf16 v[68:71], a[196:199], a[56:59], v[68:71]
    v_mfma_f32_16x16x32_bf16 v[76:79], a[196:199], a[60:63], v[76:79]
    s_waitcnt lgkmcnt(0)
    v_mfma_f32_16x16x32_bf16 v[128:131], a[128:131], a[64:67], v[128:131]
    s_waitcnt vmcnt(20)
    v_bfe_u32 v19, v0, 1, 2
    v_mul_u32_u24 v19, 0xc000, v19
    v_mfma_f32_16x16x32_bf16 v[132:135], a[132:135], a[64:67], v[132:135]
    s_barrier
    v_lshrrev_b32 v18, 5, v0
    v_lshl_add_u32 v19, v18, 9, v19
    v_mfma_f32_16x16x32_bf16 v[80:83], a[136:139], a[64:67], v[80:83]
    s_add_u32 m0, s70, s71
    ds_read_b64_tr_b16 a[160:161], v12 offset:16384
    global_load_lds_dwordx4 v6, s[6:7]
    v_mfma_f32_16x16x32_bf16 v[84:87], a[140:143], a[64:67], v[84:87]
    ds_read_b64_tr_b16 a[162:163], v12 offset:17408
    v_bfe_u32 v18, v0, 3, 2
    v_mfma_f32_16x16x32_bf16 v[192:195], a[64:67], a[144:147], v[192:195]
    ds_read_b64_tr_b16 a[164:165], v13 offset:16384
    v_lshl_add_u32 v19, v18, 5, v19
    v_mfma_f32_16x16x32_bf16 v[200:203], a[64:67], a[148:151], v[200:203]
    ds_read_b64_tr_b16 a[166:167], v13 offset:17408
    v_and_b32 v18, 1, v0
    v_mfma_f32_16x16x32_bf16 a[232:235], a[64:67], a[152:155], a[232:235]
    ds_read_b64_tr_b16 a[168:169], v14 offset:16384
    v_lshl_add_u32 v19, v18, 4, v19
    v_mfma_f32_16x16x32_bf16 a[240:243], a[64:67], a[156:159], a[240:243]
    ds_read_b64_tr_b16 a[170:171], v14 offset:17408
    v_lshlrev_b32 v18, 2, v0
    v_mfma_f32_16x16x32_bf16 v[136:139], a[128:131], a[72:75], v[136:139]
    ds_read_b64_tr_b16 a[172:173], v15 offset:16384
    global_load_lds_dwordx4 v7, s[6:7] offset:1024
    v_mfma_f32_16x16x32_bf16 v[140:143], a[132:135], a[72:75], v[140:143]
    ds_read_b64_tr_b16 a[174:175], v15 offset:17408
    v_mov_b32 v22, s95
    v_mfma_f32_16x16x32_bf16 v[24:27], a[136:139], a[72:75], v[24:27]
    ds_read_b64_tr_b16 a[176:177], v12 offset:24576
    v_mfma_f32_16x16x32_bf16 v[28:31], a[140:143], a[72:75], v[28:31]
    ds_read_b64_tr_b16 a[178:179], v12 offset:25600
    v_mfma_f32_16x16x32_bf16 v[196:199], a[72:75], a[144:147], v[196:199]
    ds_read_b64_tr_b16 a[180:181], v13 offset:24576
    v_mfma_f32_16x16x32_bf16 v[204:207], a[72:75], a[148:151], v[204:207]
    ds_read_b64_tr_b16 a[182:183], v13 offset:25600
    v_mfma_f32_16x16x32_bf16 a[236:239], a[72:75], a[152:155], a[236:239]
    s_add_u32 m0, s70, s72
    ds_read_b64_tr_b16 a[184:185], v14 offset:24576
    global_load_lds_dwordx4 v8, s[8:9]
    v_mfma_f32_16x16x32_bf16 a[244:247], a[72:75], a[156:159], a[244:247]
    ds_read_b64_tr_b16 a[186:187], v14 offset:25600
    v_mfma_f32_16x16x32_bf16 v[144:147], a[128:131], a[80:83], v[144:147]
    ds_read_b64_tr_b16 a[188:189], v15 offset:24576
    v_mfma_f32_16x16x32_bf16 v[148:151], a[132:135], a[80:83], v[148:151]
    ds_read_b64_tr_b16 a[190:191], v15 offset:25600
    v_mfma_f32_16x16x32_bf16 v[32:35], a[136:139], a[80:83], v[32:35]
    ds_read_b128 a[68:71], v21 offset:0
    v_mfma_f32_16x16x32_bf16 v[36:39], a[140:143], a[80:83], v[36:39]
    ds_read_b128 a[76:79], v21 offset:2048
    v_mfma_f32_16x16x32_bf16 v[208:211], a[80:83], a[144:147], v[208:211]
    s_add_u32 m0, s70, s73
    ds_read_b128 a[84:87], v21 offset:4096
    global_load_lds_dwordx4 v9, s[10:11]
    v_mfma_f32_16x16x32_bf16 v[216:219], a[80:83], a[148:151], v[216:219]
    s_add_u32 m0, s65, 4096
    ds_read_b128 a[92:95], v21 offset:6144
    v_mfma_f32_16x16x32_bf16 a[248:251], a[80:83], a[152:155], a[248:251]
    s_add_u32 s91, s91, 1
    ds_read_b128 a[100:103], v21 offset:8192
    v_mfma_f32_16x16x32_bf16 v[40:43], a[80:83], a[156:159], v[40:43]
    s_and_b32 s91, s91, 15
    ds_read_b128 a[108:111], v21 offset:10240
    v_mfma_f32_16x16x32_bf16 v[152:155], a[128:131], a[88:91], v[152:155]
    s_lshl_b32 s75, s91, 18
    ds_read_b128 a[116:119], v21 offset:12288
    v_mfma_f32_16x16x32_bf16 v[156:159], a[132:135], a[88:91], v[156:159]
    s_xor_b32 s75, s75, s101
    ds_read_b128 a[124:127], v21 offset:14336
    v_mfma_f32_16x16x32_bf16 v[88:91], a[136:139], a[88:91], v[88:91]
    s_add_u32 s6, s84, s75
    global_load_lds_dwordx4 v2, s[4:5] offset:0
    v_mfma_f32_16x16x32_bf16 v[92:95], a[140:143], a[88:91], v[92:95]
    s_addc_u32 s7, s85, 0
    v_mfma_f32_16x16x32_bf16 v[212:215], a[88:91], a[144:147], v[212:215]
    s_add_u32 s8, s86, s75
    v_mfma_f32_16x16x32_bf16 v[220:223], a[88:91], a[148:151], v[220:223]
    s_addc_u32 s9, s87, 0
    v_mfma_f32_16x16x32_bf16 a[252:255], a[88:91], a[152:155], a[252:255]
    s_mov_b64 s[10:11], s[8:9]
    buffer_store_dwordx4 a[200:203], v19, s[24:27], 0 offen sc1
    v_add_u32 v11, 65536, v10
    v_mfma_f32_16x16x32_bf16 v[44:47], a[88:91], a[156:159], v[44:47]
    s_add_u32 s70, s70, 16384
    v_xor_b32 v21, 64, v11
    v_mfma_f32_16x16x32_bf16 v[160:163], a[128:131], a[96:99], v[160:163]
    s_and_b32 s70, s70, 0xffff
    global_load_lds_dwordx4 v3, s[4:5] offset:1024
    v_mfma_f32_16x16x32_bf16 v[164:167], a[132:135], a[96:99], v[164:167]
    buffer_store_dwordx4 a[204:207], v19, s[24:27], 0 offen offset:128 sc1
    v_mfma_f32_16x16x32_bf16 v[96:99], a[136:139], a[96:99], v[96:99]
    v_mfma_f32_16x16x32_bf16 v[100:103], a[140:143], a[96:99], v[100:103]
    v_mfma_f32_16x16x32_bf16 v[224:227], a[96:99], a[144:147], v[224:227]
    buffer_store_dword v22, v18, s[48:51], 0 offen sc1
    v_mfma_f32_16x16x32_bf16 v[232:235], a[96:99], a[148:151], v[232:235]
    v_mfma_f32_16x16x32_bf16 v[48:51], a[96:99], a[152:155], v[48:51]
    global_load_lds_dwordx4 v4, s[4:5] offset:2048
    v_mfma_f32_16x16x32_bf16 v[56:59], a[96:99], a[156:159], v[56:59]
    v_mfma_f32_16x16x32_bf16 v[168:171], a[128:131], a[104:107], v[168:171]
    v_mfma_f32_16x16x32_bf16 v[172:175], a[132:135], a[104:107], v[172:175]
    v_mfma_f32_16x16x32_bf16 v[104:107], a[136:139], a[104:107], v[104:107]
    v_mfma_f32_16x16x32_bf16 v[108:111], a[140:143], a[104:107], v[108:111]
    v_mfma_f32_16x16x32_bf16 v[228:231], a[104:107], a[144:147], v[228:231]
    global_load_lds_dwordx4 v5, s[4:5] offset:3072
    v_mfma_f32_16x16x32_bf16 v[236:239], a[104:107], a[148:151], v[236:239]
    s_add_u32 s90, s90, 1
    v_mfma_f32_16x16x32_bf16 v[52:55], a[104:107], a[152:155], v[52:55]
    s_and_b32 s90, s90, 7
    v_mfma_f32_16x16x32_bf16 v[60:63], a[104:107], a[156:159], v[60:63]
    s_lshl_b32 s75, s90, 7
    global_load_dword v23, v20, s[96:97]
    v_mfma_f32_16x16x32_bf16 v[176:179], a[128:131], a[112:115], v[176:179]
    s_xor_b32 s75, s75, s100
    v_add_u32 v20, 1024, v20
    v_and_b32 v20, 0xfff, v20
    v_mfma_f32_16x16x32_bf16 v[180:183], a[132:135], a[112:115], v[180:183]
    s_add_u32 s4, s82, s75
    v_mfma_f32_16x16x32_bf16 v[112:115], a[136:139], a[112:115], v[112:115]
    s_addc_u32 s5, s83, 0
    v_mfma_f32_16x16x32_bf16 v[116:119], a[140:143], a[112:115], v[116:119]
    s_add_u32 s65, s65, 32768
    v_mfma_f32_16x16x32_bf16 v[240:243], a[112:115], a[144:147], v[240:243]
    s_cmp_ge_u32 s65, 163840
    v_mfma_f32_16x16x32_bf16 v[248:251], a[112:115], a[148:151], v[248:251]
    s_cselect_b32 s75, 98304, 0
    v_mfma_f32_16x16x32_bf16 v[64:67], a[112:115], a[152:155], v[64:67]
    s_sub_u32 s65, s65, s75
    v_mfma_f32_16x16x32_bf16 v[72:75], a[112:115], a[156:159], v[72:75]
    v_mfma_f32_16x16x32_bf16 v[184:187], a[128:131], a[120:123], v[184:187]
    v_mfma_f32_16x16x32_bf16 v[188:191], a[132:135], a[120:123], v[188:191]
    v_mfma_f32_16x16x32_bf16 v[120:123], a[136:139], a[120:123], v[120:123]
    v_mfma_f32_16x16x32_bf16 v[124:127], a[140:143], a[120:123], v[124:127]
    v_mfma_f32_16x16x32_bf16 v[244:247], a[120:123], a[144:147], v[244:247]
    v_mfma_f32_16x16x32_bf16 v[252:255], a[120:123], a[148:151], v[252:255]
    v_mfma_f32_16x16x32_bf16 v[68:71], a[120:123], a[152:155], v[68:71]
    v_mfma_f32_16x16x32_bf16 v[76:79], a[120:123], a[156:159], v[76:79]
    s_waitcnt lgkmcnt(0)
    v_mfma_f32_16x16x32_bf16 v[128:131], a[160:163], a[68:71], v[128:131]
    s_waitcnt vmcnt(20)
    v_mov_b32 v22, 1
    v_mfma_f32_16x16x32_bf16 v[132:135], a[164:167], a[68:71], v[132:135]
    s_barrier
    v_mfma_f32_16x16x32_bf16 v[80:83], a[168:171], a[68:71], v[80:83]
    s_add_u32 m0, s70, s71
    ds_read_b64_tr_b16 a[0:1], v12 offset:32768
    global_load_lds_dwordx4 v6, s[6:7]
    v_mfma_f32_16x16x32_bf16 v[84:87], a[172:175], a[68:71], v[84:87]
    s_min_u32 s50, s50, 4
    ds_read_b64_tr_b16 a[2:3], v12 offset:33792
    v_mfma_f32_16x16x32_bf16 v[192:195], a[68:71], a[176:179], v[192:195]
    s_mov_b32 s30, s50
    ds_read_b64_tr_b16 a[4:5], v13 offset:32768
    v_mfma_f32_16x16x32_bf16 v[200:203], a[68:71], a[180:183], v[200:203]
    ds_read_b64_tr_b16 a[6:7], v13 offset:33792
    v_mfma_f32_16x16x32_bf16 a[232:235], a[68:71], a[184:187], a[232:235]
    ds_read_b64_tr_b16 a[8:9], v14 offset:32768
    v_mfma_f32_16x16x32_bf16 a[240:243], a[68:71], a[188:191], a[240:243]
    ds_read_b64_tr_b16 a[10:11], v14 offset:33792
    v_mfma_f32_16x16x32_bf16 v[136:139], a[160:163], a[76:79], v[136:139]
    ds_read_b64_tr_b16 a[12:13], v15 offset:32768
    global_load_lds_dwordx4 v7, s[6:7] offset:1024
    v_mfma_f32_16x16x32_bf16 v[140:143], a[164:167], a[76:79], v[140:143]
    ds_read_b64_tr_b16 a[14:15], v15 offset:33792
    v_mfma_f32_16x16x32_bf16 v[24:27], a[168:171], a[76:79], v[24:27]
    ds_read_b64_tr_b16 a[16:17], v12 offset:40960
    v_mfma_f32_16x16x32_bf16 v[28:31], a[172:175], a[76:79], v[28:31]
    ds_read_b64_tr_b16 a[18:19], v12 offset:41984
    v_mfma_f32_16x16x32_bf16 v[196:199], a[76:79], a[176:179], v[196:199]
    ds_read_b64_tr_b16 a[20:21], v13 offset:40960
    v_mfma_f32_16x16x32_bf16 v[204:207], a[76:79], a[180:183], v[204:207]
    ds_read_b64_tr_b16 a[22:23], v13 offset:41984
    v_mfma_f32_16x16x32_bf16 a[236:239], a[76:79], a[184:187], a[236:239]
    s_add_u32 m0, s70, s72
    ds_read_b64_tr_b16 a[24:25], v14 offset:40960
    global_load_lds_dwordx4 v8, s[8:9]
    v_mfma_f32_16x16x32_bf16 a[244:247], a[76:79], a[188:191], a[244:247]
    ds_read_b64_tr_b16 a[26:27], v14 offset:41984
    v_mfma_f32_16x16x32_bf16 v[144:147], a[160:163], a[84:87], v[144:147]
    ds_read_b64_tr_b16 a[28:29], v15 offset:40960
    v_mfma_f32_16x16x32_bf16 v[148:151], a[164:167], a[84:87], v[148:151]
    ds_read_b64_tr_b16 a[30:31], v15 offset:41984
    v_mfma_f32_16x16x32_bf16 v[32:35], a[168:171], a[84:87], v[32:35]
    ds_read_b128 a[64:67], v11 offset:0
    v_mfma_f32_16x16x32_bf16 v[36:39], a[172:175], a[84:87], v[36:39]
    ds_read_b128 a[72:75], v11 offset:2048
    v_mfma_f32_16x16x32_bf16 v[208:211], a[84:87], a[176:179], v[208:211]
    s_add_u32 m0, s70, s73
    ds_read_b128 a[80:83], v11 offset:4096
    global_load_lds_dwordx4 v9, s[10:11]
    v_mfma_f32_16x16x32_bf16 v[216:219], a[84:87], a[180:183], v[216:219]
    s_add_u32 m0, s65, 0
    ds_read_b128 a[88:91], v11 offset:6144
    v_mfma_f32_16x16x32_bf16 a[248:251], a[84:87], a[184:187], a[248:251]
    s_add_u32 s91, s91, 1
    ds_read_b128 a[96:99], v11 offset:8192
    v_mfma_f32_16x16x32_bf16 v[40:43], a[84:87], a[188:191], v[40:43]
    s_and_b32 s91, s91, 15
    ds_read_b128 a[104:107], v11 offset:10240
    v_mfma_f32_16x16x32_bf16 v[152:155], a[160:163], a[92:95], v[152:155]
    s_lshl_b32 s75, s91, 18
    ds_read_b128 a[112:115], v11 offset:12288
    v_mfma_f32_16x16x32_bf16 v[156:159], a[164:167], a[92:95], v[156:159]
    s_xor_b32 s75, s75, s101
    ds_read_b128 a[192:195], v11 offset:14336
    v_mfma_f32_16x16x32_bf16 v[88:91], a[168:171], a[92:95], v[88:91]
    s_add_u32 s6, s84, s75
    ds_read_b128 a[196:199], v21 offset:14336
    global_load_lds_dwordx4 v2, s[4:5] offset:0
    v_mfma_f32_16x16x32_bf16 v[92:95], a[172:175], a[92:95], v[92:95]
    s_addc_u32 s7, s85, 0
    ds_read_b128 a[68:71], v21 offset:0
    v_mfma_f32_16x16x32_bf16 v[212:215], a[92:95], a[176:179], v[212:215]
    s_add_u32 s8, s86, s75
    ds_read_b128 a[76:79], v21 offset:2048
    v_mfma_f32_16x16x32_bf16 v[220:223], a[92:95], a[180:183], v[220:223]
    s_addc_u32 s9, s87, 0
    ds_read_b128 a[84:87], v21 offset:4096
    v_mfma_f32_16x16x32_bf16 a[252:255], a[92:95], a[184:187], a[252:255]
    s_mov_b64 s[10:11], s[8:9]
    v_mfma_f32_16x16x32_bf16 v[44:47], a[92:95], a[188:191], v[44:47]
    s_waitcnt vmcnt(21)
    v_mfma_f32_16x16x32_bf16 v[160:163], a[160:163], a[100:103], v[160:163]
    s_barrier
    global_load_lds_dwordx4 v3, s[4:5] offset:1024
    v_mfma_f32_16x16x32_bf16 v[164:167], a[164:167], a[100:103], v[164:167]
    s_add_u32 s70, s70, 16384
    ds_read_b128 a[92:95], v21 offset:6144
    v_mfma_f32_16x16x32_bf16 v[96:99], a[168:171], a[100:103], v[96:99]
    s_and_b32 s70, s70, 0xffff
    ds_read_b64_tr_b16 a[32:33], v12 offset:49152
    v_mfma_f32_16x16x32_bf16 v[100:103], a[172:175], a[100:103], v[100:103]
    ds_read_b64_tr_b16 a[34:35], v12 offset:50176
    v_mfma_f32_16x16x32_bf16 v[224:227], a[100:103], a[176:179], v[224:227]
    ds_read_b64_tr_b16 a[36:37], v13 offset:49152
    v_mfma_f32_16x16x32_bf16 v[232:235], a[100:103], a[180:183], v[232:235]
    ds_read_b64_tr_b16 a[38:39], v13 offset:50176
    v_mfma_f32_16x16x32_bf16 v[48:51], a[100:103], a[184:187], v[48:51]
    ds_read_b64_tr_b16 a[40:41], v14 offset:49152
    global_load_lds_dwordx4 v4, s[4:5] offset:2048
    v_mfma_f32_16x16x32_bf16 v[56:59], a[100:103], a[188:191], v[56:59]
    ds_read_b64_tr_b16 a[42:43], v14 offset:50176
    v_mfma_f32_16x16x32_bf16 v[168:171], a[160:163], a[108:111], v[168:171]
    ds_read_b64_tr_b16 a[44:45], v15 offset:49152
    v_mfma_f32_16x16x32_bf16 v[172:175], a[164:167], a[108:111], v[172:175]
    ds_read_b128 a[100:103], v21 offset:8192
    v_mfma_f32_16x16x32_bf16 v[104:107], a[168:171], a[108:111], v[104:107]
    ds_read_b64_tr_b16 a[46:47], v15 offset:50176
    v_mfma_f32_16x16x32_bf16 v[108:111], a[172:175], a[108:111], v[108:111]
    ds_read_b64_tr_b16 a[48:49], v12 offset:57344
    v_mfma_f32_16x16x32_bf16 v[228:231], a[108:111], a[176:179], v[228:231]
    ds_read_b64_tr_b16 a[50:51], v12 offset:58368
    global_load_lds_dwordx4 v5, s[4:5] offset:3072
    v_mfma_f32_16x16x32_bf16 v[236:239], a[108:111], a[180:183], v[236:239]
    s_add_u32 s4, s4, s94
    ds_read_b64_tr_b16 a[52:53], v13 offset:57344
    v_mfma_f32_16x16x32_bf16 v[52:55], a[108:111], a[184:187], v[52:55]
    s_addc_u32 s5, s5, 0
    ds_read_b64_tr_b16 a[54:55], v13 offset:58368
    v_mfma_f32_16x16x32_bf16 v[60:63], a[108:111], a[188:191], v[60:63]
    ds_read_b64_tr_b16 a[56:57], v14 offset:57344
    global_load_dword v23, v20, s[96:97]
    v_mfma_f32_16x16x32_bf16 v[176:179], a[160:163], a[116:119], v[176:179]
    ds_read_b64_tr_b16 a[58:59], v14 offset:58368
    v_add_u32 v20, 1024, v20
    v_and_b32 v20, 0xfff, v20
    v_mfma_f32_16x16x32_bf16 v[180:183], a[164:167], a[116:119], v[180:183]
    ds_read_b128 a[108:111], v21 offset:10240
    v_mfma_f32_16x16x32_bf16 v[112:115], a[168:171], a[116:119], v[112:115]
    ds_read_b64_tr_b16 a[60:61], v15 offset:57344
    v_mfma_f32_16x16x32_bf16 v[116:119], a[172:175], a[116:119], v[116:119]
    ds_read_b64_tr_b16 a[62:63], v15 offset:58368
    v_mfma_f32_16x16x32_bf16 v[240:243], a[116:119], a[176:179], v[240:243]
    v_mfma_f32_16x16x32_bf16 v[248:251], a[116:119], a[180:183], v[248:251]
    v_mfma_f32_16x16x32_bf16 v[64:67], a[116:119], a[184:187], v[64:67]
    v_mfma_f32_16x16x32_bf16 v[72:75], a[116:119], a[188:191], v[72:75]
    v_mfma_f32_16x16x32_bf16 v[184:187], a[160:163], a[124:127], v[184:187]
    ds_read_b128 a[116:119], v21 offset:12288
    v_mfma_f32_16x16x32_bf16 v[188:191], a[164:167], a[124:127], v[188:191]
    v_mfma_f32_16x16x32_bf16 v[120:123], a[168:171], a[124:127], v[120:123]
    v_add_u32 v11, 98304, v10
    v_xor_b32 v21, 64, v11
    v_mfma_f32_16x16x32_bf16 v[124:127], a[172:175], a[124:127], v[124:127]
    v_mfma_f32_16x16x32_bf16 v[244:247], a[124:127], a[176:179], v[244:247]
    v_mfma_f32_16x16x32_bf16 v[252:255], a[124:127], a[180:183], v[252:255]
    v_mfma_f32_16x16x32_bf16 v[68:71], a[124:127], a[184:187], v[68:71]
    v_mfma_f32_16x16x32_bf16 v[76:79], a[124:127], a[188:191], v[76:79]
    s_waitcnt lgkmcnt(0)
    v_mfma_f32_16x16x32_bf16 v[128:131], a[0:3], a[64:67], v[128:131]
    s_waitcnt vmcnt(10)
    v_mfma_f32_16x16x32_bf16 v[128:131], a[32:35], a[68:71], v[128:131]
    s_barrier
    v_mfma_f32_16x16x32_bf16 v[132:135], a[36:39], a[68:71], v[132:135]
    s_add_u32 m0, s70, s71
    ds_read_b128 a[120:123], v11 offset:14336
    global_load_lds_dwordx4 v6, s[6:7]
    v_mfma_f32_16x16x32_bf16 v[132:135], a[4:7], a[64:67], v[132:135]
    ds_read_b128 a[124:127], v21 offset:14336
    v_mfma_f32_16x16x32_bf16 v[80:83], a[8:11], a[64:67], v[80:83]
    ds_read_b64_tr_b16 a[128:129], v12 offset:0
    v_mfma_f32_16x16x32_bf16 v[80:83], a[40:43], a[68:71], v[80:83]
    ds_read_b64_tr_b16 a[130:131], v12 offset:1024
    global_load_lds_dwordx4 v7, s[6:7] offset:1024
    v_mfma_f32_16x16x32_bf16 v[84:87], a[44:47], a[68:71], v[84:87]
    ds_read_b64_tr_b16 a[132:133], v13 offset:0
    v_mfma_f32_16x16x32_bf16 v[84:87], a[12:15], a[64:67], v[84:87]
    ds_read_b64_tr_b16 a[134:135], v13 offset:1024
    v_mfma_f32_16x16x32_bf16 v[192:195], a[64:67], a[16:19], v[192:195]
    s_add_u32 m0, s70, s72
    ds_read_b64_tr_b16 a[136:137], v14 offset:0
    global_load_lds_dwordx4 v8, s[8:9]
    v_mfma_f32_16x16x32_bf16 v[192:195], a[68:71], a[48:51], v[192:195]
    ds_read_b64_tr_b16 a[138:139], v14 offset:1024
    v_mfma_f32_16x16x32_bf16 v[200:203], a[68:71], a[52:55], v[200:203]
    ds_read_b64_tr_b16 a[140:141], v15 offset:0
    v_mfma_f32_16x16x32_bf16 v[200:203], a[64:67], a[20:23], v[200:203]
    s_add_u32 m0, s70, s73
    ds_read_b64_tr_b16 a[142:143], v15 offset:1024
    global_load_lds_dwordx4 v9, s[10:11]
    v_mfma_f32_16x16x32_bf16 a[232:235], a[64:67], a[24:27], a[232:235]
    s_add_u32 m0, s65, 4096
    ds_read_b64_tr_b16 a[144:145], v12 offset:8192
    v_mfma_f32_16x16x32_bf16 a[232:235], a[68:71], a[56:59], a[232:235]
    s_add_u32 s91, s91, 1
    ds_read_b64_tr_b16 a[146:147], v12 offset:9216
    v_mfma_f32_16x16x32_bf16 a[240:243], a[68:71], a[60:63], a[240:243]
    s_and_b32 s91, s91, 15
    ds_read_b64_tr_b16 a[148:149], v13 offset:8192
    global_load_lds_dwordx4 v2, s[4:5] offset:0
    v_mfma_f32_16x16x32_bf16 a[240:243], a[64:67], a[28:31], a[240:243]
    s_lshl_b32 s75, s91, 18
    ds_read_b64_tr_b16 a[150:151], v13 offset:9216
    v_mfma_f32_16x16x32_bf16 v[136:139], a[0:3], a[72:75], v[136:139]
    s_xor_b32 s75, s75, s101
    ds_read_b128 a[64:67], v11 offset:0
    v_mfma_f32_16x16x32_bf16 v[136:139], a[32:35], a[76:79], v[136:139]
    s_add_u32 s6, s84, s75
    ds_read_b128 a[68:71], v21 offset:0
    global_load_lds_dwordx4 v3, s[4:5] offset:1024
    v_mfma_f32_16x16x32_bf16 v[140:143], a[36:39], a[76:79], v[140:143]
    s_addc_u32 s7, s85, 0
    ds_read_b64_tr_b16 a[152:153], v14 offset:8192
    v_mfma_f32_16x16x32_bf16 v[140:143], a[4:7], a[72:75], v[140:143]
    s_add_u32 s8, s86, s75
    ds_read_b64_tr_b16 a[154:155], v14 offset:9216
    v_mfma_f32_16x16x32_bf16 v[24:27], a[8:11], a[72:75], v[24:27]
    s_addc_u32 s9, s87, 0
    ds_read_b64_tr_b16 a[156:157], v15 offset:8192
    global_load_lds_dwordx4 v4, s[4:5] offset:2048
    v_mfma_f32_16x16x32_bf16 v[24:27], a[40:43], a[76:79], v[24:27]
    s_mov_b64 s[10:11], s[8:9]
    ds_read_b64_tr_b16 a[158:159], v15 offset:9216
    v_mfma_f32_16x16x32_bf16 v[28:31], a[44:47], a[76:79], v[28:31]
    s_add_u32 s70, s70, 16384
    v_mfma_f32_16x16x32_bf16 v[28:31], a[12:15], a[72:75], v[28:31]
    s_and_b32 s70, s70, 0xffff
    global_load_lds_dwordx4 v5, s[4:5] offset:3072
    v_mfma_f32_16x16x32_bf16 v[196:199], a[72:75], a[16:19], v[196:199]
    s_add_u32 s90, s90, 1
    v_mfma_f32_16x16x32_bf16 v[196:199], a[76:79], a[48:51], v[196:199]
    s_and_b32 s90, s90, 7
    v_mfma_f32_16x16x32_bf16 v[204:207], a[76:79], a[52:55], v[204:207]
    s_lshl_b32 s75, s90, 7
    v_mfma_f32_16x16x32_bf16 v[204:207], a[72:75], a[20:23], v[204:207]
    s_xor_b32 s75, s75, s100
    v_mfma_f32_16x16x32_bf16 a[236:239], a[72:75], a[24:27], a[236:239]
    s_add_u32 s4, s82, s75
    v_mfma_f32_16x16x32_bf16 a[236:239], a[76:79], a[56:59], a[236:239]
    s_addc_u32 s5, s83, 0
    v_mfma_f32_16x16x32_bf16 a[244:247], a[76:79], a[60:63], a[244:247]
    s_add_u32 s65, s65, 32768
    v_mfma_f32_16x16x32_bf16 a[244:247], a[72:75], a[28:31], a[244:247]
    s_cmp_ge_u32 s65, 163840
    v_mfma_f32_16x16x32_bf16 v[144:147], a[0:3], a[80:83], v[144:147]
    s_cselect_b32 s75, 98304, 0
    ds_read_b128 a[72:75], v11 offset:2048
    v_mfma_f32_16x16x32_bf16 v[144:147], a[32:35], a[84:87], v[144:147]
    s_sub_u32 s65, s65, s75
    ds_read_b128 a[76:79], v21 offset:2048
    v_mfma_f32_16x16x32_bf16 v[148:151], a[36:39], a[84:87], v[148:151]
    s_add_u32 m0, s70, s71
    v_mfma_f32_16x16x32_bf16 v[148:151], a[4:7], a[80:83], v[148:151]
    global_load_lds_dwordx4 v6, s[6:7]
    v_mfma_f32_16x16x32_bf16 v[32:35], a[8:11], a[80:83], v[32:35]
    v_mfma_f32_16x16x32_bf16 v[32:35], a[40:43], a[84:87], v[32:35]
    v_mfma_f32_16x16x32_bf16 v[36:39], a[44:47], a[84:87], v[36:39]
    global_load_lds_dwordx4 v7, s[6:7] offset:1024
    v_mfma_f32_16x16x32_bf16 v[36:39], a[12:15], a[80:83], v[36:39]
    v_mfma_f32_16x16x32_bf16 v[208:211], a[80:83], a[16:19], v[208:211]
    v_mfma_f32_16x16x32_bf16 v[208:211], a[84:87], a[48:51], v[208:211]
    s_add_u32 m0, s70, s72
    v_mfma_f32_16x16x32_bf16 v[216:219], a[84:87], a[52:55], v[216:219]
    global_load_lds_dwordx4 v8, s[8:9]
    v_mfma_f32_16x16x32_bf16 v[216:219], a[80:83], a[20:23], v[216:219]
    v_mfma_f32_16x16x32_bf16 a[248:251], a[80:83], a[24:27], a[248:251]
    v_mfma_f32_16x16x32_bf16 a[248:251], a[84:87], a[56:59], a[248:251]
    s_add_u32 m0, s70, s73
    v_mfma_f32_16x16x32_bf16 v[40:43], a[84:87], a[60:63], v[40:43]
    global_load_lds_dwordx4 v9, s[10:11]
    v_mfma_f32_16x16x32_bf16 v[40:43], a[80:83], a[28:31], v[40:43]
    s_add_u32 m0, s65, 0
    v_mfma_f32_16x16x32_bf16 v[152:155], a[0:3], a[88:91], v[152:155]
    s_add_u32 s91, s91, 1
    ds_read_b128 a[80:83], v11 offset:4096
    v_mfma_f32_16x16x32_bf16 v[152:155], a[32:35], a[92:95], v[152:155]
    s_and_b32 s91, s91, 15
    ds_read_b128 a[84:87], v21 offset:4096
    global_load_lds_dwordx4 v2, s[4:5] offset:0
    v_mfma_f32_16x16x32_bf16 v[156:159], a[36:39], a[92:95], v[156:159]
    s_lshl_b32 s75, s91, 18
    v_mfma_f32_16x16x32_bf16 v[156:159], a[4:7], a[88:91], v[156:159]
    s_xor_b32 s75, s75, s101
    v_mfma_f32_16x16x32_bf16 v[88:91], a[8:11], a[88:91], v[88:91]
    s_add_u32 s6, s84, s75
    global_load_lds_dwordx4 v3, s[4:5] offset:1024
    v_mfma_f32_16x16x32_bf16 v[88:91], a[40:43], a[92:95], v[88:91]
    s_addc_u32 s7, s85, 0
    v_mfma_f32_16x16x32_bf16 v[92:95], a[44:47], a[92:95], v[92:95]
    s_add_u32 s8, s86, s75
    v_mfma_f32_16x16x32_bf16 v[92:95], a[12:15], a[88:91], v[92:95]
    s_addc_u32 s9, s87, 0
    global_load_lds_dwordx4 v4, s[4:5] offset:2048
    v_mfma_f32_16x16x32_bf16 v[212:215], a[88:91], a[16:19], v[212:215]
    s_mov_b64 s[10:11], s[8:9]
    v_mfma_f32_16x16x32_bf16 v[212:215], a[92:95], a[48:51], v[212:215]
    s_add_u32 s70, s70, 16384
    v_mfma_f32_16x16x32_bf16 v[220:223], a[92:95], a[52:55], v[220:223]
    s_and_b32 s70, s70, 0xffff
    global_load_lds_dwordx4 v5, s[4:5] offset:3072
    v_mfma_f32_16x16x32_bf16 v[220:223], a[88:91], a[20:23], v[220:223]
    s_add_u32 s4, s4, s94
    v_mfma_f32_16x16x32_bf16 a[252:255], a[88:91], a[24:27], a[252:255]
    s_addc_u32 s5, s5, 0
    v_mfma_f32_16x16x32_bf16 a[252:255], a[92:95], a[56:59], a[252:255]
    v_mfma_f32_16x16x32_bf16 v[44:47], a[92:95], a[60:63], v[44:47]
    v_mfma_f32_16x16x32_bf16 v[44:47], a[88:91], a[28:31], v[44:47]
    s_waitcnt lgkmcnt(0)
    v_mfma_f32_16x16x32_bf16 v[160:163], a[0:3], a[96:99], v[160:163]
    s_waitcnt vmcnt(21)
    v_mfma_f32_16x16x32_bf16 v[160:163], a[32:35], a[100:103], v[160:163]
    s_barrier
    v_mfma_f32_16x16x32_bf16 v[164:167], a[36:39], a[100:103], v[164:167]
    s_add_u32 m0, s70, s71
    ds_read_b128 a[88:91], v11 offset:6144
    global_load_lds_dwordx4 v6, s[6:7]
    v_mfma_f32_16x16x32_bf16 v[164:167], a[4:7], a[96:99], v[164:167]
    ds_read_b128 a[92:95], v21 offset:6144
    v_mfma_f32_16x16x32_bf16 v[96:99], a[8:11], a[96:99], v[96:99]
    ds_read_b64_tr_b16 a[160:161], v12 offset:16384
    v_mfma_f32_16x16x32_bf16 v[96:99], a[40:43], a[100:103], v[96:99]
    ds_read_b64_tr_b16 a[162:163], v12 offset:17408
    v_mfma_f32_16x16x32_bf16 v[100:103], a[44:47], a[100:103], v[100:103]
    ds_read_b64_tr_b16 a[164:165], v13 offset:16384
    v_mfma_f32_16x16x32_bf16 v[100:103], a[12:15], a[96:99], v[100:103]
    ds_read_b64_tr_b16 a[166:167], v13 offset:17408
    v_mfma_f32_16x16x32_bf16 v[224:227], a[96:99], a[16:19], v[224:227]
    ds_read_b64_tr_b16 a[168:169], v14 offset:16384
    global_load_lds_dwordx4 v7, s[6:7] offset:1024
    v_mfma_f32_16x16x32_bf16 v[224:227], a[100:103], a[48:51], v[224:227]
    ds_read_b64_tr_b16 a[170:171], v14 offset:17408
    v_mfma_f32_16x16x32_bf16 v[232:235], a[100:103], a[52:55], v[232:235]
    ds_read_b64_tr_b16 a[172:173], v15 offset:16384
    v_mfma_f32_16x16x32_bf16 v[232:235], a[96:99], a[20:23], v[232:235]
    ds_read_b64_tr_b16 a[174:175], v15 offset:17408
    v_mfma_f32_16x16x32_bf16 v[48:51], a[96:99], a[24:27], v[48:51]
    ds_read_b64_tr_b16 a[176:177], v12 offset:24576
    v_mfma_f32_16x16x32_bf16 v[48:51], a[100:103], a[56:59], v[48:51]
    ds_read_b64_tr_b16 a[178:179], v12 offset:25600
    v_mfma_f32_16x16x32_bf16 v[56:59], a[100:103], a[60:63], v[56:59]
    s_add_u32 m0, s70, s72
    ds_read_b64_tr_b16 a[180:181], v13 offset:24576
    global_load_lds_dwordx4 v8, s[8:9]
    v_mfma_f32_16x16x32_bf16 v[56:59], a[96:99], a[28:31], v[56:59]
    ds_read_b64_tr_b16 a[182:183], v13 offset:25600
    v_mfma_f32_16x16x32_bf16 v[168:171], a[0:3], a[104:107], v[168:171]
    ds_read_b128 a[96:99], v11 offset:8192
    v_mfma_f32_16x16x32_bf16 v[168:171], a[32:35], a[108:111], v[168:171]
    ds_read_b128 a[100:103], v21 offset:8192
    v_mfma_f32_16x16x32_bf16 v[172:175], a[36:39], a[108:111], v[172:175]
    ds_read_b64_tr_b16 a[184:185], v14 offset:24576
    v_mfma_f32_16x16x32_bf16 v[172:175], a[4:7], a[104:107], v[172:175]
    ds_read_b64_tr_b16 a[186:187], v14 offset:25600
    v_mfma_f32_16x16x32_bf16 v[104:107], a[8:11], a[104:107], v[104:107]
    s_add_u32 m0, s70, s73
    ds_read_b64_tr_b16 a[188:189], v15 offset:24576
    global_load_lds_dwordx4 v9, s[10:11]
    v_mfma_f32_16x16x32_bf16 v[104:107], a[40:43], a[108:111], v[104:107]
    s_add_u32 m0, s65, 4096
    ds_read_b64_tr_b16 a[190:191], v15 offset:25600
    v_mfma_f32_16x16x32_bf16 v[108:111], a[44:47], a[108:111], v[108:111]
    s_add_u32 s91, s91, 1
    v_mfma_f32_16x16x32_bf16 v[108:111], a[12:15], a[104:107], v[108:111]
    s_and_b32 s91, s91, 15
    v_mfma_f32_16x16x32_bf16 v[228:231], a[104:107], a[16:19], v[228:231]
    s_lshl_b32 s75, s91, 18
    v_mfma_f32_16x16x32_bf16 v[228:231], a[108:111], a[48:51], v[228:231]
    s_xor_b32 s75, s75, s101
    v_mfma_f32_16x16x32_bf16 v[236:239], a[108:111], a[52:55], v[236:239]
    s_add_u32 s6, s84, s75
    global_load_lds_dwordx4 v2, s[4:5] offset:0
    v_mfma_f32_16x16x32_bf16 v[236:239], a[104:107], a[20:23], v[236:239]
    s_addc_u32 s7, s85, 0
    v_mfma_f32_16x16x32_bf16 v[52:55], a[104:107], a[24:27], v[52:55]
    s_add_u32 s8, s86, s75
    v_mfma_f32_16x16x32_bf16 v[52:55], a[108:111], a[56:59], v[52:55]
    s_addc_u32 s9, s87, 0
    v_mfma_f32_16x16x32_bf16 v[60:63], a[108:111], a[60:63], v[60:63]
    s_mov_b64 s[10:11], s[8:9]
    v_mfma_f32_16x16x32_bf16 v[60:63], a[104:107], a[28:31], v[60:63]
    s_add_u32 s70, s70, 16384
    v_mfma_f32_16x16x32_bf16 v[176:179], a[0:3], a[112:115], v[176:179]
    s_and_b32 s70, s70, 0xffff
    ds_read_b128 a[104:107], v11 offset:10240
    global_load_lds_dwordx4 v3, s[4:5] offset:1024
    v_mfma_f32_16x16x32_bf16 v[176:179], a[32:35], a[116:119], v[176:179]
    ds_read_b128 a[108:111], v21 offset:10240
    v_mfma_f32_16x16x32_bf16 v[180:183], a[36:39], a[116:119], v[180:183]
    v_mfma_f32_16x16x32_bf16 v[180:183], a[4:7], a[112:115], v[180:183]
    v_mfma_f32_16x16x32_bf16 v[112:115], a[8:11], a[112:115], v[112:115]
    v_mfma_f32_16x16x32_bf16 v[112:115], a[40:43], a[116:119], v[112:115]
    v_mfma_f32_16x16x32_bf16 v[116:119], a[44:47], a[116:119], v[116:119]
    global_load_lds_dwordx4 v4, s[4:5] offset:2048
    v_mfma_f32_16x16x32_bf16 v[116:119], a[12:15], a[112:115], v[116:119]
    v_mfma_f32_16x16x32_bf16 v[240:243], a[112:115], a[16:19], v[240:243]
    v_mfma_f32_16x16x32_bf16 v[240:243], a[116:119], a[48:51], v[240:243]
    v_mfma_f32_16x16x32_bf16 v[248:251], a[116:119], a[52:55], v[248:251]
    v_mfma_f32_16x16x32_bf16 v[248:251], a[112:115], a[20:23], v[248:251]
    v_mfma_f32_16x16x32_bf16 v[64:67], a[112:115], a[24:27], v[64:67]
    global_load_lds_dwordx4 v5, s[4:5] offset:3072
    v_mfma_f32_16x16x32_bf16 v[64:67], a[116:119], a[56:59], v[64:67]
    s_add_u32 s90, s90, 1
    v_mfma_f32_16x16x32_bf16 v[72:75], a[116:119], a[60:63], v[72:75]
    s_and_b32 s90, s90, 7
    v_mfma_f32_16x16x32_bf16 v[72:75], a[112:115], a[28:31], v[72:75]
    s_lshl_b32 s75, s90, 7
    global_load_dword v23, v20, s[96:97]
    v_mfma_f32_16x16x32_bf16 v[184:187], a[0:3], a[192:195], v[184:187]
L_wk1:
    s_cbranch_execz L_wk5
    s_xor_b32 s75, s75, s100
    ds_read_b128 a[112:115], v11 offset:12288
    v_add_u32 v20, 1024, v20
    v_and_b32 v20, 0xfff, v20
    v_mfma_f32_16x16x32_bf16 v[184:187], a[32:35], a[196:199], v[184:187]
    s_add_u32 s4, s82, s75
    ds_read_b128 a[116:119], v21 offset:12288
    v_mfma_f32_16x16x32_bf16 v[188:191], a[36:39], a[196:199], v[188:191]
    s_addc_u32 s5, s83, 0
    v_mfma_f32_16x16x32_bf16 v[188:191], a[4:7], a[192:195], v[188:191]
    s_add_u32 s65, s65, 32768
    v_mfma_f32_16x16x32_bf16 v[120:123], a[8:11], a[192:195], v[120:123]
    s_cmp_ge_u32 s65, 163840
    v_add_u32 v11, 131072, v10
    v_xor_b32 v21, 64, v11
    v_mfma_f32_16x16x32_bf16 v[120:123], a[40:43], a[196:199], v[120:123]
    s_cselect_b32 s75, 98304, 0
    v_mfma_f32_16x16x32_bf16 v[124:127], a[44:47], a[196:199], v[124:127]
    s_sub_u32 s65, s65, s75
    v_mfma_f32_16x16x32_bf16 v[124:127], a[12:15], a[192:195], v[124:127]
    s_lshr_b32 s34, s33, 1
    v_mfma_f32_16x16x32_bf16 v[244:247], a[192:195], a[16:19], v[244:247]
    s_cmp_lg_u32 s34, 0
    v_mfma_f32_16x16x32_bf16 v[244:247], a[196:199], a[48:51], v[244:247]
    s_cbranch_scc1 L_e0s7
    buffer_atomic_add v22, v1, s[28:31], 0 offen sc1
L_e0s7:
    v_mfma_f32_16x16x32_bf16 v[252:255], a[196:199], a[52:55], v[252:255]
    v_mfma_f32_16x16x32_bf16 v[252:255], a[192:195], a[20:23], v[252:255]
    v_mfma_f32_16x16x32_bf16 v[68:71], a[192:195], a[24:27], v[68:71]
    v_mfma_f32_16x16x32_bf16 v[68:71], a[196:199], a[56:59], v[68:71]
    v_mfma_f32_16x16x32_bf16 v[76:79], a[196:199], a[60:63], v[76:79]
    v_mfma_f32_16x16x32_bf16 v[76:79], a[192:195], a[28:31], v[76:79]
    s_waitcnt lgkmcnt(0)
    v_mfma_f32_16x16x32_bf16 v[128:131], a[128:131], a[64:67], v[128:131]
    s_waitcnt vmcnt(17)
    v_mfma_f32_16x16x32_bf16 v[128:131], a[160:163], a[68:71], v[128:131]
    s_barrier
    v_mfma_f32_16x16x32_bf16 v[132:135], a[164:167], a[68:71], v[132:135]
    s_add_u32 m0, s70, s71
    ds_read_b128 a[192:195], v11 offset:14336
    global_load_lds_dwordx4 v6, s[6:7]
    v_mfma_f32_16x16x32_bf16 v[132:135], a[132:135], a[64:67], v[132:135]
    ds_read_b128 a[196:199], v21 offset:14336
    v_mfma_f32_16x16x32_bf16 v[80:83], a[136:139], a[64:67], v[80:83]
    ds_read_b64_tr_b16 a[0:1], v12 offset:32768
    v_mfma_f32_16x16x32_bf16 v[80:83], a[168:171], a[68:71], v[80:83]
    ds_read_b64_tr_b16 a[2:3], v12 offset:33792
    v_mfma_f32_16x16x32_bf16 v[84:87], a[172:175], a[68:71], v[84:87]
    ds_read_b64_tr_b16 a[4:5], v13 offset:32768
    v_mfma_f32_16x16x32_bf16 v[84:87], a[140:143], a[64:67], v[84:87]
    ds_read_b64_tr_b16 a[6:7], v13 offset:33792
    v_mfma_f32_16x16x32_bf16 v[192:195], a[64:67], a[144:147], v[192:195]
    ds_read_b64_tr_b16 a[8:9], v14 offset:32768
    global_load_lds_dwordx4 v7, s[6:7] offset:1024
    v_mfma_f32_16x16x32_bf16 v[192:195], a[68:71], a[176:179], v[192:195]
    ds_read_b64_tr_b16 a[10:11], v14 offset:33792
    v_mfma_f32_16x16x32_bf16 v[200:203], a[68:71], a[180:183], v[200:203]
    ds_read_b64_tr_b16 a[12:13], v15 offset:32768
    v_mfma_f32_16x16x32_bf16 v[200:203], a[64:67], a[148:151], v[200:203]
    ds_read_b64_tr_b16 a[14:15], v15 offset:33792
    v_mfma_f32_16x16x32_bf16 a[232:235], a[64:67], a[152:155], a[232:235]
    ds_read_b64_tr_b16 a[16:17], v12 offset:40960
    v_mfma_f32_16x16x32_bf16 a[232:235], a[68:71], a[184:187], a[232:235]
    ds_read_b64_tr_b16 a[18:19], v12 offset:41984
    v_mfma_f32_16x16x32_bf16 a[240:243], a[68:71], a[188:191], a[240:243]
    s_add_u32 m0, s70, s72
    ds_read_b64_tr_b16 a[20:21], v13 offset:40960
    global_load_lds_dwordx4 v8, s[8:9]
    v_mfma_f32_16x16x32_bf16 a[240:243], a[64:67], a[156:159], a[240:243]
    ds_read_b64_tr_b16 a[22:23], v13 offset:41984
    v_mfma_f32_16x16x32_bf16 v[136:139], a[128:131], a[72:75], v[136:139]
    ds_read_b128 a[64:67], v11 offset:0
    v_mfma_f32_16x16x32_bf16 v[136:139], a[160:163], a[76:79], v[136:139]
    ds_read_b128 a[68:71], v21 offset:0
    v_mfma_f32_16x16x32_bf16 v[140:143], a[164:167], a[76:79], v[140:143]
    ds_read_b64_tr_b16 a[24:25], v14 offset:40960
    v_mfma_f32_16x16x32_bf16 v[140:143], a[132:135], a[72:75], v[140:143]
    ds_read_b64_tr_b16 a[26:27], v14 offset:41984
    v_mfma_f32_16x16x32_bf16 v[24:27], a[136:139], a[72:75], v[24:27]
    s_add_u32 m0, s70, s73
    ds_read_b64_tr_b16 a[28:29], v15 offset:40960
    global_load_lds_dwordx4 v9, s[10:11]
    v_mfma_f32_16x16x32_bf16 v[24:27], a[168:171], a[76:79], v[24:27]
    s_add_u32 m0, s65, 0
    ds_read_b64_tr_b16 a[30:31], v15 offset:41984
    v_mfma_f32_16x16x32_bf16 v[28:31], a[172:175], a[76:79], v[28:31]
    s_add_u32 s91, s91, 1
    v_mfma_f32_16x16x32_bf16 v[28:31], a[140:143], a[72:75], v[28:31]
    s_and_b32 s91, s91, 15
    v_mfma_f32_16x16x32_bf16 v[196:199], a[72:75], a[144:147], v[196:199]
    s_lshl_b32 s75, s91, 18
    v_mfma_f32_16x16x32_bf16 v[196:199], a[76:79], a[176:179], v[196:199]
    s_xor_b32 s75, s75, s101
    v_mfma_f32_16x16x32_bf16 v[204:207], a[76:79], a[180:183], v[204:207]
    s_add_u32 s6, s84, s75
    global_load_lds_dwordx4 v2, s[4:5] offset:0
    v_mfma_f32_16x16x32_bf16 v[204:207], a[72:75], a[148:151], v[204:207]
    s_addc_u32 s7, s85, 0
    v_mfma_f32_16x16x32_bf16 a[236:239], a[72:75], a[152:155], a[236:239]
    s_add_u32 s8, s86, s75
    v_mfma_f32_16x16x32_bf16 a[236:239], a[76:79], a[184:187], a[236:239]
    s_addc_u32 s9, s87, 0
    v_mfma_f32_16x16x32_bf16 a[244:247], a[76:79], a[188:191], a[244:247]
    s_mov_b64 s[10:11], s[8:9]
    v_mfma_f32_16x16x32_bf16 a[244:247], a[72:75], a[156:159], a[244:247]
    s_add_u32 s70, s70, 16384
    v_mfma_f32_16x16x32_bf16 v[144:147], a[128:131], a[80:83], v[144:147]
    s_and_b32 s70, s70, 0xffff
    ds_read_b128 a[72:75], v11 offset:2048
    global_load_lds_dwordx4 v3, s[4:5] offset:1024
    v_mfma_f32_16x16x32_bf16 v[144:147], a[160:163], a[84:87], v[144:147]
    ds_read_b128 a[76:79], v21 offset:2048
    v_mfma_f32_16x16x32_bf16 v[148:151], a[164:167], a[84:87], v[148:151]
    v_mfma_f32_16x16x32_bf16 v[148:151], a[132:135], a[80:83], v[148:151]
    v_mfma_f32_16x16x32_bf16 v[32:35], a[136:139], a[80:83], v[32:35]
    v_mfma_f32_16x16x32_bf16 v[32:35], a[168:171], a[84:87], v[32:35]
    v_mfma_f32_16x16x32_bf16 v[36:39], a[172:175], a[84:87], v[36:39]
    global_load_lds_dwordx4 v4, s[4:5] offset:2048
    v_mfma_f32_16x16x32_bf16 v[36:39], a[140:143], a[80:83], v[36:39]
    v_mfma_f32_16x16x32_bf16 v[208:211], a[80:83], a[144:147], v[208:211]
    v_mfma_f32_16x16x32_bf16 v[208:211], a[84:87], a[176:179], v[208:211]
    v_mfma_f32_16x16x32_bf16 v[216:219], a[84:87], a[180:183], v[216:219]
    v_mfma_f32_16x16x32_bf16 v[216:219], a[80:83], a[148:151], v[216:219]
    v_mfma_f32_16x16x32_bf16 a[248:251], a[80:83], a[152:155], a[248:251]
    global_load_lds_dwordx4 v5, s[4:5] offset:3072
    v_mfma_f32_16x16x32_bf16 a[248:251], a[84:87], a[184:187], a[248:251]
    s_add_u32 s4, s4, s94
    v_mfma_f32_16x16x32_bf16 v[40:43], a[84:87], a[188:191], v[40:43]
    s_addc_u32 s5, s5, 0
    v_mfma_f32_16x16x32_bf16 v[40:43], a[80:83], a[156:159], v[40:43]
    s_lshr_b32 s34, s33, 1
    global_load_dword v23, v20, s[96:97]
    v_mfma_f32_16x16x32_bf16 v[152:155], a[128:131], a[88:91], v[152:155]
    s_cmp_lg_u32 s34, 1
    ds_read_b128 a[80:83], v11 offset:4096
    v_add_u32 v20, 1024, v20
    v_and_b32 v20, 0xfff, v20
    v_mfma_f32_16x16x32_bf16 v[152:155], a[160:163], a[92:95], v[152:155]
    s_cbranch_scc1 L_e0s8
    buffer_atomic_add v22, v1, s[28:31], 0 offen sc1
L_e0s8:
    ds_read_b128 a[84:87], v21 offset:4096
    v_mfma_f32_16x16x32_bf16 v[156:159], a[164:167], a[92:95], v[156:159]
    v_mfma_f32_16x16x32_bf16 v[156:159], a[132:135], a[88:91], v[156:159]
    v_mfma_f32_16x16x32_bf16 v[88:91], a[136:139], a[88:91], v[88:91]
    v_mfma_f32_16x16x32_bf16 v[88:91], a[168:171], a[92:95], v[88:91]
    v_mfma_f32_16x16x32_bf16 v[92:95], a[172:175], a[92:95], v[92:95]
    v_mfma_f32_16x16x32_bf16 v[92:95], a[140:143], a[88:91], v[92:95]
    v_mfma_f32_16x16x32_bf16 v[212:215], a[88:91], a[144:147], v[212:215]
    v_mfma_f32_16x16x32_bf16 v[212:215], a[92:95], a[176:179], v[212:215]
    v_mfma_f32_16x16x32_bf16 v[220:223], a[92:95], a[180:183], v[220:223]
    v_mfma_f32_16x16x32_bf16 v[220:223], a[88:91], a[148:151], v[220:223]
    v_mfma_f32_16x16x32_bf16 a[252:255], a[88:91], a[152:155], a[252:255]
    v_mfma_f32_16x16x32_bf16 a[252:255], a[92:95], a[184:187], a[252:255]
    v_mfma_f32_16x16x32_bf16 v[44:47], a[92:95], a[188:191], v[44:47]
    v_mfma_f32_16x16x32_bf16 v[44:47], a[88:91], a[156:159], v[44:47]
    s_waitcnt lgkmcnt(0)
    v_mfma_f32_16x16x32_bf16 v[160:163], a[128:131], a[96:99], v[160:163]
    s_waitcnt vmcnt(22)
    v_mfma_f32_16x16x32_bf16 v[160:163], a[160:163], a[100:103], v[160:163]
    s_barrier
    v_mfma_f32_16x16x32_bf16 v[164:167], a[164:167], a[100:103], v[164:167]
    s_add_u32 m0, s70, s71
    ds_read_b128 a[88:91], v11 offset:6144
    global_load_lds_dwordx4 v6, s[6:7]
    v_mfma_f32_16x16x32_bf16 v[164:167], a[132:135], a[96:99], v[164:167]
    ds_read_b128 a[92:95], v21 offset:6144
    v_mfma_f32_16x16x32_bf16 v[96:99], a[136:139], a[96:99], v[96:99]
    ds_read_b64_tr_b16 a[32:33], v12 offset:49152
    v_mfma_f32_16x16x32_bf16 v[96:99], a[168:171], a[100:103], v[96:99]
    ds_read_b64_tr_b16 a[34:35], v12 offset:50176
    v_mfma_f32_16x16x32_bf16 v[100:103], a[172:175], a[100:103], v[100:103]
    ds_read_b64_tr_b16 a[36:37], v13 offset:49152
    v_mfma_f32_16x16x32_bf16 v[100:103], a[140:143], a[96:99], v[100:103]
    ds_read_b64_tr_b16 a[38:39], v13 offset:50176
    v_mfma_f32_16x16x32_bf16 v[224:227], a[96:99], a[144:147], v[224:227]
    ds_read_b64_tr_b16 a[40:41], v14 offset:49152
    global_load_lds_dwordx4 v7, s[6:7] offset:1024
    v_mfma_f32_16x16x32_bf16 v[224:227], a[100:103], a[176:179], v[224:227]
    ds_read_b64_tr_b16 a[42:43], v14 offset:50176
    v_mfma_f32_16x16x32_bf16 v[232:235], a[100:103], a[180:183], v[232:235]
    ds_read_b64_tr_b16 a[44:45], v15 offset:49152
    v_mfma_f32_16x16x32_bf16 v[232:235], a[96:99], a[148:151], v[232:235]
    ds_read_b64_tr_b16 a[46:47], v15 offset:50176
    v_mfma_f32_16x16x32_bf16 v[48:51], a[96:99], a[152:155], v[48:51]
    ds_read_b64_tr_b16 a[48:49], v12 offset:57344
    v_mfma_f32_16x16x32_bf16 v[48:51], a[100:103], a[184:187], v[48:51]
    ds_read_b64_tr_b16 a[50:51], v12 offset:58368
    v_mfma_f32_16x16x32_bf16 v[56:59], a[100:103], a[188:191], v[56:59]
    s_add_u32 m0, s70, s72
    ds_read_b64_tr_b16 a[52:53], v13 offset:57344
    global_load_lds_dwordx4 v8, s[8:9]
    v_mfma_f32_16x16x32_bf16 v[56:59], a[96:99], a[156:159], v[56:59]
    ds_read_b64_tr_b16 a[54:55], v13 offset:58368
    v_mfma_f32_16x16x32_bf16 v[168:171], a[128:131], a[104:107], v[168:171]
    ds_read_b128 a[96:99], v11 offset:8192
    v_mfma_f32_16x16x32_bf16 v[168:171], a[160:163], a[108:111], v[168:171]
    ds_read_b128 a[100:103], v21 offset:8192
    v_mfma_f32_16x16x32_bf16 v[172:175], a[164:167], a[108:111], v[172:175]
    ds_read_b64_tr_b16 a[56:57], v14 offset:57344
    v_mfma_f32_16x16x32_bf16 v[172:175], a[132:135], a[104:107], v[172:175]
    ds_read_b64_tr_b16 a[58:59], v14 offset:58368
    v_mfma_f32_16x16x32_bf16 v[104:107], a[136:139], a[104:107], v[104:107]
    s_add_u32 m0, s70, s73
    ds_read_b64_tr_b16 a[60:61], v15 offset:57344
    global_load_lds_dwordx4 v9, s[10:11]
    v_mfma_f32_16x16x32_bf16 v[104:107], a[168:171], a[108:111], v[104:107]
    s_add_u32 m0, s65, 4096
    ds_read_b64_tr_b16 a[62:63], v15 offset:58368
    v_mfma_f32_16x16x32_bf16 v[108:111], a[172:175], a[108:111], v[108:111]
    s_add_u32 s91, s91, 1
    v_mfma_f32_16x16x32_bf16 v[108:111], a[140:143], a[104:107], v[108:111]
    s_and_b32 s91, s91, 15
    v_mfma_f32_16x16x32_bf16 v[228:231], a[104:107], a[144:147], v[228:231]
    s_lshl_b32 s75, s91, 18
    v_mfma_f32_16x16x32_bf16 v[228:231], a[108:111], a[176:179], v[228:231]
    s_xor_b32 s75, s75, s101
    v_mfma_f32_16x16x32_bf16 v[236:239], a[108:111], a[180:183], v[236:239]
    s_add_u32 s6, s84, s75
    global_load_lds_dwordx4 v2, s[4:5] offset:0
    v_mfma_f32_16x16x32_bf16 v[236:239], a[104:107], a[148:151], v[236:239]
    s_addc_u32 s7, s85, 0
    v_mfma_f32_16x16x32_bf16 v[52:55], a[104:107], a[152:155], v[52:55]
    s_add_u32 s8, s86, s75
    v_mfma_f32_16x16x32_bf16 v[52:55], a[108:111], a[184:187], v[52:55]
    s_addc_u32 s9, s87, 0
    v_mfma_f32_16x16x32_bf16 v[60:63], a[108:111], a[188:191], v[60:63]
    s_mov_b64 s[10:11], s[8:9]
    v_mfma_f32_16x16x32_bf16 v[60:63], a[104:107], a[156:159], v[60:63]
    s_add_u32 s70, s70, 16384
    v_mfma_f32_16x16x32_bf16 v[176:179], a[128:131], a[112:115], v[176:179]
    s_and_b32 s70, s70, 0xffff
    ds_read_b128 a[104:107], v11 offset:10240
    global_load_lds_dwordx4 v3, s[4:5] offset:1024
    v_mfma_f32_16x16x32_bf16 v[176:179], a[160:163], a[116:119], v[176:179]
    ds_read_b128 a[108:111], v21 offset:10240
    v_mfma_f32_16x16x32_bf16 v[180:183], a[164:167], a[116:119], v[180:183]
    v_mfma_f32_16x16x32_bf16 v[180:183], a[132:135], a[112:115], v[180:183]
    v_mfma_f32_16x16x32_bf16 v[112:115], a[136:139], a[112:115], v[112:115]
    v_mfma_f32_16x16x32_bf16 v[112:115], a[168:171], a[116:119], v[112:115]
    v_mfma_f32_16x16x32_bf16 v[116:119], a[172:175], a[116:119], v[116:119]
    global_load_lds_dwordx4 v4, s[4:5] offset:2048
    v_mfma_f32_16x16x32_bf16 v[116:119], a[140:143], a[112:115], v[116:119]
    v_mfma_f32_16x16x32_bf16 v[240:243], a[112:115], a[144:147], v[240:243]
    v_mfma_f32_16x16x32_bf16 v[240:243], a[116:119], a[176:179], v[240:243]
    v_mfma_f32_16x16x32_bf16 v[248:251], a[116:119], a[180:183], v[248:251]
    v_mfma_f32_16x16x32_bf16 v[248:251], a[112:115], a[148:151], v[248:251]
    v_mfma_f32_16x16x32_bf16 v[64:67], a[112:115], a[152:155], v[64:67]
    global_load_lds_dwordx4 v5, s[4:5] offset:3072
    v_mfma_f32_16x16x32_bf16 v[64:67], a[116:119], a[184:187], v[64:67]
    s_add_u32 s90, s90, 1
    v_mfma_f32_16x16x32_bf16 v[72:75], a[116:119], a[188:191], v[72:75]
    s_and_b32 s90, s90, 7
    v_mfma_f32_16x16x32_bf16 v[72:75], a[112:115], a[156:159], v[72:75]
    s_mov_b64 s[82:83], s[12:13]
    v_mfma_f32_16x16x32_bf16 v[184:187], a[128:131], a[120:123], v[184:187]
    s_mov_b32 s90, s92
    ds_read_b128 a[112:115], v11 offset:12288
    v_mfma_f32_16x16x32_bf16 v[184:187], a[160:163], a[124:127], v[184:187]
    s_mov_b32 s94, 32768
    ds_read_b128 a[116:119], v21 offset:12288
    v_mfma_f32_16x16x32_bf16 v[188:191], a[164:167], a[124:127], v[188:191]
    s_lshl_b32 s75, s90, 7
    v_mfma_f32_16x16x32_bf16 v[188:191], a[132:135], a[120:123], v[188:191]
    s_add_u32 s4, s82, s75
    v_mfma_f32_16x16x32_bf16 v[120:123], a[136:139], a[120:123], v[120:123]
    s_addc_u32 s5, s83, 0
    v_add_u32 v11, 65536, v10
    v_xor_b32 v21, 64, v11
    v_mfma_f32_16x16x32_bf16 v[120:123], a[168:171], a[124:127], v[120:123]
    s_add_u32 s65, s65, 32768
    v_mfma_f32_16x16x32_bf16 v[124:127], a[172:175], a[124:127], v[124:127]
    s_cmp_ge_u32 s65, 163840
    v_mfma_f32_16x16x32_bf16 v[124:127], a[140:143], a[120:123], v[124:127]
    s_cselect_b32 s75, 98304, 0
    v_mfma_f32_16x16x32_bf16 v[244:247], a[120:123], a[144:147], v[244:247]
    s_sub_u32 s65, s65, s75
    v_mfma_f32_16x16x32_bf16 v[244:247], a[124:127], a[176:179], v[244:247]
    s_lshr_b32 s34, s33, 1
    v_mfma_f32_16x16x32_bf16 v[252:255], a[124:127], a[180:183], v[252:255]
    s_cmp_lg_u32 s34, 2
    v_mfma_f32_16x16x32_bf16 v[252:255], a[120:123], a[148:151], v[252:255]
    s_cbranch_scc1 L_e0s9
    buffer_atomic_add v22, v1, s[28:31], 0 offen sc1
L_e0s9:
    v_mfma_f32_16x16x32_bf16 v[68:71], a[120:123], a[152:155], v[68:71]
    v_mfma_f32_16x16x32_bf16 v[68:71], a[124:127], a[184:187], v[68:71]
    v_mfma_f32_16x16x32_bf16 v[76:79], a[124:127], a[188:191], v[76:79]
    v_mfma_f32_16x16x32_bf16 v[76:79], a[120:123], a[156:159], v[76:79]
    s_waitcnt lgkmcnt(0)
    v_mfma_f32_16x16x32_bf16 v[128:131], a[0:3], a[64:67], v[128:131]
    s_waitcnt vmcnt(18)
    v_mfma_f32_16x16x32_bf16 v[128:131], a[32:35], a[68:71], v[128:131]
    s_barrier
    v_mfma_f32_16x16x32_bf16 v[132:135], a[36:39], a[68:71], v[132:135]
    s_add_u32 m0, s70, s71
    ds_read_b128 a[120:123], v11 offset:14336
    global_load_lds_dwordx4 v6, s[6:7]
    v_mfma_f32_16x16x32_bf16 v[132:135], a[4:7], a[64:67], v[132:135]
    ds_read_b128 a[124:127], v21 offset:14336
    v_mfma_f32_16x16x32_bf16 v[80:83], a[8:11], a[64:67], v[80:83]
    ds_read_b64_tr_b16 a[128:129], v12 offset:0
    v_mfma_f32_16x16x32_bf16 v[80:83], a[40:43], a[68:71], v[80:83]
    ds_read_b64_tr_b16 a[130:131], v12 offset:1024
    v_mfma_f32_16x16x32_bf16 v[84:87], a[44:47], a[68:71], v[84:87]
    ds_read_b64_tr_b16 a[132:133], v13 offset:0
    global_load_lds_dwordx4 v7, s[6:7] offset:1024
    v_mfma_f32_16x16x32_bf16 v[84:87], a[12:15], a[64:67], v[84:87]
    ds_read_b64_tr_b16 a[134:135], v13 offset:1024
    v_mfma_f32_16x16x32_bf16 v[192:195], a[64:67], a[16:19], v[192:195]
    ds_read_b64_tr_b16 a[136:137], v14 offset:0
    v_mfma_f32_16x16x32_bf16 v[192:195], a[68:71], a[48:51], v[192:195]
    ds_read_b64_tr_b16 a[138:139], v14 offset:1024
    v_mfma_f32_16x16x32_bf16 v[200:203], a[68:71], a[52:55], v[200:203]
    s_add_u32 m0, s70, s72
    ds_read_b64_tr_b16 a[140:141], v15 offset:0
    global_load_lds_dwordx4 v8, s[8:9]
    v_mfma_f32_16x16x32_bf16 v[200:203], a[64:67], a[20:23], v[200:203]
    ds_read_b64_tr_b16 a[142:143], v15 offset:1024
    v_mfma_f32_16x16x32_bf16 a[232:235], a[64:67], a[24:27], a[232:235]
    ds_read_b64_tr_b16 a[144:145], v12 offset:8192
    v_mfma_f32_16x16x32_bf16 a[232:235], a[68:71], a[56:59], a[232:235]
    ds_read_b64_tr_b16 a[146:147], v12 offset:9216
    v_mfma_f32_16x16x32_bf16 a[240:243], a[68:71], a[60:63], a[240:243]
    s_add_u32 m0, s70, s73
    ds_read_b64_tr_b16 a[148:149], v13 offset:8192
    global_load_lds_dwordx4 v9, s[10:11]
    v_mfma_f32_16x16x32_bf16 a[240:243], a[64:67], a[28:31], a[240:243]
    s_add_u32 m0, s65, 0
    ds_read_b64_tr_b16 a[150:151], v13 offset:9216
    v_mfma_f32_16x16x32_bf16 v[136:139], a[0:3], a[72:75], v[136:139]
    s_add_u32 s70, s70, 16384
    ds_read_b128 a[64:67], v11 offset:0
    v_mfma_f32_16x16x32_bf16 v[136:139], a[32:35], a[76:79], v[136:139]
    s_and_b32 s70, s70, 0xffff
    ds_read_b128 a[68:71], v21 offset:0
    v_mfma_f32_16x16x32_bf16 v[140:143], a[36:39], a[76:79], v[140:143]
    s_lshl_b32 s76, s3, 16
    ds_read_b64_tr_b16 a[152:153], v14 offset:8192
    global_load_lds_dwordx4 v2, s[4:5] offset:0
    v_mfma_f32_16x16x32_bf16 v[140:143], a[4:7], a[72:75], v[140:143]
    s_lshl_b32 s35, s32, 8
    ds_read_b64_tr_b16 a[154:155], v14 offset:9216
    v_mfma_f32_16x16x32_bf16 v[24:27], a[8:11], a[72:75], v[24:27]
    s_add_u32 s76, s76, s35
    ds_read_b64_tr_b16 a[156:157], v15 offset:8192
    v_mfma_f32_16x16x32_bf16 v[24:27], a[40:43], a[76:79], v[24:27]
    s_add_u32 s84, s46, s76
    ds_read_b64_tr_b16 a[158:159], v15 offset:9216
    v_mfma_f32_16x16x32_bf16 v[28:31], a[44:47], a[76:79], v[28:31]
    s_addc_u32 s85, s47, 0
    global_load_lds_dwordx4 v3, s[4:5] offset:1024
    v_mfma_f32_16x16x32_bf16 v[28:31], a[12:15], a[72:75], v[28:31]
    s_lshl_b32 s34, s3, 10
    v_mfma_f32_16x16x32_bf16 v[196:199], a[72:75], a[16:19], v[196:199]
    s_add_u32 s72, s34, 8192
    v_mfma_f32_16x16x32_bf16 v[196:199], a[76:79], a[48:51], v[196:199]
    s_add_u32 s73, s34, 12288
    v_mfma_f32_16x16x32_bf16 v[204:207], a[76:79], a[52:55], v[204:207]
    s_min_u32 s34, s3, 2
    global_load_lds_dwordx4 v4, s[4:5] offset:2048
    v_mfma_f32_16x16x32_bf16 v[204:207], a[72:75], a[20:23], v[204:207]
    s_lshl_b32 s34, s34, 10
    v_mfma_f32_16x16x32_bf16 a[236:239], a[72:75], a[24:27], a[236:239]
    s_lshl_b32 s35, s32, 5
    v_mfma_f32_16x16x32_bf16 a[236:239], a[76:79], a[56:59], a[236:239]
    s_add_u32 s34, s34, s35
    v_mfma_f32_16x16x32_bf16 a[244:247], a[76:79], a[60:63], a[244:247]
    s_add_u32 s86, s38, s34
    global_load_lds_dwordx4 v5, s[4:5] offset:3072
    v_bfe_u32 v8, v0, 3, 2
    v_mfma_f32_16x16x32_bf16 a[244:247], a[72:75], a[28:31], a[244:247]
    s_addc_u32 s87, s39, 0
    v_lshlrev_b32 v8, 3, v8
    v_lshrrev_b32 v9, 5, v0
    v_mfma_f32_16x16x32_bf16 v[144:147], a[0:3], a[80:83], v[144:147]
    s_mov_b32 s68, 98304
    ds_read_b128 a[72:75], v11 offset:2048
    v_lshl_add_u32 v8, v9, 2, v8
    v_mfma_f32_16x16x32_bf16 v[144:147], a[32:35], a[84:87], v[144:147]
    s_mov_b32 s69, 64
    ds_read_b128 a[76:79], v21 offset:2048
    v_bfe_u32 v9, v0, 1, 2
    v_mfma_f32_16x16x32_bf16 v[148:151], a[36:39], a[84:87], v[148:151]
    s_sub_u32 s34, 15, s33
    v_add_u32 v8, v8, v9
    v_mul_u32_u24 v8, 0xc00, v8
    v_mfma_f32_16x16x32_bf16 v[148:151], a[4:7], a[80:83], v[148:151]
    s_bitcmp0_b32 s3, 0
    v_and_b32 v9, 1, v0
    v_lshl_add_u32 v8, v9, 4, v8
    v_mfma_f32_16x16x32_bf16 v[32:35], a[8:11], a[80:83], v[32:35]
    s_cselect_b32 s34, s33, s34
    v_and_b32 v9, 15, v0
    v_lshlrev_b32 v9, 10, v9
    v_mfma_f32_16x16x32_bf16 v[32:35], a[40:43], a[84:87], v[32:35]
    s_lshl_b32 s34, s34, 17
    v_lshl_add_u32 v9, v16, 4, v9
    v_and_b32 v8, s62, v8
    v_mfma_f32_16x16x32_bf16 v[36:39], a[44:47], a[84:87], v[36:39]
    s_max_u32 s34, s34, 16384
    v_and_b32 v9, s63, v9
    v_mfma_f32_16x16x32_bf16 v[36:39], a[12:15], a[80:83], v[36:39]
    s_sub_u32 s34, s34, 16384
    v_mfma_f32_16x16x32_bf16 v[208:211], a[80:83], a[16:19], v[208:211]
    s_add_u32 s88, s36, s34
    v_mfma_f32_16x16x32_bf16 v[208:211], a[84:87], a[48:51], v[208:211]
    s_addc_u32 s89, s37, 0
    v_mfma_f32_16x16x32_bf16 v[216:219], a[84:87], a[52:55], v[216:219]
    s_lshl_b32 s91, s92, 1
    v_mfma_f32_16x16x32_bf16 v[216:219], a[80:83], a[20:23], v[216:219]
    s_lshl_b32 s75, s91, 18
    v_mfma_f32_16x16x32_bf16 a[248:251], a[80:83], a[24:27], a[248:251]
    s_add_u32 s6, s84, s75
    v_mfma_f32_16x16x32_bf16 a[248:251], a[84:87], a[56:59], a[248:251]
    s_addc_u32 s7, s85, 0
    v_mfma_f32_16x16x32_bf16 v[40:43], a[84:87], a[60:63], v[40:43]
    s_mul_i32 s75, s91, s68
    v_mfma_f32_16x16x32_bf16 v[40:43], a[80:83], a[28:31], v[40:43]
    s_add_u32 s8, s86, s75
    v_mfma_f32_16x16x32_bf16 v[152:155], a[0:3], a[88:91], v[152:155]
    s_addc_u32 s9, s87, 0
    ds_read_b128 a[80:83], v11 offset:4096
    v_mfma_f32_16x16x32_bf16 v[152:155], a[32:35], a[92:95], v[152:155]
    s_mul_i32 s75, s91, s69
    ds_read_b128 a[84:87], v21 offset:4096
    v_mfma_f32_16x16x32_bf16 v[156:159], a[36:39], a[92:95], v[156:159]
    s_add_u32 s10, s88, s75
    v_mfma_f32_16x16x32_bf16 v[156:159], a[4:7], a[88:91], v[156:159]
    s_addc_u32 s11, s89, 0
    v_mfma_f32_16x16x32_bf16 v[88:91], a[8:11], a[88:91], v[88:91]
    s_add_u32 s4, s4, s94
    v_mfma_f32_16x16x32_bf16 v[88:91], a[40:43], a[92:95], v[88:91]
    s_addc_u32 s5, s5, 0
    v_mfma_f32_16x16x32_bf16 v[92:95], a[44:47], a[92:95], v[92:95]
    v_mfma_f32_16x16x32_bf16 v[92:95], a[12:15], a[88:91], v[92:95]
    v_mfma_f32_16x16x32_bf16 v[212:215], a[88:91], a[16:19], v[212:215]
    v_mfma_f32_16x16x32_bf16 v[212:215], a[92:95], a[48:51], v[212:215]
    v_mfma_f32_16x16x32_bf16 v[220:223], a[92:95], a[52:55], v[220:223]
    v_mfma_f32_16x16x32_bf16 v[220:223], a[88:91], a[20:23], v[220:223]
    v_mfma_f32_16x16x32_bf16 a[252:255], a[88:91], a[24:27], a[252:255]
    v_mfma_f32_16x16x32_bf16 a[252:255], a[92:95], a[56:59], a[252:255]
    v_mfma_f32_16x16x32_bf16 v[44:47], a[92:95], a[60:63], v[44:47]
    v_mfma_f32_16x16x32_bf16 v[44:47], a[88:91], a[28:31], v[44:47]
    s_waitcnt lgkmcnt(0)
    v_mfma_f32_16x16x32_bf16 v[160:163], a[0:3], a[96:99], v[160:163]
    s_waitcnt vmcnt(21)
    v_mfma_f32_16x16x32_bf16 v[160:163], a[32:35], a[100:103], v[160:163]
    s_barrier
    v_mfma_f32_16x16x32_bf16 v[164:167], a[36:39], a[100:103], v[164:167]
    s_add_u32 m0, s70, s71
    ds_read_b128 a[88:91], v11 offset:6144
    global_load_lds_dwordx4 v6, s[6:7]
    v_mfma_f32_16x16x32_bf16 v[164:167], a[4:7], a[96:99], v[164:167]
    ds_read_b128 a[92:95], v21 offset:6144
    v_mfma_f32_16x16x32_bf16 v[96:99], a[8:11], a[96:99], v[96:99]
    ds_read_b64_tr_b16 a[160:161], v12 offset:16384
    v_mfma_f32_16x16x32_bf16 v[96:99], a[40:43], a[100:103], v[96:99]
    ds_read_b64_tr_b16 a[162:163], v12 offset:17408
    v_mfma_f32_16x16x32_bf16 v[100:103], a[44:47], a[100:103], v[100:103]
    ds_read_b64_tr_b16 a[164:165], v13 offset:16384
    v_mfma_f32_16x16x32_bf16 v[100:103], a[12:15], a[96:99], v[100:103]
    ds_read_b64_tr_b16 a[166:167], v13 offset:17408
    v_mfma_f32_16x16x32_bf16 v[224:227], a[96:99], a[16:19], v[224:227]
    ds_read_b64_tr_b16 a[168:169], v14 offset:16384
    global_load_lds_dwordx4 v7, s[6:7] offset:1024
    v_mfma_f32_16x16x32_bf16 v[224:227], a[100:103], a[48:51], v[224:227]
    ds_read_b64_tr_b16 a[170:171], v14 offset:17408
    v_mfma_f32_16x16x32_bf16 v[232:235], a[100:103], a[52:55], v[232:235]
    ds_read_b64_tr_b16 a[172:173], v15 offset:16384
    v_mfma_f32_16x16x32_bf16 v[232:235], a[96:99], a[20:23], v[232:235]
    ds_read_b64_tr_b16 a[174:175], v15 offset:17408
    v_mfma_f32_16x16x32_bf16 v[48:51], a[96:99], a[24:27], v[48:51]
    ds_read_b64_tr_b16 a[176:177], v12 offset:24576
    v_mfma_f32_16x16x32_bf16 v[48:51], a[100:103], a[56:59], v[48:51]
    ds_read_b64_tr_b16 a[178:179], v12 offset:25600
    v_mfma_f32_16x16x32_bf16 v[56:59], a[100:103], a[60:63], v[56:59]
    s_add_u32 m0, s70, s72
    ds_read_b64_tr_b16 a[180:181], v13 offset:24576
    global_load_lds_dwordx4 v8, s[8:9]
    v_mfma_f32_16x16x32_bf16 v[56:59], a[96:99], a[28:31], v[56:59]
    ds_read_b64_tr_b16 a[182:183], v13 offset:25600
    v_mfma_f32_16x16x32_bf16 v[168:171], a[0:3], a[104:107], v[168:171]
    ds_read_b128 a[96:99], v11 offset:8192
    v_mfma_f32_16x16x32_bf16 v[168:171], a[32:35], a[108:111], v[168:171]
    ds_read_b128 a[100:103], v21 offset:8192
    v_mfma_f32_16x16x32_bf16 v[172:175], a[36:39], a[108:111], v[172:175]
    ds_read_b64_tr_b16 a[184:185], v14 offset:24576
    v_mfma_f32_16x16x32_bf16 v[172:175], a[4:7], a[104:107], v[172:175]
    ds_read_b64_tr_b16 a[186:187], v14 offset:25600
    v_mfma_f32_16x16x32_bf16 v[104:107], a[8:11], a[104:107], v[104:107]
    s_add_u32 m0, s70, s73
    ds_read_b64_tr_b16 a[188:189], v15 offset:24576
    global_load_lds_dwordx4 v9, s[10:11]
    v_mfma_f32_16x16x32_bf16 v[104:107], a[40:43], a[108:111], v[104:107]
    s_add_u32 m0, s65, 4096
    ds_read_b64_tr_b16 a[190:191], v15 offset:25600
    v_mfma_f32_16x16x32_bf16 v[108:111], a[44:47], a[108:111], v[108:111]
    s_add_u32 s91, s91, 1
    v_mfma_f32_16x16x32_bf16 v[108:111], a[12:15], a[104:107], v[108:111]
    s_and_b32 s91, s91, 15
    v_mfma_f32_16x16x32_bf16 v[228:231], a[104:107], a[16:19], v[228:231]
    s_lshl_b32 s75, s91, 18
    v_mfma_f32_16x16x32_bf16 v[228:231], a[108:111], a[48:51], v[228:231]
    s_add_u32 s6, s84, s75
    v_mfma_f32_16x16x32_bf16 v[236:239], a[108:111], a[52:55], v[236:239]
    s_addc_u32 s7, s85, 0
    global_load_lds_dwordx4 v2, s[4:5] offset:0
    v_mfma_f32_16x16x32_bf16 v[236:239], a[104:107], a[20:23], v[236:239]
    s_mul_i32 s75, s91, s68
    v_mfma_f32_16x16x32_bf16 v[52:55], a[104:107], a[24:27], v[52:55]
    s_add_u32 s8, s86, s75
    v_mfma_f32_16x16x32_bf16 v[52:55], a[108:111], a[56:59], v[52:55]
    s_addc_u32 s9, s87, 0
    v_mfma_f32_16x16x32_bf16 v[60:63], a[108:111], a[60:63], v[60:63]
    s_mul_i32 s75, s91, s69
    v_mfma_f32_16x16x32_bf16 v[60:63], a[104:107], a[28:31], v[60:63]
    s_add_u32 s10, s88, s75
    v_mfma_f32_16x16x32_bf16 v[176:179], a[0:3], a[112:115], v[176:179]
    s_addc_u32 s11, s89, 0
    ds_read_b128 a[104:107], v11 offset:10240
    global_load_lds_dwordx4 v3, s[4:5] offset:1024
    v_mfma_f32_16x16x32_bf16 v[176:179], a[32:35], a[116:119], v[176:179]
    s_add_u32 s70, s70, 16384
    ds_read_b128 a[108:111], v21 offset:10240
    v_mfma_f32_16x16x32_bf16 v[180:183], a[36:39], a[116:119], v[180:183]
    s_and_b32 s70, s70, 0xffff
    v_mfma_f32_16x16x32_bf16 v[180:183], a[4:7], a[112:115], v[180:183]
    v_mfma_f32_16x16x32_bf16 v[112:115], a[8:11], a[112:115], v[112:115]
    v_mfma_f32_16x16x32_bf16 v[112:115], a[40:43], a[116:119], v[112:115]
    v_mfma_f32_16x16x32_bf16 v[116:119], a[44:47], a[116:119], v[116:119]
    global_load_lds_dwordx4 v4, s[4:5] offset:2048
    v_mfma_f32_16x16x32_bf16 v[116:119], a[12:15], a[112:115], v[116:119]
    v_mfma_f32_16x16x32_bf16 v[240:243], a[112:115], a[16:19], v[240:243]
    v_mfma_f32_16x16x32_bf16 v[240:243], a[116:119], a[48:51], v[240:243]
    v_mfma_f32_16x16x32_bf16 v[248:251], a[116:119], a[52:55], v[248:251]
    v_mfma_f32_16x16x32_bf16 v[248:251], a[112:115], a[20:23], v[248:251]
    v_mfma_f32_16x16x32_bf16 v[64:67], a[112:115], a[24:27], v[64:67]
    global_load_lds_dwordx4 v5, s[4:5] offset:3072
    v_mfma_f32_16x16x32_bf16 v[64:67], a[116:119], a[56:59], v[64:67]
    s_add_u32 s90, s90, 1
    v_mfma_f32_16x16x32_bf16 v[72:75], a[116:119], a[60:63], v[72:75]
    s_and_b32 s90, s90, 7
    v_mfma_f32_16x16x32_bf16 v[72:75], a[112:115], a[28:31], v[72:75]
    s_lshl_b32 s75, s90, 7
    v_mfma_f32_16x16x32_bf16 v[184:187], a[0:3], a[192:195], v[184:187]
    s_add_u32 s4, s82, s75
    ds_read_b128 a[112:115], v11 offset:12288
    v_mfma_f32_16x16x32_bf16 v[184:187], a[32:35], a[196:199], v[184:187]
    s_addc_u32 s5, s83, 0
    ds_read_b128 a[116:119], v21 offset:12288
    v_mfma_f32_16x16x32_bf16 v[188:191], a[36:39], a[196:199], v[188:191]
    s_add_u32 s65, s65, 32768
    v_mfma_f32_16x16x32_bf16 v[188:191], a[4:7], a[192:195], v[188:191]
    s_cmp_ge_u32 s65, 163840
    v_mfma_f32_16x16x32_bf16 v[120:123], a[8:11], a[192:195], v[120:123]
    s_cselect_b32 s75, 98304, 0
    v_add_u32 v11, 98304, v10
    v_xor_b32 v21, 64, v11
    v_mfma_f32_16x16x32_bf16 v[120:123], a[40:43], a[196:199], v[120:123]
    s_sub_u32 s65, s65, s75
    v_mfma_f32_16x16x32_bf16 v[124:127], a[44:47], a[196:199], v[124:127]
    s_lshr_b32 s34, s33, 1
    v_mfma_f32_16x16x32_bf16 v[124:127], a[12:15], a[192:195], v[124:127]
    s_cmp_lg_u32 s34, 3
    v_mfma_f32_16x16x32_bf16 v[244:247], a[192:195], a[16:19], v[244:247]
    s_cbranch_scc1 L_e0s11
    buffer_atomic_add v22, v1, s[28:31], 0 offen sc1
L_e0s11:
    v_mfma_f32_16x16x32_bf16 v[244:247], a[196:199], a[48:51], v[244:247]
    v_mfma_f32_16x16x32_bf16 v[252:255], a[196:199], a[52:55], v[252:255]
    v_mfma_f32_16x16x32_bf16 v[252:255], a[192:195], a[20:23], v[252:255]
    v_mfma_f32_16x16x32_bf16 v[68:71], a[192:195], a[24:27], v[68:71]
    v_mfma_f32_16x16x32_bf16 v[68:71], a[196:199], a[56:59], v[68:71]
    v_mfma_f32_16x16x32_bf16 v[76:79], a[196:199], a[60:63], v[76:79]
    v_mfma_f32_16x16x32_bf16 v[76:79], a[192:195], a[28:31], v[76:79]
    s_waitcnt lgkmcnt(0)
    v_mfma_f32_16x16x32_bf16 v[128:131], a[128:131], a[64:67], v[128:131]
    s_waitcnt vmcnt(16)
    v_mfma_f32_16x16x32_bf16 v[128:131], a[160:163], a[68:71], v[128:131]
L_wk2:
    s_cbranch_execz L_wk6
    s_barrier
    v_mfma_f32_16x16x32_bf16 v[132:135], a[164:167], a[68:71], v[132:135]
    s_lshl_b32 s34, s32, 20
    ds_read_b128 a[192:195], v11 offset:14336
    v_mfma_f32_16x16x32_bf16 v[132:135], a[132:135], a[64:67], v[132:135]
    s_add_u32 s20, s60, s34
    ds_read_b128 a[196:199], v21 offset:14336
    v_mfma_f32_16x16x32_bf16 v[80:83], a[136:139], a[64:67], v[80:83]
    s_addc_u32 s21, s61, 0
    ds_read_b64_tr_b16 a[0:1], v12 offset:32768
    v_mfma_f32_16x16x32_bf16 v[80:83], a[168:171], a[68:71], v[80:83]
    s_mov_b32 s22, 0x100000
    ds_read_b64_tr_b16 a[2:3], v12 offset:33792
    v_mfma_f32_16x16x32_bf16 v[84:87], a[172:175], a[68:71], v[84:87]
    s_mov_b32 s23, 0x20000
    ds_read_b64_tr_b16 a[4:5], v13 offset:32768
    v_mfma_f32_16x16x32_bf16 v[84:87], a[140:143], a[64:67], v[84:87]
    s_mov_b32 s93, 0x3e0293ee
    ds_read_b64_tr_b16 a[6:7], v13 offset:33792
    v_mfma_f32_16x16x32_bf16 v[192:195], a[64:67], a[144:147], v[192:195]
    ds_read_b64_tr_b16 a[8:9], v14 offset:32768
    v_mfma_f32_16x16x32_bf16 v[192:195], a[68:71], a[176:179], v[192:195]
    ds_read_b64_tr_b16 a[10:11], v14 offset:33792
    v_mfma_f32_16x16x32_bf16 v[200:203], a[68:71], a[180:183], v[200:203]
    ds_read_b64_tr_b16 a[12:13], v15 offset:32768
    v_mfma_f32_16x16x32_bf16 v[200:203], a[64:67], a[148:151], v[200:203]
    ds_read_b64_tr_b16 a[14:15], v15 offset:33792
    v_mfma_f32_16x16x32_bf16 a[232:235], a[64:67], a[152:155], a[232:235]
    ds_read_b64_tr_b16 a[16:17], v12 offset:40960
    v_mfma_f32_16x16x32_bf16 a[232:235], a[68:71], a[184:187], a[232:235]
    ds_read_b64_tr_b16 a[18:19], v12 offset:41984
    v_mfma_f32_16x16x32_bf16 a[240:243], a[68:71], a[188:191], a[240:243]
    ds_read_b64_tr_b16 a[20:21], v13 offset:40960
    v_mfma_f32_16x16x32_bf16 a[240:243], a[64:67], a[156:159], a[240:243]
    ds_read_b64_tr_b16 a[22:23], v13 offset:41984
    v_mfma_f32_16x16x32_bf16 v[136:139], a[128:131], a[72:75], v[136:139]
    ds_read_b128 a[64:67], v11 offset:0
    v_mfma_f32_16x16x32_bf16 v[136:139], a[160:163], a[76:79], v[136:139]
    ds_read_b128 a[68:71], v21 offset:0
    v_mfma_f32_16x16x32_bf16 v[140:143], a[164:167], a[76:79], v[140:143]
    ds_read_b64_tr_b16 a[24:25], v14 offset:40960
    v_mfma_f32_16x16x32_bf16 v[140:143], a[132:135], a[72:75], v[140:143]
    ds_read_b64_tr_b16 a[26:27], v14 offset:41984
    v_mfma_f32_16x16x32_bf16 v[24:27], a[136:139], a[72:75], v[24:27]
    ds_read_b64_tr_b16 a[28:29], v15 offset:40960
    v_mfma_f32_16x16x32_bf16 v[24:27], a[168:171], a[76:79], v[24:27]
    ds_read_b64_tr_b16 a[30:31], v15 offset:41984
    v_mfma_f32_16x16x32_bf16 v[28:31], a[172:175], a[76:79], v[28:31]
    v_mfma_f32_16x16x32_bf16 v[28:31], a[140:143], a[72:75], v[28:31]
    v_mfma_f32_16x16x32_bf16 v[196:199], a[72:75], a[144:147], v[196:199]
    v_mfma_f32_16x16x32_bf16 v[196:199], a[76:79], a[176:179], v[196:199]
    v_mfma_f32_16x16x32_bf16 v[204:207], a[76:79], a[180:183], v[204:207]
    v_mfma_f32_16x16x32_bf16 v[204:207], a[72:75], a[148:151], v[204:207]
    v_mfma_f32_16x16x32_bf16 a[236:239], a[72:75], a[152:155], a[236:239]
    v_mfma_f32_16x16x32_bf16 a[236:239], a[76:79], a[184:187], a[236:239]
    v_mfma_f32_16x16x32_bf16 a[244:247], a[76:79], a[188:191], a[244:247]
    v_mfma_f32_16x16x32_bf16 a[244:247], a[72:75], a[156:159], a[244:247]
    v_mfma_f32_16x16x32_bf16 v[144:147], a[128:131], a[80:83], v[144:147]
    ds_read_b128 a[72:75], v11 offset:2048
    v_mfma_f32_16x16x32_bf16 v[144:147], a[160:163], a[84:87], v[144:147]
    ds_read_b128 a[76:79], v21 offset:2048
    v_mfma_f32_16x16x32_bf16 v[148:151], a[164:167], a[84:87], v[148:151]
    v_mfma_f32_16x16x32_bf16 v[148:151], a[132:135], a[80:83], v[148:151]
    v_mfma_f32_16x16x32_bf16 v[32:35], a[136:139], a[80:83], v[32:35]
    v_mfma_f32_16x16x32_bf16 v[32:35], a[168:171], a[84:87], v[32:35]
    v_mfma_f32_16x16x32_bf16 v[36:39], a[172:175], a[84:87], v[36:39]
    v_mfma_f32_16x16x32_bf16 v[36:39], a[140:143], a[80:83], v[36:39]
    v_mfma_f32_16x16x32_bf16 v[208:211], a[80:83], a[144:147], v[208:211]
    v_mfma_f32_16x16x32_bf16 v[208:211], a[84:87], a[176:179], v[208:211]
    v_mfma_f32_16x16x32_bf16 v[216:219], a[84:87], a[180:183], v[216:219]
    v_mfma_f32_16x16x32_bf16 v[216:219], a[80:83], a[148:151], v[216:219]
    v_mfma_f32_16x16x32_bf16 a[248:251], a[80:83], a[152:155], a[248:251]
    v_mfma_f32_16x16x32_bf16 a[248:251], a[84:87], a[184:187], a[248:251]
    v_mfma_f32_16x16x32_bf16 v[40:43], a[84:87], a[188:191], v[40:43]
    v_mfma_f32_16x16x32_bf16 v[40:43], a[80:83], a[156:159], v[40:43]
    v_mfma_f32_16x16x32_bf16 v[152:155], a[128:131], a[88:91], v[152:155]
    ds_read_b128 a[80:83], v11 offset:4096
    v_mfma_f32_16x16x32_bf16 v[152:155], a[160:163], a[92:95], v[152:155]
    ds_read_b128 a[84:87], v21 offset:4096
    v_mfma_f32_16x16x32_bf16 v[156:159], a[164:167], a[92:95], v[156:159]
    v_mfma_f32_16x16x32_bf16 v[156:159], a[132:135], a[88:91], v[156:159]
    v_mfma_f32_16x16x32_bf16 v[88:91], a[136:139], a[88:91], v[88:91]
    v_mfma_f32_16x16x32_bf16 v[88:91], a[168:171], a[92:95], v[88:91]
    v_mfma_f32_16x16x32_bf16 v[92:95], a[172:175], a[92:95], v[92:95]
    v_mfma_f32_16x16x32_bf16 v[92:95], a[140:143], a[88:91], v[92:95]
    v_mfma_f32_16x16x32_bf16 v[212:215], a[88:91], a[144:147], v[212:215]
    v_mfma_f32_16x16x32_bf16 v[212:215], a[92:95], a[176:179], v[212:215]
    v_mfma_f32_16x16x32_bf16 v[220:223], a[92:95], a[180:183], v[220:223]
    v_mfma_f32_16x16x32_bf16 v[220:223], a[88:91], a[148:151], v[220:223]
    v_mfma_f32_16x16x32_bf16 a[252:255], a[88:91], a[152:155], a[252:255]
    v_mfma_f32_16x16x32_bf16 a[252:255], a[92:95], a[184:187], a[252:255]
    v_mfma_f32_16x16x32_bf16 v[44:47], a[92:95], a[188:191], v[44:47]
    v_mfma_f32_16x16x32_bf16 v[44:47], a[88:91], a[156:159], v[44:47]
    s_waitcnt lgkmcnt(0)
    v_mfma_f32_16x16x32_bf16 v[160:163], a[128:131], a[96:99], v[160:163]
    s_waitcnt vmcnt(12)
    v_mfma_f32_16x16x32_bf16 v[160:163], a[160:163], a[100:103], v[160:163]
    s_barrier
    v_mfma_f32_16x16x32_bf16 v[164:167], a[164:167], a[100:103], v[164:167]
    s_add_u32 m0, s70, s71
    ds_read_b128 a[88:91], v11 offset:6144
    global_load_lds_dwordx4 v6, s[6:7]
    v_mfma_f32_16x16x32_bf16 v[164:167], a[132:135], a[96:99], v[164:167]
    ds_read_b128 a[92:95], v21 offset:6144
    v_mfma_f32_16x16x32_bf16 v[96:99], a[136:139], a[96:99], v[96:99]
    ds_read_b64_tr_b16 a[32:33], v12 offset:49152
    v_mfma_f32_16x16x32_bf16 v[96:99], a[168:171], a[100:103], v[96:99]
    ds_read_b64_tr_b16 a[34:35], v12 offset:50176
    v_mfma_f32_16x16x32_bf16 v[100:103], a[172:175], a[100:103], v[100:103]
    ds_read_b64_tr_b16 a[36:37], v13 offset:49152
    v_mfma_f32_16x16x32_bf16 v[100:103], a[140:143], a[96:99], v[100:103]
    ds_read_b64_tr_b16 a[38:39], v13 offset:50176
    v_mfma_f32_16x16x32_bf16 v[224:227], a[96:99], a[144:147], v[224:227]
    ds_read_b64_tr_b16 a[40:41], v14 offset:49152
    global_load_lds_dwordx4 v7, s[6:7] offset:1024
    v_mfma_f32_16x16x32_bf16 v[224:227], a[100:103], a[176:179], v[224:227]
    ds_read_b64_tr_b16 a[42:43], v14 offset:50176
    v_mfma_f32_16x16x32_bf16 v[232:235], a[100:103], a[180:183], v[232:235]
    ds_read_b64_tr_b16 a[44:45], v15 offset:49152
    v_mfma_f32_16x16x32_bf16 v[232:235], a[96:99], a[148:151], v[232:235]
    ds_read_b64_tr_b16 a[46:47], v15 offset:50176
    v_mfma_f32_16x16x32_bf16 v[48:51], a[96:99], a[152:155], v[48:51]
    ds_read_b64_tr_b16 a[48:49], v12 offset:57344
    v_mfma_f32_16x16x32_bf16 v[48:51], a[100:103], a[184:187], v[48:51]
    ds_read_b64_tr_b16 a[50:51], v12 offset:58368
    v_mfma_f32_16x16x32_bf16 v[56:59], a[100:103], a[188:191], v[56:59]
    s_add_u32 m0, s70, s72
    ds_read_b64_tr_b16 a[52:53], v13 offset:57344
    global_load_lds_dwordx4 v8, s[8:9]
    v_mfma_f32_16x16x32_bf16 v[56:59], a[96:99], a[156:159], v[56:59]
    ds_read_b64_tr_b16 a[54:55], v13 offset:58368
    v_mfma_f32_16x16x32_bf16 v[168:171], a[128:131], a[104:107], v[168:171]
    ds_read_b128 a[96:99], v11 offset:8192
    v_mfma_f32_16x16x32_bf16 v[168:171], a[160:163], a[108:111], v[168:171]
    ds_read_b128 a[100:103], v21 offset:8192
    v_mfma_f32_16x16x32_bf16 v[172:175], a[164:167], a[108:111], v[172:175]
    ds_read_b64_tr_b16 a[56:57], v14 offset:57344
    v_mfma_f32_16x16x32_bf16 v[172:175], a[132:135], a[104:107], v[172:175]
    ds_read_b64_tr_b16 a[58:59], v14 offset:58368
    v_mfma_f32_16x16x32_bf16 v[104:107], a[136:139], a[104:107], v[104:107]
    s_add_u32 m0, s70, s73
    ds_read_b64_tr_b16 a[60:61], v15 offset:57344
    global_load_lds_dwordx4 v9, s[10:11]
    v_mfma_f32_16x16x32_bf16 v[104:107], a[168:171], a[108:111], v[104:107]
    s_add_u32 m0, s65, 0
    ds_read_b64_tr_b16 a[62:63], v15 offset:58368
    v_mfma_f32_16x16x32_bf16 v[108:111], a[172:175], a[108:111], v[108:111]
    s_add_u32 s91, s91, 1
    v_mfma_f32_16x16x32_bf16 v[108:111], a[140:143], a[104:107], v[108:111]
    s_and_b32 s91, s91, 15
    v_mfma_f32_16x16x32_bf16 v[228:231], a[104:107], a[144:147], v[228:231]
    s_lshl_b32 s75, s91, 18
    v_mfma_f32_16x16x32_bf16 v[228:231], a[108:111], a[176:179], v[228:231]
    s_add_u32 s6, s84, s75
    v_mfma_f32_16x16x32_bf16 v[236:239], a[108:111], a[180:183], v[236:239]
    s_addc_u32 s7, s85, 0
    global_load_lds_dwordx4 v2, s[4:5] offset:0
    v_mfma_f32_16x16x32_bf16 v[236:239], a[104:107], a[148:151], v[236:239]
    s_mul_i32 s75, s91, s68
    v_mfma_f32_16x16x32_bf16 v[52:55], a[104:107], a[152:155], v[52:55]
    s_add_u32 s8, s86, s75
    v_mfma_f32_16x16x32_bf16 v[52:55], a[108:111], a[184:187], v[52:55]
    s_addc_u32 s9, s87, 0
    v_mfma_f32_16x16x32_bf16 v[60:63], a[108:111], a[188:191], v[60:63]
    s_mul_i32 s75, s91, s69
    v_mfma_f32_16x16x32_bf16 v[60:63], a[104:107], a[156:159], v[60:63]
    s_add_u32 s10, s88, s75
    v_mfma_f32_16x16x32_bf16 v[176:179], a[128:131], a[112:115], v[176:179]
    s_addc_u32 s11, s89, 0
    ds_read_b128 a[104:107], v11 offset:10240
    global_load_lds_dwordx4 v3, s[4:5] offset:1024
    v_mfma_f32_16x16x32_bf16 v[176:179], a[160:163], a[116:119], v[176:179]
    s_add_u32 s70, s70, 16384
    ds_read_b128 a[108:111], v21 offset:10240
    v_mfma_f32_16x16x32_bf16 v[180:183], a[164:167], a[116:119], v[180:183]
    s_and_b32 s70, s70, 0xffff
    v_mfma_f32_16x16x32_bf16 v[180:183], a[132:135], a[112:115], v[180:183]
    v_mfma_f32_16x16x32_bf16 v[112:115], a[136:139], a[112:115], v[112:115]
    v_mfma_f32_16x16x32_bf16 v[112:115], a[168:171], a[116:119], v[112:115]
    v_mfma_f32_16x16x32_bf16 v[116:119], a[172:175], a[116:119], v[116:119]
    global_load_lds_dwordx4 v4, s[4:5] offset:2048
    v_mfma_f32_16x16x32_bf16 v[116:119], a[140:143], a[112:115], v[116:119]
    v_mfma_f32_16x16x32_bf16 v[240:243], a[112:115], a[144:147], v[240:243]
    v_mfma_f32_16x16x32_bf16 v[240:243], a[116:119], a[176:179], v[240:243]
    v_mfma_f32_16x16x32_bf16 v[248:251], a[116:119], a[180:183], v[248:251]
    v_mfma_f32_16x16x32_bf16 v[248:251], a[112:115], a[148:151], v[248:251]
    v_mfma_f32_16x16x32_bf16 v[64:67], a[112:115], a[152:155], v[64:67]
    global_load_lds_dwordx4 v5, s[4:5] offset:3072
    v_mfma_f32_16x16x32_bf16 v[64:67], a[116:119], a[184:187], v[64:67]
    s_add_u32 s4, s4, s94
    v_mfma_f32_16x16x32_bf16 v[72:75], a[116:119], a[188:191], v[72:75]
    s_addc_u32 s5, s5, 0
    v_mfma_f32_16x16x32_bf16 v[72:75], a[112:115], a[156:159], v[72:75]
    v_mfma_f32_16x16x32_bf16 v[184:187], a[128:131], a[120:123], v[184:187]
    ds_read_b128 a[112:115], v11 offset:12288
    v_mfma_f32_16x16x32_bf16 v[184:187], a[160:163], a[124:127], v[184:187]
    ds_read_b128 a[116:119], v21 offset:12288
    v_mfma_f32_16x16x32_bf16 v[188:191], a[164:167], a[124:127], v[188:191]
    v_mfma_f32_16x16x32_bf16 v[188:191], a[132:135], a[120:123], v[188:191]
    v_mfma_f32_16x16x32_bf16 v[120:123], a[136:139], a[120:123], v[120:123]
    v_mfma_f32_16x16x32_bf16 v[120:123], a[168:171], a[124:127], v[120:123]
    v_mfma_f32_16x16x32_bf16 v[124:127], a[172:175], a[124:127], v[124:127]
    v_mfma_f32_16x16x32_bf16 v[124:127], a[140:143], a[120:123], v[124:127]
    v_mfma_f32_16x16x32_bf16 v[244:247], a[120:123], a[144:147], v[244:247]
    v_mfma_f32_16x16x32_bf16 v[244:247], a[124:127], a[176:179], v[244:247]
    v_mfma_f32_16x16x32_bf16 v[252:255], a[124:127], a[180:183], v[252:255]
    v_mfma_f32_16x16x32_bf16 v[252:255], a[120:123], a[148:151], v[252:255]
    v_mfma_f32_16x16x32_bf16 v[68:71], a[120:123], a[152:155], v[68:71]
    v_mfma_f32_16x16x32_bf16 v[68:71], a[124:127], a[184:187], v[68:71]
    v_mfma_f32_16x16x32_bf16 v[76:79], a[124:127], a[188:191], v[76:79]
    v_mfma_f32_16x16x32_bf16 v[76:79], a[120:123], a[156:159], v[76:79]
    s_waitcnt lgkmcnt(0)
    v_mfma_f32_16x16x32_bf16 v[128:131], a[0:3], a[64:67], v[128:131]
    s_waitcnt vmcnt(20)
    v_add_u32 v10, s66, v10
    v_lshlrev_b32 v12, 3, v0
    v_mfma_f32_16x16x32_bf16 v[128:131], a[32:35], a[68:71], v[128:131]
    s_barrier
    v_add_u32 v13, s67, v1
    v_add_u32 v11, 131072, v10
    v_mfma_f32_16x16x32_bf16 v[132:135], a[36:39], a[68:71], v[132:135]
    s_add_u32 m0, s70, s71
    v_add_u32 v20, s77, v1
    v_add_u32 v21, 0x1000, v20
    v_mfma_f32_16x16x32_bf16 v[132:135], a[4:7], a[64:67], v[132:135]
    s_mov_b32 s30, 4
    global_load_lds_dwordx4 v6, s[6:7]
    v_add_u32 v22, s64, v1
    v_mfma_f32_16x16x32_bf16 v[80:83], a[8:11], a[64:67], v[80:83]
    v_mfma_f32_16x16x32_bf16 v[80:83], a[40:43], a[68:71], v[80:83]
    v_mfma_f32_16x16x32_bf16 v[84:87], a[44:47], a[68:71], v[84:87]
    v_mfma_f32_16x16x32_bf16 v[84:87], a[12:15], a[64:67], v[84:87]
    v_mfma_f32_16x16x32_bf16 v[192:195], a[64:67], a[16:19], v[192:195]
    v_mfma_f32_16x16x32_bf16 v[192:195], a[68:71], a[48:51], v[192:195]
    global_load_lds_dwordx4 v7, s[6:7] offset:1024
    v_mfma_f32_16x16x32_bf16 v[200:203], a[68:71], a[52:55], v[200:203]
    v_mfma_f32_16x16x32_bf16 v[200:203], a[64:67], a[20:23], v[200:203]
    v_mfma_f32_16x16x32_bf16 a[232:235], a[64:67], a[24:27], a[232:235]
    v_mfma_f32_16x16x32_bf16 a[232:235], a[68:71], a[56:59], a[232:235]
    v_mul_f32 v128, s93, v128
    v_mul_f32 v129, s93, v129
    v_mfma_f32_16x16x32_bf16 a[240:243], a[68:71], a[60:63], a[240:243]
    v_cvt_pk_bf16_f32 v128, v128, v129
    v_mul_f32 v130, s93, v130
    v_mfma_f32_16x16x32_bf16 a[240:243], a[64:67], a[28:31], a[240:243]
    s_add_u32 m0, s70, s72
    v_mul_f32 v131, s93, v131
    v_cvt_pk_bf16_f32 v129, v130, v131
    v_mfma_f32_16x16x32_bf16 v[136:139], a[0:3], a[72:75], v[136:139]
    global_load_lds_dwordx4 v8, s[8:9]
    v_mul_f32 v132, s93, v132
    v_mfma_f32_16x16x32_bf16 v[136:139], a[32:35], a[76:79], v[136:139]
    v_mul_f32 v133, s93, v133
    v_cvt_pk_bf16_f32 v130, v132, v133
    v_mfma_f32_16x16x32_bf16 v[140:143], a[36:39], a[76:79], v[140:143]
    v_mul_f32 v134, s93, v134
    v_mul_f32 v135, s93, v135
    v_mfma_f32_16x16x32_bf16 v[140:143], a[4:7], a[72:75], v[140:143]
    v_cvt_pk_bf16_f32 v131, v134, v135
    v_mul_f32 v80, s93, v80
    v_mfma_f32_16x16x32_bf16 v[24:27], a[8:11], a[72:75], v[24:27]
    v_mul_f32 v81, s93, v81
    v_cvt_pk_bf16_f32 v132, v80, v81
    v_mfma_f32_16x16x32_bf16 v[24:27], a[40:43], a[76:79], v[24:27]
    v_mul_f32 v82, s93, v82
    v_mul_f32 v83, s93, v83
    v_mfma_f32_16x16x32_bf16 v[28:31], a[44:47], a[76:79], v[28:31]
    s_add_u32 m0, s70, s73
    v_cvt_pk_bf16_f32 v133, v82, v83
    v_mul_f32 v84, s93, v84
    v_mfma_f32_16x16x32_bf16 v[28:31], a[12:15], a[72:75], v[28:31]
    global_load_lds_dwordx4 v9, s[10:11]
    v_mul_f32 v85, s93, v85
    v_mfma_f32_16x16x32_bf16 v[196:199], a[72:75], a[16:19], v[196:199]
    s_add_u32 m0, s65, 4096
    v_cvt_pk_bf16_f32 v134, v84, v85
    v_mul_f32 v86, s93, v86
    v_mfma_f32_16x16x32_bf16 v[196:199], a[76:79], a[48:51], v[196:199]
    s_add_u32 s91, s91, 1
    v_mul_f32 v87, s93, v87
    v_cvt_pk_bf16_f32 v135, v86, v87
    v_mfma_f32_16x16x32_bf16 v[204:207], a[76:79], a[52:55], v[204:207]
    s_and_b32 s91, s91, 15
    v_xor_b32 v80, 0, v17
    v_xor_b32 v81, 32, v17
    v_mfma_f32_16x16x32_bf16 v[204:207], a[72:75], a[20:23], v[204:207]
    s_lshl_b32 s75, s91, 18
    v_xor_b32 v82, 64, v17
    v_xor_b32 v83, 96, v17
    v_mfma_f32_16x16x32_bf16 a[236:239], a[72:75], a[24:27], a[236:239]
    s_add_u32 s6, s84, s75
    v_xor_b32 v84, 128, v17
    v_xor_b32 v85, 160, v17
    v_mfma_f32_16x16x32_bf16 a[236:239], a[76:79], a[56:59], a[236:239]
    s_addc_u32 s7, s85, 0
    global_load_lds_dwordx4 v2, s[4:5] offset:0
    v_xor_b32 v86, 192, v17
    v_mfma_f32_16x16x32_bf16 a[244:247], a[76:79], a[60:63], a[244:247]
    s_mul_i32 s75, s91, s68
    v_xor_b32 v87, 224, v17
    v_mul_f32 v136, s93, v136
    v_mfma_f32_16x16x32_bf16 a[244:247], a[72:75], a[28:31], a[244:247]
    s_add_u32 s8, s86, s75
    v_mul_f32 v137, s93, v137
    v_cvt_pk_bf16_f32 v136, v136, v137
    v_mfma_f32_16x16x32_bf16 v[144:147], a[0:3], a[80:83], v[144:147]
    s_addc_u32 s9, s87, 0
    v_mul_f32 v138, s93, v138
    v_mul_f32 v139, s93, v139
    v_mfma_f32_16x16x32_bf16 v[144:147], a[32:35], a[84:87], v[144:147]
    s_mul_i32 s75, s91, s69
    v_cvt_pk_bf16_f32 v137, v138, v139
    v_mul_f32 v140, s93, v140
    v_mfma_f32_16x16x32_bf16 v[148:151], a[36:39], a[84:87], v[148:151]
    s_add_u32 s10, s88, s75
    v_mul_f32 v141, s93, v141
    v_cvt_pk_bf16_f32 v138, v140, v141
    v_mfma_f32_16x16x32_bf16 v[148:151], a[4:7], a[80:83], v[148:151]
    s_addc_u32 s11, s89, 0
    global_load_lds_dwordx4 v3, s[4:5] offset:1024
    v_mul_f32 v142, s93, v142
    v_mfma_f32_16x16x32_bf16 v[32:35], a[8:11], a[80:83], v[32:35]
    s_add_u32 s70, s70, 16384
    v_mul_f32 v143, s93, v143
    v_cvt_pk_bf16_f32 v139, v142, v143
    v_mfma_f32_16x16x32_bf16 v[32:35], a[40:43], a[84:87], v[32:35]
    s_and_b32 s70, s70, 0xffff
    v_mul_f32 v24, s93, v24
    v_mul_f32 v25, s93, v25
    v_mfma_f32_16x16x32_bf16 v[36:39], a[44:47], a[84:87], v[36:39]
    v_cvt_pk_bf16_f32 v140, v24, v25
    v_mul_f32 v26, s93, v26
    v_mfma_f32_16x16x32_bf16 v[36:39], a[12:15], a[80:83], v[36:39]
    v_mul_f32 v27, s93, v27
    v_cvt_pk_bf16_f32 v141, v26, v27
    v_mfma_f32_16x16x32_bf16 v[208:211], a[80:83], a[16:19], v[208:211]
    v_mul_f32 v28, s93, v28
    v_mul_f32 v29, s93, v29
    v_mfma_f32_16x16x32_bf16 v[208:211], a[84:87], a[48:51], v[208:211]
    global_load_lds_dwordx4 v4, s[4:5] offset:2048
    v_cvt_pk_bf16_f32 v142, v28, v29
    v_mfma_f32_16x16x32_bf16 v[216:219], a[84:87], a[52:55], v[216:219]
    v_mul_f32 v30, s93, v30
    v_mul_f32 v31, s93, v31
    v_mfma_f32_16x16x32_bf16 v[216:219], a[80:83], a[20:23], v[216:219]
    v_cvt_pk_bf16_f32 v143, v30, v31
    v_cvt_pk_bf16_f32 v192, v192, v193
    v_mfma_f32_16x16x32_bf16 a[248:251], a[80:83], a[24:27], a[248:251]
    v_cvt_pk_bf16_f32 v193, v194, v195
    v_cvt_pk_bf16_f32 v194, v196, v197
    v_mfma_f32_16x16x32_bf16 a[248:251], a[84:87], a[56:59], a[248:251]
    v_cvt_pk_bf16_f32 v195, v198, v199
    v_cvt_pk_bf16_f32 v200, v200, v201
    v_mfma_f32_16x16x32_bf16 v[40:43], a[84:87], a[60:63], v[40:43]
    v_cvt_pk_bf16_f32 v201, v202, v203
    v_cvt_pk_bf16_f32 v202, v204, v205
    v_mfma_f32_16x16x32_bf16 v[40:43], a[80:83], a[28:31], v[40:43]
    global_load_lds_dwordx4 v5, s[4:5] offset:3072
    buffer_load_dword v23, off, s[28:31], 0 sc1
    v_mfma_f32_16x16x32_bf16 v[152:155], a[0:3], a[88:91], v[152:155]
    s_add_u32 s90, s90, 1
    v_cvt_pk_bf16_f32 v203, v206, v207
    v_accvgpr_read_b32 v18, a232
    v_mfma_f32_16x16x32_bf16 v[152:155], a[32:35], a[92:95], v[152:155]
    s_and_b32 s90, s90, 7
    v_accvgpr_read_b32 v19, a233
    v_cvt_pk_bf16_f32 v196, v18, v19
    v_mfma_f32_16x16x32_bf16 v[156:159], a[36:39], a[92:95], v[156:159]
    s_lshl_b32 s75, s90, 7
    v_accvgpr_read_b32 v14, a234
    v_accvgpr_read_b32 v15, a235
    v_mfma_f32_16x16x32_bf16 v[156:159], a[4:7], a[88:91], v[156:159]
    s_add_u32 s4, s82, s75
    v_cvt_pk_bf16_f32 v197, v14, v15
    v_accvgpr_read_b32 v18, a236
    v_mfma_f32_16x16x32_bf16 v[88:91], a[8:11], a[88:91], v[88:91]
    s_addc_u32 s5, s83, 0
    v_accvgpr_read_b32 v19, a237
    v_cvt_pk_bf16_f32 v198, v18, v19
    v_mfma_f32_16x16x32_bf16 v[88:91], a[40:43], a[92:95], v[88:91]
    s_add_u32 s65, s65, 32768
    v_accvgpr_read_b32 v14, a238
    v_accvgpr_read_b32 v15, a239
    v_mfma_f32_16x16x32_bf16 v[92:95], a[44:47], a[92:95], v[92:95]
    s_cmp_ge_u32 s65, 163840
    v_cvt_pk_bf16_f32 v199, v14, v15
    v_accvgpr_read_b32 v18, a240
    v_mfma_f32_16x16x32_bf16 v[92:95], a[12:15], a[88:91], v[92:95]
    s_cselect_b32 s75, 98304, 0
    v_accvgpr_read_b32 v19, a241
    v_cvt_pk_bf16_f32 v204, v18, v19
    v_mfma_f32_16x16x32_bf16 v[212:215], a[88:91], a[16:19], v[212:215]
    s_sub_u32 s65, s65, s75
    v_accvgpr_read_b32 v14, a242
    v_accvgpr_read_b32 v15, a243
    v_mfma_f32_16x16x32_bf16 v[212:215], a[92:95], a[48:51], v[212:215]
    v_cvt_pk_bf16_f32 v205, v14, v15
    v_accvgpr_read_b32 v18, a244
    v_mfma_f32_16x16x32_bf16 v[220:223], a[92:95], a[52:55], v[220:223]
    v_accvgpr_read_b32 v19, a245
    v_cvt_pk_bf16_f32 v206, v18, v19
    v_mfma_f32_16x16x32_bf16 v[220:223], a[88:91], a[20:23], v[220:223]
    v_accvgpr_read_b32 v14, a246
    v_accvgpr_read_b32 v15, a247
    v_mfma_f32_16x16x32_bf16 a[252:255], a[88:91], a[24:27], a[252:255]
    v_cvt_pk_bf16_f32 v207, v14, v15
    v_mul_f32 v144, s93, v144
    v_mfma_f32_16x16x32_bf16 a[252:255], a[92:95], a[56:59], a[252:255]
    v_mul_f32 v145, s93, v145
    v_cvt_pk_bf16_f32 v144, v144, v145
    v_mfma_f32_16x16x32_bf16 v[44:47], a[92:95], a[60:63], v[44:47]
    v_mul_f32 v146, s93, v146
    v_mul_f32 v147, s93, v147
    v_mfma_f32_16x16x32_bf16 v[44:47], a[88:91], a[28:31], v[44:47]
    s_waitcnt lgkmcnt(0)
    v_cvt_pk_bf16_f32 v145, v146, v147
    v_mul_f32 v148, s93, v148
    v_mfma_f32_16x16x32_bf16 v[160:163], a[0:3], a[96:99], v[160:163]
    s_waitcnt vmcnt(17)
    v_mul_f32 v149, s93, v149
    v_cvt_pk_bf16_f32 v146, v148, v149
    v_mfma_f32_16x16x32_bf16 v[160:163], a[32:35], a[100:103], v[160:163]
    s_barrier
    v_mul_f32 v150, s93, v150
    v_mul_f32 v151, s93, v151
    v_mfma_f32_16x16x32_bf16 v[164:167], a[36:39], a[100:103], v[164:167]
    s_add_u32 m0, s70, s71
    ds_read_b128 a[128:131], v11 offset:0
    global_load_lds_dwordx4 v6, s[6:7]
    v_mfma_f32_16x16x32_bf16 v[164:167], a[4:7], a[96:99], v[164:167]
    ds_read_b128 a[132:135], v11 offset:8192
    v_cvt_pk_bf16_f32 v147, v150, v151
    v_mfma_f32_16x16x32_bf16 v[96:99], a[8:11], a[96:99], v[96:99]
    ds_read_b128 a[136:139], v11 offset:16384
    v_mul_f32 v32, s93, v32
    v_mfma_f32_16x16x32_bf16 v[96:99], a[40:43], a[100:103], v[96:99]
    ds_read_b128 a[140:143], v11 offset:24576
    v_mul_f32 v33, s93, v33
    v_mfma_f32_16x16x32_bf16 v[100:103], a[44:47], a[100:103], v[100:103]
    ds_read_b64_tr_b16 a[148:149], v80 offset:0
    v_cvt_pk_bf16_f32 v148, v32, v33
    v_mfma_f32_16x16x32_bf16 v[100:103], a[12:15], a[96:99], v[100:103]
    ds_read_b64_tr_b16 a[150:151], v80 offset:1024
    v_mul_f32 v34, s93, v34
    v_mfma_f32_16x16x32_bf16 v[224:227], a[96:99], a[16:19], v[224:227]
    ds_read_b64_tr_b16 a[152:153], v81 offset:0
    global_load_lds_dwordx4 v7, s[6:7] offset:1024
    v_mfma_f32_16x16x32_bf16 v[224:227], a[100:103], a[48:51], v[224:227]
    ds_read_b64_tr_b16 a[154:155], v81 offset:1024
    v_xor_b32 v11, 64, v11
    v_mfma_f32_16x16x32_bf16 v[232:235], a[100:103], a[52:55], v[232:235]
    ds_read_b64_tr_b16 a[156:157], v82 offset:0
    v_mul_f32 v35, s93, v35
    v_mfma_f32_16x16x32_bf16 v[232:235], a[96:99], a[20:23], v[232:235]
    ds_read_b64_tr_b16 a[158:159], v82 offset:1024
    v_cvt_pk_bf16_f32 v149, v34, v35
    v_mfma_f32_16x16x32_bf16 v[48:51], a[96:99], a[24:27], v[48:51]
    ds_read_b64_tr_b16 a[160:161], v83 offset:0
    v_mul_f32 v36, s93, v36
    v_mfma_f32_16x16x32_bf16 v[48:51], a[100:103], a[56:59], v[48:51]
    ds_read_b64_tr_b16 a[162:163], v83 offset:1024
    v_mul_f32 v37, s93, v37
    v_mfma_f32_16x16x32_bf16 v[56:59], a[100:103], a[60:63], v[56:59]
    s_add_u32 m0, s70, s72
    ds_read_b64_tr_b16 a[164:165], v84 offset:0
    global_load_lds_dwordx4 v8, s[8:9]
    v_mfma_f32_16x16x32_bf16 v[56:59], a[96:99], a[28:31], v[56:59]
    ds_read_b64_tr_b16 a[166:167], v84 offset:1024
    v_cvt_pk_bf16_f32 v150, v36, v37
    v_mfma_f32_16x16x32_bf16 v[168:171], a[0:3], a[104:107], v[168:171]
    ds_read_b64_tr_b16 a[168:169], v85 offset:0
    v_mul_f32 v38, s93, v38
    v_mfma_f32_16x16x32_bf16 v[168:171], a[32:35], a[108:111], v[168:171]
    ds_read_b64_tr_b16 a[170:171], v85 offset:1024
    v_mul_f32 v39, s93, v39
    v_mfma_f32_16x16x32_bf16 v[172:175], a[36:39], a[108:111], v[172:175]
    ds_read_b64_tr_b16 a[172:173], v86 offset:0
    v_cvt_pk_bf16_f32 v151, v38, v39
    v_mfma_f32_16x16x32_bf16 v[172:175], a[4:7], a[104:107], v[172:175]
    ds_read_b64_tr_b16 a[174:175], v86 offset:1024
    v_cvt_pk_bf16_f32 v208, v208, v209
    v_mfma_f32_16x16x32_bf16 v[104:107], a[8:11], a[104:107], v[104:107]
    s_add_u32 m0, s70, s73
    ds_read_b64_tr_b16 a[176:177], v87 offset:0
    global_load_lds_dwordx4 v9, s[10:11]
    v_mfma_f32_16x16x32_bf16 v[104:107], a[40:43], a[108:111], v[104:107]
    s_add_u32 m0, s65, 0
    ds_read_b64_tr_b16 a[178:179], v87 offset:1024
    v_cvt_pk_bf16_f32 v209, v210, v211
    v_mfma_f32_16x16x32_bf16 v[108:111], a[44:47], a[108:111], v[108:111]
    s_add_u32 s91, s91, 1
    ds_read_b64_tr_b16 a[180:181], v12 offset:8192
    v_cvt_pk_bf16_f32 v210, v212, v213
    v_mfma_f32_16x16x32_bf16 v[108:111], a[12:15], a[104:107], v[108:111]
    s_and_b32 s91, s91, 15
    ds_read_b64_tr_b16 a[182:183], v12 offset:8704
    v_cvt_pk_bf16_f32 v211, v214, v215
    v_mfma_f32_16x16x32_bf16 v[228:231], a[104:107], a[16:19], v[228:231]
    s_lshl_b32 s75, s91, 18
    ds_read_b64_tr_b16 a[184:185], v12 offset:9216
    v_cvt_pk_bf16_f32 v216, v216, v217
    v_mfma_f32_16x16x32_bf16 v[228:231], a[108:111], a[48:51], v[228:231]
    s_add_u32 s6, s84, s75
    ds_read_b64_tr_b16 a[186:187], v12 offset:9728
    v_cvt_pk_bf16_f32 v217, v218, v219
    v_mfma_f32_16x16x32_bf16 v[236:239], a[108:111], a[52:55], v[236:239]
    s_addc_u32 s7, s85, 0
    ds_read_b64_tr_b16 a[188:189], v12 offset:10240
    global_load_lds_dwordx4 v2, s[4:5] offset:0
    v_mfma_f32_16x16x32_bf16 v[236:239], a[104:107], a[20:23], v[236:239]
    s_mul_i32 s75, s91, s68
    ds_read_b64_tr_b16 a[190:191], v12 offset:10752
    v_cvt_pk_bf16_f32 v218, v220, v221
    v_mfma_f32_16x16x32_bf16 v[52:55], a[104:107], a[24:27], v[52:55]
    s_add_u32 s8, s86, s75
    ds_read_b128 a[144:147], v13 offset:12288
    v_cvt_pk_bf16_f32 v219, v222, v223
    v_mfma_f32_16x16x32_bf16 v[52:55], a[108:111], a[56:59], v[52:55]
    s_addc_u32 s9, s87, 0
    v_accvgpr_read_b32 v18, a248
    v_accvgpr_read_b32 v19, a249
    v_mfma_f32_16x16x32_bf16 v[60:63], a[108:111], a[60:63], v[60:63]
    s_mul_i32 s75, s91, s69
    v_cvt_pk_bf16_f32 v212, v18, v19
    v_accvgpr_read_b32 v14, a250
    v_mfma_f32_16x16x32_bf16 v[60:63], a[104:107], a[28:31], v[60:63]
    s_add_u32 s10, s88, s75
    v_accvgpr_read_b32 v15, a251
    v_cvt_pk_bf16_f32 v213, v14, v15
    v_mfma_f32_16x16x32_bf16 v[176:179], a[0:3], a[112:115], v[176:179]
    s_addc_u32 s11, s89, 0
    global_load_lds_dwordx4 v3, s[4:5] offset:1024
    v_accvgpr_read_b32 v18, a252
    v_mfma_f32_16x16x32_bf16 v[176:179], a[32:35], a[116:119], v[176:179]
    s_add_u32 s70, s70, 16384
    v_accvgpr_read_b32 v19, a253
    v_cvt_pk_bf16_f32 v214, v18, v19
    v_mfma_f32_16x16x32_bf16 v[180:183], a[36:39], a[116:119], v[180:183]
    s_and_b32 s70, s70, 0xffff
    v_accvgpr_read_b32 v14, a254
    v_accvgpr_read_b32 v15, a255
    v_mfma_f32_16x16x32_bf16 v[180:183], a[4:7], a[112:115], v[180:183]
    v_cvt_pk_bf16_f32 v215, v14, v15
    v_cvt_pk_bf16_f32 v220, v40, v41
    v_mfma_f32_16x16x32_bf16 v[112:115], a[8:11], a[112:115], v[112:115]
    v_cvt_pk_bf16_f32 v221, v42, v43
    v_cvt_pk_bf16_f32 v222, v44, v45
    v_mfma_f32_16x16x32_bf16 v[112:115], a[40:43], a[116:119], v[112:115]
    v_cvt_pk_bf16_f32 v223, v46, v47
    v_mul_f32 v152, s93, v152
    v_mfma_f32_16x16x32_bf16 v[116:119], a[44:47], a[116:119], v[116:119]
    global_load_lds_dwordx4 v4, s[4:5] offset:2048
    v_mul_f32 v153, s93, v153
    v_mfma_f32_16x16x32_bf16 v[116:119], a[12:15], a[112:115], v[116:119]
    v_cvt_pk_bf16_f32 v152, v152, v153
    v_mul_f32 v154, s93, v154
    v_mfma_f32_16x16x32_bf16 v[240:243], a[112:115], a[16:19], v[240:243]
    v_mul_f32 v155, s93, v155
    v_cvt_pk_bf16_f32 v153, v154, v155
    v_mfma_f32_16x16x32_bf16 v[240:243], a[116:119], a[48:51], v[240:243]
    v_mul_f32 v156, s93, v156
    v_mul_f32 v157, s93, v157
    v_mfma_f32_16x16x32_bf16 v[248:251], a[116:119], a[52:55], v[248:251]
    v_cvt_pk_bf16_f32 v154, v156, v157
    v_mul_f32 v158, s93, v158
    v_mfma_f32_16x16x32_bf16 v[248:251], a[112:115], a[20:23], v[248:251]
    v_mul_f32 v159, s93, v159
    v_cvt_pk_bf16_f32 v155, v158, v159
    v_mfma_f32_16x16x32_bf16 v[64:67], a[112:115], a[24:27], v[64:67]
    global_load_lds_dwordx4 v5, s[4:5] offset:3072
    v_mul_f32 v88, s93, v88
    v_mfma_f32_16x16x32_bf16 v[64:67], a[116:119], a[56:59], v[64:67]
    s_add_u32 s4, s4, s94
    v_mul_f32 v89, s93, v89
    v_cvt_pk_bf16_f32 v156, v88, v89
    v_mfma_f32_16x16x32_bf16 v[72:75], a[116:119], a[60:63], v[72:75]
    s_addc_u32 s5, s5, 0
    v_mul_f32 v90, s93, v90
    v_mul_f32 v91, s93, v91
    v_mfma_f32_16x16x32_bf16 v[72:75], a[112:115], a[28:31], v[72:75]
L_wk3:
    s_cbranch_execz L_wk7
    s_add_u32 s24, s60, 33554432
    v_cvt_pk_bf16_f32 v157, v90, v91
    v_mul_f32 v92, s93, v92
    v_mfma_f32_16x16x32_bf16 v[184:187], a[0:3], a[192:195], v[184:187]
    s_addc_u32 s25, s61, 0
    v_mul_f32 v93, s93, v93
    v_cvt_pk_bf16_f32 v158, v92, v93
    v_mfma_f32_16x16x32_bf16 v[184:187], a[32:35], a[196:199], v[184:187]
    s_mov_b32 s26, 18874368
    v_mul_f32 v94, s93, v94
    v_mul_f32 v95, s93, v95
    v_mfma_f32_16x16x32_bf16 v[188:191], a[36:39], a[196:199], v[188:191]
    s_mov_b32 s27, 0x20000
    v_cvt_pk_bf16_f32 v159, v94, v95
    v_cvt_pk_bf16_f32 v224, v224, v225
    v_mfma_f32_16x16x32_bf16 v[188:191], a[4:7], a[192:195], v[188:191]
    s_and_b32 s34, s3, 1
    v_cvt_pk_bf16_f32 v225, v226, v227
    v_cvt_pk_bf16_f32 v226, v228, v229
    v_mfma_f32_16x16x32_bf16 v[120:123], a[8:11], a[192:195], v[120:123]
    s_lshl_b32 s78, s34, 3
    v_cvt_pk_bf16_f32 v227, v230, v231
    v_cvt_pk_bf16_f32 v232, v232, v233
    v_mfma_f32_16x16x32_bf16 v[120:123], a[40:43], a[196:199], v[120:123]
    s_add_u32 s78, s78, s33
    v_cvt_pk_bf16_f32 v233, v234, v235
    v_cvt_pk_bf16_f32 v234, v236, v237
    v_mfma_f32_16x16x32_bf16 v[124:127], a[44:47], a[196:199], v[124:127]
    s_lshl_b32 s78, s78, 14
    v_cvt_pk_bf16_f32 v235, v238, v239
    v_cvt_pk_bf16_f32 v228, v48, v49
    v_mfma_f32_16x16x32_bf16 v[124:127], a[12:15], a[192:195], v[124:127]
    s_add_u32 s79, s78, 0x40000
    v_cvt_pk_bf16_f32 v229, v50, v51
    v_cvt_pk_bf16_f32 v230, v52, v53
    v_mfma_f32_16x16x32_bf16 v[244:247], a[192:195], a[16:19], v[244:247]
    s_add_u32 s80, s78, 0x80000
    v_cvt_pk_bf16_f32 v231, v54, v55
    v_cvt_pk_bf16_f32 v236, v56, v57
    v_mfma_f32_16x16x32_bf16 v[244:247], a[196:199], a[48:51], v[244:247]
    s_add_u32 s81, s78, 0xc0000
    v_cvt_pk_bf16_f32 v237, v58, v59
    v_cvt_pk_bf16_f32 v238, v60, v61
    v_mfma_f32_16x16x32_bf16 v[252:255], a[196:199], a[52:55], v[252:255]
    v_cvt_pk_bf16_f32 v239, v62, v63
    v_mul_f32 v160, s93, v160
    v_mfma_f32_16x16x32_bf16 v[252:255], a[192:195], a[20:23], v[252:255]
    v_mul_f32 v161, s93, v161
    v_cvt_pk_bf16_f32 v160, v160, v161
    v_mfma_f32_16x16x32_bf16 v[68:71], a[192:195], a[24:27], v[68:71]
    v_mul_f32 v162, s93, v162
    v_mul_f32 v163, s93, v163
    v_mfma_f32_16x16x32_bf16 v[68:71], a[196:199], a[56:59], v[68:71]
    v_cvt_pk_bf16_f32 v161, v162, v163
    v_mul_f32 v164, s93, v164
    v_mfma_f32_16x16x32_bf16 v[76:79], a[196:199], a[60:63], v[76:79]
    v_mul_f32 v165, s93, v165
    v_cvt_pk_bf16_f32 v162, v164, v165
    v_mfma_f32_16x16x32_bf16 v[76:79], a[192:195], a[28:31], v[76:79]
    s_waitcnt lgkmcnt(0)
    v_mul_f32 v166, s93, v166
    v_mul_f32 v167, s93, v167
    v_mfma_f32_16x16x32_bf16 a[0:3], a[148:151], a[128:131], 0
    s_waitcnt vmcnt(21)
    v_cvt_pk_bf16_f32 v163, v166, v167
    v_mul_f32 v96, s93, v96
    v_mfma_f32_16x16x32_bf16 a[32:35], a[148:151], a[132:135], 0
    s_barrier
    v_mul_f32 v97, s93, v97
    v_cvt_pk_bf16_f32 v164, v96, v97
    v_mfma_f32_16x16x32_bf16 a[64:67], a[148:151], a[136:139], 0
    s_add_u32 m0, s65, 4096
    ds_read_b128 a[192:195], v11 offset:0
    global_load_lds_dwordx4 v2, s[4:5] offset:0
    v_mfma_f32_16x16x32_bf16 a[96:99], a[148:151], a[140:143], 0
    ds_read_b128 a[196:199], v11 offset:8192
    v_mul_f32 v98, s93, v98
    v_mfma_f32_16x16x32_bf16 a[4:7], a[152:155], a[128:131], 0
    ds_read_b128 a[200:203], v11 offset:16384
    v_mul_f32 v99, s93, v99
    v_mfma_f32_16x16x32_bf16 a[36:39], a[152:155], a[132:135], 0
    ds_read_b128 a[204:207], v11 offset:24576
    global_load_lds_dwordx4 v3, s[4:5] offset:1024
    v_mfma_f32_16x16x32_bf16 a[68:71], a[152:155], a[136:139], 0
    ds_read_b64_tr_b16 a[236:237], v86 offset:16384
    v_cvt_pk_bf16_f32 v165, v98, v99
    v_mfma_f32_16x16x32_bf16 a[100:103], a[152:155], a[140:143], 0
    ds_read_b64_tr_b16 a[238:239], v86 offset:17408
    v_mul_f32 v100, s93, v100
    v_mfma_f32_16x16x32_bf16 a[8:11], a[156:159], a[128:131], 0
    ds_read_b64_tr_b16 a[240:241], v87 offset:16384
    global_load_lds_dwordx4 v4, s[4:5] offset:2048
    v_mfma_f32_16x16x32_bf16 a[40:43], a[156:159], a[132:135], 0
    ds_read_b64_tr_b16 a[242:243], v87 offset:17408
    v_add_u32 v11, 65536, v10
    v_mfma_f32_16x16x32_bf16 a[72:75], a[156:159], a[136:139], 0
    ds_read_b64_tr_b16 a[244:245], v12 offset:24576
    v_mul_f32 v101, s93, v101
    v_mfma_f32_16x16x32_bf16 a[104:107], a[156:159], a[140:143], 0
    ds_read_b64_tr_b16 a[246:247], v12 offset:25088
    global_load_lds_dwordx4 v5, s[4:5] offset:3072
    v_mfma_f32_16x16x32_bf16 a[12:15], a[160:163], a[128:131], 0
    s_add_u32 s90, s90, 1
    ds_read_b64_tr_b16 a[248:249], v12 offset:25600
    v_cvt_pk_bf16_f32 v166, v100, v101
    v_mfma_f32_16x16x32_bf16 a[44:47], a[160:163], a[132:135], 0
    s_and_b32 s90, s90, 7
    ds_read_b64_tr_b16 a[250:251], v12 offset:26112
    v_mul_f32 v102, s93, v102
    v_mfma_f32_16x16x32_bf16 a[76:79], a[160:163], a[136:139], 0
    s_lshl_b32 s75, s90, 7
    ds_read_b64_tr_b16 a[252:253], v12 offset:26624
    v_mul_f32 v103, s93, v103
    v_mfma_f32_16x16x32_bf16 a[108:111], a[160:163], a[140:143], 0
    s_add_u32 s4, s82, s75
    ds_read_b64_tr_b16 a[254:255], v12 offset:27136
    v_cvt_pk_bf16_f32 v167, v102, v103
    v_mfma_f32_16x16x32_bf16 a[16:19], a[164:167], a[128:131], 0
    s_addc_u32 s5, s83, 0
    ds_read_b128 a[208:211], v13 offset:28672
    v_cvt_pk_bf16_f32 v240, v240, v241
    v_mfma_f32_16x16x32_bf16 a[48:51], a[164:167], a[132:135], 0
    s_add_u32 s65, s65, 32768
    v_cvt_pk_bf16_f32 v241, v242, v243
    v_cvt_pk_bf16_f32 v242, v244, v245
    v_mfma_f32_16x16x32_bf16 a[80:83], a[164:167], a[136:139], 0
    s_cmp_ge_u32 s65, 163840
    v_cvt_pk_bf16_f32 v243, v246, v247
    v_cvt_pk_bf16_f32 v248, v248, v249
    v_mfma_f32_16x16x32_bf16 a[112:115], a[164:167], a[140:143], 0
    s_cselect_b32 s75, 98304, 0
    v_cvt_pk_bf16_f32 v249, v250, v251
    v_cvt_pk_bf16_f32 v250, v252, v253
    v_mfma_f32_16x16x32_bf16 a[20:23], a[168:171], a[128:131], 0
    s_sub_u32 s65, s65, s75
    v_cvt_pk_bf16_f32 v251, v254, v255
    v_cvt_pk_bf16_f32 v244, v64, v65
    v_mfma_f32_16x16x32_bf16 a[52:55], a[168:171], a[132:135], 0
    v_cvt_pk_bf16_f32 v245, v66, v67
    v_cvt_pk_bf16_f32 v246, v68, v69
    v_mfma_f32_16x16x32_bf16 a[84:87], a[168:171], a[136:139], 0
    v_cvt_pk_bf16_f32 v247, v70, v71
    v_cvt_pk_bf16_f32 v252, v72, v73
    v_mfma_f32_16x16x32_bf16 a[116:119], a[168:171], a[140:143], 0
    s_waitcnt lgkmcnt(0)
    v_cvt_pk_bf16_f32 v253, v74, v75
    v_cvt_pk_bf16_f32 v254, v76, v77
    v_mfma_f32_16x16x32_bf16 a[24:27], a[172:175], a[128:131], 0
    s_waitcnt vmcnt(12)
    v_cmp_gt_u32 vcc, 0x100, v23
    v_cvt_pk_bf16_f32 v255, v78, v79
    v_mfma_f32_16x16x32_bf16 a[24:27], a[236:239], a[192:195], a[24:27]
    s_barrier
    v_and_b32 v8, s62, v1
    v_mul_f32 v168, s93, v168
    v_mfma_f32_16x16x32_bf16 a[56:59], a[236:239], a[196:199], 0
    s_add_u32 m0, s70, s71
    ds_read_b128 v[88:91], v11 offset:0
    global_load_lds_dwordx4 v6, s[6:7]
    v_mfma_f32_16x16x32_bf16 a[56:59], a[172:175], a[132:135], a[56:59]
    s_cbranch_vccnz L_e0_slow
L_e0_ok:
    ds_read_b128 v[92:95], v11 offset:8192
    v_mul_f32 v169, s93, v169
    v_mfma_f32_16x16x32_bf16 a[88:91], a[172:175], a[136:139], 0
    s_mov_b64 s[86:87], s[16:17]
    ds_read_b128 v[96:99], v11 offset:16384
    v_cvt_pk_bf16_f32 v168, v168, v169
    v_mfma_f32_16x16x32_bf16 a[88:91], a[236:239], a[200:203], a[88:91]
    s_mov_b32 s68, 3072
    ds_read_b128 v[100:103], v11 offset:24576
    v_mul_f32 v170, s93, v170
    v_mfma_f32_16x16x32_bf16 a[120:123], a[236:239], a[204:207], 0
    s_mul_i32 s34, s91, 3072
    ds_read_b64_tr_b16 a[212:213], v80 offset:16384
    global_load_lds_dwordx4 v7, s[6:7] offset:1024
    v_mfma_f32_16x16x32_bf16 a[120:123], a[172:175], a[140:143], a[120:123]
    s_add_u32 s8, s86, s34
    ds_read_b64_tr_b16 a[214:215], v80 offset:17408
    v_mul_f32 v171, s93, v171
    v_mfma_f32_16x16x32_bf16 a[28:31], a[176:179], a[128:131], 0
    s_addc_u32 s9, s87, 0
    ds_read_b64_tr_b16 a[216:217], v81 offset:16384
    v_xor_b32 v11, 64, v11
    v_mfma_f32_16x16x32_bf16 a[28:31], a[240:243], a[192:195], a[28:31]
    ds_read_b64_tr_b16 a[218:219], v81 offset:17408
    v_cvt_pk_bf16_f32 v169, v170, v171
    v_mfma_f32_16x16x32_bf16 a[60:63], a[240:243], a[196:199], 0
    s_add_u32 m0, s70, s72
    ds_read_b64_tr_b16 a[220:221], v82 offset:16384
    global_load_lds_dwordx4 v8, s[8:9] sc1
    v_mfma_f32_16x16x32_bf16 a[60:63], a[176:179], a[132:135], a[60:63]
    ds_read_b64_tr_b16 a[222:223], v82 offset:17408
    v_mul_f32 v172, s93, v172
    v_mfma_f32_16x16x32_bf16 a[92:95], a[176:179], a[136:139], 0
    ds_read_b64_tr_b16 a[224:225], v83 offset:16384
    v_mul_f32 v173, s93, v173
    v_mfma_f32_16x16x32_bf16 a[92:95], a[240:243], a[200:203], a[92:95]
    ds_read_b64_tr_b16 a[226:227], v83 offset:17408
    v_cvt_pk_bf16_f32 v170, v172, v173
    v_mfma_f32_16x16x32_bf16 a[124:127], a[240:243], a[204:207], 0
    s_add_u32 m0, s70, s73
    ds_read_b64_tr_b16 a[228:229], v84 offset:16384
    global_load_lds_dwordx4 v9, s[10:11]
    v_mfma_f32_16x16x32_bf16 a[124:127], a[176:179], a[140:143], a[124:127]
    s_add_u32 m0, s65, 0
    ds_read_b64_tr_b16 a[230:231], v84 offset:17408
    v_mul_f32 v174, s93, v174
    v_mfma_f32_16x16x32_bf16 v[24:27], a[180:183], a[128:131], 0
    s_add_u32 s91, s91, 1
    ds_read_b64_tr_b16 a[232:233], v85 offset:16384
    v_mul_f32 v175, s93, v175
    v_mfma_f32_16x16x32_bf16 v[24:27], a[244:247], a[192:195], v[24:27]
    s_and_b32 s91, s91, 15
    ds_read_b64_tr_b16 a[234:235], v85 offset:17408
    v_cvt_pk_bf16_f32 v171, v174, v175
    v_mfma_f32_16x16x32_bf16 v[36:39], a[244:247], a[196:199], 0
    s_lshl_b32 s75, s91, 18
    ds_read_b64_tr_b16 a[148:149], v80 offset:32768
    global_load_lds_dwordx4 v2, s[4:5] offset:0
    v_mfma_f32_16x16x32_bf16 v[36:39], a[180:183], a[132:135], v[36:39]
    s_add_u32 s6, s84, s75
    ds_read_b64_tr_b16 a[150:151], v80 offset:33792
    v_mul_f32 v104, s93, v104
    v_mfma_f32_16x16x32_bf16 v[48:51], a[180:183], a[136:139], 0
    s_addc_u32 s7, s85, 0
    ds_read_b64_tr_b16 a[152:153], v81 offset:32768
    v_mul_f32 v105, s93, v105
    v_mfma_f32_16x16x32_bf16 v[48:51], a[244:247], a[200:203], v[48:51]
    s_mul_i32 s75, s91, s68
    ds_read_b64_tr_b16 a[154:155], v81 offset:33792
    v_cvt_pk_bf16_f32 v172, v104, v105
    v_mfma_f32_16x16x32_bf16 v[60:63], a[244:247], a[204:207], 0
    s_add_u32 s8, s86, s75
    ds_read_b64_tr_b16 a[156:157], v82 offset:32768
    global_load_lds_dwordx4 v3, s[4:5] offset:1024
    v_mfma_f32_16x16x32_bf16 v[60:63], a[180:183], a[140:143], v[60:63]
    s_addc_u32 s9, s87, 0
    ds_read_b64_tr_b16 a[158:159], v82 offset:33792
    v_mul_f32 v106, s93, v106
    v_mfma_f32_16x16x32_bf16 v[28:31], a[184:187], a[128:131], 0
    s_mul_i32 s75, s91, s69
    ds_read_b64_tr_b16 a[160:161], v83 offset:32768
    v_mul_f32 v107, s93, v107
    v_mfma_f32_16x16x32_bf16 v[28:31], a[248:251], a[192:195], v[28:31]
    s_add_u32 s10, s88, s75
    ds_read_b64_tr_b16 a[162:163], v83 offset:33792
    v_cvt_pk_bf16_f32 v173, v106, v107
    v_mfma_f32_16x16x32_bf16 v[40:43], a[248:251], a[196:199], 0
    s_addc_u32 s11, s89, 0
    ds_read_b64_tr_b16 a[164:165], v84 offset:32768
    global_load_lds_dwordx4 v4, s[4:5] offset:2048
    v_mfma_f32_16x16x32_bf16 v[40:43], a[184:187], a[132:135], v[40:43]
    s_add_u32 s70, s70, 16384
    ds_read_b64_tr_b16 a[166:167], v84 offset:33792
    v_mul_f32 v108, s93, v108
    v_mfma_f32_16x16x32_bf16 v[52:55], a[184:187], a[136:139], 0
    s_and_b32 s70, s70, 0xffff
    ds_read_b64_tr_b16 a[168:169], v85 offset:32768
    v_mul_f32 v109, s93, v109
    v_mfma_f32_16x16x32_bf16 v[52:55], a[248:251], a[200:203], v[52:55]
    ds_read_b64_tr_b16 a[170:171], v85 offset:33792
    v_cvt_pk_bf16_f32 v174, v108, v109
    v_mfma_f32_16x16x32_bf16 v[64:67], a[248:251], a[204:207], 0
    global_load_lds_dwordx4 v5, s[4:5] offset:3072
    v_mul_f32 v110, s93, v110
    v_mfma_f32_16x16x32_bf16 v[64:67], a[184:187], a[140:143], v[64:67]
    s_add_u32 s4, s4, s94
    v_mul_f32 v111, s93, v111
    v_cvt_pk_bf16_f32 v175, v110, v111
    v_mfma_f32_16x16x32_bf16 v[72:75], a[184:187], a[144:147], 0
    s_addc_u32 s5, s5, 0
    v_mul_f32 v176, s93, v176
    v_mul_f32 v177, s93, v177
    v_mfma_f32_16x16x32_bf16 v[72:75], a[248:251], a[208:211], v[72:75]
    s_lshl_b32 s34, s32, 3
    v_cvt_pk_bf16_f32 v176, v176, v177
    v_mul_f32 v178, s93, v178
    v_mfma_f32_16x16x32_bf16 v[32:35], a[192:195], a[252:255], 0
    s_add_u32 s34, s34, s33
    v_mul_f32 v179, s93, v179
    v_cvt_pk_bf16_f32 v177, v178, v179
    v_mfma_f32_16x16x32_bf16 v[32:35], a[128:131], a[188:191], v[32:35]
    s_lshl_b32 s34, s34, 2
    v_mul_f32 v180, s93, v180
    v_mul_f32 v181, s93, v181
    v_mfma_f32_16x16x32_bf16 v[44:47], a[132:135], a[188:191], 0
    s_add_u32 s34, s34, s3
    v_cvt_pk_bf16_f32 v178, v180, v181
    v_mul_f32 v182, s93, v182
    v_mfma_f32_16x16x32_bf16 v[44:47], a[196:199], a[252:255], v[44:47]
    s_lshl_b32 s95, s34, 7
    v_mul_f32 v183, s93, v183
    v_cvt_pk_bf16_f32 v179, v182, v183
    v_mfma_f32_16x16x32_bf16 v[56:59], a[200:203], a[252:255], 0
    s_lshl_b32 s34, s34, 11
    v_mul_f32 v112, s93, v112
    v_mul_f32 v113, s93, v113
    v_mfma_f32_16x16x32_bf16 v[56:59], a[136:139], a[188:191], v[56:59]
    s_add_u32 s18, s36, s34
    v_cvt_pk_bf16_f32 v180, v112, v113
    v_mul_f32 v114, s93, v114
    v_mfma_f32_16x16x32_bf16 v[68:71], a[140:143], a[188:191], 0
    s_addc_u32 s19, s37, 0
    v_mul_f32 v115, s93, v115
    v_cvt_pk_bf16_f32 v181, v114, v115
    v_mfma_f32_16x16x32_bf16 v[68:71], a[204:207], a[252:255], v[68:71]
    v_mul_f32 v116, s93, v116
    v_mul_f32 v117, s93, v117
    v_mfma_f32_16x16x32_bf16 v[76:79], a[208:211], a[252:255], 0
    v_cvt_pk_bf16_f32 v182, v116, v117
    v_mul_f32 v118, s93, v118
    v_mfma_f32_16x16x32_bf16 v[76:79], a[144:147], a[188:191], v[76:79]
    s_waitcnt lgkmcnt(0)
    v_mul_f32 v119, s93, v119
    v_cvt_pk_bf16_f32 v183, v118, v119
    v_mfma_f32_16x16x32_bf16 a[0:3], a[212:215], a[192:195], a[0:3]
    s_waitcnt vmcnt(16)
    v_mul_f32 v184, s93, v184
    v_mul_f32 v185, s93, v185
    v_mfma_f32_16x16x32_bf16 a[0:3], a[148:151], v[88:91], a[0:3]
    s_barrier
    v_cvt_pk_bf16_f32 v184, v184, v185
    v_mul_f32 v186, s93, v186
    v_mfma_f32_16x16x32_bf16 a[32:35], a[148:151], v[92:95], a[32:35]
    s_add_u32 m0, s70, s71
    ds_read_b128 a[128:131], v11 offset:0
    global_load_lds_dwordx4 v6, s[6:7]
    v_mfma_f32_16x16x32_bf16 a[32:35], a[212:215], a[196:199], a[32:35]
    ds_read_b128 a[132:135], v11 offset:8192
    v_mul_f32 v187, s93, v187
    v_mfma_f32_16x16x32_bf16 a[64:67], a[212:215], a[200:203], a[64:67]
    ds_read_b128 a[136:139], v11 offset:16384
    v_cvt_pk_bf16_f32 v185, v186, v187
    v_mfma_f32_16x16x32_bf16 a[64:67], a[148:151], v[96:99], a[64:67]
    ds_read_b128 a[140:143], v11 offset:24576
    v_mul_f32 v188, s93, v188
    v_mfma_f32_16x16x32_bf16 a[96:99], a[148:151], v[100:103], a[96:99]
    ds_read_b64_tr_b16 a[172:173], v86 offset:32768
    global_load_lds_dwordx4 v7, s[6:7] offset:1024
    v_mfma_f32_16x16x32_bf16 a[96:99], a[212:215], a[204:207], a[96:99]
    ds_read_b64_tr_b16 a[174:175], v86 offset:33792
    v_mul_f32 v189, s93, v189
    v_mfma_f32_16x16x32_bf16 a[4:7], a[216:219], a[192:195], a[4:7]
    ds_read_b64_tr_b16 a[176:177], v87 offset:32768
    v_add_u32 v11, 98304, v10
    v_mfma_f32_16x16x32_bf16 a[4:7], a[152:155], v[88:91], a[4:7]
    ds_read_b64_tr_b16 a[178:179], v87 offset:33792
    v_cvt_pk_bf16_f32 v186, v188, v189
    v_mfma_f32_16x16x32_bf16 a[36:39], a[152:155], v[92:95], a[36:39]
    s_add_u32 m0, s70, s72
    ds_read_b64_tr_b16 a[180:181], v12 offset:40960
    global_load_lds_dwordx4 v8, s[8:9] sc1
    v_mfma_f32_16x16x32_bf16 a[36:39], a[216:219], a[196:199], a[36:39]
    ds_read_b64_tr_b16 a[182:183], v12 offset:41472
    v_mul_f32 v190, s93, v190
    v_mfma_f32_16x16x32_bf16 a[68:71], a[216:219], a[200:203], a[68:71]
    ds_read_b64_tr_b16 a[184:185], v12 offset:41984
    v_mul_f32 v191, s93, v191
    v_mfma_f32_16x16x32_bf16 a[68:71], a[152:155], v[96:99], a[68:71]
    ds_read_b64_tr_b16 a[186:187], v12 offset:42496
    v_cvt_pk_bf16_f32 v187, v190, v191
    v_mfma_f32_16x16x32_bf16 a[100:103], a[152:155], v[100:103], a[100:103]
    s_add_u32 m0, s70, s73
    ds_read_b64_tr_b16 a[188:189], v12 offset:43008
    global_load_lds_dwordx4 v9, s[10:11]
    v_mfma_f32_16x16x32_bf16 a[100:103], a[216:219], a[204:207], a[100:103]
    s_add_u32 m0, s65, 4096
    ds_read_b64_tr_b16 a[190:191], v12 offset:43520
    v_mul_f32 v120, s93, v120
    v_mfma_f32_16x16x32_bf16 a[8:11], a[220:223], a[192:195], a[8:11]
    s_add_u32 s91, s91, 1
    ds_read_b128 a[144:147], v13 offset:45056
    v_mul_f32 v121, s93, v121
    v_mfma_f32_16x16x32_bf16 a[8:11], a[156:159], v[88:91], a[8:11]
    s_and_b32 s91, s91, 15
    ds_read_b64_tr_b16 a[236:237], v86 offset:49152
    v_cvt_pk_bf16_f32 v188, v120, v121
    v_mfma_f32_16x16x32_bf16 a[40:43], a[156:159], v[92:95], a[40:43]
    s_lshl_b32 s75, s91, 18
    ds_read_b64_tr_b16 a[238:239], v86 offset:50176
    global_load_lds_dwordx4 v2, s[4:5] offset:0
    v_mfma_f32_16x16x32_bf16 a[40:43], a[220:223], a[196:199], a[40:43]
    s_add_u32 s6, s84, s75
    ds_read_b64_tr_b16 a[240:241], v87 offset:49152
    v_mul_f32 v122, s93, v122
    v_mfma_f32_16x16x32_bf16 a[72:75], a[220:223], a[200:203], a[72:75]
    s_addc_u32 s7, s85, 0
    ds_read_b64_tr_b16 a[242:243], v87 offset:50176
    v_mul_f32 v123, s93, v123
    v_mfma_f32_16x16x32_bf16 a[72:75], a[156:159], v[96:99], a[72:75]
    s_mul_i32 s75, s91, s68
    ds_read_b64_tr_b16 a[244:245], v12 offset:57344
    v_cvt_pk_bf16_f32 v189, v122, v123
    v_mfma_f32_16x16x32_bf16 a[104:107], a[156:159], v[100:103], a[104:107]
    s_add_u32 s8, s86, s75
    ds_read_b64_tr_b16 a[246:247], v12 offset:57856
    global_load_lds_dwordx4 v3, s[4:5] offset:1024
    v_mfma_f32_16x16x32_bf16 a[104:107], a[220:223], a[204:207], a[104:107]
    s_addc_u32 s9, s87, 0
    ds_read_b64_tr_b16 a[248:249], v12 offset:58368
    v_mul_f32 v124, s93, v124
    v_mfma_f32_16x16x32_bf16 a[12:15], a[224:227], a[192:195], a[12:15]
    s_mul_i32 s75, s91, s69
    ds_read_b64_tr_b16 a[250:251], v12 offset:58880
    v_mul_f32 v125, s93, v125
    v_mfma_f32_16x16x32_bf16 a[12:15], a[160:163], v[88:91], a[12:15]
    s_add_u32 s10, s88, s75
    ds_read_b64_tr_b16 a[252:253], v12 offset:59392
    v_cvt_pk_bf16_f32 v190, v124, v125
    v_mfma_f32_16x16x32_bf16 a[44:47], a[160:163], v[92:95], a[44:47]
    s_addc_u32 s11, s89, 0
    ds_read_b64_tr_b16 a[254:255], v12 offset:59904
    global_load_lds_dwordx4 v4, s[4:5] offset:2048
    v_mfma_f32_16x16x32_bf16 a[44:47], a[224:227], a[196:199], a[44:47]
    s_add_u32 s70, s70, 16384
    ds_read_b128 a[208:211], v13 offset:61440
    v_mul_f32 v126, s93, v126
    v_mfma_f32_16x16x32_bf16 a[76:79], a[224:227], a[200:203], a[76:79]
    s_and_b32 s70, s70, 0xffff
    v_mul_f32 v127, s93, v127
    v_cvt_pk_bf16_f32 v191, v126, v127
    v_mfma_f32_16x16x32_bf16 a[76:79], a[160:163], v[96:99], a[76:79]
    v_mfma_f32_16x16x32_bf16 a[108:111], a[160:163], v[100:103], a[108:111]
    global_load_lds_dwordx4 v5, s[4:5] offset:3072
    v_mfma_f32_16x16x32_bf16 a[108:111], a[224:227], a[204:207], a[108:111]
    s_add_u32 s90, s90, 1
    v_mfma_f32_16x16x32_bf16 a[16:19], a[228:231], a[192:195], a[16:19]
    s_and_b32 s90, s90, 7
    v_mfma_f32_16x16x32_bf16 a[16:19], a[164:167], v[88:91], a[16:19]
    s_lshl_b32 s75, s90, 7
    v_mfma_f32_16x16x32_bf16 a[48:51], a[164:167], v[92:95], a[48:51]
    s_add_u32 s4, s82, s75
    v_mfma_f32_16x16x32_bf16 a[48:51], a[228:231], a[196:199], a[48:51]
    s_addc_u32 s5, s83, 0
    v_mfma_f32_16x16x32_bf16 a[80:83], a[228:231], a[200:203], a[80:83]
    s_add_u32 s65, s65, 32768
    buffer_store_dwordx4 v[128:131], v20, s[20:23], s78 offen offset:0
    v_mfma_f32_16x16x32_bf16 a[80:83], a[164:167], v[96:99], a[80:83]
    s_cmp_ge_u32 s65, 163840
    v_mfma_f32_16x16x32_bf16 a[112:115], a[164:167], v[100:103], a[112:115]
    s_cselect_b32 s75, 98304, 0
    v_mfma_f32_16x16x32_bf16 a[112:115], a[228:231], a[204:207], a[112:115]
    s_sub_u32 s65, s65, s75
    v_mfma_f32_16x16x32_bf16 a[20:23], a[232:235], a[192:195], a[20:23]
    buffer_store_dwordx4 v[132:135], v20, s[20:23], s78 offen offset:1024
    v_mfma_f32_16x16x32_bf16 a[20:23], a[168:171], v[88:91], a[20:23]
    v_mfma_f32_16x16x32_bf16 a[52:55], a[168:171], v[92:95], a[52:55]
    v_mfma_f32_16x16x32_bf16 a[52:55], a[232:235], a[196:199], a[52:55]
    v_mfma_f32_16x16x32_bf16 a[84:87], a[232:235], a[200:203], a[84:87]
    v_mfma_f32_16x16x32_bf16 a[84:87], a[168:171], v[96:99], a[84:87]
    v_mfma_f32_16x16x32_bf16 a[116:119], a[168:171], v[100:103], a[116:119]
    v_mfma_f32_16x16x32_bf16 a[116:119], a[232:235], a[204:207], a[116:119]
    s_waitcnt lgkmcnt(0)
    v_mfma_f32_16x16x32_bf16 a[24:27], a[172:175], v[88:91], a[24:27]
    s_waitcnt vmcnt(14)
    v_mfma_f32_16x16x32_bf16 a[24:27], a[236:239], a[128:131], a[24:27]
    s_barrier
    v_mfma_f32_16x16x32_bf16 a[56:59], a[236:239], a[132:135], a[56:59]
    s_add_u32 m0, s70, s71
    ds_read_b128 a[192:195], v11 offset:0
    global_load_lds_dwordx4 v6, s[6:7]
    v_mfma_f32_16x16x32_bf16 a[56:59], a[172:175], v[92:95], a[56:59]
    ds_read_b128 a[196:199], v11 offset:8192
    v_mfma_f32_16x16x32_bf16 a[88:91], a[172:175], v[96:99], a[88:91]
    ds_read_b128 a[200:203], v11 offset:16384
    v_mfma_f32_16x16x32_bf16 a[88:91], a[236:239], a[136:139], a[88:91]
    ds_read_b128 a[204:207], v11 offset:24576
    v_mfma_f32_16x16x32_bf16 a[120:123], a[236:239], a[140:143], a[120:123]
    ds_read_b64_tr_b16 a[212:213], v80 offset:49152
    global_load_lds_dwordx4 v7, s[6:7] offset:1024
    v_mfma_f32_16x16x32_bf16 a[120:123], a[172:175], v[100:103], a[120:123]
    ds_read_b64_tr_b16 a[214:215], v80 offset:50176
    v_mfma_f32_16x16x32_bf16 a[28:31], a[176:179], v[88:91], a[28:31]
    ds_read_b64_tr_b16 a[216:217], v81 offset:49152
    v_xor_b32 v11, 64, v11
    v_mfma_f32_16x16x32_bf16 a[28:31], a[240:243], a[128:131], a[28:31]
    ds_read_b64_tr_b16 a[218:219], v81 offset:50176
    v_mfma_f32_16x16x32_bf16 a[60:63], a[240:243], a[132:135], a[60:63]
    s_add_u32 m0, s70, s72
    ds_read_b64_tr_b16 a[220:221], v82 offset:49152
    global_load_lds_dwordx4 v8, s[8:9] sc1
    v_mfma_f32_16x16x32_bf16 a[60:63], a[176:179], v[92:95], a[60:63]
    ds_read_b64_tr_b16 a[222:223], v82 offset:50176
    v_mfma_f32_16x16x32_bf16 a[92:95], a[176:179], v[96:99], a[92:95]
    ds_read_b64_tr_b16 a[224:225], v83 offset:49152
    v_mfma_f32_16x16x32_bf16 a[92:95], a[240:243], a[136:139], a[92:95]
    ds_read_b64_tr_b16 a[226:227], v83 offset:50176
    v_mfma_f32_16x16x32_bf16 a[124:127], a[240:243], a[140:143], a[124:127]
    s_add_u32 m0, s70, s73
    ds_read_b64_tr_b16 a[228:229], v84 offset:49152
    global_load_lds_dwordx4 v9, s[10:11]
    v_mfma_f32_16x16x32_bf16 a[124:127], a[176:179], v[100:103], a[124:127]
    s_add_u32 m0, s65, 0
    ds_read_b64_tr_b16 a[230:231], v84 offset:50176
    v_mfma_f32_16x16x32_bf16 v[24:27], a[180:183], v[88:91], v[24:27]
    s_add_u32 s91, s91, 1
    ds_read_b64_tr_b16 a[232:233], v85 offset:49152
    v_mfma_f32_16x16x32_bf16 v[24:27], a[244:247], a[128:131], v[24:27]
    s_and_b32 s91, s91, 15
    ds_read_b64_tr_b16 a[234:235], v85 offset:50176
    v_mfma_f32_16x16x32_bf16 v[36:39], a[244:247], a[132:135], v[36:39]
    s_lshl_b32 s75, s91, 18
    ds_read_b64_tr_b16 a[148:149], v80 offset:0
    global_load_lds_dwordx4 v2, s[4:5] offset:0
    v_mfma_f32_16x16x32_bf16 v[36:39], a[180:183], v[92:95], v[36:39]
    s_add_u32 s6, s84, s75
    ds_read_b64_tr_b16 a[150:151], v80 offset:1024
    v_mfma_f32_16x16x32_bf16 v[48:51], a[180:183], v[96:99], v[48:51]
    s_addc_u32 s7, s85, 0
    ds_read_b64_tr_b16 a[152:153], v81 offset:0
    v_mfma_f32_16x16x32_bf16 v[48:51], a[244:247], a[136:139], v[48:51]
    s_mul_i32 s75, s91, s68
    ds_read_b64_tr_b16 a[154:155], v81 offset:1024
    v_mfma_f32_16x16x32_bf16 v[60:63], a[244:247], a[140:143], v[60:63]
    s_add_u32 s8, s86, s75
    ds_read_b64_tr_b16 a[156:157], v82 offset:0
    global_load_lds_dwordx4 v3, s[4:5] offset:1024
    v_mfma_f32_16x16x32_bf16 v[60:63], a[180:183], v[100:103], v[60:63]
    s_addc_u32 s9, s87, 0
    ds_read_b64_tr_b16 a[158:159], v82 offset:1024
    v_mfma_f32_16x16x32_bf16 v[28:31], a[184:187], v[88:91], v[28:31]
    s_mul_i32 s75, s91, s69
    ds_read_b64_tr_b16 a[160:161], v83 offset:0
    v_mfma_f32_16x16x32_bf16 v[28:31], a[248:251], a[128:131], v[28:31]
    s_add_u32 s10, s88, s75
    ds_read_b64_tr_b16 a[162:163], v83 offset:1024
    v_mfma_f32_16x16x32_bf16 v[40:43], a[248:251], a[132:135], v[40:43]
    s_addc_u32 s11, s89, 0
    ds_read_b64_tr_b16 a[164:165], v84 offset:0
    global_load_lds_dwordx4 v4, s[4:5] offset:2048
    v_mfma_f32_16x16x32_bf16 v[40:43], a[184:187], v[92:95], v[40:43]
    s_add_u32 s70, s70, 16384
    ds_read_b64_tr_b16 a[166:167], v84 offset:1024
    v_mfma_f32_16x16x32_bf16 v[52:55], a[184:187], v[96:99], v[52:55]
    s_and_b32 s70, s70, 0xffff
    ds_read_b64_tr_b16 a[168:169], v85 offset:0
    v_mfma_f32_16x16x32_bf16 v[52:55], a[248:251], a[136:139], v[52:55]
    ds_read_b64_tr_b16 a[170:171], v85 offset:1024
    v_mfma_f32_16x16x32_bf16 v[64:67], a[248:251], a[140:143], v[64:67]
    global_load_lds_dwordx4 v5, s[4:5] offset:3072
    v_mfma_f32_16x16x32_bf16 v[64:67], a[184:187], v[100:103], v[64:67]
    s_add_u32 s4, s4, s94
    v_mfma_f32_16x16x32_bf16 v[72:75], a[184:187], a[144:147], v[72:75]
    s_addc_u32 s5, s5, 0
    global_load_dwordx4 v[104:107], v1, s[18:19]
    v_mfma_f32_16x16x32_bf16 v[72:75], a[248:251], a[208:211], v[72:75]
    s_add_u32 s28, s60, 61865984
    v_mfma_f32_16x16x32_bf16 v[32:35], a[128:131], a[252:255], v[32:35]
    s_addc_u32 s29, s61, 0
    v_mfma_f32_16x16x32_bf16 v[32:35], v[88:91], a[188:191], v[32:35]
    s_mov_b32 s30, 128
    global_load_dwordx4 v[108:111], v1, s[18:19] offset:1024
    v_mfma_f32_16x16x32_bf16 v[44:47], v[92:95], a[188:191], v[44:47]
    s_mov_b32 s31, 0x20000
    v_mfma_f32_16x16x32_bf16 v[44:47], a[132:135], a[252:255], v[44:47]
    s_add_u32 s28, s28, s95
    v_mfma_f32_16x16x32_bf16 v[56:59], a[136:139], a[252:255], v[56:59]
    s_addc_u32 s29, s29, 0
    global_load_dwordx4 v[112:115], v1, s[54:55]
    v_mfma_f32_16x16x32_bf16 v[56:59], v[96:99], a[188:191], v[56:59]
    v_mfma_f32_16x16x32_bf16 v[68:71], v[100:103], a[188:191], v[68:71]
    v_mfma_f32_16x16x32_bf16 v[68:71], a[140:143], a[252:255], v[68:71]
    v_mfma_f32_16x16x32_bf16 v[76:79], a[208:211], a[252:255], v[76:79]
    v_mfma_f32_16x16x32_bf16 v[76:79], a[144:147], a[188:191], v[76:79]
    s_waitcnt lgkmcnt(0)
    v_mfma_f32_16x16x32_bf16 a[0:3], a[212:215], a[128:131], a[0:3]
    s_waitcnt vmcnt(17)
    v_mfma_f32_16x16x32_bf16 a[0:3], a[148:151], a[192:195], a[0:3]
    s_barrier
    v_mfma_f32_16x16x32_bf16 a[32:35], a[148:151], a[196:199], a[32:35]
    s_add_u32 m0, s70, s71
    ds_read_b128 v[88:91], v11 offset:0
    global_load_lds_dwordx4 v6, s[6:7]
    v_mfma_f32_16x16x32_bf16 a[32:35], a[212:215], a[132:135], a[32:35]
    ds_read_b128 v[92:95], v11 offset:8192
    v_mfma_f32_16x16x32_bf16 a[64:67], a[212:215], a[136:139], a[64:67]
    ds_read_b128 v[96:99], v11 offset:16384
    v_mfma_f32_16x16x32_bf16 a[64:67], a[148:151], a[200:203], a[64:67]
    ds_read_b128 v[100:103], v11 offset:24576
    v_mfma_f32_16x16x32_bf16 a[96:99], a[148:151], a[204:207], a[96:99]
    ds_read_b64_tr_b16 a[172:173], v86 offset:0
    global_load_lds_dwordx4 v7, s[6:7] offset:1024
    v_mfma_f32_16x16x32_bf16 a[96:99], a[212:215], a[140:143], a[96:99]
    ds_read_b64_tr_b16 a[174:175], v86 offset:1024
    v_mfma_f32_16x16x32_bf16 a[4:7], a[216:219], a[128:131], a[4:7]
    ds_read_b64_tr_b16 a[176:177], v87 offset:0
    v_add_u32 v11, 131072, v10
    v_mfma_f32_16x16x32_bf16 a[4:7], a[152:155], a[192:195], a[4:7]
    ds_read_b64_tr_b16 a[178:179], v87 offset:1024
    v_mfma_f32_16x16x32_bf16 a[36:39], a[152:155], a[196:199], a[36:39]
    s_add_u32 m0, s70, s72
    ds_read_b64_tr_b16 a[180:181], v12 offset:8192
    global_load_lds_dwordx4 v8, s[8:9] sc1
    v_mfma_f32_16x16x32_bf16 a[36:39], a[216:219], a[132:135], a[36:39]
    ds_read_b64_tr_b16 a[182:183], v12 offset:8704
    v_mfma_f32_16x16x32_bf16 a[68:71], a[216:219], a[136:139], a[68:71]
L_wk4:
    s_cbranch_execz L_wk8
    ds_read_b64_tr_b16 a[184:185], v12 offset:9216
    v_mfma_f32_16x16x32_bf16 a[68:71], a[152:155], a[200:203], a[68:71]
    ds_read_b64_tr_b16 a[186:187], v12 offset:9728
    v_mfma_f32_16x16x32_bf16 a[100:103], a[152:155], a[204:207], a[100:103]
    s_add_u32 m0, s70, s73
    ds_read_b64_tr_b16 a[188:189], v12 offset:10240
    global_load_lds_dwordx4 v9, s[10:11]
    v_mfma_f32_16x16x32_bf16 a[100:103], a[216:219], a[140:143], a[100:103]
    s_add_u32 m0, s65, 4096
    ds_read_b64_tr_b16 a[190:191], v12 offset:10752
    v_mfma_f32_16x16x32_bf16 a[8:11], a[220:223], a[128:131], a[8:11]
    s_add_u32 s91, s91, 1
    ds_read_b128 a[144:147], v13 offset:12288
    v_mfma_f32_16x16x32_bf16 a[8:11], a[156:159], a[192:195], a[8:11]
    s_and_b32 s91, s91, 15
    ds_read_b64_tr_b16 a[236:237], v86 offset:16384
    v_mfma_f32_16x16x32_bf16 a[40:43], a[156:159], a[196:199], a[40:43]
    s_lshl_b32 s75, s91, 18
    ds_read_b64_tr_b16 a[238:239], v86 offset:17408
    global_load_lds_dwordx4 v2, s[4:5] offset:0
    v_mfma_f32_16x16x32_bf16 a[40:43], a[220:223], a[132:135], a[40:43]
    s_add_u32 s6, s84, s75
    ds_read_b64_tr_b16 a[240:241], v87 offset:16384
    v_mfma_f32_16x16x32_bf16 a[72:75], a[220:223], a[136:139], a[72:75]
    s_addc_u32 s7, s85, 0
    ds_read_b64_tr_b16 a[242:243], v87 offset:17408
    v_mfma_f32_16x16x32_bf16 a[72:75], a[156:159], a[200:203], a[72:75]
    s_mul_i32 s75, s91, s68
    ds_read_b64_tr_b16 a[244:245], v12 offset:24576
    v_mfma_f32_16x16x32_bf16 a[104:107], a[156:159], a[204:207], a[104:107]
    s_add_u32 s8, s86, s75
    ds_read_b64_tr_b16 a[246:247], v12 offset:25088
    global_load_lds_dwordx4 v3, s[4:5] offset:1024
    v_mfma_f32_16x16x32_bf16 a[104:107], a[220:223], a[140:143], a[104:107]
    s_addc_u32 s9, s87, 0
    ds_read_b64_tr_b16 a[248:249], v12 offset:25600
    v_mfma_f32_16x16x32_bf16 a[12:15], a[224:227], a[128:131], a[12:15]
    s_mul_i32 s75, s91, s69
    ds_read_b64_tr_b16 a[250:251], v12 offset:26112
    v_mfma_f32_16x16x32_bf16 a[12:15], a[160:163], a[192:195], a[12:15]
    s_add_u32 s10, s88, s75
    ds_read_b64_tr_b16 a[252:253], v12 offset:26624
    v_mfma_f32_16x16x32_bf16 a[44:47], a[160:163], a[196:199], a[44:47]
    s_addc_u32 s11, s89, 0
    ds_read_b64_tr_b16 a[254:255], v12 offset:27136
    global_load_lds_dwordx4 v4, s[4:5] offset:2048
    v_mfma_f32_16x16x32_bf16 a[44:47], a[224:227], a[132:135], a[44:47]
    s_add_u32 s70, s70, 16384
    ds_read_b128 a[208:211], v13 offset:28672
    v_mfma_f32_16x16x32_bf16 a[76:79], a[224:227], a[136:139], a[76:79]
    s_and_b32 s70, s70, 0xffff
    v_mfma_f32_16x16x32_bf16 a[76:79], a[160:163], a[200:203], a[76:79]
    v_mfma_f32_16x16x32_bf16 a[108:111], a[160:163], a[204:207], a[108:111]
    global_load_lds_dwordx4 v5, s[4:5] offset:3072
    v_mfma_f32_16x16x32_bf16 a[108:111], a[224:227], a[140:143], a[108:111]
    s_add_u32 s90, s90, 1
    v_mfma_f32_16x16x32_bf16 a[16:19], a[228:231], a[128:131], a[16:19]
    s_and_b32 s90, s90, 7
    v_mfma_f32_16x16x32_bf16 a[16:19], a[164:167], a[192:195], a[16:19]
    s_lshl_b32 s75, s90, 7
    v_mfma_f32_16x16x32_bf16 a[48:51], a[164:167], a[196:199], a[48:51]
    s_add_u32 s4, s82, s75
    v_mfma_f32_16x16x32_bf16 a[48:51], a[228:231], a[132:135], a[48:51]
    s_addc_u32 s5, s83, 0
    v_mfma_f32_16x16x32_bf16 a[80:83], a[228:231], a[136:139], a[80:83]
    s_add_u32 s65, s65, 32768
    buffer_store_dwordx4 v[136:139], v21, s[20:23], s78 offen offset:0
    v_mfma_f32_16x16x32_bf16 a[80:83], a[164:167], a[200:203], a[80:83]
    s_cmp_ge_u32 s65, 163840
    v_mfma_f32_16x16x32_bf16 a[112:115], a[164:167], a[204:207], a[112:115]
    s_cselect_b32 s75, 98304, 0
    v_mfma_f32_16x16x32_bf16 a[112:115], a[228:231], a[140:143], a[112:115]
    s_sub_u32 s65, s65, s75
    v_mfma_f32_16x16x32_bf16 a[20:23], a[232:235], a[128:131], a[20:23]
    buffer_store_dwordx4 v[140:143], v21, s[20:23], s78 offen offset:1024
    v_mfma_f32_16x16x32_bf16 a[20:23], a[168:171], a[192:195], a[20:23]
    v_mfma_f32_16x16x32_bf16 a[52:55], a[168:171], a[196:199], a[52:55]
    v_mfma_f32_16x16x32_bf16 a[52:55], a[232:235], a[132:135], a[52:55]
    v_mfma_f32_16x16x32_bf16 a[84:87], a[232:235], a[136:139], a[84:87]
    v_mfma_f32_16x16x32_bf16 a[84:87], a[168:171], a[200:203], a[84:87]
    v_mfma_f32_16x16x32_bf16 a[116:119], a[168:171], a[204:207], a[116:119]
    v_mfma_f32_16x16x32_bf16 a[116:119], a[232:235], a[140:143], a[116:119]
    s_waitcnt lgkmcnt(0)
    v_mfma_f32_16x16x32_bf16 a[24:27], a[172:175], a[192:195], a[24:27]
    s_waitcnt vmcnt(17)
    v_mfma_f32_16x16x32_bf16 a[24:27], a[236:239], v[88:91], a[24:27]
    s_barrier
    v_mfma_f32_16x16x32_bf16 a[56:59], a[236:239], v[92:95], a[56:59]
    s_add_u32 m0, s70, s71
    ds_read_b128 a[128:131], v11 offset:0
    global_load_lds_dwordx4 v6, s[6:7]
    v_mfma_f32_16x16x32_bf16 a[56:59], a[172:175], a[196:199], a[56:59]
    ds_read_b128 a[132:135], v11 offset:8192
    v_mfma_f32_16x16x32_bf16 a[88:91], a[172:175], a[200:203], a[88:91]
    ds_read_b128 a[136:139], v11 offset:16384
    v_mfma_f32_16x16x32_bf16 a[88:91], a[236:239], v[96:99], a[88:91]
    ds_read_b128 a[140:143], v11 offset:24576
    v_mfma_f32_16x16x32_bf16 a[120:123], a[236:239], v[100:103], a[120:123]
    ds_read_b64_tr_b16 a[212:213], v80 offset:16384
    global_load_lds_dwordx4 v7, s[6:7] offset:1024
    v_mfma_f32_16x16x32_bf16 a[120:123], a[172:175], a[204:207], a[120:123]
    ds_read_b64_tr_b16 a[214:215], v80 offset:17408
    v_mfma_f32_16x16x32_bf16 a[28:31], a[176:179], a[192:195], a[28:31]
    ds_read_b64_tr_b16 a[216:217], v81 offset:16384
    v_xor_b32 v11, 64, v11
    v_mfma_f32_16x16x32_bf16 a[28:31], a[240:243], v[88:91], a[28:31]
    ds_read_b64_tr_b16 a[218:219], v81 offset:17408
    v_mfma_f32_16x16x32_bf16 a[60:63], a[240:243], v[92:95], a[60:63]
    s_add_u32 m0, s70, s72
    ds_read_b64_tr_b16 a[220:221], v82 offset:16384
    global_load_lds_dwordx4 v8, s[8:9] sc1
    v_mfma_f32_16x16x32_bf16 a[60:63], a[176:179], a[196:199], a[60:63]
    ds_read_b64_tr_b16 a[222:223], v82 offset:17408
    v_mfma_f32_16x16x32_bf16 a[92:95], a[176:179], a[200:203], a[92:95]
    ds_read_b64_tr_b16 a[224:225], v83 offset:16384
    v_mfma_f32_16x16x32_bf16 a[92:95], a[240:243], v[96:99], a[92:95]
    ds_read_b64_tr_b16 a[226:227], v83 offset:17408
    v_mfma_f32_16x16x32_bf16 a[124:127], a[240:243], v[100:103], a[124:127]
    s_add_u32 m0, s70, s73
    ds_read_b64_tr_b16 a[228:229], v84 offset:16384
    global_load_lds_dwordx4 v9, s[10:11]
    v_mfma_f32_16x16x32_bf16 a[124:127], a[176:179], a[204:207], a[124:127]
    s_add_u32 m0, s65, 0
    ds_read_b64_tr_b16 a[230:231], v84 offset:17408
    v_mfma_f32_16x16x32_bf16 v[24:27], a[180:183], a[192:195], v[24:27]
    s_add_u32 s91, s91, 1
    ds_read_b64_tr_b16 a[232:233], v85 offset:16384
    v_mfma_f32_16x16x32_bf16 v[24:27], a[244:247], v[88:91], v[24:27]
    s_and_b32 s91, s91, 15
    ds_read_b64_tr_b16 a[234:235], v85 offset:17408
    v_mfma_f32_16x16x32_bf16 v[36:39], a[244:247], v[92:95], v[36:39]
    s_lshl_b32 s75, s91, 18
    ds_read_b64_tr_b16 a[148:149], v80 offset:32768
    global_load_lds_dwordx4 v2, s[4:5] offset:0
    v_mfma_f32_16x16x32_bf16 v[36:39], a[180:183], a[196:199], v[36:39]
    s_add_u32 s6, s84, s75
    ds_read_b64_tr_b16 a[150:151], v80 offset:33792
    v_mfma_f32_16x16x32_bf16 v[48:51], a[180:183], a[200:203], v[48:51]
    s_addc_u32 s7, s85, 0
    ds_read_b64_tr_b16 a[152:153], v81 offset:32768
    v_mfma_f32_16x16x32_bf16 v[48:51], a[244:247], v[96:99], v[48:51]
    s_mul_i32 s75, s91, s68
    ds_read_b64_tr_b16 a[154:155], v81 offset:33792
    v_mfma_f32_16x16x32_bf16 v[60:63], a[244:247], v[100:103], v[60:63]
    s_add_u32 s8, s86, s75
    ds_read_b64_tr_b16 a[156:157], v82 offset:32768
    global_load_lds_dwordx4 v3, s[4:5] offset:1024
    v_mfma_f32_16x16x32_bf16 v[60:63], a[180:183], a[204:207], v[60:63]
    s_addc_u32 s9, s87, 0
    ds_read_b64_tr_b16 a[158:159], v82 offset:33792
    v_mfma_f32_16x16x32_bf16 v[28:31], a[184:187], a[192:195], v[28:31]
    s_mul_i32 s75, s91, s69
    ds_read_b64_tr_b16 a[160:161], v83 offset:32768
    v_mfma_f32_16x16x32_bf16 v[28:31], a[248:251], v[88:91], v[28:31]
    s_add_u32 s10, s88, s75
    ds_read_b64_tr_b16 a[162:163], v83 offset:33792
    v_mfma_f32_16x16x32_bf16 v[40:43], a[248:251], v[92:95], v[40:43]
    s_addc_u32 s11, s89, 0
    ds_read_b64_tr_b16 a[164:165], v84 offset:32768
    global_load_lds_dwordx4 v4, s[4:5] offset:2048
    v_mfma_f32_16x16x32_bf16 v[40:43], a[184:187], a[196:199], v[40:43]
    s_add_u32 s70, s70, 16384
    ds_read_b64_tr_b16 a[166:167], v84 offset:33792
    v_mfma_f32_16x16x32_bf16 v[52:55], a[184:187], a[200:203], v[52:55]
    s_and_b32 s70, s70, 0xffff
    ds_read_b64_tr_b16 a[168:169], v85 offset:32768
    v_mfma_f32_16x16x32_bf16 v[52:55], a[248:251], v[96:99], v[52:55]
    ds_read_b64_tr_b16 a[170:171], v85 offset:33792
    v_mfma_f32_16x16x32_bf16 v[64:67], a[248:251], v[100:103], v[64:67]
    global_load_lds_dwordx4 v5, s[4:5] offset:3072
    v_mfma_f32_16x16x32_bf16 v[64:67], a[184:187], a[204:207], v[64:67]
    s_add_u32 s4, s4, s94
    v_mfma_f32_16x16x32_bf16 v[72:75], a[184:187], a[144:147], v[72:75]
    s_addc_u32 s5, s5, 0
    v_mfma_f32_16x16x32_bf16 v[72:75], a[248:251], a[208:211], v[72:75]
    s_lshl_b32 s34, s32, 11
    v_mfma_f32_16x16x32_bf16 v[32:35], v[88:91], a[252:255], v[32:35]
    s_getreg_b32 s35, hwreg(HW_REG_XCC_ID, 0, 4)
    v_mfma_f32_16x16x32_bf16 v[32:35], a[192:195], a[188:191], v[32:35]
    v_min_u32 v18, 7, v0
    v_lshlrev_b32 v18, 8, v18
    v_mfma_f32_16x16x32_bf16 v[44:47], a[196:199], a[188:191], v[44:47]
    v_add_u32 v18, s34, v18
    v_mov_b32 v23, s35
    v_mfma_f32_16x16x32_bf16 v[44:47], v[92:95], a[252:255], v[44:47]
    v_mfma_f32_16x16x32_bf16 v[56:59], v[96:99], a[252:255], v[56:59]
    v_mfma_f32_16x16x32_bf16 v[56:59], a[200:203], a[188:191], v[56:59]
    v_mfma_f32_16x16x32_bf16 v[68:71], a[204:207], a[188:191], v[68:71]
    v_mfma_f32_16x16x32_bf16 v[68:71], v[100:103], a[252:255], v[68:71]
    v_mfma_f32_16x16x32_bf16 v[76:79], a[208:211], a[252:255], v[76:79]
    global_load_dword v19, v18, s[44:45] sc1
    v_mfma_f32_16x16x32_bf16 v[76:79], a[144:147], a[188:191], v[76:79]
    s_waitcnt lgkmcnt(0)
    v_mfma_f32_16x16x32_bf16 a[0:3], a[212:215], v[88:91], a[0:3]
    s_waitcnt vmcnt(15)
    v_mfma_f32_16x16x32_bf16 a[0:3], a[148:151], a[128:131], a[0:3]
    s_barrier
    v_mfma_f32_16x16x32_bf16 a[32:35], a[148:151], a[132:135], a[32:35]
    s_add_u32 m0, s70, s71
    ds_read_b128 a[192:195], v11 offset:0
    global_load_lds_dwordx4 v6, s[6:7]
    v_mfma_f32_16x16x32_bf16 a[32:35], a[212:215], v[92:95], a[32:35]
    ds_read_b128 a[196:199], v11 offset:8192
    v_lshlrev_b32 v120, 16, v112
    v_mfma_f32_16x16x32_bf16 a[64:67], a[212:215], v[96:99], a[64:67]
    ds_read_b128 a[200:203], v11 offset:16384
    v_and_b32 v121, 0xffff0000, v112
    v_mfma_f32_16x16x32_bf16 a[64:67], a[148:151], a[136:139], a[64:67]
    ds_read_b128 a[204:207], v11 offset:24576
    v_lshlrev_b32 v122, 16, v113
    v_mfma_f32_16x16x32_bf16 a[96:99], a[148:151], a[140:143], a[96:99]
    ds_read_b64_tr_b16 a[172:173], v86 offset:32768
    global_load_lds_dwordx4 v7, s[6:7] offset:1024
    v_mfma_f32_16x16x32_bf16 a[96:99], a[212:215], v[100:103], a[96:99]
    ds_read_b64_tr_b16 a[174:175], v86 offset:33792
    v_and_b32 v123, 0xffff0000, v113
    v_mfma_f32_16x16x32_bf16 a[4:7], a[216:219], v[88:91], a[4:7]
    ds_read_b64_tr_b16 a[176:177], v87 offset:32768
    v_lshlrev_b32 v124, 16, v114
    v_mfma_f32_16x16x32_bf16 a[4:7], a[152:155], a[128:131], a[4:7]
    ds_read_b64_tr_b16 a[178:179], v87 offset:33792
    v_and_b32 v125, 0xffff0000, v114
    v_mfma_f32_16x16x32_bf16 a[36:39], a[152:155], a[132:135], a[36:39]
    s_add_u32 m0, s70, s72
    ds_read_b64_tr_b16 a[180:181], v12 offset:40960
    global_load_lds_dwordx4 v8, s[8:9] sc1
    v_mfma_f32_16x16x32_bf16 a[36:39], a[216:219], v[92:95], a[36:39]
    ds_read_b64_tr_b16 a[182:183], v12 offset:41472
    v_lshlrev_b32 v126, 16, v115
    v_mfma_f32_16x16x32_bf16 a[68:71], a[216:219], v[96:99], a[68:71]
    ds_read_b64_tr_b16 a[184:185], v12 offset:41984
    v_and_b32 v127, 0xffff0000, v115
    v_mfma_f32_16x16x32_bf16 a[68:71], a[152:155], a[136:139], a[68:71]
    ds_read_b64_tr_b16 a[186:187], v12 offset:42496
    v_lshlrev_b32 v114, 16, v104
    v_mfma_f32_16x16x32_bf16 a[100:103], a[152:155], a[140:143], a[100:103]
    s_add_u32 m0, s70, s73
    ds_read_b64_tr_b16 a[188:189], v12 offset:43008
    global_load_lds_dwordx4 v9, s[10:11]
    v_mfma_f32_16x16x32_bf16 a[100:103], a[216:219], v[100:103], a[100:103]
    s_add_u32 m0, s65, 4096
    ds_read_b64_tr_b16 a[190:191], v12 offset:43520
    v_and_b32 v104, 0xffff0000, v104
    v_mfma_f32_16x16x32_bf16 a[8:11], a[220:223], v[88:91], a[8:11]
    s_add_u32 s91, s91, 1
    ds_read_b128 a[144:147], v13 offset:45056
    v_mul_f32 v112, v114, v120
    v_mfma_f32_16x16x32_bf16 a[8:11], a[156:159], a[128:131], a[8:11]
    s_and_b32 s91, s91, 15
    ds_read_b64_tr_b16 a[236:237], v86 offset:49152
    v_fmac_f32 v112, v104, v121
    v_mfma_f32_16x16x32_bf16 a[40:43], a[156:159], a[132:135], a[40:43]
    s_lshl_b32 s75, s91, 18
    ds_read_b64_tr_b16 a[238:239], v86 offset:50176
    global_load_lds_dwordx4 v2, s[4:5] offset:0
    v_mfma_f32_16x16x32_bf16 a[40:43], a[220:223], v[92:95], a[40:43]
    s_add_u32 s6, s84, s75
    ds_read_b64_tr_b16 a[240:241], v87 offset:49152
    v_lshlrev_b32 v114, 16, v105
    v_mfma_f32_16x16x32_bf16 a[72:75], a[220:223], v[96:99], a[72:75]
    s_addc_u32 s7, s85, 0
    ds_read_b64_tr_b16 a[242:243], v87 offset:50176
    v_and_b32 v105, 0xffff0000, v105
    v_mfma_f32_16x16x32_bf16 a[72:75], a[156:159], a[136:139], a[72:75]
    s_mul_i32 s75, s91, s68
    ds_read_b64_tr_b16 a[244:245], v12 offset:57344
    v_fmac_f32 v112, v114, v122
    v_mfma_f32_16x16x32_bf16 a[104:107], a[156:159], a[140:143], a[104:107]
    s_add_u32 s8, s86, s75
    ds_read_b64_tr_b16 a[246:247], v12 offset:57856
    global_load_lds_dwordx4 v3, s[4:5] offset:1024
    v_mfma_f32_16x16x32_bf16 a[104:107], a[220:223], v[100:103], a[104:107]
    s_addc_u32 s9, s87, 0
    ds_read_b64_tr_b16 a[248:249], v12 offset:58368
    v_fmac_f32 v112, v105, v123
    v_mfma_f32_16x16x32_bf16 a[12:15], a[224:227], v[88:91], a[12:15]
    s_mul_i32 s75, s91, s69
    ds_read_b64_tr_b16 a[250:251], v12 offset:58880
    v_lshlrev_b32 v114, 16, v106
    v_mfma_f32_16x16x32_bf16 a[12:15], a[160:163], a[128:131], a[12:15]
    s_add_u32 s10, s88, s75
    ds_read_b64_tr_b16 a[252:253], v12 offset:59392
    v_and_b32 v106, 0xffff0000, v106
    v_mfma_f32_16x16x32_bf16 a[44:47], a[160:163], a[132:135], a[44:47]
    s_addc_u32 s11, s89, 0
    ds_read_b64_tr_b16 a[254:255], v12 offset:59904
    global_load_lds_dwordx4 v4, s[4:5] offset:2048
    v_mfma_f32_16x16x32_bf16 a[44:47], a[224:227], v[92:95], a[44:47]
    s_add_u32 s70, s70, 16384
    ds_read_b128 a[208:211], v13 offset:61440
    v_fmac_f32 v112, v114, v124
    v_mfma_f32_16x16x32_bf16 a[76:79], a[224:227], v[96:99], a[76:79]
    s_and_b32 s70, s70, 0xffff
    v_fmac_f32 v112, v106, v125
    v_lshlrev_b32 v114, 16, v107
    v_mfma_f32_16x16x32_bf16 a[76:79], a[160:163], a[136:139], a[76:79]
    v_and_b32 v107, 0xffff0000, v107
    v_fmac_f32 v112, v114, v126
    v_mfma_f32_16x16x32_bf16 a[108:111], a[160:163], a[140:143], a[108:111]
    global_load_lds_dwordx4 v5, s[4:5] offset:3072
    v_fmac_f32 v112, v107, v127
    v_mfma_f32_16x16x32_bf16 a[108:111], a[224:227], v[100:103], a[108:111]
    s_add_u32 s90, s90, 1
    v_lshlrev_b32 v115, 16, v108
    v_and_b32 v108, 0xffff0000, v108
    v_mfma_f32_16x16x32_bf16 a[16:19], a[228:231], v[88:91], a[16:19]
    s_and_b32 s90, s90, 7
    v_mul_f32 v113, v115, v120
    v_fmac_f32 v113, v108, v121
    v_mfma_f32_16x16x32_bf16 a[16:19], a[164:167], a[128:131], a[16:19]
    s_lshl_b32 s75, s90, 7
    v_lshlrev_b32 v115, 16, v109
    v_and_b32 v109, 0xffff0000, v109
    v_mfma_f32_16x16x32_bf16 a[48:51], a[164:167], a[132:135], a[48:51]
    s_add_u32 s4, s82, s75
    v_fmac_f32 v113, v115, v122
    v_fmac_f32 v113, v109, v123
    v_mfma_f32_16x16x32_bf16 a[48:51], a[228:231], v[92:95], a[48:51]
    s_addc_u32 s5, s83, 0
    v_lshlrev_b32 v115, 16, v110
    v_and_b32 v110, 0xffff0000, v110
    v_mfma_f32_16x16x32_bf16 a[80:83], a[228:231], v[96:99], a[80:83]
    s_add_u32 s65, s65, 32768
    buffer_store_dwordx4 v[192:195], v22, s[20:23], s78 offen offset:0
    v_mfma_f32_16x16x32_bf16 a[80:83], a[164:167], a[136:139], a[80:83]
    s_cmp_ge_u32 s65, 163840
    v_fmac_f32 v113, v115, v124
    v_fmac_f32 v113, v110, v125
    v_mfma_f32_16x16x32_bf16 a[112:115], a[164:167], a[140:143], a[112:115]
    s_cselect_b32 s75, 98304, 0
    v_lshlrev_b32 v115, 16, v111
    v_and_b32 v111, 0xffff0000, v111
    v_mfma_f32_16x16x32_bf16 a[112:115], a[228:231], v[100:103], a[112:115]
    s_sub_u32 s65, s65, s75
    v_fmac_f32 v113, v115, v126
    v_fmac_f32 v113, v111, v127
    v_mfma_f32_16x16x32_bf16 a[20:23], a[232:235], v[88:91], a[20:23]
    buffer_store_dwordx4 v[200:203], v22, s[20:23], s78 offen offset:1024
    v_mfma_f32_16x16x32_bf16 a[20:23], a[168:171], a[128:131], a[20:23]
    v_add_u32 v11, 65536, v10
    v_mfma_f32_16x16x32_bf16 a[52:55], a[168:171], a[132:135], a[52:55]
    v_mfma_f32_16x16x32_bf16 a[52:55], a[232:235], v[92:95], a[52:55]
    v_mfma_f32_16x16x32_bf16 a[84:87], a[232:235], v[96:99], a[84:87]
    v_mfma_f32_16x16x32_bf16 a[84:87], a[168:171], a[136:139], a[84:87]
    v_mfma_f32_16x16x32_bf16 a[116:119], a[168:171], a[140:143], a[116:119]
    v_mfma_f32_16x16x32_bf16 a[116:119], a[232:235], v[100:103], a[116:119]
    s_waitcnt lgkmcnt(0)
    v_mfma_f32_16x16x32_bf16 a[24:27], a[172:175], a[128:131], a[24:27]
    s_waitcnt vmcnt(15)
    v_add_f32_dpp v112, v112, v112 quad_perm:[1,0,3,2] row_mask:0xf bank_mask:0xf
    v_add_f32_dpp v113, v113, v113 quad_perm:[1,0,3,2] row_mask:0xf bank_mask:0xf
    v_mfma_f32_16x16x32_bf16 a[24:27], a[236:239], a[192:195], a[24:27]
    s_barrier
    v_add_f32_dpp v112, v112, v112 quad_perm:[2,3,0,1] row_mask:0xf bank_mask:0xf
    v_add_f32_dpp v113, v113, v113 quad_perm:[2,3,0,1] row_mask:0xf bank_mask:0xf
    v_mfma_f32_16x16x32_bf16 a[56:59], a[236:239], a[196:199], a[56:59]
    s_add_u32 m0, s70, s71
    ds_read_b128 v[88:91], v11 offset:0
    global_load_lds_dwordx4 v6, s[6:7]
    v_mfma_f32_16x16x32_bf16 a[56:59], a[172:175], a[132:135], a[56:59]
    ds_read_b128 v[92:95], v11 offset:8192
    v_mfma_f32_16x16x32_bf16 a[88:91], a[172:175], a[136:139], a[88:91]
    ds_read_b128 v[96:99], v11 offset:16384
    v_mfma_f32_16x16x32_bf16 a[88:91], a[236:239], a[200:203], a[88:91]
    ds_read_b128 v[100:103], v11 offset:24576
    v_mfma_f32_16x16x32_bf16 a[120:123], a[236:239], a[204:207], a[120:123]
    ds_read_b64_tr_b16 a[212:213], v80 offset:49152
    global_load_lds_dwordx4 v7, s[6:7] offset:1024
    v_mfma_f32_16x16x32_bf16 a[120:123], a[172:175], a[140:143], a[120:123]
    ds_read_b64_tr_b16 a[214:215], v80 offset:50176
    v_mfma_f32_16x16x32_bf16 a[28:31], a[176:179], a[128:131], a[28:31]
    ds_read_b64_tr_b16 a[216:217], v81 offset:49152
    v_xor_b32 v11, 64, v11
    v_mfma_f32_16x16x32_bf16 a[28:31], a[240:243], a[192:195], a[28:31]
    ds_read_b64_tr_b16 a[218:219], v81 offset:50176
    v_mfma_f32_16x16x32_bf16 a[60:63], a[240:243], a[196:199], a[60:63]
    s_add_u32 m0, s70, s72
    ds_read_b64_tr_b16 a[220:221], v82 offset:49152
    global_load_lds_dwordx4 v8, s[8:9] sc1
    v_mfma_f32_16x16x32_bf16 a[60:63], a[176:179], a[132:135], a[60:63]
    ds_read_b64_tr_b16 a[222:223], v82 offset:50176
    v_mfma_f32_16x16x32_bf16 a[92:95], a[176:179], a[136:139], a[92:95]
    ds_read_b64_tr_b16 a[224:225], v83 offset:49152
    v_mfma_f32_16x16x32_bf16 a[92:95], a[240:243], a[200:203], a[92:95]
    ds_read_b64_tr_b16 a[226:227], v83 offset:50176
    v_mfma_f32_16x16x32_bf16 a[124:127], a[240:243], a[204:207], a[124:127]
    s_add_u32 m0, s70, s73
    ds_read_b64_tr_b16 a[228:229], v84 offset:49152
    global_load_lds_dwordx4 v9, s[10:11]
    v_mfma_f32_16x16x32_bf16 a[124:127], a[176:179], a[140:143], a[124:127]
    s_add_u32 m0, s65, 0
    ds_read_b64_tr_b16 a[230:231], v84 offset:50176
    v_mfma_f32_16x16x32_bf16 v[24:27], a[180:183], a[128:131], v[24:27]
    s_add_u32 s91, s91, 1
    ds_read_b64_tr_b16 a[232:233], v85 offset:49152
    v_mfma_f32_16x16x32_bf16 v[24:27], a[244:247], a[192:195], v[24:27]
    s_and_b32 s91, s91, 15
    ds_read_b64_tr_b16 a[234:235], v85 offset:50176
    v_mfma_f32_16x16x32_bf16 v[36:39], a[244:247], a[196:199], v[36:39]
    s_lshl_b32 s75, s91, 18
    ds_read_b64_tr_b16 a[148:149], v80 offset:0
    global_load_lds_dwordx4 v2, s[4:5] offset:0
    v_mfma_f32_16x16x32_bf16 v[36:39], a[180:183], a[132:135], v[36:39]
    s_add_u32 s6, s84, s75
    ds_read_b64_tr_b16 a[150:151], v80 offset:1024
    v_mfma_f32_16x16x32_bf16 v[48:51], a[180:183], a[136:139], v[48:51]
    s_addc_u32 s7, s85, 0
    ds_read_b64_tr_b16 a[152:153], v81 offset:0
    v_mfma_f32_16x16x32_bf16 v[48:51], a[244:247], a[200:203], v[48:51]
    s_mul_i32 s75, s91, s68
    ds_read_b64_tr_b16 a[154:155], v81 offset:1024
    v_mfma_f32_16x16x32_bf16 v[60:63], a[244:247], a[204:207], v[60:63]
    s_add_u32 s8, s86, s75
    ds_read_b64_tr_b16 a[156:157], v82 offset:0
    global_load_lds_dwordx4 v3, s[4:5] offset:1024
    v_mfma_f32_16x16x32_bf16 v[60:63], a[180:183], a[140:143], v[60:63]
    s_addc_u32 s9, s87, 0
    ds_read_b64_tr_b16 a[158:159], v82 offset:1024
    v_mfma_f32_16x16x32_bf16 v[28:31], a[184:187], a[128:131], v[28:31]
    s_mul_i32 s75, s91, s69
    ds_read_b64_tr_b16 a[160:161], v83 offset:0
    v_mfma_f32_16x16x32_bf16 v[28:31], a[248:251], a[192:195], v[28:31]
    s_add_u32 s10, s88, s75
    ds_read_b64_tr_b16 a[162:163], v83 offset:1024
    v_mfma_f32_16x16x32_bf16 v[40:43], a[248:251], a[196:199], v[40:43]
    s_addc_u32 s11, s89, 0
    ds_read_b64_tr_b16 a[164:165], v84 offset:0
    global_load_lds_dwordx4 v4, s[4:5] offset:2048
    v_mfma_f32_16x16x32_bf16 v[40:43], a[184:187], a[132:135], v[40:43]
    s_add_u32 s70, s70, 16384
    ds_read_b64_tr_b16 a[166:167], v84 offset:1024
    v_mfma_f32_16x16x32_bf16 v[52:55], a[184:187], a[136:139], v[52:55]
    s_and_b32 s70, s70, 0xffff
    ds_read_b64_tr_b16 a[168:169], v85 offset:0
    v_mfma_f32_16x16x32_bf16 v[52:55], a[248:251], a[200:203], v[52:55]
    ds_read_b64_tr_b16 a[170:171], v85 offset:1024
    v_mfma_f32_16x16x32_bf16 v[64:67], a[248:251], a[204:207], v[64:67]
    global_load_lds_dwordx4 v5, s[4:5] offset:3072
    v_mfma_f32_16x16x32_bf16 v[64:67], a[184:187], a[140:143], v[64:67]
    s_add_u32 s4, s4, s94
    v_add_f32_dpp v112, v112, v112 row_half_mirror row_mask:0xf bank_mask:0xf
    v_add_f32_dpp v113, v113, v113 row_half_mirror row_mask:0xf bank_mask:0xf
    v_mfma_f32_16x16x32_bf16 v[72:75], a[184:187], a[144:147], v[72:75]
    s_addc_u32 s5, s5, 0
    v_add_f32_dpp v112, v112, v112 row_mirror row_mask:0xf bank_mask:0xf
    v_add_f32_dpp v113, v113, v113 row_mirror row_mask:0xf bank_mask:0xf
    v_mfma_f32_16x16x32_bf16 v[72:75], a[248:251], a[208:211], v[72:75]
    v_mov_b32 v114, v112
    v_mov_b32 v115, v113
    v_mfma_f32_16x16x32_bf16 v[32:35], a[192:195], a[252:255], v[32:35]
    v_permlane32_swap_b32 v112, v114
    v_permlane32_swap_b32 v113, v115
    v_mfma_f32_16x16x32_bf16 v[32:35], a[128:131], a[188:191], v[32:35]
    v_add_f32 v112, v112, v114
    v_add_f32 v113, v113, v115
    v_mfma_f32_16x16x32_bf16 v[44:47], a[132:135], a[188:191], v[44:47]
    buffer_store_dwordx4 v[196:199], v22, s[20:23], s78 offen offset:2048
    v_mfma_f32_16x16x32_bf16 v[44:47], a[196:199], a[252:255], v[44:47]
    v_mov_b32 v114, v112
    v_mov_b32 v115, v113
    v_mfma_f32_16x16x32_bf16 v[56:59], a[200:203], a[252:255], v[56:59]
    buffer_store_dwordx4 v[204:207], v22, s[20:23], s78 offen offset:3072
    v_mfma_f32_16x16x32_bf16 v[56:59], a[136:139], a[188:191], v[56:59]
    v_permlane16_swap_b32 v112, v114
    v_permlane16_swap_b32 v113, v115
    v_mfma_f32_16x16x32_bf16 v[68:71], a[140:143], a[188:191], v[68:71]
    v_add_f32 v112, v112, v114
    v_add_f32 v113, v113, v115
    v_mfma_f32_16x16x32_bf16 v[68:71], a[204:207], a[252:255], v[68:71]
    v_mul_f32 v112, 0x3fb8aa3b, v112
    v_mul_f32 v113, 0x3fb8aa3b, v113
    v_mfma_f32_16x16x32_bf16 v[76:79], a[208:211], a[252:255], v[76:79]
    v_min_f32 v112, 0x42800000, v112
    v_min_f32 v113, 0x42800000, v113
    v_mfma_f32_16x16x32_bf16 v[76:79], a[144:147], a[188:191], v[76:79]
    s_waitcnt lgkmcnt(0)
    v_max_f32 v112, 0xc2800000, v112
    v_max_f32 v113, 0xc2800000, v113
    v_mfma_f32_16x16x32_bf16 a[0:3], a[212:215], a[192:195], a[0:3]
    s_waitcnt vmcnt(16)
    v_mfma_f32_16x16x32_bf16 a[0:3], a[148:151], v[88:91], a[0:3]
    s_barrier
    v_and_b32 v19, 0xff, v19
    v_cmp_ne_u32 vcc, v19, v23
    v_mfma_f32_16x16x32_bf16 a[32:35], a[148:151], v[92:95], a[32:35]
    s_add_u32 m0, s70, s71
    ds_read_b128 a[128:131], v11 offset:0
    global_load_lds_dwordx4 v6, s[6:7]
    v_mfma_f32_16x16x32_bf16 a[32:35], a[212:215], a[196:199], a[32:35]
    ds_read_b128 a[132:135], v11 offset:8192
    v_or_b32 v23, 0x100, v23
    v_mfma_f32_16x16x32_bf16 a[64:67], a[212:215], a[200:203], a[64:67]
    ds_read_b128 a[136:139], v11 offset:16384
    v_mfma_f32_16x16x32_bf16 a[64:67], a[148:151], v[96:99], a[64:67]
    ds_read_b128 a[140:143], v11 offset:24576
    v_mfma_f32_16x16x32_bf16 a[96:99], a[148:151], v[100:103], a[96:99]
    ds_read_b64_tr_b16 a[172:173], v86 offset:0
    global_load_lds_dwordx4 v7, s[6:7] offset:1024
    v_mfma_f32_16x16x32_bf16 a[96:99], a[212:215], a[204:207], a[96:99]
    ds_read_b64_tr_b16 a[174:175], v86 offset:1024
    v_mfma_f32_16x16x32_bf16 a[4:7], a[216:219], a[192:195], a[4:7]
    ds_read_b64_tr_b16 a[176:177], v87 offset:0
    v_add_u32 v11, 98304, v10
    v_mfma_f32_16x16x32_bf16 a[4:7], a[152:155], v[88:91], a[4:7]
    ds_read_b64_tr_b16 a[178:179], v87 offset:1024
    v_mfma_f32_16x16x32_bf16 a[36:39], a[152:155], v[92:95], a[36:39]
    s_add_u32 m0, s70, s72
    ds_read_b64_tr_b16 a[180:181], v12 offset:8192
    global_load_lds_dwordx4 v8, s[8:9] sc1
    v_mfma_f32_16x16x32_bf16 a[36:39], a[216:219], a[196:199], a[36:39]
    ds_read_b64_tr_b16 a[182:183], v12 offset:8704
    v_mfma_f32_16x16x32_bf16 a[68:71], a[216:219], a[200:203], a[68:71]
    ds_read_b64_tr_b16 a[184:185], v12 offset:9216
    v_mfma_f32_16x16x32_bf16 a[68:71], a[152:155], v[96:99], a[68:71]
    ds_read_b64_tr_b16 a[186:187], v12 offset:9728
    v_mfma_f32_16x16x32_bf16 a[100:103], a[152:155], v[100:103], a[100:103]
    s_add_u32 m0, s70, s73
    ds_read_b64_tr_b16 a[188:189], v12 offset:10240
    global_load_lds_dwordx4 v9, s[10:11]
    v_mfma_f32_16x16x32_bf16 a[100:103], a[216:219], a[204:207], a[100:103]
    s_add_u32 m0, s65, 4096
    ds_read_b64_tr_b16 a[190:191], v12 offset:10752
    v_mfma_f32_16x16x32_bf16 a[8:11], a[220:223], a[192:195], a[8:11]
    s_add_u32 s91, s91, 1
    ds_read_b128 a[144:147], v13 offset:12288
    v_mfma_f32_16x16x32_bf16 a[8:11], a[156:159], v[88:91], a[8:11]
    s_and_b32 s91, s91, 15
    ds_read_b64_tr_b16 a[236:237], v86 offset:16384
    v_mfma_f32_16x16x32_bf16 a[40:43], a[156:159], v[92:95], a[40:43]
    s_lshl_b32 s75, s91, 18
    ds_read_b64_tr_b16 a[238:239], v86 offset:17408
    global_load_lds_dwordx4 v2, s[4:5] offset:0
    v_mfma_f32_16x16x32_bf16 a[40:43], a[220:223], a[196:199], a[40:43]
    s_add_u32 s6, s84, s75
    ds_read_b64_tr_b16 a[240:241], v87 offset:16384
    v_mfma_f32_16x16x32_bf16 a[72:75], a[220:223], a[200:203], a[72:75]
    s_addc_u32 s7, s85, 0
    ds_read_b64_tr_b16 a[242:243], v87 offset:17408
    v_mfma_f32_16x16x32_bf16 a[72:75], a[156:159], v[96:99], a[72:75]
    s_mul_i32 s75, s91, s68
    ds_read_b64_tr_b16 a[244:245], v12 offset:24576
    v_mfma_f32_16x16x32_bf16 a[104:107], a[156:159], v[100:103], a[104:107]
    s_add_u32 s8, s86, s75
    ds_read_b64_tr_b16 a[246:247], v12 offset:25088
    global_load_lds_dwordx4 v3, s[4:5] offset:1024
    v_mfma_f32_16x16x32_bf16 a[104:107], a[220:223], a[204:207], a[104:107]
    s_addc_u32 s9, s87, 0
    ds_read_b64_tr_b16 a[248:249], v12 offset:25600
    v_mfma_f32_16x16x32_bf16 a[12:15], a[224:227], a[192:195], a[12:15]
    s_mul_i32 s75, s91, s69
    ds_read_b64_tr_b16 a[250:251], v12 offset:26112
    v_mfma_f32_16x16x32_bf16 a[12:15], a[160:163], v[88:91], a[12:15]
    s_add_u32 s10, s88, s75
    ds_read_b64_tr_b16 a[252:253], v12 offset:26624
    v_mfma_f32_16x16x32_bf16 a[44:47], a[160:163], v[92:95], a[44:47]
    s_addc_u32 s11, s89, 0
    ds_read_b64_tr_b16 a[254:255], v12 offset:27136
    global_load_lds_dwordx4 v4, s[4:5] offset:2048
    v_mfma_f32_16x16x32_bf16 a[44:47], a[224:227], a[196:199], a[44:47]
    s_add_u32 s70, s70, 16384
    ds_read_b128 a[208:211], v13 offset:28672
    v_mfma_f32_16x16x32_bf16 a[76:79], a[224:227], a[200:203], a[76:79]
    s_and_b32 s70, s70, 0xffff
    v_mfma_f32_16x16x32_bf16 a[76:79], a[160:163], v[96:99], a[76:79]
    v_mfma_f32_16x16x32_bf16 a[108:111], a[160:163], v[100:103], a[108:111]
    global_load_lds_dwordx4 v5, s[4:5] offset:3072
    v_mfma_f32_16x16x32_bf16 a[108:111], a[224:227], a[204:207], a[108:111]
    s_add_u32 s90, s90, 1
    v_exp_f32 v112, v112
    v_mfma_f32_16x16x32_bf16 a[16:19], a[228:231], a[192:195], a[16:19]
    s_and_b32 s90, s90, 7
    v_exp_f32 v113, v113
    v_mfma_f32_16x16x32_bf16 a[16:19], a[164:167], v[88:91], a[16:19]
    s_lshl_b32 s75, s90, 7
    v_mfma_f32_16x16x32_bf16 a[48:51], a[164:167], v[92:95], a[48:51]
    s_add_u32 s4, s82, s75
    v_mfma_f32_16x16x32_bf16 a[48:51], a[228:231], a[196:199], a[48:51]
    s_addc_u32 s5, s83, 0
    v_mfma_f32_16x16x32_bf16 a[80:83], a[228:231], a[200:203], a[80:83]
    s_add_u32 s65, s65, 32768
    buffer_store_dwordx4 v[144:147], v20, s[20:23], s79 offen offset:0
    v_mfma_f32_16x16x32_bf16 a[80:83], a[164:167], v[96:99], a[80:83]
    s_cmp_ge_u32 s65, 163840
    v_mfma_f32_16x16x32_bf16 a[112:115], a[164:167], v[100:103], a[112:115]
    s_cselect_b32 s75, 98304, 0
    v_mfma_f32_16x16x32_bf16 a[112:115], a[228:231], a[204:207], a[112:115]
    s_sub_u32 s65, s65, s75
    v_mfma_f32_16x16x32_bf16 a[20:23], a[232:235], a[192:195], a[20:23]
    s_or_b32 s74, vcc_lo, vcc_hi
    buffer_store_dwordx4 v[148:151], v20, s[20:23], s79 offen offset:1024
    v_mfma_f32_16x16x32_bf16 a[20:23], a[168:171], v[88:91], a[20:23]
    s_cmp_eq_u32 s3, 0
    v_mfma_f32_16x16x32_bf16 a[52:55], a[168:171], v[92:95], a[52:55]
    s_cselect_b32 s74, s74, 0
    v_mfma_f32_16x16x32_bf16 a[52:55], a[232:235], a[196:199], a[52:55]
L_wk5:
    s_cbranch_execz L_wk9
    v_mfma_f32_16x16x32_bf16 a[84:87], a[232:235], a[200:203], a[84:87]
    v_mfma_f32_16x16x32_bf16 a[84:87], a[168:171], v[96:99], a[84:87]
    v_mfma_f32_16x16x32_bf16 a[116:119], a[168:171], v[100:103], a[116:119]
    v_mfma_f32_16x16x32_bf16 a[116:119], a[232:235], a[204:207], a[116:119]
    s_waitcnt lgkmcnt(0)
    v_mfma_f32_16x16x32_bf16 a[24:27], a[172:175], v[88:91], a[24:27]
    s_waitcnt vmcnt(16)
    v_mfma_f32_16x16x32_bf16 a[24:27], a[236:239], a[128:131], a[24:27]
    s_barrier
    v_mfma_f32_16x16x32_bf16 a[56:59], a[236:239], a[132:135], a[56:59]
    s_add_u32 m0, s70, s71
    ds_read_b128 a[192:195], v11 offset:0
    global_load_lds_dwordx4 v6, s[6:7]
    v_mfma_f32_16x16x32_bf16 a[56:59], a[172:175], v[92:95], a[56:59]
    ds_read_b128 a[196:199], v11 offset:8192
    v_mfma_f32_16x16x32_bf16 a[88:91], a[172:175], v[96:99], a[88:91]
    ds_read_b128 a[200:203], v11 offset:16384
    v_mfma_f32_16x16x32_bf16 a[88:91], a[236:239], a[136:139], a[88:91]
    ds_read_b128 a[204:207], v11 offset:24576
    v_mfma_f32_16x16x32_bf16 a[120:123], a[236:239], a[140:143], a[120:123]
    ds_read_b64_tr_b16 a[212:213], v80 offset:16384
    global_load_lds_dwordx4 v7, s[6:7] offset:1024
    v_mfma_f32_16x16x32_bf16 a[120:123], a[172:175], v[100:103], a[120:123]
    ds_read_b64_tr_b16 a[214:215], v80 offset:17408
    v_mfma_f32_16x16x32_bf16 a[28:31], a[176:179], v[88:91], a[28:31]
    ds_read_b64_tr_b16 a[216:217], v81 offset:16384
    v_xor_b32 v11, 64, v11
    v_mfma_f32_16x16x32_bf16 a[28:31], a[240:243], a[128:131], a[28:31]
    ds_read_b64_tr_b16 a[218:219], v81 offset:17408
    v_mfma_f32_16x16x32_bf16 a[60:63], a[240:243], a[132:135], a[60:63]
    s_add_u32 m0, s70, s72
    ds_read_b64_tr_b16 a[220:221], v82 offset:16384
    global_load_lds_dwordx4 v8, s[8:9] sc1
    v_mfma_f32_16x16x32_bf16 a[60:63], a[176:179], v[92:95], a[60:63]
    ds_read_b64_tr_b16 a[222:223], v82 offset:17408
    v_mfma_f32_16x16x32_bf16 a[92:95], a[176:179], v[96:99], a[92:95]
    ds_read_b64_tr_b16 a[224:225], v83 offset:16384
    v_mfma_f32_16x16x32_bf16 a[92:95], a[240:243], a[136:139], a[92:95]
    ds_read_b64_tr_b16 a[226:227], v83 offset:17408
    v_mfma_f32_16x16x32_bf16 a[124:127], a[240:243], a[140:143], a[124:127]
    s_add_u32 m0, s70, s73
    ds_read_b64_tr_b16 a[228:229], v84 offset:16384
    global_load_lds_dwordx4 v9, s[10:11]
    v_mfma_f32_16x16x32_bf16 a[124:127], a[176:179], v[100:103], a[124:127]
    s_add_u32 m0, s65, 0
    ds_read_b64_tr_b16 a[230:231], v84 offset:17408
    v_mfma_f32_16x16x32_bf16 v[24:27], a[180:183], v[88:91], v[24:27]
    s_add_u32 s91, s91, 1
    ds_read_b64_tr_b16 a[232:233], v85 offset:16384
    v_mfma_f32_16x16x32_bf16 v[24:27], a[244:247], a[128:131], v[24:27]
    s_and_b32 s91, s91, 15
    ds_read_b64_tr_b16 a[234:235], v85 offset:17408
    v_mfma_f32_16x16x32_bf16 v[36:39], a[244:247], a[132:135], v[36:39]
    s_lshl_b32 s75, s91, 18
    ds_read_b64_tr_b16 a[148:149], v80 offset:32768
    global_load_lds_dwordx4 v2, s[4:5] offset:0
    v_mfma_f32_16x16x32_bf16 v[36:39], a[180:183], v[92:95], v[36:39]
    s_add_u32 s6, s84, s75
    ds_read_b64_tr_b16 a[150:151], v80 offset:33792
    v_mfma_f32_16x16x32_bf16 v[48:51], a[180:183], v[96:99], v[48:51]
    s_addc_u32 s7, s85, 0
    ds_read_b64_tr_b16 a[152:153], v81 offset:32768
    v_mfma_f32_16x16x32_bf16 v[48:51], a[244:247], a[136:139], v[48:51]
    s_mul_i32 s75, s91, s68
    ds_read_b64_tr_b16 a[154:155], v81 offset:33792
    v_mfma_f32_16x16x32_bf16 v[60:63], a[244:247], a[140:143], v[60:63]
    s_add_u32 s8, s86, s75
    ds_read_b64_tr_b16 a[156:157], v82 offset:32768
    global_load_lds_dwordx4 v3, s[4:5] offset:1024
    v_mfma_f32_16x16x32_bf16 v[60:63], a[180:183], v[100:103], v[60:63]
    s_addc_u32 s9, s87, 0
    ds_read_b64_tr_b16 a[158:159], v82 offset:33792
    v_mfma_f32_16x16x32_bf16 v[28:31], a[184:187], v[88:91], v[28:31]
    s_mul_i32 s75, s91, s69
    ds_read_b64_tr_b16 a[160:161], v83 offset:32768
    v_mfma_f32_16x16x32_bf16 v[28:31], a[248:251], a[128:131], v[28:31]
    s_add_u32 s10, s88, s75
    ds_read_b64_tr_b16 a[162:163], v83 offset:33792
    v_mfma_f32_16x16x32_bf16 v[40:43], a[248:251], a[132:135], v[40:43]
    s_addc_u32 s11, s89, 0
    ds_read_b64_tr_b16 a[164:165], v84 offset:32768
    global_load_lds_dwordx4 v4, s[4:5] offset:2048
    v_mfma_f32_16x16x32_bf16 v[40:43], a[184:187], v[92:95], v[40:43]
    s_add_u32 s70, s70, 16384
    ds_read_b64_tr_b16 a[166:167], v84 offset:33792
    v_mfma_f32_16x16x32_bf16 v[52:55], a[184:187], v[96:99], v[52:55]
    s_and_b32 s70, s70, 0xffff
    ds_read_b64_tr_b16 a[168:169], v85 offset:32768
    v_mfma_f32_16x16x32_bf16 v[52:55], a[248:251], a[136:139], v[52:55]
    ds_read_b64_tr_b16 a[170:171], v85 offset:33792
    v_mfma_f32_16x16x32_bf16 v[64:67], a[248:251], a[140:143], v[64:67]
    global_load_lds_dwordx4 v5, s[4:5] offset:3072
    v_mfma_f32_16x16x32_bf16 v[64:67], a[184:187], v[100:103], v[64:67]
    s_add_u32 s4, s4, s94
    v_mfma_f32_16x16x32_bf16 v[72:75], a[184:187], a[144:147], v[72:75]
    s_addc_u32 s5, s5, 0
    v_mfma_f32_16x16x32_bf16 v[72:75], a[248:251], a[208:211], v[72:75]
    v_mfma_f32_16x16x32_bf16 v[32:35], a[128:131], a[252:255], v[32:35]
    v_mfma_f32_16x16x32_bf16 v[32:35], v[88:91], a[188:191], v[32:35]
    v_mfma_f32_16x16x32_bf16 v[44:47], v[92:95], a[188:191], v[44:47]
    buffer_store_dwordx2 v[112:113], v12, s[28:31], 0 offen sc1
    v_mfma_f32_16x16x32_bf16 v[44:47], a[132:135], a[252:255], v[44:47]
    v_mfma_f32_16x16x32_bf16 v[56:59], a[136:139], a[252:255], v[56:59]
    v_mfma_f32_16x16x32_bf16 v[56:59], v[96:99], a[188:191], v[56:59]
    v_mfma_f32_16x16x32_bf16 v[68:71], v[100:103], a[188:191], v[68:71]
    v_mfma_f32_16x16x32_bf16 v[68:71], a[140:143], a[252:255], v[68:71]
    v_mfma_f32_16x16x32_bf16 v[76:79], a[208:211], a[252:255], v[76:79]
    v_mfma_f32_16x16x32_bf16 v[76:79], a[144:147], a[188:191], v[76:79]
    s_waitcnt lgkmcnt(0)
    v_mfma_f32_16x16x32_bf16 a[0:3], a[212:215], a[128:131], a[0:3]
    s_waitcnt vmcnt(15)
    v_mfma_f32_16x16x32_bf16 a[0:3], a[148:151], a[192:195], a[0:3]
    s_barrier
    v_mfma_f32_16x16x32_bf16 a[32:35], a[148:151], a[196:199], a[32:35]
    s_cmp_lg_u32 s74, 0
    s_cbranch_scc1 L_s1_wb
L_s1_pub:
    ds_read_b128 v[88:91], v11 offset:0
    buffer_store_dword v23, v1, s[48:51], 0 offen sc1
    v_mfma_f32_16x16x32_bf16 a[32:35], a[212:215], a[132:135], a[32:35]
    s_add_u32 m0, s70, s71
    ds_read_b128 v[92:95], v11 offset:8192
    global_load_lds_dwordx4 v6, s[6:7]
    v_mfma_f32_16x16x32_bf16 a[64:67], a[212:215], a[136:139], a[64:67]
    ds_read_b128 v[96:99], v11 offset:16384
    v_mfma_f32_16x16x32_bf16 a[64:67], a[148:151], a[200:203], a[64:67]
    ds_read_b128 v[100:103], v11 offset:24576
    v_mfma_f32_16x16x32_bf16 a[96:99], a[148:151], a[204:207], a[96:99]
    ds_read_b64_tr_b16 a[172:173], v86 offset:32768
    v_mfma_f32_16x16x32_bf16 a[96:99], a[212:215], a[140:143], a[96:99]
    ds_read_b64_tr_b16 a[174:175], v86 offset:33792
    global_load_lds_dwordx4 v7, s[6:7] offset:1024
    v_mfma_f32_16x16x32_bf16 a[4:7], a[216:219], a[128:131], a[4:7]
    ds_read_b64_tr_b16 a[176:177], v87 offset:32768
    v_add_u32 v11, 131072, v10
    v_mfma_f32_16x16x32_bf16 a[4:7], a[152:155], a[192:195], a[4:7]
    ds_read_b64_tr_b16 a[178:179], v87 offset:33792
    v_mfma_f32_16x16x32_bf16 a[36:39], a[152:155], a[196:199], a[36:39]
    ds_read_b64_tr_b16 a[180:181], v12 offset:40960
    v_mfma_f32_16x16x32_bf16 a[36:39], a[216:219], a[132:135], a[36:39]
    s_add_u32 m0, s70, s72
    ds_read_b64_tr_b16 a[182:183], v12 offset:41472
    global_load_lds_dwordx4 v8, s[8:9] sc1
    v_mfma_f32_16x16x32_bf16 a[68:71], a[216:219], a[136:139], a[68:71]
    ds_read_b64_tr_b16 a[184:185], v12 offset:41984
    v_mfma_f32_16x16x32_bf16 a[68:71], a[152:155], a[200:203], a[68:71]
    ds_read_b64_tr_b16 a[186:187], v12 offset:42496
    v_mfma_f32_16x16x32_bf16 a[100:103], a[152:155], a[204:207], a[100:103]
    ds_read_b64_tr_b16 a[188:189], v12 offset:43008
    v_mfma_f32_16x16x32_bf16 a[100:103], a[216:219], a[140:143], a[100:103]
    s_add_u32 m0, s70, s73
    ds_read_b64_tr_b16 a[190:191], v12 offset:43520
    global_load_lds_dwordx4 v9, s[10:11]
    v_mfma_f32_16x16x32_bf16 a[8:11], a[220:223], a[128:131], a[8:11]
    s_add_u32 m0, s65, 4096
    ds_read_b128 a[144:147], v13 offset:45056
    v_mfma_f32_16x16x32_bf16 a[8:11], a[156:159], a[192:195], a[8:11]
    s_add_u32 s91, s91, 1
    ds_read_b64_tr_b16 a[236:237], v86 offset:49152
    v_mfma_f32_16x16x32_bf16 a[40:43], a[156:159], a[196:199], a[40:43]
    s_and_b32 s91, s91, 15
    ds_read_b64_tr_b16 a[238:239], v86 offset:50176
    v_mfma_f32_16x16x32_bf16 a[40:43], a[220:223], a[132:135], a[40:43]
    s_lshl_b32 s75, s91, 18
    ds_read_b64_tr_b16 a[240:241], v87 offset:49152
    global_load_lds_dwordx4 v2, s[4:5] offset:0
    v_mfma_f32_16x16x32_bf16 a[72:75], a[220:223], a[136:139], a[72:75]
    s_add_u32 s6, s84, s75
    ds_read_b64_tr_b16 a[242:243], v87 offset:50176
    v_mfma_f32_16x16x32_bf16 a[72:75], a[156:159], a[200:203], a[72:75]
    s_addc_u32 s7, s85, 0
    ds_read_b64_tr_b16 a[244:245], v12 offset:57344
    v_mfma_f32_16x16x32_bf16 a[104:107], a[156:159], a[204:207], a[104:107]
    s_mul_i32 s75, s91, s68
    ds_read_b64_tr_b16 a[246:247], v12 offset:57856
    v_mfma_f32_16x16x32_bf16 a[104:107], a[220:223], a[140:143], a[104:107]
    s_add_u32 s8, s86, s75
    ds_read_b64_tr_b16 a[248:249], v12 offset:58368
    global_load_lds_dwordx4 v3, s[4:5] offset:1024
    v_mfma_f32_16x16x32_bf16 a[12:15], a[224:227], a[128:131], a[12:15]
    s_addc_u32 s9, s87, 0
    ds_read_b64_tr_b16 a[250:251], v12 offset:58880
    v_mfma_f32_16x16x32_bf16 a[12:15], a[160:163], a[192:195], a[12:15]
    s_mul_i32 s75, s91, s69
    ds_read_b64_tr_b16 a[252:253], v12 offset:59392
    v_mfma_f32_16x16x32_bf16 a[44:47], a[160:163], a[196:199], a[44:47]
    s_add_u32 s10, s88, s75
    ds_read_b64_tr_b16 a[254:255], v12 offset:59904
    v_mfma_f32_16x16x32_bf16 a[44:47], a[224:227], a[132:135], a[44:47]
    s_addc_u32 s11, s89, 0
    ds_read_b128 a[208:211], v13 offset:61440
    global_load_lds_dwordx4 v4, s[4:5] offset:2048
    v_mfma_f32_16x16x32_bf16 a[76:79], a[224:227], a[136:139], a[76:79]
    s_add_u32 s70, s70, 16384
    v_mfma_f32_16x16x32_bf16 a[76:79], a[160:163], a[200:203], a[76:79]
    s_and_b32 s70, s70, 0xffff
    v_mfma_f32_16x16x32_bf16 a[108:111], a[160:163], a[204:207], a[108:111]
    v_mfma_f32_16x16x32_bf16 a[108:111], a[224:227], a[140:143], a[108:111]
    global_load_lds_dwordx4 v5, s[4:5] offset:3072
    v_mfma_f32_16x16x32_bf16 a[16:19], a[228:231], a[128:131], a[16:19]
    s_add_u32 s90, s90, 1
    v_mfma_f32_16x16x32_bf16 a[16:19], a[164:167], a[192:195], a[16:19]
    s_and_b32 s90, s90, 7
    v_mfma_f32_16x16x32_bf16 a[48:51], a[164:167], a[196:199], a[48:51]
    s_lshl_b32 s75, s90, 7
    v_mfma_f32_16x16x32_bf16 a[48:51], a[228:231], a[132:135], a[48:51]
    s_add_u32 s4, s82, s75
    v_mfma_f32_16x16x32_bf16 a[80:83], a[228:231], a[136:139], a[80:83]
    s_addc_u32 s5, s83, 0
    buffer_store_dwordx4 v[152:155], v21, s[20:23], s79 offen offset:0
    v_mfma_f32_16x16x32_bf16 a[80:83], a[164:167], a[200:203], a[80:83]
    s_add_u32 s65, s65, 32768
    v_mfma_f32_16x16x32_bf16 a[112:115], a[164:167], a[204:207], a[112:115]
    s_cmp_ge_u32 s65, 163840
    v_mfma_f32_16x16x32_bf16 a[112:115], a[228:231], a[140:143], a[112:115]
    s_cselect_b32 s75, 98304, 0
    v_mfma_f32_16x16x32_bf16 a[20:23], a[232:235], a[128:131], a[20:23]
    s_sub_u32 s65, s65, s75
    buffer_store_dwordx4 v[156:159], v21, s[20:23], s79 offen offset:1024
    v_mfma_f32_16x16x32_bf16 a[20:23], a[168:171], a[192:195], a[20:23]
    v_mfma_f32_16x16x32_bf16 a[52:55], a[168:171], a[196:199], a[52:55]
    v_mfma_f32_16x16x32_bf16 a[52:55], a[232:235], a[132:135], a[52:55]
    v_mfma_f32_16x16x32_bf16 a[84:87], a[232:235], a[136:139], a[84:87]
    v_mfma_f32_16x16x32_bf16 a[84:87], a[168:171], a[200:203], a[84:87]
    v_mfma_f32_16x16x32_bf16 a[116:119], a[168:171], a[204:207], a[116:119]
    v_mfma_f32_16x16x32_bf16 a[116:119], a[232:235], a[140:143], a[116:119]
    s_waitcnt lgkmcnt(0)
    v_mfma_f32_16x16x32_bf16 a[24:27], a[172:175], a[192:195], a[24:27]
    s_waitcnt vmcnt(16)
    v_lshrrev_b32 v2, 3, v0
    v_and_b32 v3, 7, v0
    v_mfma_f32_16x16x32_bf16 a[24:27], a[236:239], v[88:91], a[24:27]
    s_barrier
    v_lshlrev_b32 v3, 4, v3
    v_lshl_add_u32 v2, v2, 10, v3
    v_mfma_f32_16x16x32_bf16 a[56:59], a[236:239], v[92:95], a[56:59]
    s_add_u32 m0, s70, s71
    ds_read_b128 a[128:131], v11 offset:0
    global_load_lds_dwordx4 v6, s[6:7]
    v_mfma_f32_16x16x32_bf16 a[56:59], a[172:175], a[196:199], a[56:59]
    ds_read_b128 a[132:135], v11 offset:8192
    v_add_u32 v3, 0x1c00, v2
    v_mfma_f32_16x16x32_bf16 a[88:91], a[172:175], a[200:203], a[88:91]
    ds_read_b128 a[136:139], v11 offset:16384
    v_add_u32 v4, 0x3800, v2
    v_mfma_f32_16x16x32_bf16 a[88:91], a[236:239], v[96:99], a[88:91]
    ds_read_b128 a[140:143], v11 offset:24576
    global_load_lds_dwordx4 v7, s[6:7] offset:1024
    v_mfma_f32_16x16x32_bf16 a[120:123], a[236:239], v[100:103], a[120:123]
    ds_read_b64_tr_b16 a[212:213], v80 offset:49152
    v_add_u32 v5, 0x5400, v2
    v_mfma_f32_16x16x32_bf16 a[120:123], a[172:175], a[204:207], a[120:123]
    ds_read_b64_tr_b16 a[214:215], v80 offset:50176
    v_mfma_f32_16x16x32_bf16 a[28:31], a[176:179], a[192:195], a[28:31]
    s_add_u32 m0, s70, s72
    ds_read_b64_tr_b16 a[216:217], v81 offset:49152
    global_load_lds_dwordx4 v8, s[8:9] sc1
    v_mfma_f32_16x16x32_bf16 a[28:31], a[240:243], v[88:91], a[28:31]
    ds_read_b64_tr_b16 a[218:219], v81 offset:50176
    v_xor_b32 v11, 64, v11
    v_mfma_f32_16x16x32_bf16 a[60:63], a[240:243], v[92:95], a[60:63]
    ds_read_b64_tr_b16 a[220:221], v82 offset:49152
    v_mfma_f32_16x16x32_bf16 a[60:63], a[176:179], a[196:199], a[60:63]
    s_add_u32 m0, s70, s73
    ds_read_b64_tr_b16 a[222:223], v82 offset:50176
    global_load_lds_dwordx4 v9, s[10:11]
    v_mfma_f32_16x16x32_bf16 a[92:95], a[176:179], a[200:203], a[92:95]
    s_lshl_b32 s34, s32, 2
    ds_read_b64_tr_b16 a[224:225], v83 offset:49152
    v_mfma_f32_16x16x32_bf16 a[92:95], a[240:243], v[96:99], a[92:95]
    s_add_u32 s34, s34, s3
    ds_read_b64_tr_b16 a[226:227], v83 offset:50176
    v_mfma_f32_16x16x32_bf16 a[124:127], a[240:243], v[100:103], a[124:127]
    s_lshl_b32 s34, s34, 15
    ds_read_b64_tr_b16 a[228:229], v84 offset:49152
    v_mfma_f32_16x16x32_bf16 a[124:127], a[176:179], a[204:207], a[124:127]
    s_lshl_b32 s35, s33, 7
    ds_read_b64_tr_b16 a[230:231], v84 offset:50176
    v_mfma_f32_16x16x32_bf16 v[24:27], a[180:183], a[192:195], v[24:27]
    s_add_u32 s34, s34, s35
    ds_read_b64_tr_b16 a[232:233], v85 offset:49152
    v_mfma_f32_16x16x32_bf16 v[24:27], a[244:247], v[88:91], v[24:27]
    s_add_u32 s18, s52, s34
    ds_read_b64_tr_b16 a[234:235], v85 offset:50176
    v_mfma_f32_16x16x32_bf16 v[36:39], a[244:247], v[92:95], v[36:39]
    s_addc_u32 s19, s53, 0
    ds_read_b64_tr_b16 a[148:149], v80 offset:0
    v_mfma_f32_16x16x32_bf16 v[36:39], a[180:183], a[196:199], v[36:39]
    s_lshl_b32 s75, s3, 12
    ds_read_b64_tr_b16 a[150:151], v80 offset:1024
    v_mfma_f32_16x16x32_bf16 v[48:51], a[180:183], a[200:203], v[48:51]
    s_add_u32 m0, s75, 98304
    ds_read_b64_tr_b16 a[152:153], v81 offset:0
    v_mfma_f32_16x16x32_bf16 v[48:51], a[244:247], v[96:99], v[48:51]
    ds_read_b64_tr_b16 a[154:155], v81 offset:1024
    global_load_lds_dwordx4 v2, s[18:19] offset:0
    v_mfma_f32_16x16x32_bf16 v[60:63], a[244:247], v[100:103], v[60:63]
    s_and_b32 s34, s32, 15
    ds_read_b64_tr_b16 a[156:157], v82 offset:0
    v_mfma_f32_16x16x32_bf16 v[60:63], a[180:183], a[204:207], v[60:63]
    s_lshl_b32 s34, s34, 2
    ds_read_b64_tr_b16 a[158:159], v82 offset:1024
    v_mfma_f32_16x16x32_bf16 v[28:31], a[184:187], a[192:195], v[28:31]
    s_add_u32 s34, s34, s3
    ds_read_b64_tr_b16 a[160:161], v83 offset:0
    global_load_lds_dwordx4 v3, s[18:19] offset:1024
    v_mfma_f32_16x16x32_bf16 v[28:31], a[248:251], v[88:91], v[28:31]
    s_lshl_b32 s34, s34, 13
    ds_read_b64_tr_b16 a[162:163], v83 offset:1024
    v_mfma_f32_16x16x32_bf16 v[40:43], a[248:251], v[92:95], v[40:43]
    s_add_u32 s34, s34, s35
    ds_read_b64_tr_b16 a[164:165], v84 offset:0
    v_mfma_f32_16x16x32_bf16 v[40:43], a[184:187], a[196:199], v[40:43]
    s_add_u32 s4, s40, s34
    ds_read_b64_tr_b16 a[166:167], v84 offset:1024
    global_load_lds_dwordx4 v4, s[18:19] offset:2048
    v_mfma_f32_16x16x32_bf16 v[52:55], a[184:187], a[200:203], v[52:55]
    s_addc_u32 s5, s41, 0
    ds_read_b64_tr_b16 a[168:169], v85 offset:0
    v_mfma_f32_16x16x32_bf16 v[52:55], a[248:251], v[96:99], v[52:55]
    ds_read_b64_tr_b16 a[170:171], v85 offset:1024
    v_mfma_f32_16x16x32_bf16 v[64:67], a[248:251], v[100:103], v[64:67]
    global_load_lds_dwordx4 v5, s[18:19] offset:3072
    v_mfma_f32_16x16x32_bf16 v[64:67], a[184:187], a[204:207], v[64:67]
    s_lshl_b32 s75, s3, 10
    v_mfma_f32_16x16x32_bf16 v[72:75], a[184:187], a[144:147], v[72:75]
    s_add_u32 m0, s75, 114688
    v_mfma_f32_16x16x32_bf16 v[72:75], a[248:251], a[208:211], v[72:75]
    global_load_lds_dwordx4 v2, s[4:5]
    v_mfma_f32_16x16x32_bf16 v[32:35], v[88:91], a[252:255], v[32:35]
    v_mfma_f32_16x16x32_bf16 v[32:35], a[192:195], a[188:191], v[32:35]
    v_mfma_f32_16x16x32_bf16 v[44:47], a[196:199], a[188:191], v[44:47]
    buffer_store_dwordx4 v[208:211], v22, s[20:23], s79 offen offset:0
    v_mfma_f32_16x16x32_bf16 v[44:47], v[92:95], a[252:255], v[44:47]
    v_mfma_f32_16x16x32_bf16 v[56:59], v[96:99], a[252:255], v[56:59]
    buffer_store_dwordx4 v[216:219], v22, s[20:23], s79 offen offset:1024
    v_mfma_f32_16x16x32_bf16 v[56:59], a[200:203], a[188:191], v[56:59]
    v_mfma_f32_16x16x32_bf16 v[68:71], a[204:207], a[188:191], v[68:71]
    v_mfma_f32_16x16x32_bf16 v[68:71], v[100:103], a[252:255], v[68:71]
    v_mfma_f32_16x16x32_bf16 v[76:79], a[208:211], a[252:255], v[76:79]
    v_mfma_f32_16x16x32_bf16 v[76:79], a[144:147], a[188:191], v[76:79]
    s_waitcnt lgkmcnt(0)
    v_mfma_f32_16x16x32_bf16 a[0:3], a[212:215], v[88:91], a[0:3]
    s_waitcnt vmcnt(17)
    v_mfma_f32_16x16x32_bf16 a[0:3], a[148:151], a[128:131], a[0:3]
    s_barrier
    v_mfma_f32_16x16x32_bf16 a[32:35], a[148:151], a[132:135], a[32:35]
    s_add_u32 s91, s91, 1
    ds_read_b128 a[192:195], v11 offset:0
    v_and_b32 v204, 15, v0
    v_mfma_f32_16x16x32_bf16 a[32:35], a[212:215], v[92:95], a[32:35]
    s_and_b32 s91, s91, 15
    ds_read_b128 a[196:199], v11 offset:8192
    buffer_store_dwordx4 v[212:215], v22, s[20:23], s79 offen offset:2048
    v_mfma_f32_16x16x32_bf16 a[64:67], a[212:215], v[96:99], a[64:67]
    s_lshl_b32 s75, s91, 18
    ds_read_b128 a[200:203], v11 offset:16384
    v_lshlrev_b32 v205, 2, v16
    v_mfma_f32_16x16x32_bf16 a[64:67], a[148:151], a[136:139], a[64:67]
    s_add_u32 s6, s84, s75
    ds_read_b128 a[204:207], v11 offset:24576
    v_sub_u32 v204, v204, v205
    v_mfma_f32_16x16x32_bf16 a[96:99], a[148:151], a[140:143], a[96:99]
    s_addc_u32 s7, s85, 0
    ds_read_b64_tr_b16 a[172:173], v86 offset:0
    v_mov_b32 v205, 0xf149f2ca
    v_mfma_f32_16x16x32_bf16 a[96:99], a[212:215], v[100:103], a[96:99]
    s_mul_i32 s75, s91, s68
    ds_read_b64_tr_b16 a[174:175], v86 offset:1024
    v_add_u32 v192, 0, v204
    v_mfma_f32_16x16x32_bf16 a[4:7], a[216:219], v[88:91], a[4:7]
    s_add_u32 s8, s86, s75
    ds_read_b64_tr_b16 a[176:177], v87 offset:0
    v_add_u32 v193, -1, v204
    v_mfma_f32_16x16x32_bf16 a[4:7], a[152:155], a[128:131], a[4:7]
    s_addc_u32 s9, s87, 0
    ds_read_b64_tr_b16 a[178:179], v87 offset:1024
    v_add_u32 v194, -2, v204
    v_mfma_f32_16x16x32_bf16 a[36:39], a[152:155], a[132:135], a[36:39]
    s_mul_i32 s75, s91, s69
    ds_read_b64_tr_b16 a[180:181], v12 offset:8192
    v_add_u32 v195, -3, v204
    v_mfma_f32_16x16x32_bf16 a[36:39], a[216:219], v[92:95], a[36:39]
    s_add_u32 s10, s88, s75
    ds_read_b64_tr_b16 a[182:183], v12 offset:8704
    v_add_u32 v196, 16, v204
    v_mfma_f32_16x16x32_bf16 a[68:71], a[216:219], v[96:99], a[68:71]
    s_addc_u32 s11, s89, 0
    ds_read_b64_tr_b16 a[184:185], v12 offset:9216
    v_add_u32 v197, 15, v204
    v_mfma_f32_16x16x32_bf16 a[68:71], a[152:155], a[136:139], a[68:71]
    s_add_u32 s70, s70, 16384
    ds_read_b64_tr_b16 a[186:187], v12 offset:9728
    v_add_u32 v198, 14, v204
    v_mfma_f32_16x16x32_bf16 a[100:103], a[152:155], a[140:143], a[100:103]
    s_and_b32 s70, s70, 0xffff
    ds_read_b64_tr_b16 a[188:189], v12 offset:10240
    v_add_u32 v199, 13, v204
    v_mfma_f32_16x16x32_bf16 a[100:103], a[216:219], v[100:103], a[100:103]
    s_add_u32 m0, s70, s71
    ds_read_b64_tr_b16 a[190:191], v12 offset:10752
    global_load_lds_dwordx4 v6, s[6:7]
    v_mfma_f32_16x16x32_bf16 a[8:11], a[220:223], v[88:91], a[8:11]
    ds_read_b128 a[144:147], v13 offset:12288
    v_and_b32 v192, 0xfffffff1, v192
    v_mfma_f32_16x16x32_bf16 a[8:11], a[156:159], a[128:131], a[8:11]
    ds_read_b64_tr_b16 a[236:237], v86 offset:16384
    v_and_b32 v193, 0xfffffff1, v193
    v_mfma_f32_16x16x32_bf16 a[40:43], a[156:159], a[132:135], a[40:43]
    ds_read_b64_tr_b16 a[238:239], v86 offset:17408
    global_load_lds_dwordx4 v7, s[6:7] offset:1024
    v_mfma_f32_16x16x32_bf16 a[40:43], a[220:223], v[92:95], a[40:43]
    ds_read_b64_tr_b16 a[240:241], v87 offset:16384
    v_and_b32 v194, 0xfffffff1, v194
    v_mfma_f32_16x16x32_bf16 a[72:75], a[220:223], v[96:99], a[72:75]
    ds_read_b64_tr_b16 a[242:243], v87 offset:17408
    v_and_b32 v195, 0xfffffff1, v195
    v_mfma_f32_16x16x32_bf16 a[72:75], a[156:159], a[136:139], a[72:75]
    s_add_u32 m0, s70, s72
    ds_read_b64_tr_b16 a[244:245], v12 offset:24576
    global_load_lds_dwordx4 v8, s[8:9] sc1
    v_mfma_f32_16x16x32_bf16 a[104:107], a[156:159], a[140:143], a[104:107]
    ds_read_b64_tr_b16 a[246:247], v12 offset:25088
    v_and_b32 v196, 0xfffffff1, v196
    v_mfma_f32_16x16x32_bf16 a[104:107], a[220:223], v[100:103], a[104:107]
    ds_read_b64_tr_b16 a[248:249], v12 offset:25600
    v_and_b32 v197, 0xfffffff1, v197
    v_mfma_f32_16x16x32_bf16 a[12:15], a[224:227], v[88:91], a[12:15]
    s_add_u32 m0, s70, s73
    ds_read_b64_tr_b16 a[250:251], v12 offset:26112
    global_load_lds_dwordx4 v9, s[10:11]
    v_mfma_f32_16x16x32_bf16 a[12:15], a[160:163], a[128:131], a[12:15]
    s_or_b32 s90, s33, s3
    ds_read_b64_tr_b16 a[252:253], v12 offset:26624
    v_and_b32 v198, 0xfffffff1, v198
    v_mfma_f32_16x16x32_bf16 a[44:47], a[160:163], a[132:135], a[44:47]
    s_cmp_eq_u32 s90, 0
    ds_read_b64_tr_b16 a[254:255], v12 offset:27136
    v_and_b32 v199, 0xfffffff1, v199
    v_mfma_f32_16x16x32_bf16 a[44:47], a[224:227], v[92:95], a[44:47]
    s_cselect_b64 s[88:89], -1, 0
    ds_read_b128 a[208:211], v13 offset:28672
    buffer_store_dwordx4 v[220:223], v22, s[20:23], s79 offen offset:3072
    v_mfma_f32_16x16x32_bf16 a[76:79], a[224:227], v[96:99], a[76:79]
    s_lshl_b32 s90, s3, 10
    v_add_u32 v11, 65536, v10
    v_mfma_f32_16x16x32_bf16 a[76:79], a[160:163], a[136:139], a[76:79]
    s_add_u32 s90, s90, 131072
    v_mfma_f32_16x16x32_bf16 a[108:111], a[160:163], a[140:143], a[108:111]
    s_and_b32 s91, s3, 1
    v_cmp_eq_u32 s[64:65], 0, v192
    v_cmp_eq_u32 s[66:67], 0, v193
    v_mfma_f32_16x16x32_bf16 a[108:111], a[224:227], v[100:103], a[108:111]
    s_mul_i32 s91, s91, 9216
    v_cmp_eq_u32 s[68:69], 0, v194
    v_cmp_eq_u32 s[70:71], 0, v195
    v_mfma_f32_16x16x32_bf16 a[16:19], a[228:231], v[88:91], a[16:19]
    s_add_u32 s91, s91, 131072
    v_cmp_eq_u32 s[72:73], 0, v196
    v_cmp_eq_u32 s[82:83], 0, v197
    v_mfma_f32_16x16x32_bf16 a[16:19], a[164:167], a[128:131], a[16:19]
    s_mov_b32 s92, 0x3eb8aa3b
    v_cmp_eq_u32 s[84:85], 0, v198
    v_cmp_eq_u32 s[86:87], 0, v199
    v_mfma_f32_16x16x32_bf16 a[48:51], a[164:167], a[132:135], a[48:51]
    s_mul_i32 s34, s33, 589824
    v_cndmask_b32_e64 v192, v205, 0, s[64:65]
    v_cndmask_b32_e64 v193, v205, 0, s[66:67]
    v_mfma_f32_16x16x32_bf16 a[48:51], a[228:231], v[92:95], a[48:51]
    s_lshl_b32 s35, s3, 12
    v_cndmask_b32_e64 v194, v205, 0, s[68:69]
    v_cndmask_b32_e64 v195, v205, 0, s[70:71]
    v_mfma_f32_16x16x32_bf16 a[80:83], a[228:231], v[96:99], a[80:83]
    s_add_u32 s34, s34, s35
    v_cndmask_b32_e64 v196, v205, 0, s[72:73]
    v_cndmask_b32_e64 v197, v205, 0, s[82:83]
    v_mfma_f32_16x16x32_bf16 a[80:83], a[164:167], a[136:139], a[80:83]
    s_add_u32 s34, s34, 54525952
    buffer_store_dwordx4 v[160:163], v20, s[20:23], s80 offen offset:0
    v_mfma_f32_16x16x32_bf16 a[112:115], a[164:167], a[140:143], a[112:115]
    s_add_u32 s16, s60, s34
    v_cndmask_b32_e64 v198, v205, 0, s[84:85]
    v_cndmask_b32_e64 v199, v205, 0, s[86:87]
    v_mfma_f32_16x16x32_bf16 a[112:115], a[228:231], v[100:103], a[112:115]
    s_addc_u32 s17, s61, 0
    v_cndmask_b32_e64 v200, v196, v205, s[88:89]
    v_cndmask_b32_e64 v201, v197, v205, s[88:89]
    v_mfma_f32_16x16x32_bf16 a[20:23], a[232:235], v[88:91], a[20:23]
    s_cmp_ge_u32 s33, 2
    v_cndmask_b32_e64 v202, v198, v205, s[88:89]
    v_cndmask_b32_e64 v203, v199, v205, s[88:89]
    v_mfma_f32_16x16x32_bf16 a[20:23], a[168:171], a[128:131], a[20:23]
    s_cselect_b64 s[4:5], 24, 0
    v_mfma_f32_16x16x32_bf16 a[52:55], a[168:171], a[132:135], a[52:55]
    s_lshl_b32 s34, s33, 1
    v_mfma_f32_16x16x32_bf16 a[52:55], a[232:235], v[92:95], a[52:55]
    s_bitset1_b64 s[4:5], s34
    v_mfma_f32_16x16x32_bf16 a[84:87], a[232:235], v[96:99], a[84:87]
    s_sub_u32 s34, 30, s34
    v_mfma_f32_16x16x32_bf16 a[84:87], a[168:171], a[136:139], a[84:87]
    s_bitset1_b64 s[4:5], s34
    v_mfma_f32_16x16x32_bf16 a[116:119], a[168:171], a[140:143], a[116:119]
    v_mfma_f32_16x16x32_bf16 a[116:119], a[232:235], v[100:103], a[116:119]
    s_waitcnt lgkmcnt(0)
    v_mfma_f32_16x16x32_bf16 a[24:27], a[172:175], a[128:131], a[24:27]
    s_waitcnt vmcnt(14)
    v_mfma_f32_16x16x32_bf16 a[24:27], a[236:239], a[192:195], a[24:27]
    s_barrier
    global_load_dword v19, v18, s[44:45] sc1
    v_mfma_f32_16x16x32_bf16 a[56:59], a[236:239], a[196:199], a[56:59]
    s_lshl_b32 s34, s3, 12
    ds_read_b128 v[88:91], v11 offset:0
    v_mfma_f32_16x16x32_bf16 a[56:59], a[172:175], a[132:135], a[56:59]
    s_add_u32 s34, s34, 98304
    ds_read_b128 v[92:95], v11 offset:8192
    v_mfma_f32_16x16x32_bf16 a[88:91], a[172:175], a[136:139], a[88:91]
    s_lshr_b32 s35, s3, 1
    ds_read_b128 v[96:99], v11 offset:16384
    buffer_store_dwordx4 v[164:167], v20, s[20:23], s80 offen offset:1024
    v_mfma_f32_16x16x32_bf16 a[88:91], a[236:239], a[200:203], a[88:91]
    s_lshl_b32 s35, s35, 6
    ds_read_b128 v[100:103], v11 offset:24576
    v_mfma_f32_16x16x32_bf16 a[120:123], a[236:239], a[204:207], a[120:123]
    s_and_b32 s75, s3, 1
    ds_read_b64_tr_b16 a[212:213], v80 offset:16384
    v_mfma_f32_16x16x32_bf16 a[120:123], a[172:175], a[140:143], a[120:123]
    s_lshl_b32 s75, s75, 3
    ds_read_b64_tr_b16 a[214:215], v80 offset:17408
    v_mfma_f32_16x16x32_bf16 a[28:31], a[176:179], a[128:131], a[28:31]
    s_add_u32 s35, s35, s75
    ds_read_b64_tr_b16 a[216:217], v81 offset:16384
    v_xor_b32 v11, 64, v11
    v_mfma_f32_16x16x32_bf16 a[28:31], a[240:243], a[192:195], a[28:31]
    s_add_u32 s35, s35, 114688
    ds_read_b64_tr_b16 a[218:219], v81 offset:17408
    v_mfma_f32_16x16x32_bf16 a[60:63], a[240:243], a[196:199], a[60:63]
    s_add_u32 s6, s16, 180224
    ds_read_b64_tr_b16 a[220:221], v82 offset:16384
    v_mfma_f32_16x16x32_bf16 a[60:63], a[176:179], a[132:135], a[60:63]
    s_addc_u32 s7, s17, 0
    ds_read_b64_tr_b16 a[222:223], v82 offset:17408
    v_mfma_f32_16x16x32_bf16 a[92:95], a[176:179], a[136:139], a[92:95]
    s_mov_b32 s96, 0
    ds_read_b64_tr_b16 a[224:225], v83 offset:16384
    v_mfma_f32_16x16x32_bf16 a[92:95], a[240:243], a[200:203], a[92:95]
    s_mov_b32 s99, 0
    ds_read_b64_tr_b16 a[226:227], v83 offset:17408
    buffer_store_dwordx4 v[168:171], v21, s[20:23], s80 offen offset:0
    v_mfma_f32_16x16x32_bf16 a[124:127], a[240:243], a[204:207], a[124:127]
    s_lshl_b32 s58, s33, 1
    ds_read_b64_tr_b16 a[228:229], v84 offset:16384
    v_mfma_f32_16x16x32_bf16 a[124:127], a[176:179], a[140:143], a[124:127]
    s_and_b32 s58, s58, 2
    ds_read_b64_tr_b16 a[230:231], v84 offset:17408
    v_mfma_f32_16x16x32_bf16 v[24:27], a[180:183], a[128:131], v[24:27]
    s_xor_b32 s58, s58, s3
    ds_read_b64_tr_b16 a[232:233], v85 offset:16384
    v_mfma_f32_16x16x32_bf16 v[24:27], a[244:247], a[192:195], v[24:27]
    s_mov_b32 s100, 0
    ds_read_b64_tr_b16 a[234:235], v85 offset:17408
    v_mfma_f32_16x16x32_bf16 v[36:39], a[244:247], a[196:199], v[36:39]
    s_mov_b32 s63, 0
    ds_read_b64_tr_b16 a[148:149], v80 offset:32768
    v_mfma_f32_16x16x32_bf16 v[36:39], a[180:183], a[132:135], v[36:39]
    s_lshl_b32 s36, s3, 4
    ds_read_b64_tr_b16 a[150:151], v80 offset:33792
    v_mfma_f32_16x16x32_bf16 v[48:51], a[180:183], a[136:139], v[48:51]
    s_lshl_b32 s37, s32, 3
    ds_read_b64_tr_b16 a[152:153], v81 offset:32768
    v_mfma_f32_16x16x32_bf16 v[48:51], a[244:247], a[200:203], v[48:51]
    s_sub_u32 s54, 31, s32
    ds_read_b64_tr_b16 a[154:155], v81 offset:33792
    v_mfma_f32_16x16x32_bf16 v[60:63], a[244:247], a[204:207], v[60:63]
    s_min_u32 s54, s54, s32
    ds_read_b64_tr_b16 a[156:157], v82 offset:32768
    v_mfma_f32_16x16x32_bf16 v[60:63], a[180:183], a[140:143], v[60:63]
    s_lshr_b32 s54, s54, 1
    ds_read_b64_tr_b16 a[158:159], v82 offset:33792
    buffer_store_dwordx4 v[172:175], v21, s[20:23], s80 offen offset:1024
    v_mfma_f32_16x16x32_bf16 v[28:31], a[184:187], a[128:131], v[28:31]
L_wk6:
    s_cbranch_execz L_wk10
    s_cmp_lg_u32 s33, 0
    ds_read_b64_tr_b16 a[160:161], v83 offset:32768
    v_mfma_f32_16x16x32_bf16 v[28:31], a[248:251], a[192:195], v[28:31]
    s_cselect_b32 s55, 64, 0
    ds_read_b64_tr_b16 a[162:163], v83 offset:33792
    v_mfma_f32_16x16x32_bf16 v[40:43], a[248:251], a[196:199], v[40:43]
    s_lshr_b32 s18, s32, 1
    ds_read_b64_tr_b16 a[164:165], v84 offset:32768
    v_mfma_f32_16x16x32_bf16 v[40:43], a[184:187], a[132:135], v[40:43]
    s_lshl_b32 s18, s18, 12
    ds_read_b64_tr_b16 a[166:167], v84 offset:33792
    v_mfma_f32_16x16x32_bf16 v[52:55], a[184:187], a[136:139], v[52:55]
    s_and_b32 s19, s32, 1
    ds_read_b64_tr_b16 a[168:169], v85 offset:32768
    v_mfma_f32_16x16x32_bf16 v[52:55], a[248:251], a[200:203], v[52:55]
    s_lshl_b32 s19, s19, 9
    ds_read_b64_tr_b16 a[170:171], v85 offset:33792
    v_mfma_f32_16x16x32_bf16 v[64:67], a[248:251], a[204:207], v[64:67]
    s_add_u32 s18, s18, s19
    v_mfma_f32_16x16x32_bf16 v[64:67], a[184:187], a[140:143], v[64:67]
    s_lshl_b32 s19, s3, 10
    v_mfma_f32_16x16x32_bf16 v[72:75], a[184:187], a[144:147], v[72:75]
    s_add_u32 s18, s18, s19
    v_mfma_f32_16x16x32_bf16 v[72:75], a[248:251], a[208:211], v[72:75]
    s_lshl_b32 s101, s32, 14
    buffer_store_dwordx4 v[224:227], v22, s[20:23], s80 offen offset:0
    v_mfma_f32_16x16x32_bf16 v[32:35], a[192:195], a[252:255], v[32:35]
    s_add_u32 s101, s101, s19
    v_bfe_u32 v14, v0, 2, 4
    v_lshlrev_b32 v14, 7, v14
    v_mfma_f32_16x16x32_bf16 v[32:35], a[128:131], a[188:191], v[32:35]
    s_add_u32 s101, s101, 65536
    v_and_b32 v15, 3, v0
    v_lshl_add_u32 v14, v15, 4, v14
    v_mfma_f32_16x16x32_bf16 v[44:47], a[132:135], a[188:191], v[44:47]
    s_mul_i32 s19, s33, 1179648
    v_lshl_add_u32 v15, v16, 9, v14
    v_and_b32 v9, 0xf0, v1
    v_mfma_f32_16x16x32_bf16 v[44:47], a[196:199], a[252:255], v[44:47]
    s_add_u32 s8, s18, s19
    v_lshrrev_b32 v8, 5, v0
    v_lshl_add_u32 v9, v8, 8, v9
    v_mfma_f32_16x16x32_bf16 v[56:59], a[200:203], a[252:255], v[56:59]
    s_add_u32 s9, s8, 589824
    v_and_b32 v8, 1, v16
    v_lshl_add_u32 v9, v8, 3, v9
    v_mfma_f32_16x16x32_bf16 v[56:59], a[136:139], a[188:191], v[56:59]
    s_sub_u32 s18, s18, s19
    v_mfma_f32_16x16x32_bf16 v[68:71], a[140:143], a[188:191], v[68:71]
    s_add_u32 s52, s18, 17694720
    v_mfma_f32_16x16x32_bf16 v[68:71], a[204:207], a[252:255], v[68:71]
    s_add_u32 s59, s18, 18284544
    v_add_u32 v15, s35, v15
    v_add_u32 v14, s34, v14
    v_mfma_f32_16x16x32_bf16 v[76:79], a[208:211], a[252:255], v[76:79]
    v_mfma_f32_16x16x32_bf16 v[76:79], a[144:147], a[188:191], v[76:79]
    s_waitcnt lgkmcnt(0)
    v_mfma_f32_16x16x32_bf16 a[0:3], a[212:215], a[192:195], a[0:3]
    s_waitcnt vmcnt(7)
    v_mfma_f32_16x16x32_bf16 a[0:3], a[148:151], v[88:91], a[0:3]
    s_barrier
    v_mfma_f32_16x16x32_bf16 a[32:35], a[148:151], v[92:95], a[32:35]
    ds_read_b128 a[128:131], v11 offset:0
    v_add_u32 v3, 0x4000, v1
    v_mfma_f32_16x16x32_bf16 a[32:35], a[212:215], a[196:199], a[32:35]
    s_add_u32 s28, s60, 54525952
    ds_read_b128 a[132:135], v11 offset:8192
    buffer_store_dwordx4 v[232:235], v22, s[20:23], s80 offen offset:1024
    v_mfma_f32_16x16x32_bf16 a[64:67], a[212:215], a[200:203], a[64:67]
    s_addc_u32 s29, s61, 0
    ds_read_b128 a[136:139], v11 offset:16384
    v_add_u32 v2, 114688, v1
    v_mfma_f32_16x16x32_bf16 a[64:67], a[148:151], v[96:99], a[64:67]
    s_mov_b32 s30, 4718592
    ds_read_b128 a[140:143], v11 offset:24576
    v_cmp_gt_u32 vcc, 32, v0
    v_mfma_f32_16x16x32_bf16 a[96:99], a[148:151], v[100:103], a[96:99]
    s_mov_b32 s31, 0x20000
    ds_read_b64_tr_b16 a[172:173], v86 offset:32768
    v_lshlrev_b32 v5, 3, v0
    v_mfma_f32_16x16x32_bf16 a[96:99], a[212:215], a[204:207], a[96:99]
    s_mul_i32 s75, s33, 144
    ds_read_b64_tr_b16 a[174:175], v86 offset:33792
    v_add_u32 v5, s33, v5
    v_mfma_f32_16x16x32_bf16 a[4:7], a[216:219], a[192:195], a[4:7]
    s_lshl_b32 s76, s32, 2
    ds_read_b64_tr_b16 a[176:177], v87 offset:32768
    v_and_b32 v4, 7, v0
    v_mfma_f32_16x16x32_bf16 a[4:7], a[152:155], v[88:91], a[4:7]
    s_add_u32 s76, s76, s3
    ds_read_b64_tr_b16 a[178:179], v87 offset:33792
    v_add_u32 v4, s37, v4
    v_mfma_f32_16x16x32_bf16 a[36:39], a[152:155], v[92:95], a[36:39]
    s_add_u32 s76, s76, s75
    ds_read_b64_tr_b16 a[180:181], v12 offset:40960
    v_cndmask_b32 v5, v4, v5, vcc
    v_mfma_f32_16x16x32_bf16 a[36:39], a[216:219], a[196:199], a[36:39]
    s_add_u32 s76, s76, 16
    ds_read_b64_tr_b16 a[182:183], v12 offset:41472
    v_lshlrev_b32 v5, 8, v5
    v_mfma_f32_16x16x32_bf16 a[68:71], a[216:219], a[200:203], a[68:71]
    s_lshl_b32 s76, s76, 12
    ds_read_b64_tr_b16 a[184:185], v12 offset:41984
    v_and_b32 v17, 31, v0
    v_mfma_f32_16x16x32_bf16 a[68:71], a[152:155], v[96:99], a[68:71]
    s_add_u32 s75, s75, s32
    ds_read_b64_tr_b16 a[186:187], v12 offset:42496
    v_lshlrev_b32 v17, 3, v17
    v_mfma_f32_16x16x32_bf16 a[100:103], a[152:155], v[100:103], a[100:103]
    s_lshl_b32 s75, s75, 2
    ds_read_b64_tr_b16 a[188:189], v12 offset:43008
    buffer_store_dwordx4 v[228:231], v22, s[20:23], s80 offen offset:2048
    v_mfma_f32_16x16x32_bf16 a[100:103], a[216:219], a[204:207], a[100:103]
    s_add_u32 s75, s75, s3
    ds_read_b64_tr_b16 a[190:191], v12 offset:43520
    v_add_u32 v17, s54, v17
    v_mfma_f32_16x16x32_bf16 a[8:11], a[220:223], a[192:195], a[8:11]
    s_lshl_b32 s75, s75, 10
    ds_read_b128 a[144:147], v13 offset:45056
    v_lshlrev_b32 v17, 8, v17
    v_mfma_f32_16x16x32_bf16 a[8:11], a[156:159], v[88:91], a[8:11]
    s_cmp_ge_u32 s32, 16
    ds_read_b64_tr_b16 a[236:237], v86 offset:49152
    v_and_b32 v6, 15, v0
    v_mfma_f32_16x16x32_bf16 a[40:43], a[156:159], v[92:95], a[40:43]
    s_cselect_b32 s75, 1073741824, s75
    ds_read_b64_tr_b16 a[238:239], v86 offset:50176
    v_add_u32 v6, s36, v6
    v_mfma_f32_16x16x32_bf16 a[40:43], a[220:223], a[196:199], a[40:43]
    s_lshl_b32 s34, s3, 12
    ds_read_b64_tr_b16 a[240:241], v87 offset:49152
    v_lshlrev_b32 v4, 2, v16
    v_mfma_f32_16x16x32_bf16 a[72:75], a[220:223], a[200:203], a[72:75]
    s_add_u32 s14, s20, s34
    ds_read_b64_tr_b16 a[242:243], v87 offset:50176
    v_sub_u32 v6, v6, v4
    v_mfma_f32_16x16x32_bf16 a[72:75], a[156:159], v[96:99], a[72:75]
    s_addc_u32 s15, s21, 0
    ds_read_b64_tr_b16 a[244:245], v12 offset:57344
    v_mov_b32 v7, 0xf149f2ca
    v_mfma_f32_16x16x32_bf16 a[104:107], a[156:159], v[100:103], a[104:107]
    s_add_u32 s10, s14, 32768
    ds_read_b64_tr_b16 a[246:247], v12 offset:57856
    v_add_u32 v4, s55, v6
    v_mfma_f32_16x16x32_bf16 a[104:107], a[220:223], a[204:207], a[104:107]
    s_addc_u32 s11, s15, 0
    ds_read_b64_tr_b16 a[248:249], v12 offset:58368
    v_cmp_le_i32 s[64:65], 0, v6
    v_mfma_f32_16x16x32_bf16 a[12:15], a[224:227], a[192:195], a[12:15]
    s_add_u32 s12, s14, 65536
    ds_read_b64_tr_b16 a[250:251], v12 offset:58880
    v_cmp_le_i32 s[66:67], 1, v6
    v_mfma_f32_16x16x32_bf16 a[12:15], a[160:163], v[88:91], a[12:15]
    s_addc_u32 s13, s15, 0
    ds_read_b64_tr_b16 a[252:253], v12 offset:59392
    buffer_store_dwordx4 v[236:239], v22, s[20:23], s80 offen offset:3072
    v_mfma_f32_16x16x32_bf16 a[44:47], a[160:163], v[92:95], a[44:47]
    s_add_u32 s38, s34, 0
    ds_read_b64_tr_b16 a[254:255], v12 offset:59904
    v_cmp_le_i32 s[68:69], 2, v6
    v_mfma_f32_16x16x32_bf16 a[44:47], a[224:227], a[196:199], a[44:47]
    s_add_u32 s39, s34, 16384
    ds_read_b128 a[208:211], v13 offset:61440
    v_cmp_le_i32 s[70:71], 3, v6
    v_mfma_f32_16x16x32_bf16 a[76:79], a[224:227], a[200:203], a[76:79]
    s_add_u32 s40, s34, 32768
    v_cmp_le_i32 s[72:73], 16, v6
    v_cmp_le_i32 s[82:83], 33, v6
    v_mfma_f32_16x16x32_bf16 a[76:79], a[160:163], v[96:99], a[76:79]
    s_add_u32 s41, s34, 49152
    v_cmp_le_i32 s[84:85], 34, v6
    v_cmp_le_i32 s[86:87], 35, v6
    v_mfma_f32_16x16x32_bf16 a[108:111], a[160:163], v[100:103], a[108:111]
    s_add_u32 s46, s34, 65536
    ds_read_b64_tr_b16 v[104:105], v14 offset:0
    v_cmp_le_i32 s[88:89], 48, v6
    v_mfma_f32_16x16x32_bf16 a[108:111], a[224:227], a[204:207], a[108:111]
    s_add_u32 s47, s34, 81920
    ds_read_b64_tr_b16 v[106:107], v14 offset:2048
    v_cmp_le_i32 s[94:95], 51, v6
    v_mfma_f32_16x16x32_bf16 a[16:19], a[228:231], a[192:195], a[16:19]
    s_add_u32 m0, s34, 114688
    ds_read_b64_tr_b16 v[108:109], v14 offset:8
    v_mfma_f32_16x16x32_bf16 a[16:19], a[164:167], v[88:91], a[16:19]
    s_lshl_b32 s97, s33, 1
    ds_read_b64_tr_b16 v[110:111], v14 offset:2056
    v_mfma_f32_16x16x32_bf16 a[48:51], a[164:167], v[92:95], a[48:51]
    s_sub_u32 s97, 29, s97
    ds_read_b64_tr_b16 v[112:113], v14 offset:64
    v_mfma_f32_16x16x32_bf16 a[48:51], a[228:231], a[196:199], a[48:51]
    s_mov_b32 s53, s74
    ds_read_b64_tr_b16 v[114:115], v14 offset:2112
    v_mfma_f32_16x16x32_bf16 a[80:83], a[228:231], a[200:203], a[80:83]
    ds_read_b64_tr_b16 v[116:117], v14 offset:72
    buffer_store_dwordx4 v[176:179], v20, s[20:23], s81 offen offset:0
    v_mfma_f32_16x16x32_bf16 a[80:83], a[164:167], v[96:99], a[80:83]
    ds_read_b64_tr_b16 v[118:119], v14 offset:2120
    v_mfma_f32_16x16x32_bf16 a[112:115], a[164:167], v[100:103], a[112:115]
    ds_read_b64_tr_b16 v[120:121], v15 offset:0
    v_mfma_f32_16x16x32_bf16 a[112:115], a[228:231], a[204:207], a[112:115]
    ds_read_b64_tr_b16 v[122:123], v15 offset:512
    v_mfma_f32_16x16x32_bf16 a[20:23], a[232:235], a[192:195], a[20:23]
    v_mfma_f32_16x16x32_bf16 a[20:23], a[168:171], v[88:91], a[20:23]
    v_mfma_f32_16x16x32_bf16 a[52:55], a[168:171], v[92:95], a[52:55]
    v_mfma_f32_16x16x32_bf16 a[52:55], a[232:235], a[196:199], a[52:55]
    v_mfma_f32_16x16x32_bf16 a[84:87], a[232:235], a[200:203], a[84:87]
    v_mfma_f32_16x16x32_bf16 a[84:87], a[168:171], v[96:99], a[84:87]
    v_mfma_f32_16x16x32_bf16 a[116:119], a[168:171], v[100:103], a[116:119]
    v_mfma_f32_16x16x32_bf16 a[116:119], a[232:235], a[204:207], a[116:119]
    s_waitcnt lgkmcnt(0)
    v_mfma_f32_16x16x32_bf16 v[28:31], a[184:187], v[88:91], v[28:31]
    s_waitcnt vmcnt(8)
    v_cmp_gt_u32 vcc, 0x100, v19
    v_mfma_f32_16x16x32_bf16 v[28:31], a[248:251], a[128:131], v[28:31]
    s_barrier
    v_mfma_f32_16x16x32_bf16 v[40:43], a[248:251], a[132:135], v[40:43]
    s_cbranch_vccnz L_e1_slow
L_e1_ok:
    ds_read_b64_tr_b16 a[212:213], v80 offset:49152
    global_load_lds_dwordx4 v1, s[14:15] offset:0 sc1
    v_mfma_f32_16x16x32_bf16 v[40:43], a[184:187], v[92:95], v[40:43]
    ds_read_b64_tr_b16 a[214:215], v80 offset:50176
    v_mfma_f32_16x16x32_bf16 v[52:55], a[184:187], v[96:99], v[52:55]
    ds_read_b64_tr_b16 a[216:217], v81 offset:49152
    v_mfma_f32_16x16x32_bf16 v[52:55], a[248:251], a[136:139], v[52:55]
    ds_read_b64_tr_b16 a[218:219], v81 offset:50176
    global_load_lds_dwordx4 v1, s[14:15] offset:1024 sc1
    v_mfma_f32_16x16x32_bf16 v[64:67], a[248:251], a[140:143], v[64:67]
    ds_read_b64_tr_b16 a[220:221], v82 offset:49152
    v_mfma_f32_16x16x32_bf16 v[64:67], a[184:187], v[100:103], v[64:67]
    ds_read_b64_tr_b16 a[222:223], v82 offset:50176
    v_add_u32 v14, s90, v1
    v_mfma_f32_16x16x32_bf16 v[72:75], a[184:187], a[144:147], v[72:75]
    ds_read_b64_tr_b16 a[224:225], v83 offset:49152
    v_add_u32 v15, s91, v1
    v_mfma_f32_16x16x32_bf16 v[72:75], a[248:251], a[208:211], v[72:75]
    ds_read_b64_tr_b16 a[226:227], v83 offset:50176
    global_load_lds_dwordx4 v1, s[14:15] offset:2048 sc1
    v_mfma_f32_16x16x32_bf16 v[32:35], a[128:131], a[252:255], v[32:35]
    ds_read_b64_tr_b16 a[228:229], v84 offset:49152
    v_cvt_pk_bf16_f32 v28, v28, v29
    v_mfma_f32_16x16x32_bf16 v[32:35], v[88:91], a[188:191], v[32:35]
    ds_read_b64_tr_b16 a[230:231], v84 offset:50176
    v_cvt_pk_bf16_f32 v29, v30, v31
    v_mfma_f32_16x16x32_bf16 v[44:47], v[92:95], a[188:191], v[44:47]
    ds_read_b64_tr_b16 a[232:233], v85 offset:49152
    v_cvt_pk_bf16_f32 v40, v40, v41
    v_mfma_f32_16x16x32_bf16 v[44:47], a[132:135], a[252:255], v[44:47]
    ds_read_b64_tr_b16 a[234:235], v85 offset:50176
    global_load_lds_dwordx4 v1, s[14:15] offset:3072 sc1
    v_mfma_f32_16x16x32_bf16 v[56:59], a[136:139], a[252:255], v[56:59]
    s_mov_b32 m0, s38
    v_cvt_pk_bf16_f32 v41, v42, v43
    v_cvt_pk_bf16_f32 v52, v52, v53
    v_mfma_f32_16x16x32_bf16 v[56:59], v[96:99], a[188:191], v[56:59]
    v_cvt_pk_bf16_f32 v53, v54, v55
    v_cvt_pk_bf16_f32 v64, v64, v65
    v_mfma_f32_16x16x32_bf16 v[68:71], v[100:103], a[188:191], v[68:71]
    v_cvt_pk_bf16_f32 v65, v66, v67
    v_cvt_pk_bf16_f32 v72, v72, v73
    v_mfma_f32_16x16x32_bf16 v[68:71], a[140:143], a[252:255], v[68:71]
    buffer_store_dwordx4 v[104:107], v1, s[28:31], s76 offen offset:0 sc1
    v_mfma_f32_16x16x32_bf16 v[76:79], a[208:211], a[252:255], v[76:79]
    v_cvt_pk_bf16_f32 v73, v74, v75
    v_cvt_pk_bf16_f32 v30, v32, v33
    v_mfma_f32_16x16x32_bf16 v[76:79], a[144:147], a[188:191], v[76:79]
    v_cvt_pk_bf16_f32 v31, v34, v35
    v_mfma_f32_16x16x32_bf16 v[24:27], a[180:183], v[88:91], v[24:27]
    ds_write_b128 v14, v[28:31] offset:1024
    v_cvt_pk_bf16_f32 v42, v44, v45
    v_mfma_f32_16x16x32_bf16 v[24:27], a[244:247], a[128:131], v[24:27]
    buffer_store_dwordx4 v[108:111], v1, s[28:31], s76 offen offset:1024 sc1
    v_mfma_f32_16x16x32_bf16 v[36:39], a[244:247], a[132:135], v[36:39]
    v_cvt_pk_bf16_f32 v43, v46, v47
    v_mfma_f32_16x16x32_bf16 v[36:39], a[180:183], v[92:95], v[36:39]
    ds_write_b128 v14, v[40:43] offset:5120
    v_cvt_pk_bf16_f32 v54, v56, v57
    v_mfma_f32_16x16x32_bf16 v[48:51], a[180:183], v[96:99], v[48:51]
    buffer_store_dwordx4 v[112:115], v1, s[28:31], s76 offen offset:2048 sc1
    v_mfma_f32_16x16x32_bf16 v[48:51], a[244:247], a[136:139], v[48:51]
    v_cvt_pk_bf16_f32 v55, v58, v59
    v_mfma_f32_16x16x32_bf16 v[60:63], a[244:247], a[140:143], v[60:63]
    ds_write_b128 v14, v[52:55] offset:10240
    v_cvt_pk_bf16_f32 v66, v68, v69
    v_mfma_f32_16x16x32_bf16 v[60:63], a[180:183], v[100:103], v[60:63]
    v_cvt_pk_bf16_f32 v67, v70, v71
    v_mfma_f32_16x16x32_bf16 a[120:123], a[172:175], v[100:103], a[120:123]
    buffer_store_dwordx4 v[116:119], v1, s[28:31], s76 offen offset:3072 sc1
    v_mfma_f32_16x16x32_bf16 a[120:123], a[236:239], a[140:143], a[120:123]
    ds_write_b128 v14, v[64:67] offset:14336
    v_cvt_pk_bf16_f32 v74, v76, v77
    v_mfma_f32_16x16x32_bf16 a[124:127], a[240:243], a[140:143], a[124:127]
    v_cvt_pk_bf16_f32 v75, v78, v79
    v_mfma_f32_16x16x32_bf16 a[124:127], a[176:179], v[100:103], a[124:127]
    ds_write_b128 v15, v[72:75]
    v_mul_f32 v24, s92, v24
    v_mfma_f32_16x16x32_bf16 a[88:91], a[172:175], v[96:99], a[88:91]
    global_load_lds_dwordx4 v3, s[14:15] offset:0 sc1
    v_mul_f32 v25, s92, v25
    v_mfma_f32_16x16x32_bf16 a[88:91], a[236:239], a[136:139], a[88:91]
    v_mul_f32 v26, s92, v26
    v_mul_f32 v27, s92, v27
    v_mfma_f32_16x16x32_bf16 a[92:95], a[240:243], a[136:139], a[92:95]
    v_cvt_pk_bf16_f32 v24, v24, v25
    v_cvt_pk_bf16_f32 v25, v26, v27
    v_mfma_f32_16x16x32_bf16 a[92:95], a[176:179], v[96:99], a[92:95]
    v_mov_b32 v34, v30
    v_mov_b32 v35, v31
    v_mfma_f32_16x16x32_bf16 a[56:59], a[172:175], v[92:95], a[56:59]
    buffer_store_dwordx4 v[120:123], v1, s[28:31], s75 offen sc1
    v_mfma_f32_16x16x32_bf16 a[56:59], a[236:239], a[132:135], a[56:59]
    v_mul_f32 v36, s92, v36
    v_mul_f32 v37, s92, v37
    v_mfma_f32_16x16x32_bf16 a[60:63], a[240:243], a[132:135], a[60:63]
    v_mul_f32 v38, s92, v38
    v_mul_f32 v39, s92, v39
    v_mfma_f32_16x16x32_bf16 a[60:63], a[176:179], v[92:95], a[60:63]
    v_cvt_pk_bf16_f32 v36, v36, v37
    v_cvt_pk_bf16_f32 v37, v38, v39
    v_mfma_f32_16x16x32_bf16 a[24:27], a[172:175], v[88:91], a[24:27]
    global_load_lds_dwordx4 v3, s[14:15] offset:1024 sc1
    v_mov_b32 v46, v42
    v_mfma_f32_16x16x32_bf16 a[24:27], a[236:239], a[128:131], a[24:27]
    v_mov_b32 v47, v43
    v_mul_f32 v48, s92, v48
    v_mfma_f32_16x16x32_bf16 a[28:31], a[240:243], a[128:131], a[28:31]
    v_mul_f32 v49, s92, v49
    v_mul_f32 v50, s92, v50
    v_mfma_f32_16x16x32_bf16 a[28:31], a[176:179], v[88:91], a[28:31]
    s_waitcnt lgkmcnt(0)
    v_mul_f32 v51, s92, v51
    v_cvt_pk_bf16_f32 v48, v48, v49
    v_mfma_f32_16x16x32_bf16 a[96:99], a[212:215], a[140:143], a[96:99]
    s_barrier
    buffer_store_dwordx4 v[180:183], v20, s[20:23], s81 offen offset:1024
    v_mfma_f32_16x16x32_bf16 a[100:103], a[216:219], a[140:143], a[100:103]
    v_cvt_pk_bf16_f32 v49, v50, v51
    v_mov_b32 v58, v54
    v_mfma_f32_16x16x32_bf16 a[104:107], a[220:223], a[140:143], a[104:107]
    v_mov_b32 v59, v55
    v_mul_f32 v60, s92, v60
    v_mfma_f32_16x16x32_bf16 a[108:111], a[224:227], a[140:143], a[108:111]
    global_load_lds_dwordx4 v3, s[14:15] offset:2048 sc1
    v_mul_f32 v61, s92, v61
    v_mfma_f32_16x16x32_bf16 a[112:115], a[228:231], a[140:143], a[112:115]
    v_mul_f32 v62, s92, v62
    v_mul_f32 v63, s92, v63
    v_mfma_f32_16x16x32_bf16 a[116:119], a[232:235], a[140:143], a[116:119]
    v_cvt_pk_bf16_f32 v60, v60, v61
    v_cvt_pk_bf16_f32 v61, v62, v63
    v_mfma_f32_16x16x32_bf16 a[64:67], a[212:215], a[136:139], a[64:67]
    v_mov_b32 v70, v66
    v_mov_b32 v71, v67
    v_mfma_f32_16x16x32_bf16 a[68:71], a[216:219], a[136:139], a[68:71]
    buffer_store_dwordx4 v[184:187], v21, s[20:23], s81 offen offset:0
    v_mfma_f32_16x16x32_bf16 a[72:75], a[220:223], a[136:139], a[72:75]
    ds_read_b64 v[26:27], v14 offset:0
    v_mfma_f32_16x16x32_bf16 a[76:79], a[224:227], a[136:139], a[76:79]
    ds_read_b64 v[38:39], v14 offset:4096
    v_mfma_f32_16x16x32_bf16 a[80:83], a[228:231], a[136:139], a[80:83]
    ds_read_b64 v[50:51], v14 offset:9216
    v_mfma_f32_16x16x32_bf16 a[84:87], a[232:235], a[136:139], a[84:87]
    ds_read_b64 v[62:63], v14 offset:13312
    global_load_lds_dwordx4 v3, s[14:15] offset:3072 sc1
    v_mfma_f32_16x16x32_bf16 a[32:35], a[212:215], a[132:135], a[32:35]
    s_mov_b32 m0, s39
    ds_read_b64 v[32:33], v14 offset:8
    v_accvgpr_read_b32 v208, a96
    v_mfma_f32_16x16x32_bf16 a[36:39], a[216:219], a[132:135], a[36:39]
    ds_read_b64 v[44:45], v14 offset:4104
    v_accvgpr_read_b32 v209, a97
    v_mfma_f32_16x16x32_bf16 a[40:43], a[220:223], a[132:135], a[40:43]
    ds_read_b64 v[56:57], v14 offset:9224
    v_cvt_pk_bf16_f32 v112, v208, v209
    v_mfma_f32_16x16x32_bf16 a[44:47], a[224:227], a[132:135], a[44:47]
    buffer_store_dwordx4 v[188:191], v21, s[20:23], s81 offen offset:1024
    v_mfma_f32_16x16x32_bf16 a[48:51], a[228:231], a[132:135], a[48:51]
    ds_read_b64 v[68:69], v14 offset:13320
    v_accvgpr_read_b32 v210, a98
    v_mfma_f32_16x16x32_bf16 a[52:55], a[232:235], a[132:135], a[52:55]
    v_accvgpr_read_b32 v211, a99
    v_cvt_pk_bf16_f32 v113, v210, v211
    v_mfma_f32_16x16x32_bf16 a[0:3], a[212:215], a[128:131], a[0:3]
    v_accvgpr_read_b32 v212, a100
    v_accvgpr_read_b32 v213, a101
    v_mfma_f32_16x16x32_bf16 a[4:7], a[216:219], a[128:131], a[4:7]
    global_load_lds_dwordx4 v1, s[10:11] offset:0 sc1
    v_cvt_pk_bf16_f32 v114, v212, v213
    v_mfma_f32_16x16x32_bf16 a[8:11], a[220:223], a[128:131], a[8:11]
    v_accvgpr_read_b32 v214, a102
    v_accvgpr_read_b32 v215, a103
    v_mfma_f32_16x16x32_bf16 a[12:15], a[224:227], a[128:131], a[12:15]
    v_cvt_pk_bf16_f32 v115, v214, v215
    v_accvgpr_read_b32 v216, a104
    v_mfma_f32_16x16x32_bf16 a[16:19], a[228:231], a[128:131], a[16:19]
    v_accvgpr_read_b32 v217, a105
    v_cvt_pk_bf16_f32 v116, v216, v217
    v_mfma_f32_16x16x32_bf16 a[20:23], a[232:235], a[128:131], a[20:23]
    v_accvgpr_read_b32 v218, a106
    v_accvgpr_read_b32 v219, a107
    v_mfma_f32_16x16x16_bf16 v[132:135], v[28:29], v[24:25], v[192:195]
    v_cvt_pk_bf16_f32 v117, v218, v219
    v_accvgpr_read_b32 v220, a108
    v_mfma_f32_16x16x16_bf16 v[140:143], v[40:41], v[36:37], v[192:195]
    v_accvgpr_read_b32 v221, a109
    v_cvt_pk_bf16_f32 v118, v220, v221
    v_mfma_f32_16x16x16_bf16 v[148:151], v[52:53], v[48:49], v[192:195]
    v_accvgpr_read_b32 v222, a110
    v_accvgpr_read_b32 v223, a111
    v_mfma_f32_16x16x16_bf16 v[156:159], v[64:65], v[60:61], v[192:195]
    v_cvt_pk_bf16_f32 v119, v222, v223
    v_accvgpr_read_b32 v224, a112
    s_waitcnt lgkmcnt(0)
    v_mfma_f32_16x16x16_bf16 v[128:131], v[26:27], v[24:25], v[200:203]
    v_accvgpr_read_b32 v225, a113
    v_cvt_pk_bf16_f32 v120, v224, v225
    v_mfma_f32_16x16x16_bf16 v[136:139], v[38:39], v[36:37], v[196:199]
    v_accvgpr_read_b32 v226, a114
    v_accvgpr_read_b32 v227, a115
    v_mfma_f32_16x16x16_bf16 v[144:147], v[50:51], v[48:49], v[196:199]
    global_load_lds_dwordx4 v1, s[10:11] offset:1024 sc1
    v_cvt_pk_bf16_f32 v121, v226, v227
    v_accvgpr_read_b32 v228, a116
    v_mfma_f32_16x16x16_bf16 v[152:155], v[62:63], v[60:61], v[196:199]
    v_accvgpr_read_b32 v229, a117
    v_cvt_pk_bf16_f32 v122, v228, v229
    v_mov_b32 v204, 0x3f803f80
    v_mov_b32 v205, v204
    v_mov_b32 v206, v204
    v_mov_b32 v207, v204
    v_max3_f32 v160, v132, v133, v134
    v_max3_f32 v164, v140, v141, v142
    v_max3_f32 v168, v148, v149, v150
    v_max3_f32 v172, v156, v157, v158
    v_max3_f32 v160, v160, v135, v128
    v_max3_f32 v164, v164, v143, v136
    v_max3_f32 v168, v168, v151, v144
    v_max3_f32 v172, v172, v159, v152
    v_max3_f32 v160, v160, v129, v130
    v_max3_f32 v164, v164, v137, v138
    global_load_lds_dwordx4 v1, s[10:11] offset:2048 sc1
    v_max3_f32 v168, v168, v145, v146
    v_max3_f32 v172, v172, v153, v154
    v_max_f32 v160, v160, v131
    v_max_f32 v164, v164, v139
    v_max_f32 v168, v168, v147
    v_max_f32 v172, v172, v155
    v_mov_b32 v161, v160
    v_mov_b32 v165, v164
    v_mov_b32 v169, v168
    v_mov_b32 v173, v172
    v_permlane32_swap_b32 v160, v161
    v_permlane32_swap_b32 v164, v165
    v_permlane32_swap_b32 v168, v169
    v_permlane32_swap_b32 v172, v173
    v_max_f32 v160, v160, v161
    v_max_f32 v164, v164, v165
    v_max_f32 v168, v168, v169
    v_max_f32 v172, v172, v173
    v_mov_b32 v161, v160
    global_load_lds_dwordx4 v1, s[10:11] offset:3072 sc1
    s_mov_b32 m0, s40
    v_mov_b32 v165, v164
    v_mov_b32 v169, v168
    v_mov_b32 v173, v172
    v_permlane16_swap_b32 v160, v161
    v_permlane16_swap_b32 v164, v165
    v_permlane16_swap_b32 v168, v169
    v_permlane16_swap_b32 v172, v173
    v_max_f32 v160, v160, v161
    v_max_f32 v164, v164, v165
    v_max_f32 v168, v168, v169
    v_max_f32 v172, v172, v173
    v_pk_add_f32 v[128:129], v[128:129], v[160:161] op_sel_hi:[1,0] neg_lo:[0,1] neg_hi:[0,1]
    v_pk_add_f32 v[130:131], v[130:131], v[160:161] op_sel_hi:[1,0] neg_lo:[0,1] neg_hi:[0,1]
    v_pk_add_f32 v[132:133], v[132:133], v[160:161] op_sel_hi:[1,0] neg_lo:[0,1] neg_hi:[0,1]
    v_pk_add_f32 v[134:135], v[134:135], v[160:161] op_sel_hi:[1,0] neg_lo:[0,1] neg_hi:[0,1]
    v_pk_add_f32 v[136:137], v[136:137], v[164:165] op_sel_hi:[1,0] neg_lo:[0,1] neg_hi:[0,1]
    v_pk_add_f32 v[138:139], v[138:139], v[164:165] op_sel_hi:[1,0] neg_lo:[0,1] neg_hi:[0,1]
    v_pk_add_f32 v[140:141], v[140:141], v[164:165] op_sel_hi:[1,0] neg_lo:[0,1] neg_hi:[0,1]
    v_pk_add_f32 v[142:143], v[142:143], v[164:165] op_sel_hi:[1,0] neg_lo:[0,1] neg_hi:[0,1]
    buffer_store_dwordx4 v[240:243], v22, s[20:23], s81 offen offset:0
    v_pk_add_f32 v[144:145], v[144:145], v[168:169] op_sel_hi:[1,0] neg_lo:[0,1] neg_hi:[0,1]
    v_pk_add_f32 v[146:147], v[146:147], v[168:169] op_sel_hi:[1,0] neg_lo:[0,1] neg_hi:[0,1]
    v_pk_add_f32 v[148:149], v[148:149], v[168:169] op_sel_hi:[1,0] neg_lo:[0,1] neg_hi:[0,1]
    v_pk_add_f32 v[150:151], v[150:151], v[168:169] op_sel_hi:[1,0] neg_lo:[0,1] neg_hi:[0,1]
    v_pk_add_f32 v[152:153], v[152:153], v[172:173] op_sel_hi:[1,0] neg_lo:[0,1] neg_hi:[0,1]
    v_pk_add_f32 v[154:155], v[154:155], v[172:173] op_sel_hi:[1,0] neg_lo:[0,1] neg_hi:[0,1]
    v_pk_add_f32 v[156:157], v[156:157], v[172:173] op_sel_hi:[1,0] neg_lo:[0,1] neg_hi:[0,1]
    v_pk_add_f32 v[158:159], v[158:159], v[172:173] op_sel_hi:[1,0] neg_lo:[0,1] neg_hi:[0,1]
    v_exp_f32 v128, v128
    v_exp_f32 v129, v129
    v_exp_f32 v130, v130
    v_exp_f32 v131, v131
    v_exp_f32 v132, v132
    v_exp_f32 v133, v133
    v_exp_f32 v134, v134
    v_exp_f32 v135, v135
    v_exp_f32 v136, v136
    v_exp_f32 v137, v137
    v_exp_f32 v138, v138
    buffer_store_dwordx4 v[248:251], v22, s[20:23], s81 offen offset:1024
    v_exp_f32 v139, v139
    v_exp_f32 v140, v140
    v_exp_f32 v141, v141
    v_exp_f32 v142, v142
    v_exp_f32 v143, v143
    v_exp_f32 v144, v144
    v_exp_f32 v145, v145
    v_exp_f32 v146, v146
    v_exp_f32 v147, v147
    v_exp_f32 v148, v148
    v_exp_f32 v149, v149
    v_exp_f32 v150, v150
    v_exp_f32 v151, v151
    v_exp_f32 v152, v152
    v_exp_f32 v153, v153
    v_exp_f32 v154, v154
    v_exp_f32 v155, v155
    v_exp_f32 v156, v156
    v_exp_f32 v157, v157
    buffer_store_dwordx4 v[244:247], v22, s[20:23], s81 offen offset:2048
    v_exp_f32 v158, v158
    v_exp_f32 v159, v159
    v_cvt_pk_bf16_f32 v128, v128, v129
    v_cvt_pk_bf16_f32 v129, v130, v131
    v_cvt_pk_bf16_f32 v130, v132, v133
    v_cvt_pk_bf16_f32 v131, v134, v135
    v_cvt_pk_bf16_f32 v136, v136, v137
    v_cvt_pk_bf16_f32 v137, v138, v139
    v_cvt_pk_bf16_f32 v138, v140, v141
    v_cvt_pk_bf16_f32 v139, v142, v143
    v_cvt_pk_bf16_f32 v144, v144, v145
    v_cvt_pk_bf16_f32 v145, v146, v147
    v_cvt_pk_bf16_f32 v146, v148, v149
    v_cvt_pk_bf16_f32 v147, v150, v151
    v_cvt_pk_bf16_f32 v152, v152, v153
    v_cvt_pk_bf16_f32 v153, v154, v155
    v_cvt_pk_bf16_f32 v154, v156, v157
    v_cvt_pk_bf16_f32 v155, v158, v159
    v_mfma_f32_16x16x32_bf16 v[24:27], v[32:35], v[128:131], 0
    buffer_store_dwordx4 v[252:255], v22, s[20:23], s81 offen offset:3072
    v_mfma_f32_16x16x32_bf16 v[160:163], v[204:207], v[128:131], 0
    v_mfma_f32_16x16x32_bf16 v[36:39], v[44:47], v[136:139], 0
    v_mfma_f32_16x16x32_bf16 v[164:167], v[204:207], v[136:139], 0
    v_mfma_f32_16x16x32_bf16 v[48:51], v[56:59], v[144:147], 0
    v_mfma_f32_16x16x32_bf16 v[168:171], v[204:207], v[144:147], 0
    v_mfma_f32_16x16x32_bf16 v[60:63], v[68:71], v[152:155], 0
    v_mfma_f32_16x16x32_bf16 v[172:175], v[204:207], v[152:155], 0
    v_accvgpr_read_b32 v230, a118
    v_accvgpr_read_b32 v231, a119
    v_cvt_pk_bf16_f32 v123, v230, v231
    v_accvgpr_read_b32 v232, a120
    v_accvgpr_read_b32 v233, a121
    v_cvt_pk_bf16_f32 v124, v232, v233
    v_rcp_f32 v160, v160
    v_rcp_f32 v164, v164
    v_rcp_f32 v168, v168
    v_rcp_f32 v172, v172
    v_pk_mul_f32 v[24:25], v[24:25], v[160:161] op_sel_hi:[1,0]
    v_pk_mul_f32 v[26:27], v[26:27], v[160:161] op_sel_hi:[1,0]
    v_cvt_pk_bf16_f32 v24, v24, v25
    v_cvt_pk_bf16_f32 v25, v26, v27
    buffer_store_dwordx2 v[24:25], v9, s[24:27], s8 offen sc1
    v_pk_mul_f32 v[36:37], v[36:37], v[164:165] op_sel_hi:[1,0]
    v_pk_mul_f32 v[38:39], v[38:39], v[164:165] op_sel_hi:[1,0]
    v_cvt_pk_bf16_f32 v36, v36, v37
    v_cvt_pk_bf16_f32 v37, v38, v39
    buffer_store_dwordx2 v[36:37], v9, s[24:27], s9 offen sc1
    v_pk_mul_f32 v[48:49], v[48:49], v[168:169] op_sel_hi:[1,0]
    v_pk_mul_f32 v[50:51], v[50:51], v[168:169] op_sel_hi:[1,0]
    v_cvt_pk_bf16_f32 v48, v48, v49
    v_cvt_pk_bf16_f32 v49, v50, v51
    buffer_store_dwordx2 v[48:49], v9, s[24:27], s52 offen sc1
    v_pk_mul_f32 v[60:61], v[60:61], v[172:173] op_sel_hi:[1,0]
    v_pk_mul_f32 v[62:63], v[62:63], v[172:173] op_sel_hi:[1,0]
    v_cvt_pk_bf16_f32 v60, v60, v61
    v_cvt_pk_bf16_f32 v61, v62, v63
    buffer_store_dwordx2 v[60:61], v9, s[24:27], s59 offen sc1
    s_waitcnt vmcnt(24)
    s_barrier
    ds_read_b128 a[128:131], v2 offset:0
    ds_read_b128 a[132:135], v2 offset:1024
    ds_read_b128 a[136:139], v2 offset:2048
    ds_read_b128 a[140:143], v2 offset:3072
    s_add_u32 s14, s14, 98304
    s_addc_u32 s15, s15, 0
    v_accvgpr_read_b32 v234, a122
    v_accvgpr_read_b32 v235, a123
    v_cvt_pk_bf16_f32 v125, v234, v235
    v_accvgpr_read_b32 v236, a124
    v_accvgpr_read_b32 v237, a125
    v_cvt_pk_bf16_f32 v126, v236, v237
    v_accvgpr_read_b32 v238, a126
    v_accvgpr_read_b32 v239, a127
L_wk7:
    s_cbranch_execz L_wk11
    v_cvt_pk_bf16_f32 v127, v238, v239
    v_accvgpr_read_b32 v208, a64
    v_accvgpr_read_b32 v209, a65
    v_cvt_pk_bf16_f32 v96, v208, v209
    v_accvgpr_read_b32 v210, a66
    v_accvgpr_read_b32 v211, a67
    v_cvt_pk_bf16_f32 v97, v210, v211
    v_accvgpr_read_b32 v212, a68
    v_accvgpr_read_b32 v213, a69
    v_cvt_pk_bf16_f32 v98, v212, v213
    v_accvgpr_read_b32 v214, a70
    v_accvgpr_read_b32 v215, a71
    v_cvt_pk_bf16_f32 v99, v214, v215
    s_waitcnt lgkmcnt(0)
    v_mfma_f32_16x16x32_bf16 v[36:39], a[128:131], v[112:115], 0
    global_load_lds_dwordx4 v3, s[10:11] offset:0 sc1
    ds_read_b128 a[144:147], v2 offset:4096
    v_accvgpr_read_b32 v216, a72
    v_accvgpr_read_b32 v217, a73
    v_cvt_pk_bf16_f32 v100, v216, v217
    v_accvgpr_read_b32 v218, a74
    v_accvgpr_read_b32 v219, a75
    v_cvt_pk_bf16_f32 v101, v218, v219
    v_accvgpr_read_b32 v220, a76
    v_accvgpr_read_b32 v221, a77
    v_cvt_pk_bf16_f32 v102, v220, v221
    v_mfma_f32_16x16x32_bf16 v[36:39], a[132:135], v[116:119], v[36:39]
    global_load_lds_dwordx4 v3, s[10:11] offset:1024 sc1
    ds_read_b128 a[148:151], v2 offset:5120
    v_accvgpr_read_b32 v222, a78
    v_accvgpr_read_b32 v223, a79
    v_cvt_pk_bf16_f32 v103, v222, v223
    v_accvgpr_read_b32 v224, a80
    v_accvgpr_read_b32 v225, a81
    v_cvt_pk_bf16_f32 v104, v224, v225
    v_accvgpr_read_b32 v226, a82
    v_accvgpr_read_b32 v227, a83
    v_cvt_pk_bf16_f32 v105, v226, v227
    v_mfma_f32_16x16x32_bf16 v[36:39], a[136:139], v[120:123], v[36:39]
    global_load_lds_dwordx4 v3, s[10:11] offset:2048 sc1
    ds_read_b128 a[152:155], v2 offset:6144
    v_accvgpr_read_b32 v228, a84
    v_accvgpr_read_b32 v229, a85
    v_cvt_pk_bf16_f32 v106, v228, v229
    v_accvgpr_read_b32 v230, a86
    v_accvgpr_read_b32 v231, a87
    v_cvt_pk_bf16_f32 v107, v230, v231
    v_accvgpr_read_b32 v232, a88
    v_accvgpr_read_b32 v233, a89
    v_cvt_pk_bf16_f32 v108, v232, v233
    v_mfma_f32_16x16x32_bf16 v[36:39], a[140:143], v[124:127], v[36:39]
    global_load_lds_dwordx4 v3, s[10:11] offset:3072 sc1
    ds_read_b128 a[156:159], v2 offset:7168
    v_accvgpr_read_b32 v234, a90
    v_accvgpr_read_b32 v235, a91
    v_cvt_pk_bf16_f32 v109, v234, v235
    v_accvgpr_read_b32 v236, a92
    v_accvgpr_read_b32 v237, a93
    v_cvt_pk_bf16_f32 v110, v236, v237
    v_accvgpr_read_b32 v238, a94
    v_accvgpr_read_b32 v239, a95
    v_cvt_pk_bf16_f32 v111, v238, v239
    v_accvgpr_read_b32 v208, a32
    v_accvgpr_read_b32 v209, a33
    v_mfma_f32_16x16x32_bf16 v[32:35], a[128:131], v[96:99], 0
    s_mov_b32 m0, s41
    ds_read_b128 a[192:195], v2 offset:8192
    v_cvt_pk_bf16_f32 v80, v208, v209
    v_accvgpr_read_b32 v210, a34
    v_accvgpr_read_b32 v211, a35
    v_cvt_pk_bf16_f32 v81, v210, v211
    v_accvgpr_read_b32 v212, a36
    v_accvgpr_read_b32 v213, a37
    v_cvt_pk_bf16_f32 v82, v212, v213
    v_accvgpr_read_b32 v214, a38
    v_accvgpr_read_b32 v215, a39
    v_cvt_pk_bf16_f32 v83, v214, v215
    v_accvgpr_read_b32 v216, a40
    v_mfma_f32_16x16x32_bf16 v[32:35], a[132:135], v[100:103], v[32:35]
    global_load_lds_dwordx4 v1, s[12:13] offset:0 sc1
    ds_read_b128 a[196:199], v2 offset:9216
    v_accvgpr_read_b32 v217, a41
    v_cvt_pk_bf16_f32 v84, v216, v217
    v_accvgpr_read_b32 v218, a42
    v_accvgpr_read_b32 v219, a43
    v_cvt_pk_bf16_f32 v85, v218, v219
    v_accvgpr_read_b32 v220, a44
    v_accvgpr_read_b32 v221, a45
    v_cvt_pk_bf16_f32 v86, v220, v221
    v_accvgpr_read_b32 v222, a46
    v_accvgpr_read_b32 v223, a47
    v_cvt_pk_bf16_f32 v87, v222, v223
    v_mfma_f32_16x16x32_bf16 v[32:35], a[136:139], v[104:107], v[32:35]
    global_load_lds_dwordx4 v1, s[12:13] offset:1024 sc1
    ds_read_b128 a[200:203], v2 offset:10240
    v_accvgpr_read_b32 v224, a48
    v_accvgpr_read_b32 v225, a49
    v_cvt_pk_bf16_f32 v88, v224, v225
    v_accvgpr_read_b32 v226, a50
    v_accvgpr_read_b32 v227, a51
    v_cvt_pk_bf16_f32 v89, v226, v227
    v_accvgpr_read_b32 v228, a52
    v_accvgpr_read_b32 v229, a53
    v_cvt_pk_bf16_f32 v90, v228, v229
    v_accvgpr_read_b32 v230, a54
    v_accvgpr_read_b32 v231, a55
    v_mfma_f32_16x16x32_bf16 v[32:35], a[140:143], v[108:111], v[32:35]
    global_load_lds_dwordx4 v1, s[12:13] offset:2048 sc1
    ds_read_b128 a[204:207], v2 offset:11264
    v_cvt_pk_bf16_f32 v91, v230, v231
    v_accvgpr_read_b32 v232, a56
    v_accvgpr_read_b32 v233, a57
    v_cvt_pk_bf16_f32 v92, v232, v233
    v_accvgpr_read_b32 v234, a58
    v_accvgpr_read_b32 v235, a59
    v_cvt_pk_bf16_f32 v93, v234, v235
    v_accvgpr_read_b32 v236, a60
    v_accvgpr_read_b32 v237, a61
    v_cvt_pk_bf16_f32 v94, v236, v237
    v_accvgpr_read_b32 v238, a62
    v_accvgpr_read_b32 v239, a63
    v_cvt_pk_bf16_f32 v95, v238, v239
    v_accvgpr_read_b32 v208, a0
    v_accvgpr_read_b32 v209, a1
    v_mfma_f32_16x16x32_bf16 v[28:31], a[128:131], v[80:83], 0
    global_load_lds_dwordx4 v1, s[12:13] offset:3072 sc1
    ds_read_b128 a[208:211], v2 offset:12288
    v_cvt_pk_bf16_f32 v64, v208, v209
    v_accvgpr_read_b32 v210, a2
    v_accvgpr_read_b32 v211, a3
    v_cvt_pk_bf16_f32 v65, v210, v211
    v_accvgpr_read_b32 v212, a4
    v_accvgpr_read_b32 v213, a5
    v_cvt_pk_bf16_f32 v66, v212, v213
    v_accvgpr_read_b32 v214, a6
    v_accvgpr_read_b32 v215, a7
    v_cvt_pk_bf16_f32 v67, v214, v215
    v_accvgpr_read_b32 v216, a8
    v_accvgpr_read_b32 v217, a9
    v_cvt_pk_bf16_f32 v68, v216, v217
    v_mfma_f32_16x16x32_bf16 v[28:31], a[132:135], v[84:87], v[28:31]
    s_mov_b32 m0, s46
    ds_read_b128 a[212:215], v2 offset:13312
    v_accvgpr_read_b32 v218, a10
    v_accvgpr_read_b32 v219, a11
    v_cvt_pk_bf16_f32 v69, v218, v219
    v_accvgpr_read_b32 v220, a12
    v_accvgpr_read_b32 v221, a13
    v_cvt_pk_bf16_f32 v70, v220, v221
    v_accvgpr_read_b32 v222, a14
    v_accvgpr_read_b32 v223, a15
    v_cvt_pk_bf16_f32 v71, v222, v223
    v_accvgpr_read_b32 v224, a16
    v_accvgpr_read_b32 v225, a17
    v_cvt_pk_bf16_f32 v72, v224, v225
    v_accvgpr_read_b32 v226, a18
    v_mfma_f32_16x16x32_bf16 v[28:31], a[136:139], v[88:91], v[28:31]
    global_load_lds_dwordx4 v3, s[12:13] offset:0 sc1
    ds_read_b128 a[216:219], v2 offset:14336
    v_accvgpr_read_b32 v227, a19
    v_cvt_pk_bf16_f32 v73, v226, v227
    v_accvgpr_read_b32 v228, a20
    v_accvgpr_read_b32 v229, a21
    v_cvt_pk_bf16_f32 v74, v228, v229
    v_accvgpr_read_b32 v230, a22
    v_accvgpr_read_b32 v231, a23
    v_cvt_pk_bf16_f32 v75, v230, v231
    v_accvgpr_read_b32 v232, a24
    v_accvgpr_read_b32 v233, a25
    v_cvt_pk_bf16_f32 v76, v232, v233
    v_accvgpr_read_b32 v234, a26
    v_accvgpr_read_b32 v235, a27
    v_mfma_f32_16x16x32_bf16 v[28:31], a[140:143], v[92:95], v[28:31]
    global_load_lds_dwordx4 v3, s[12:13] offset:1024 sc1
    ds_read_b128 a[220:223], v2 offset:15360
    v_cvt_pk_bf16_f32 v77, v234, v235
    v_accvgpr_read_b32 v236, a28
    v_accvgpr_read_b32 v237, a29
    v_cvt_pk_bf16_f32 v78, v236, v237
    v_accvgpr_read_b32 v238, a30
    v_accvgpr_read_b32 v239, a31
    v_cvt_pk_bf16_f32 v79, v238, v239
    v_cmp_le_i32 s[74:75], 0, v4
    v_cmp_le_i32 s[76:77], 1, v4
    v_cmp_le_i32 s[78:79], 2, v4
    v_cmp_le_i32 s[80:81], 3, v4
    v_cndmask_b32_e64 v8, v7, 0, s[74:75]
    v_cndmask_b32_e64 v9, v7, 0, s[76:77]
    v_cndmask_b32_e64 v10, v7, 0, s[78:79]
    v_cndmask_b32_e64 v11, v7, 0, s[80:81]
    v_cmp_le_i32 s[74:75], 17, v6
    v_cmp_le_i32 s[76:77], 18, v6
    v_mfma_f32_16x16x32_bf16 v[24:27], a[128:131], v[64:67], v[8:11]
    global_load_lds_dwordx4 v3, s[12:13] offset:2048 sc1
    v_cmp_le_i32 s[78:79], 19, v6
    v_cmp_le_i32 s[80:81], 32, v6
    v_cmp_le_i32 s[90:91], 49, v6
    v_cmp_le_i32 s[92:93], 50, v6
    v_mfma_f32_16x16x32_bf16 v[24:27], a[132:135], v[68:71], v[24:27]
    v_mov_b32 v0, v17
    v_mov_b32 v6, 0x67800000
    v_mov_b32 v56, 0
    v_mov_b32 v57, 0
    v_mfma_f32_16x16x32_bf16 v[24:27], a[136:139], v[72:75], v[24:27]
    global_load_lds_dwordx4 v3, s[12:13] offset:3072 sc1
    v_mov_b32 v58, 0
    v_mov_b32 v59, 0
    v_mov_b32 v60, 0
    v_mov_b32 v61, 0
    v_mfma_f32_16x16x32_bf16 v[24:27], a[140:143], v[76:79], v[24:27]
    s_mov_b32 m0, s47
    v_mov_b32 v62, 0
    v_mov_b32 v63, 0
    v_accvgpr_write_b32 a0, v204
    v_accvgpr_write_b32 a1, v204
    v_accvgpr_write_b32 a2, v204
    v_accvgpr_write_b32 a3, v204
    v_mfma_f32_32x32x16_bf16 v[128:143], v[56:59], v[56:59], 0
    v_max3_f32 v14, v36, v37, v38
    v_max_f32 v14, v14, v39
    v_max3_f32 v12, v32, v33, v34
    v_max_f32 v12, v12, v35
    v_max3_f32 v10, v28, v29, v30
    v_mfma_f32_32x32x16_bf16 v[144:159], v[56:59], v[56:59], 0
    v_max_f32 v10, v10, v31
    v_max3_f32 v8, v24, v25, v26
    v_max_f32 v8, v8, v27
    v_mov_b32 v15, v14
    v_mov_b32 v13, v12
    v_mfma_f32_32x32x16_bf16 v[160:175], v[56:59], v[56:59], 0
    v_mov_b32 v11, v10
    v_mov_b32 v9, v8
    v_permlane32_swap_b32 v14, v15
    v_permlane32_swap_b32 v12, v13
    v_permlane32_swap_b32 v10, v11
    v_mfma_f32_32x32x16_bf16 v[176:191], v[56:59], v[56:59], 0
    v_permlane32_swap_b32 v8, v9
    v_max_f32 v14, v14, v15
    v_max_f32 v12, v12, v13
    v_max_f32 v10, v10, v11
    v_max_f32 v8, v8, v9
    v_mfma_f32_32x32x16_bf16 v[192:207], v[56:59], v[56:59], 0
    v_mov_b32 v15, v14
    v_mov_b32 v13, v12
    v_mov_b32 v11, v10
    v_mov_b32 v9, v8
    v_permlane16_swap_b32 v14, v15
    v_mfma_f32_32x32x16_bf16 v[208:223], v[56:59], v[56:59], 0
    v_permlane16_swap_b32 v12, v13
    v_permlane16_swap_b32 v10, v11
    v_permlane16_swap_b32 v8, v9
    v_max_f32 v14, v14, v15
    v_max_f32 v12, v12, v13
    v_mfma_f32_32x32x16_bf16 v[224:239], v[56:59], v[56:59], 0
    v_max_f32 v10, v10, v11
    v_max_f32 v8, v8, v9
    v_sub_f32 v52, 0, v14
    v_sub_f32 v53, 0, v14
    v_sub_f32 v54, 0, v14
    v_mfma_f32_32x32x16_bf16 v[240:255], v[56:59], v[56:59], 0
    v_sub_f32 v55, 0, v14
    s_waitcnt lgkmcnt(0)
L_att_go:
    v_mov_b32 v2, v1
    v_mov_b32 v36, 0
    v_mov_b32 v4, 0x200
    v_mfma_f32_16x16x32_bf16 v[16:19], a[128:131], v[112:115], v[52:55]
    v_sub_f32 v48, 0, v12
    v_sub_f32 v49, 0, v12
    v_mfma_f32_16x16x32_bf16 v[16:19], a[132:135], v[116:119], v[16:19]
    v_sub_f32 v50, 0, v12
    v_sub_f32 v51, 0, v12
    v_mfma_f32_16x16x32_bf16 v[16:19], a[136:139], v[120:123], v[16:19]
    v_sub_f32 v44, 0, v10
    v_sub_f32 v45, 0, v10
    v_mfma_f32_16x16x32_bf16 v[16:19], a[140:143], v[124:127], v[16:19]
    v_sub_f32 v46, 0, v10
    v_sub_f32 v47, 0, v10
    v_mfma_f32_16x16x32_bf16 v[20:23], a[144:147], v[112:115], v[52:55]
    s_waitcnt vmcnt(12)
    v_sub_f32 v40, 0, v8
    v_sub_f32 v41, 0, v8
    v_mfma_f32_16x16x32_bf16 v[20:23], a[148:151], v[116:119], v[20:23]
    s_barrier
    v_sub_f32 v42, 0, v8
    v_sub_f32 v43, 0, v8
    v_mfma_f32_16x16x32_bf16 v[20:23], a[152:155], v[120:123], v[20:23]
    s_cmp_lg_u32 s53, 0
    s_cbranch_scc1 L_s2_wb
L_s2_pub:
    buffer_store_dword v4, v1, s[48:51], 0 offen sc1
    v_mov_b32 v37, 0
    v_mov_b32 v38, 0
    v_mfma_f32_16x16x32_bf16 v[20:23], a[156:159], v[124:127], v[20:23]
    v_mov_b32 v39, 0
    s_cmp_eq_u32 s33, 0
    s_waitcnt lgkmcnt(0)
    s_cbranch_scc1 L_att_d0
.p2align 6
L_att_l4:
    v_mfma_f32_16x16x32_bf16 v[24:27], a[128:131], v[64:67], v[40:43]
    v_exp_f32 v16, v16
    v_mfma_f32_16x16x32_bf16 v[24:27], a[132:135], v[68:71], v[24:27]
    s_add_u32 s62, m0, 16384
    global_load_lds_dwordx4 v1, s[14:15] offset:0 sc1
    v_exp_f32 v17, v17
    v_mfma_f32_16x16x32_bf16 v[24:27], a[136:139], v[72:75], v[24:27]
    s_and_b32 s62, s62, 0x1ffff
    ds_read_b128 a[160:163], v2 offset:0
    v_add_f32 v62, v62, v16
    v_mfma_f32_16x16x32_bf16 v[24:27], a[140:143], v[76:79], v[24:27]
    s_add_u32 s98, s62, 16384
    v_exp_f32 v18, v18
    v_mfma_f32_16x16x32_bf16 v[28:31], a[144:147], v[64:67], v[40:43]
    s_and_b32 s98, s98, 0x1ffff
    v_add_f32 v63, v63, v17
    v_cvt_pk_bf16_f32 v32, v16, v17
    v_mfma_f32_16x16x32_bf16 v[28:31], a[148:151], v[68:71], v[28:31]
    s_add_u32 s96, s96, 32768
    global_load_lds_dwordx4 v1, s[14:15] offset:1024 sc1
    v_exp_f32 v19, v19
    v_mfma_f32_16x16x32_bf16 v[28:31], a[152:155], v[72:75], v[28:31]
    s_and_b32 s96, s96, 0x1ffff
    ds_read_b128 a[164:167], v2 offset:1024
    v_add_f32 v62, v62, v18
    v_mfma_f32_16x16x32_bf16 v[28:31], a[156:159], v[76:79], v[28:31]
    s_add_u32 s18, s14, 32768
    v_exp_f32 v20, v20
    v_mfma_f32_16x16x32_bf16 v[192:195], a[224:227], v[36:39], v[192:195]
    s_addc_u32 s19, s15, 0
    v_add_f32 v63, v63, v19
    v_cvt_pk_bf16_f32 v33, v18, v19
    v_mfma_f32_16x16x32_bf16 v[196:199], a[228:231], v[36:39], v[196:199]
    s_sub_u32 s97, s97, 1
    global_load_lds_dwordx4 v1, s[14:15] offset:2048 sc1
    v_exp_f32 v21, v21
    v_mfma_f32_16x16x32_bf16 v[200:203], a[232:235], v[36:39], v[200:203]
    s_cmp_eq_u32 s97, 0
    ds_read_b128 a[168:171], v2 offset:2048
    v_add_f32 v62, v62, v20
    v_mfma_f32_16x16x32_bf16 v[204:207], a[236:239], v[36:39], v[204:207]
    s_cselect_b64 s[18:19], s[16:17], s[18:19]
    v_exp_f32 v22, v22
    v_mfma_f32_16x16x32_bf16 v[208:211], a[240:243], v[36:39], v[208:211]
    v_add_f32 v63, v63, v21
    v_cvt_pk_bf16_f32 v34, v20, v21
    v_mfma_f32_16x16x32_bf16 v[212:215], a[244:247], v[36:39], v[212:215]
    global_load_lds_dwordx4 v1, s[14:15] offset:3072 sc1
    v_exp_f32 v23, v23
    v_mfma_f32_16x16x32_bf16 v[216:219], a[248:251], v[36:39], v[216:219]
    s_mov_b32 m0, s62
    ds_read_b128 a[172:175], v2 offset:3072
    v_add_f32 v62, v62, v22
    v_mfma_f32_16x16x32_bf16 v[220:223], a[252:255], v[36:39], v[220:223]
    v_add_f32 v63, v63, v23
    v_cvt_pk_bf16_f32 v35, v22, v23
    v_mfma_f32_16x16x32_bf16 v[16:19], a[128:131], v[80:83], v[44:47]
    v_exp_f32 v24, v24
    v_mfma_f32_16x16x32_bf16 v[16:19], a[132:135], v[84:87], v[16:19]
    global_load_lds_dwordx4 v3, s[14:15] offset:0 sc1
    v_exp_f32 v25, v25
    v_mfma_f32_16x16x32_bf16 v[16:19], a[136:139], v[88:91], v[16:19]
    ds_read_b128 a[176:179], v2 offset:4096
    v_add_f32 v56, v56, v24
    v_mfma_f32_16x16x32_bf16 v[16:19], a[140:143], v[92:95], v[16:19]
    v_exp_f32 v26, v26
    v_mfma_f32_16x16x32_bf16 v[20:23], a[144:147], v[80:83], v[44:47]
    v_add_f32 v57, v57, v25
    v_cvt_pk_bf16_f32 v36, v24, v25
    v_mfma_f32_16x16x32_bf16 v[20:23], a[148:151], v[84:87], v[20:23]
    global_load_lds_dwordx4 v3, s[14:15] offset:1024 sc1
    v_exp_f32 v27, v27
    v_mfma_f32_16x16x32_bf16 v[20:23], a[152:155], v[88:91], v[20:23]
    ds_read_b128 a[180:183], v2 offset:5120
    v_add_f32 v56, v56, v26
    v_mfma_f32_16x16x32_bf16 v[20:23], a[156:159], v[92:95], v[20:23]
    s_waitcnt lgkmcnt(2)
    v_exp_f32 v28, v28
    v_mfma_f32_16x16x32_bf16 v[224:227], a[192:195], v[32:35], v[224:227]
    v_add_f32 v57, v57, v27
    v_cvt_pk_bf16_f32 v37, v26, v27
    v_mfma_f32_16x16x32_bf16 v[228:231], a[196:199], v[32:35], v[228:231]
    global_load_lds_dwordx4 v3, s[14:15] offset:2048 sc1
    v_exp_f32 v29, v29
    v_mfma_f32_16x16x32_bf16 v[232:235], a[200:203], v[32:35], v[232:235]
    ds_read_b128 a[184:187], v2 offset:6144
    v_add_f32 v56, v56, v28
    v_mfma_f32_16x16x32_bf16 v[236:239], a[204:207], v[32:35], v[236:239]
    v_exp_f32 v30, v30
    v_mfma_f32_16x16x32_bf16 v[240:243], a[208:211], v[32:35], v[240:243]
    v_add_f32 v57, v57, v29
    v_cvt_pk_bf16_f32 v38, v28, v29
    v_mfma_f32_16x16x32_bf16 v[244:247], a[212:215], v[32:35], v[244:247]
    global_load_lds_dwordx4 v3, s[14:15] offset:3072 sc1
    v_exp_f32 v31, v31
    v_mfma_f32_16x16x32_bf16 v[248:251], a[216:219], v[32:35], v[248:251]
    s_mov_b32 m0, s98
    ds_read_b128 a[188:191], v2 offset:7168
    v_add_f32 v56, v56, v30
    v_mfma_f32_16x16x32_bf16 v[252:255], a[220:223], v[32:35], v[252:255]
    s_mov_b64 s[14:15], s[18:19]
    v_add_f32 v57, v57, v31
    v_cvt_pk_bf16_f32 v39, v30, v31
    v_mfma_f32_16x16x32_bf16 v[24:27], a[128:131], v[96:99], v[48:51]
    v_exp_f32 v16, v16
    v_mfma_f32_16x16x32_bf16 v[24:27], a[132:135], v[100:103], v[24:27]
    v_exp_f32 v17, v17
    v_mfma_f32_16x16x32_bf16 v[24:27], a[136:139], v[104:107], v[24:27]
    ds_read_b128 a[224:227], v2 offset:8192
    v_add_f32 v58, v58, v16
    v_mfma_f32_16x16x32_bf16 v[24:27], a[140:143], v[108:111], v[24:27]
    v_exp_f32 v18, v18
    v_mfma_f32_16x16x32_bf16 v[28:31], a[144:147], v[96:99], v[48:51]
    v_add_f32 v59, v59, v17
    v_cvt_pk_bf16_f32 v32, v16, v17
    v_mfma_f32_16x16x32_bf16 v[28:31], a[148:151], v[100:103], v[28:31]
    v_exp_f32 v19, v19
    v_mfma_f32_16x16x32_bf16 v[28:31], a[152:155], v[104:107], v[28:31]
    ds_read_b128 a[228:231], v2 offset:9216
    v_add_f32 v58, v58, v18
    v_mfma_f32_16x16x32_bf16 v[28:31], a[156:159], v[108:111], v[28:31]
    v_exp_f32 v20, v20
    v_mfma_f32_16x16x32_bf16 v[128:131], a[192:195], v[36:39], v[128:131]
    v_add_f32 v59, v59, v19
    v_cvt_pk_bf16_f32 v33, v18, v19
    v_mfma_f32_16x16x32_bf16 v[132:135], a[196:199], v[36:39], v[132:135]
    v_exp_f32 v21, v21
    v_mfma_f32_16x16x32_bf16 v[136:139], a[200:203], v[36:39], v[136:139]
    ds_read_b128 a[232:235], v2 offset:10240
    v_add_f32 v58, v58, v20
    v_mfma_f32_16x16x32_bf16 v[140:143], a[204:207], v[36:39], v[140:143]
    v_exp_f32 v22, v22
    v_mfma_f32_16x16x32_bf16 v[144:147], a[208:211], v[36:39], v[144:147]
    v_add_f32 v59, v59, v21
    v_cvt_pk_bf16_f32 v34, v20, v21
    v_mfma_f32_16x16x32_bf16 v[148:151], a[212:215], v[36:39], v[148:151]
    v_exp_f32 v23, v23
    v_mfma_f32_16x16x32_bf16 v[152:155], a[216:219], v[36:39], v[152:155]
    ds_read_b128 a[236:239], v2 offset:11264
    v_add_f32 v58, v58, v22
    v_mfma_f32_16x16x32_bf16 v[156:159], a[220:223], v[36:39], v[156:159]
    v_add_f32 v59, v59, v23
    v_cvt_pk_bf16_f32 v35, v22, v23
    v_mfma_f32_16x16x32_bf16 v[16:19], a[160:163], v[112:115], v[52:55]
    v_exp_f32 v24, v24
    v_mfma_f32_16x16x32_bf16 v[16:19], a[164:167], v[116:119], v[16:19]
    v_exp_f32 v25, v25
    v_mfma_f32_16x16x32_bf16 v[16:19], a[168:171], v[120:123], v[16:19]
    ds_read_b128 a[240:243], v2 offset:12288
    v_add_f32 v60, v60, v24
    v_mfma_f32_16x16x32_bf16 v[16:19], a[172:175], v[124:127], v[16:19]
    s_waitcnt lgkmcnt(2)
    v_exp_f32 v26, v26
    v_mfma_f32_16x16x32_bf16 v[20:23], a[176:179], v[112:115], v[52:55]
    v_add_f32 v61, v61, v25
    v_cvt_pk_bf16_f32 v36, v24, v25
    v_mfma_f32_16x16x32_bf16 v[20:23], a[180:183], v[116:119], v[20:23]
    v_exp_f32 v27, v27
    v_mfma_f32_16x16x32_bf16 v[20:23], a[184:187], v[120:123], v[20:23]
    ds_read_b128 a[244:247], v2 offset:13312
    v_add_f32 v60, v60, v26
    v_mfma_f32_16x16x32_bf16 v[20:23], a[188:191], v[124:127], v[20:23]
    v_exp_f32 v28, v28
    v_mfma_f32_16x16x32_bf16 v[160:163], a[192:195], v[32:35], v[160:163]
    v_add_f32 v61, v61, v27
    v_cvt_pk_bf16_f32 v37, v26, v27
    v_mfma_f32_16x16x32_bf16 v[164:167], a[196:199], v[32:35], v[164:167]
    v_exp_f32 v29, v29
    v_mfma_f32_16x16x32_bf16 v[168:171], a[200:203], v[32:35], v[168:171]
    ds_read_b128 a[248:251], v2 offset:14336
    v_add_f32 v60, v60, v28
    v_mfma_f32_16x16x32_bf16 v[172:175], a[204:207], v[32:35], v[172:175]
    v_exp_f32 v30, v30
    v_mfma_f32_16x16x32_bf16 v[176:179], a[208:211], v[32:35], v[176:179]
    v_add_f32 v61, v61, v29
    v_cvt_pk_bf16_f32 v38, v28, v29
    v_mfma_f32_16x16x32_bf16 v[180:183], a[212:215], v[32:35], v[180:183]
    v_exp_f32 v31, v31
    v_mfma_f32_16x16x32_bf16 v[184:187], a[216:219], v[32:35], v[184:187]
    ds_read_b128 a[252:255], v2 offset:15360
    v_add_f32 v60, v60, v30
    v_mfma_f32_16x16x32_bf16 v[188:191], a[220:223], v[32:35], v[188:191]
    v_add_f32 v61, v61, v31
    v_cvt_pk_bf16_f32 v39, v30, v31
    v_mfma_f32_16x16x32_bf16 v[24:27], a[160:163], v[64:67], v[40:43]
    v_exp_f32 v16, v16
    v_mfma_f32_16x16x32_bf16 v[24:27], a[164:167], v[68:71], v[24:27]
    v_exp_f32 v17, v17
    v_mfma_f32_16x16x32_bf16 v[24:27], a[168:171], v[72:75], v[24:27]
    ds_read_b128 a[128:131], v2 offset:16384
    v_add_f32 v62, v62, v16
    v_mfma_f32_16x16x32_bf16 v[24:27], a[172:175], v[76:79], v[24:27]
    v_exp_f32 v18, v18
    v_mfma_f32_16x16x32_bf16 v[28:31], a[176:179], v[64:67], v[40:43]
    v_add_f32 v63, v63, v17
    v_cvt_pk_bf16_f32 v32, v16, v17
    v_mfma_f32_16x16x32_bf16 v[28:31], a[180:183], v[68:71], v[28:31]
    v_exp_f32 v19, v19
    v_mfma_f32_16x16x32_bf16 v[28:31], a[184:187], v[72:75], v[28:31]
    ds_read_b128 a[132:135], v2 offset:17408
    v_add_f32 v62, v62, v18
    v_mfma_f32_16x16x32_bf16 v[28:31], a[188:191], v[76:79], v[28:31]
    v_exp_f32 v20, v20
    v_mfma_f32_16x16x32_bf16 v[192:195], a[192:195], v[36:39], v[192:195]
    v_add_f32 v63, v63, v19
    v_cvt_pk_bf16_f32 v33, v18, v19
    v_mfma_f32_16x16x32_bf16 v[196:199], a[196:199], v[36:39], v[196:199]
    v_exp_f32 v21, v21
    v_mfma_f32_16x16x32_bf16 v[200:203], a[200:203], v[36:39], v[200:203]
    ds_read_b128 a[136:139], v2 offset:18432
    v_add_f32 v62, v62, v20
    v_mfma_f32_16x16x32_bf16 v[204:207], a[204:207], v[36:39], v[204:207]
    v_exp_f32 v22, v22
    v_mfma_f32_16x16x32_bf16 v[208:211], a[208:211], v[36:39], v[208:211]
    v_add_f32 v63, v63, v21
    v_cvt_pk_bf16_f32 v34, v20, v21
    v_mfma_f32_16x16x32_bf16 v[212:215], a[212:215], v[36:39], v[212:215]
    v_exp_f32 v23, v23
    v_mfma_f32_16x16x32_bf16 v[216:219], a[216:219], v[36:39], v[216:219]
    ds_read_b128 a[140:143], v2 offset:19456
    v_add_f32 v62, v62, v22
    v_mfma_f32_16x16x32_bf16 v[220:223], a[220:223], v[36:39], v[220:223]
    v_add_f32 v63, v63, v23
    v_cvt_pk_bf16_f32 v35, v22, v23
    v_mfma_f32_16x16x32_bf16 v[16:19], a[160:163], v[80:83], v[44:47]
    v_exp_f32 v24, v24
    v_mfma_f32_16x16x32_bf16 v[16:19], a[164:167], v[84:87], v[16:19]
    v_exp_f32 v25, v25
    v_mfma_f32_16x16x32_bf16 v[16:19], a[168:171], v[88:91], v[16:19]
    ds_read_b128 a[144:147], v2 offset:20480
    v_add_f32 v56, v56, v24
    v_mfma_f32_16x16x32_bf16 v[16:19], a[172:175], v[92:95], v[16:19]
    v_exp_f32 v26, v26
    v_mfma_f32_16x16x32_bf16 v[20:23], a[176:179], v[80:83], v[44:47]
    v_add_f32 v57, v57, v25
    v_cvt_pk_bf16_f32 v36, v24, v25
    v_mfma_f32_16x16x32_bf16 v[20:23], a[180:183], v[84:87], v[20:23]
    v_exp_f32 v27, v27
    v_mfma_f32_16x16x32_bf16 v[20:23], a[184:187], v[88:91], v[20:23]
    ds_read_b128 a[148:151], v2 offset:21504
    v_add_f32 v56, v56, v26
    v_mfma_f32_16x16x32_bf16 v[20:23], a[188:191], v[92:95], v[20:23]
    v_exp_f32 v28, v28
    v_mfma_f32_16x16x32_bf16 v[224:227], a[224:227], v[32:35], v[224:227]
    v_add_f32 v57, v57, v27
    v_cvt_pk_bf16_f32 v37, v26, v27
    v_mfma_f32_16x16x32_bf16 v[228:231], a[228:231], v[32:35], v[228:231]
    v_exp_f32 v29, v29
    v_mfma_f32_16x16x32_bf16 v[232:235], a[232:235], v[32:35], v[232:235]
    s_waitcnt lgkmcnt(1)
    ds_read_b128 a[152:155], v2 offset:22528
    v_add_f32 v56, v56, v28
    v_mfma_f32_16x16x32_bf16 v[236:239], a[236:239], v[32:35], v[236:239]
    v_exp_f32 v30, v30
    v_mfma_f32_16x16x32_bf16 v[240:243], a[240:243], v[32:35], v[240:243]
    v_add_f32 v57, v57, v29
    v_cvt_pk_bf16_f32 v38, v28, v29
    v_mfma_f32_16x16x32_bf16 v[244:247], a[244:247], v[32:35], v[244:247]
    v_exp_f32 v31, v31
    v_mfma_f32_16x16x32_bf16 v[248:251], a[248:251], v[32:35], v[248:251]
    ds_read_b128 a[156:159], v2 offset:23552
    v_add_f32 v56, v56, v30
    v_mfma_f32_16x16x32_bf16 v[252:255], a[252:255], v[32:35], v[252:255]
    v_add_f32 v57, v57, v31
    v_cvt_pk_bf16_f32 v39, v30, v31
    v_mfma_f32_16x16x32_bf16 v[24:27], a[160:163], v[96:99], v[48:51]
    v_exp_f32 v16, v16
    v_mfma_f32_16x16x32_bf16 v[24:27], a[164:167], v[100:103], v[24:27]
    v_exp_f32 v17, v17
    v_mfma_f32_16x16x32_bf16 v[24:27], a[168:171], v[104:107], v[24:27]
    ds_read_b128 a[192:195], v2 offset:24576
    v_add_f32 v58, v58, v16
    v_mfma_f32_16x16x32_bf16 v[24:27], a[172:175], v[108:111], v[24:27]
    v_exp_f32 v18, v18
    v_mfma_f32_16x16x32_bf16 v[28:31], a[176:179], v[96:99], v[48:51]
    v_add_f32 v59, v59, v17
    v_cvt_pk_bf16_f32 v32, v16, v17
    v_mfma_f32_16x16x32_bf16 v[28:31], a[180:183], v[100:103], v[28:31]
    v_exp_f32 v19, v19
    v_mfma_f32_16x16x32_bf16 v[28:31], a[184:187], v[104:107], v[28:31]
    ds_read_b128 a[196:199], v2 offset:25600
    v_add_f32 v58, v58, v18
    v_mfma_f32_16x16x32_bf16 v[28:31], a[188:191], v[108:111], v[28:31]
    v_exp_f32 v20, v20
    v_mfma_f32_16x16x32_bf16 v[128:131], a[224:227], v[36:39], v[128:131]
    v_add_f32 v59, v59, v19
    v_cvt_pk_bf16_f32 v33, v18, v19
    v_mfma_f32_16x16x32_bf16 v[132:135], a[228:231], v[36:39], v[132:135]
    v_exp_f32 v21, v21
    v_mfma_f32_16x16x32_bf16 v[136:139], a[232:235], v[36:39], v[136:139]
    ds_read_b128 a[200:203], v2 offset:26624
    v_add_f32 v58, v58, v20
    v_mfma_f32_16x16x32_bf16 v[140:143], a[236:239], v[36:39], v[140:143]
    v_exp_f32 v22, v22
    v_mfma_f32_16x16x32_bf16 v[144:147], a[240:243], v[36:39], v[144:147]
    v_add_f32 v59, v59, v21
    v_cvt_pk_bf16_f32 v34, v20, v21
    v_mfma_f32_16x16x32_bf16 v[148:151], a[244:247], v[36:39], v[148:151]
    v_exp_f32 v23, v23
    v_mfma_f32_16x16x32_bf16 v[152:155], a[248:251], v[36:39], v[152:155]
    ds_read_b128 a[204:207], v2 offset:27648
    v_add_f32 v58, v58, v22
    v_mfma_f32_16x16x32_bf16 v[156:159], a[252:255], v[36:39], v[156:159]
    v_add_f32 v59, v59, v23
    v_cvt_pk_bf16_f32 v35, v22, v23
    v_mfma_f32_16x16x32_bf16 v[16:19], a[128:131], v[112:115], v[52:55]
    v_exp_f32 v24, v24
    v_mfma_f32_16x16x32_bf16 v[16:19], a[132:135], v[116:119], v[16:19]
    v_exp_f32 v25, v25
    v_mfma_f32_16x16x32_bf16 v[16:19], a[136:139], v[120:123], v[16:19]
    ds_read_b128 a[208:211], v2 offset:28672
    v_add_f32 v60, v60, v24
    v_mfma_f32_16x16x32_bf16 v[16:19], a[140:143], v[124:127], v[16:19]
    v_exp_f32 v26, v26
    v_mfma_f32_16x16x32_bf16 v[20:23], a[144:147], v[112:115], v[52:55]
    s_waitcnt lgkmcnt(1)
    v_add_f32 v61, v61, v25
    v_cvt_pk_bf16_f32 v36, v24, v25
    v_mfma_f32_16x16x32_bf16 v[20:23], a[148:151], v[116:119], v[20:23]
    v_exp_f32 v27, v27
    v_mfma_f32_16x16x32_bf16 v[20:23], a[152:155], v[120:123], v[20:23]
    ds_read_b128 a[212:215], v2 offset:29696
    v_add_f32 v60, v60, v26
    v_mfma_f32_16x16x32_bf16 v[20:23], a[156:159], v[124:127], v[20:23]
    v_exp_f32 v28, v28
    v_mfma_f32_16x16x32_bf16 v[160:163], a[224:227], v[32:35], v[160:163]
    s_waitcnt vmcnt(12)
    v_add_f32 v61, v61, v27
    v_cvt_pk_bf16_f32 v37, v26, v27
    v_mfma_f32_16x16x32_bf16 v[164:167], a[228:231], v[32:35], v[164:167]
    s_barrier
    v_exp_f32 v29, v29
    v_mfma_f32_16x16x32_bf16 v[168:171], a[232:235], v[32:35], v[168:171]
    s_add_u32 s99, s99, 1
    ds_read_b128 a[216:219], v2 offset:30720
    v_add_f32 v60, v60, v28
    v_mfma_f32_16x16x32_bf16 v[172:175], a[236:239], v[32:35], v[172:175]
    s_bitcmp1_b64 s[4:5], s99
    v_exp_f32 v30, v30
    v_mfma_f32_16x16x32_bf16 v[176:179], a[240:243], v[32:35], v[176:179]
    v_add_f32 v61, v61, v29
    v_cvt_pk_bf16_f32 v38, v28, v29
    v_mfma_f32_16x16x32_bf16 v[180:183], a[244:247], v[32:35], v[180:183]
    v_exp_f32 v31, v31
    v_mfma_f32_16x16x32_bf16 v[184:187], a[248:251], v[32:35], v[184:187]
    ds_read_b128 a[220:223], v2 offset:31744
    v_add_f32 v60, v60, v30
    v_mfma_f32_16x16x32_bf16 v[188:191], a[252:255], v[32:35], v[188:191]
    v_add_f32 v61, v61, v31
    v_cvt_pk_bf16_f32 v39, v30, v31
    v_add_u32 v2, s96, v1
    s_cbranch_scc0 L_att_l4
L_att_l4x:
    s_cmp_lg_u32 s99, 3
    s_cbranch_scc1 L_att_l4y
    global_load_dword v4, v5, s[44:45] sc1
    global_load_dword a4, v0, s[44:45] sc1
    s_branch L_att_l4
L_att_l4y:
    s_cmp_ge_u32 s99, 12
    s_cbranch_scc1 L_att_d0p
    s_cmp_lg_u32 s99, 4
    s_cbranch_scc1 L_att_d0
    s_waitcnt vmcnt(8)
    v_accvgpr_read_b32 v8, a4
    v_min_u32 v4, v4, v8
    v_cmp_gt_u32 vcc, 0x200, v4
    s_nop 1
    s_cbranch_vccnz L_ev0_slow
L_ev0_a:
    s_cmp_lg_u32 s33, 2
    s_cbranch_scc1 L_att_l4
L_att_d0:
    v_cndmask_b32_e64 v8, v7, v40, s[64:65]
    v_cndmask_b32_e64 v9, v7, v40, s[66:67]
    v_cndmask_b32_e64 v10, v7, v40, s[68:69]
    v_cndmask_b32_e64 v11, v7, v40, s[70:71]
    v_cndmask_b32_e64 v12, v7, v40, s[72:73]
    v_cndmask_b32_e64 v13, v7, v40, s[74:75]
    v_cndmask_b32_e64 v14, v7, v40, s[76:77]
    v_cndmask_b32_e64 v15, v7, v40, s[78:79]
    v_mfma_f32_16x16x32_bf16 v[24:27], a[128:131], v[64:67], v[8:11]
    v_exp_f32 v16, v16
    v_mfma_f32_16x16x32_bf16 v[24:27], a[132:135], v[68:71], v[24:27]
    s_add_u32 s62, m0, 16384
    global_load_lds_dwordx4 v1, s[14:15] offset:0 sc1
    v_exp_f32 v17, v17
    v_mfma_f32_16x16x32_bf16 v[24:27], a[136:139], v[72:75], v[24:27]
    s_and_b32 s62, s62, 0x1ffff
    ds_read_b128 a[160:163], v2 offset:0
    v_add_f32 v62, v62, v16
    v_mfma_f32_16x16x32_bf16 v[24:27], a[140:143], v[76:79], v[24:27]
    s_add_u32 s98, s62, 16384
    v_exp_f32 v18, v18
    v_mfma_f32_16x16x32_bf16 v[28:31], a[144:147], v[64:67], v[12:15]
    s_and_b32 s98, s98, 0x1ffff
    v_add_f32 v63, v63, v17
    v_cvt_pk_bf16_f32 v32, v16, v17
    v_mfma_f32_16x16x32_bf16 v[28:31], a[148:151], v[68:71], v[28:31]
    s_add_u32 s96, s96, 32768
    global_load_lds_dwordx4 v1, s[14:15] offset:1024 sc1
    v_exp_f32 v19, v19
    v_mfma_f32_16x16x32_bf16 v[28:31], a[152:155], v[72:75], v[28:31]
    s_and_b32 s96, s96, 0x1ffff
    ds_read_b128 a[164:167], v2 offset:1024
    v_add_f32 v62, v62, v18
    v_mfma_f32_16x16x32_bf16 v[28:31], a[156:159], v[76:79], v[28:31]
    s_add_u32 s18, s14, 32768
    v_exp_f32 v20, v20
    v_mfma_f32_16x16x32_bf16 v[192:195], a[224:227], v[36:39], v[192:195]
    s_addc_u32 s19, s15, 0
    v_add_f32 v63, v63, v19
    v_cvt_pk_bf16_f32 v33, v18, v19
    v_mfma_f32_16x16x32_bf16 v[196:199], a[228:231], v[36:39], v[196:199]
    s_sub_u32 s97, s97, 1
    global_load_lds_dwordx4 v1, s[14:15] offset:2048 sc1
    v_exp_f32 v21, v21
    v_mfma_f32_16x16x32_bf16 v[200:203], a[232:235], v[36:39], v[200:203]
    s_cmp_eq_u32 s97, 0
    ds_read_b128 a[168:171], v2 offset:2048
    v_add_f32 v62, v62, v20
    v_mfma_f32_16x16x32_bf16 v[204:207], a[236:239], v[36:39], v[204:207]
    s_cselect_b64 s[18:19], s[16:17], s[18:19]
    v_exp_f32 v22, v22
    v_mfma_f32_16x16x32_bf16 v[208:211], a[240:243], v[36:39], v[208:211]
    v_add_f32 v63, v63, v21
    v_cvt_pk_bf16_f32 v34, v20, v21
    v_mfma_f32_16x16x32_bf16 v[212:215], a[244:247], v[36:39], v[212:215]
    global_load_lds_dwordx4 v1, s[14:15] offset:3072 sc1
    v_exp_f32 v23, v23
    v_mfma_f32_16x16x32_bf16 v[216:219], a[248:251], v[36:39], v[216:219]
    s_mov_b32 m0, s62
    ds_read_b128 a[172:175], v2 offset:3072
    v_add_f32 v62, v62, v22
    v_mfma_f32_16x16x32_bf16 v[220:223], a[252:255], v[36:39], v[220:223]
    v_add_f32 v63, v63, v23
    v_cvt_pk_bf16_f32 v35, v22, v23
    v_mfma_f32_16x16x32_bf16 v[16:19], a[128:131], v[80:83], v[44:47]
    v_exp_f32 v24, v24
    v_mfma_f32_16x16x32_bf16 v[16:19], a[132:135], v[84:87], v[16:19]
    global_load_lds_dwordx4 v3, s[14:15] offset:0 sc1
    v_exp_f32 v25, v25
    v_mfma_f32_16x16x32_bf16 v[16:19], a[136:139], v[88:91], v[16:19]
    ds_read_b128 a[176:179], v2 offset:4096
    v_add_f32 v56, v56, v24
    v_mfma_f32_16x16x32_bf16 v[16:19], a[140:143], v[92:95], v[16:19]
    v_exp_f32 v26, v26
    v_mfma_f32_16x16x32_bf16 v[20:23], a[144:147], v[80:83], v[44:47]
    v_add_f32 v57, v57, v25
    v_cvt_pk_bf16_f32 v36, v24, v25
    v_mfma_f32_16x16x32_bf16 v[20:23], a[148:151], v[84:87], v[20:23]
    global_load_lds_dwordx4 v3, s[14:15] offset:1024 sc1
    v_exp_f32 v27, v27
    v_mfma_f32_16x16x32_bf16 v[20:23], a[152:155], v[88:91], v[20:23]
    ds_read_b128 a[180:183], v2 offset:5120
    v_add_f32 v56, v56, v26
    v_mfma_f32_16x16x32_bf16 v[20:23], a[156:159], v[92:95], v[20:23]
    s_waitcnt lgkmcnt(2)
    v_exp_f32 v28, v28
    v_mfma_f32_16x16x32_bf16 v[224:227], a[192:195], v[32:35], v[224:227]
    v_add_f32 v57, v57, v27
    v_cvt_pk_bf16_f32 v37, v26, v27
    v_mfma_f32_16x16x32_bf16 v[228:231], a[196:199], v[32:35], v[228:231]
    global_load_lds_dwordx4 v3, s[14:15] offset:2048 sc1
    v_exp_f32 v29, v29
    v_mfma_f32_16x16x32_bf16 v[232:235], a[200:203], v[32:35], v[232:235]
    ds_read_b128 a[184:187], v2 offset:6144
    v_add_f32 v56, v56, v28
    v_mfma_f32_16x16x32_bf16 v[236:239], a[204:207], v[32:35], v[236:239]
    v_exp_f32 v30, v30
    v_mfma_f32_16x16x32_bf16 v[240:243], a[208:211], v[32:35], v[240:243]
    v_add_f32 v57, v57, v29
    v_cvt_pk_bf16_f32 v38, v28, v29
    v_mfma_f32_16x16x32_bf16 v[244:247], a[212:215], v[32:35], v[244:247]
    global_load_lds_dwordx4 v3, s[14:15] offset:3072 sc1
    v_exp_f32 v31, v31
    v_mfma_f32_16x16x32_bf16 v[248:251], a[216:219], v[32:35], v[248:251]
    s_mov_b32 m0, s98
    ds_read_b128 a[188:191], v2 offset:7168
    v_add_f32 v56, v56, v30
    v_mfma_f32_16x16x32_bf16 v[252:255], a[220:223], v[32:35], v[252:255]
    s_mov_b64 s[14:15], s[18:19]
    v_add_f32 v57, v57, v31
    v_cvt_pk_bf16_f32 v39, v30, v31
    v_mfma_f32_16x16x32_bf16 v[24:27], a[128:131], v[96:99], v[48:51]
    v_exp_f32 v16, v16
    v_mfma_f32_16x16x32_bf16 v[24:27], a[132:135], v[100:103], v[24:27]
    v_exp_f32 v17, v17
    v_mfma_f32_16x16x32_bf16 v[24:27], a[136:139], v[104:107], v[24:27]
    ds_read_b128 a[224:227], v2 offset:8192
    v_add_f32 v58, v58, v16
    v_mfma_f32_16x16x32_bf16 v[24:27], a[140:143], v[108:111], v[24:27]
    v_exp_f32 v18, v18
    v_mfma_f32_16x16x32_bf16 v[28:31], a[144:147], v[96:99], v[48:51]
    v_add_f32 v59, v59, v17
    v_cvt_pk_bf16_f32 v32, v16, v17
    v_mfma_f32_16x16x32_bf16 v[28:31], a[148:151], v[100:103], v[28:31]
    v_exp_f32 v19, v19
    v_mfma_f32_16x16x32_bf16 v[28:31], a[152:155], v[104:107], v[28:31]
    ds_read_b128 a[228:231], v2 offset:9216
    v_add_f32 v58, v58, v18
    v_mfma_f32_16x16x32_bf16 v[28:31], a[156:159], v[108:111], v[28:31]
    v_exp_f32 v20, v20
    v_mfma_f32_16x16x32_bf16 v[128:131], a[192:195], v[36:39], v[128:131]
    v_add_f32 v59, v59, v19
    v_cvt_pk_bf16_f32 v33, v18, v19
    v_mfma_f32_16x16x32_bf16 v[132:135], a[196:199], v[36:39], v[132:135]
    v_exp_f32 v21, v21
    v_mfma_f32_16x16x32_bf16 v[136:139], a[200:203], v[36:39], v[136:139]
    ds_read_b128 a[232:235], v2 offset:10240
    v_add_f32 v58, v58, v20
    v_mfma_f32_16x16x32_bf16 v[140:143], a[204:207], v[36:39], v[140:143]
    v_exp_f32 v22, v22
    v_mfma_f32_16x16x32_bf16 v[144:147], a[208:211], v[36:39], v[144:147]
    v_add_f32 v59, v59, v21
    v_cvt_pk_bf16_f32 v34, v20, v21
    v_mfma_f32_16x16x32_bf16 v[148:151], a[212:215], v[36:39], v[148:151]
    v_exp_f32 v23, v23
    v_mfma_f32_16x16x32_bf16 v[152:155], a[216:219], v[36:39], v[152:155]
    ds_read_b128 a[236:239], v2 offset:11264
    v_add_f32 v58, v58, v22
    v_mfma_f32_16x16x32_bf16 v[156:159], a[220:223], v[36:39], v[156:159]
    v_add_f32 v59, v59, v23
    v_cvt_pk_bf16_f32 v35, v22, v23
    v_mfma_f32_16x16x32_bf16 v[16:19], a[160:163], v[112:115], v[52:55]
    v_exp_f32 v24, v24
    v_mfma_f32_16x16x32_bf16 v[16:19], a[164:167], v[116:119], v[16:19]
    v_exp_f32 v25, v25
    v_mfma_f32_16x16x32_bf16 v[16:19], a[168:171], v[120:123], v[16:19]
    ds_read_b128 a[240:243], v2 offset:12288
    v_add_f32 v60, v60, v24
    v_mfma_f32_16x16x32_bf16 v[16:19], a[172:175], v[124:127], v[16:19]
    s_waitcnt lgkmcnt(2)
    v_exp_f32 v26, v26
    v_mfma_f32_16x16x32_bf16 v[20:23], a[176:179], v[112:115], v[52:55]
    v_add_f32 v61, v61, v25
    v_cvt_pk_bf16_f32 v36, v24, v25
    v_mfma_f32_16x16x32_bf16 v[20:23], a[180:183], v[116:119], v[20:23]
    v_exp_f32 v27, v27
    v_mfma_f32_16x16x32_bf16 v[20:23], a[184:187], v[120:123], v[20:23]
    ds_read_b128 a[244:247], v2 offset:13312
    v_add_f32 v60, v60, v26
    v_cndmask_b32_e64 v8, v7, v40, s[80:81]
    v_mfma_f32_16x16x32_bf16 v[20:23], a[188:191], v[124:127], v[20:23]
    v_exp_f32 v28, v28
    v_cndmask_b32_e64 v9, v7, v40, s[82:83]
    v_mfma_f32_16x16x32_bf16 v[160:163], a[192:195], v[32:35], v[160:163]
    v_add_f32 v61, v61, v27
    v_cvt_pk_bf16_f32 v37, v26, v27
    v_cndmask_b32_e64 v10, v7, v40, s[84:85]
    v_mfma_f32_16x16x32_bf16 v[164:167], a[196:199], v[32:35], v[164:167]
    v_exp_f32 v29, v29
    v_cndmask_b32_e64 v11, v7, v40, s[86:87]
    v_mfma_f32_16x16x32_bf16 v[168:171], a[200:203], v[32:35], v[168:171]
    ds_read_b128 a[248:251], v2 offset:14336
    v_add_f32 v60, v60, v28
    v_cndmask_b32_e64 v12, v7, v40, s[88:89]
    v_mfma_f32_16x16x32_bf16 v[172:175], a[204:207], v[32:35], v[172:175]
    v_exp_f32 v30, v30
    v_cndmask_b32_e64 v13, v7, v40, s[90:91]
    v_mfma_f32_16x16x32_bf16 v[176:179], a[208:211], v[32:35], v[176:179]
    v_add_f32 v61, v61, v29
    v_cvt_pk_bf16_f32 v38, v28, v29
    v_cndmask_b32_e64 v14, v7, v40, s[92:93]
    v_mfma_f32_16x16x32_bf16 v[180:183], a[212:215], v[32:35], v[180:183]
    v_exp_f32 v31, v31
    v_cndmask_b32_e64 v15, v7, v40, s[94:95]
    v_mfma_f32_16x16x32_bf16 v[184:187], a[216:219], v[32:35], v[184:187]
    ds_read_b128 a[252:255], v2 offset:15360
    v_add_f32 v60, v60, v30
    v_mfma_f32_16x16x32_bf16 v[188:191], a[220:223], v[32:35], v[188:191]
    v_add_f32 v61, v61, v31
    v_cvt_pk_bf16_f32 v39, v30, v31
    v_mfma_f32_16x16x32_bf16 v[24:27], a[160:163], v[64:67], v[8:11]
    v_exp_f32 v16, v16
    v_mfma_f32_16x16x32_bf16 v[24:27], a[164:167], v[68:71], v[24:27]
    v_exp_f32 v17, v17
    v_mfma_f32_16x16x32_bf16 v[24:27], a[168:171], v[72:75], v[24:27]
    ds_read_b128 a[128:131], v2 offset:16384
    v_add_f32 v62, v62, v16
    v_mfma_f32_16x16x32_bf16 v[24:27], a[172:175], v[76:79], v[24:27]
    v_exp_f32 v18, v18
    v_mfma_f32_16x16x32_bf16 v[28:31], a[176:179], v[64:67], v[12:15]
    v_add_f32 v63, v63, v17
    v_cvt_pk_bf16_f32 v32, v16, v17
    v_mfma_f32_16x16x32_bf16 v[28:31], a[180:183], v[68:71], v[28:31]
    v_exp_f32 v19, v19
    v_mfma_f32_16x16x32_bf16 v[28:31], a[184:187], v[72:75], v[28:31]
    ds_read_b128 a[132:135], v2 offset:17408
    v_add_f32 v62, v62, v18
    v_mfma_f32_16x16x32_bf16 v[28:31], a[188:191], v[76:79], v[28:31]
    v_exp_f32 v20, v20
    v_mfma_f32_16x16x32_bf16 v[192:195], a[192:195], v[36:39], v[192:195]
    v_add_f32 v63, v63, v19
    v_cvt_pk_bf16_f32 v33, v18, v19
    v_mfma_f32_16x16x32_bf16 v[196:199], a[196:199], v[36:39], v[196:199]
    v_exp_f32 v21, v21
    v_mfma_f32_16x16x32_bf16 v[200:203], a[200:203], v[36:39], v[200:203]
    ds_read_b128 a[136:139], v2 offset:18432
    v_add_f32 v62, v62, v20
    v_mfma_f32_16x16x32_bf16 v[204:207], a[204:207], v[36:39], v[204:207]
    v_exp_f32 v22, v22
    v_mfma_f32_16x16x32_bf16 v[208:211], a[208:211], v[36:39], v[208:211]
    v_add_f32 v63, v63, v21
    v_cvt_pk_bf16_f32 v34, v20, v21
    v_mfma_f32_16x16x32_bf16 v[212:215], a[212:215], v[36:39], v[212:215]
    v_exp_f32 v23, v23
    v_mfma_f32_16x16x32_bf16 v[216:219], a[216:219], v[36:39], v[216:219]
    ds_read_b128 a[140:143], v2 offset:19456
    v_add_f32 v62, v62, v22
    v_mfma_f32_16x16x32_bf16 v[220:223], a[220:223], v[36:39], v[220:223]
    v_add_f32 v63, v63, v23
    v_cvt_pk_bf16_f32 v35, v22, v23
    v_mfma_f32_16x16x32_bf16 v[16:19], a[160:163], v[80:83], v[44:47]
    v_exp_f32 v24, v24
    v_mfma_f32_16x16x32_bf16 v[16:19], a[164:167], v[84:87], v[16:19]
    v_exp_f32 v25, v25
    v_mfma_f32_16x16x32_bf16 v[16:19], a[168:171], v[88:91], v[16:19]
    ds_read_b128 a[144:147], v2 offset:20480
    v_add_f32 v56, v56, v24
    v_mfma_f32_16x16x32_bf16 v[16:19], a[172:175], v[92:95], v[16:19]
    v_exp_f32 v26, v26
    v_mfma_f32_16x16x32_bf16 v[20:23], a[176:179], v[80:83], v[44:47]
    v_add_f32 v57, v57, v25
    v_cvt_pk_bf16_f32 v36, v24, v25
    v_mfma_f32_16x16x32_bf16 v[20:23], a[180:183], v[84:87], v[20:23]
    v_exp_f32 v27, v27
    v_mfma_f32_16x16x32_bf16 v[20:23], a[184:187], v[88:91], v[20:23]
    ds_read_b128 a[148:151], v2 offset:21504
    v_add_f32 v56, v56, v26
    v_mfma_f32_16x16x32_bf16 v[20:23], a[188:191], v[92:95], v[20:23]
    v_exp_f32 v28, v28
    v_mfma_f32_16x16x32_bf16 v[224:227], a[224:227], v[32:35], v[224:227]
    v_add_f32 v57, v57, v27
    v_cvt_pk_bf16_f32 v37, v26, v27
    v_mfma_f32_16x16x32_bf16 v[228:231], a[228:231], v[32:35], v[228:231]
    v_exp_f32 v29, v29
    v_mfma_f32_16x16x32_bf16 v[232:235], a[232:235], v[32:35], v[232:235]
    s_waitcnt lgkmcnt(1)
    ds_read_b128 a[152:155], v2 offset:22528
    v_add_f32 v56, v56, v28
    v_mfma_f32_16x16x32_bf16 v[236:239], a[236:239], v[32:35], v[236:239]
    v_exp_f32 v30, v30
    v_mfma_f32_16x16x32_bf16 v[240:243], a[240:243], v[32:35], v[240:243]
    v_add_f32 v57, v57, v29
    v_cvt_pk_bf16_f32 v38, v28, v29
    v_mfma_f32_16x16x32_bf16 v[244:247], a[244:247], v[32:35], v[244:247]
    v_exp_f32 v31, v31
    v_mfma_f32_16x16x32_bf16 v[248:251], a[248:251], v[32:35], v[248:251]
    ds_read_b128 a[156:159], v2 offset:23552
    v_add_f32 v56, v56, v30
    v_mfma_f32_16x16x32_bf16 v[252:255], a[252:255], v[32:35], v[252:255]
    v_add_f32 v57, v57, v31
    v_cvt_pk_bf16_f32 v39, v30, v31
    v_mfma_f32_16x16x32_bf16 v[24:27], a[160:163], v[96:99], v[48:51]
    v_exp_f32 v16, v16
    v_mfma_f32_16x16x32_bf16 v[24:27], a[164:167], v[100:103], v[24:27]
    v_exp_f32 v17, v17
    v_mfma_f32_16x16x32_bf16 v[24:27], a[168:171], v[104:107], v[24:27]
    ds_read_b128 a[192:195], v2 offset:24576
    v_add_f32 v58, v58, v16
    v_mfma_f32_16x16x32_bf16 v[24:27], a[172:175], v[108:111], v[24:27]
    v_exp_f32 v18, v18
    v_mfma_f32_16x16x32_bf16 v[28:31], a[176:179], v[96:99], v[48:51]
    v_add_f32 v59, v59, v17
    v_cvt_pk_bf16_f32 v32, v16, v17
    v_mfma_f32_16x16x32_bf16 v[28:31], a[180:183], v[100:103], v[28:31]
    v_exp_f32 v19, v19
    v_mfma_f32_16x16x32_bf16 v[28:31], a[184:187], v[104:107], v[28:31]
    ds_read_b128 a[196:199], v2 offset:25600
    v_add_f32 v58, v58, v18
    v_mfma_f32_16x16x32_bf16 v[28:31], a[188:191], v[108:111], v[28:31]
    v_exp_f32 v20, v20
    v_mfma_f32_16x16x32_bf16 v[128:131], a[224:227], v[36:39], v[128:131]
    v_add_f32 v59, v59, v19
    v_cvt_pk_bf16_f32 v33, v18, v19
    v_mfma_f32_16x16x32_bf16 v[132:135], a[228:231], v[36:39], v[132:135]
    v_exp_f32 v21, v21
    v_mfma_f32_16x16x32_bf16 v[136:139], a[232:235], v[36:39], v[136:139]
    ds_read_b128 a[200:203], v2 offset:26624
    v_add_f32 v58, v58, v20
    v_mfma_f32_16x16x32_bf16 v[140:143], a[236:239], v[36:39], v[140:143]
    v_exp_f32 v22, v22
    v_mfma_f32_16x16x32_bf16 v[144:147], a[240:243], v[36:39], v[144:147]
    v_add_f32 v59, v59, v21
    v_cvt_pk_bf16_f32 v34, v20, v21
    v_mfma_f32_16x16x32_bf16 v[148:151], a[244:247], v[36:39], v[148:151]
    v_exp_f32 v23, v23
    v_mfma_f32_16x16x32_bf16 v[152:155], a[248:251], v[36:39], v[152:155]
    ds_read_b128 a[204:207], v2 offset:27648
    v_add_f32 v58, v58, v22
    v_mfma_f32_16x16x32_bf16 v[156:159], a[252:255], v[36:39], v[156:159]
    v_add_f32 v59, v59, v23
    v_cvt_pk_bf16_f32 v35, v22, v23
    v_mfma_f32_16x16x32_bf16 v[16:19], a[128:131], v[112:115], v[52:55]
    v_exp_f32 v24, v24
    v_mfma_f32_16x16x32_bf16 v[16:19], a[132:135], v[116:119], v[16:19]
    v_exp_f32 v25, v25
    v_mfma_f32_16x16x32_bf16 v[16:19], a[136:139], v[120:123], v[16:19]
    ds_read_b128 a[208:211], v2 offset:28672
    v_add_f32 v60, v60, v24
    v_mfma_f32_16x16x32_bf16 v[16:19], a[140:143], v[124:127], v[16:19]
    v_exp_f32 v26, v26
    v_mfma_f32_16x16x32_bf16 v[20:23], a[144:147], v[112:115], v[52:55]
    s_waitcnt lgkmcnt(1)
    v_add_f32 v61, v61, v25
    v_cvt_pk_bf16_f32 v36, v24, v25
    v_mfma_f32_16x16x32_bf16 v[20:23], a[148:151], v[116:119], v[20:23]
    v_exp_f32 v27, v27
    v_mfma_f32_16x16x32_bf16 v[20:23], a[152:155], v[120:123], v[20:23]
    ds_read_b128 a[212:215], v2 offset:29696
    v_add_f32 v60, v60, v26
    v_mfma_f32_16x16x32_bf16 v[20:23], a[156:159], v[124:127], v[20:23]
    v_exp_f32 v28, v28
    v_mfma_f32_16x16x32_bf16 v[160:163], a[224:227], v[32:35], v[160:163]
    s_waitcnt vmcnt(12)
    v_add_f32 v61, v61, v27
    v_cvt_pk_bf16_f32 v37, v26, v27
    v_mfma_f32_16x16x32_bf16 v[164:167], a[228:231], v[32:35], v[164:167]
    s_barrier
    v_exp_f32 v29, v29
    v_mfma_f32_16x16x32_bf16 v[168:171], a[232:235], v[32:35], v[168:171]
    s_add_u32 s99, s99, 1
    ds_read_b128 a[216:219], v2 offset:30720
    v_add_f32 v60, v60, v28
    v_mfma_f32_16x16x32_bf16 v[172:175], a[236:239], v[32:35], v[172:175]
    s_bitcmp1_b64 s[4:5], s99
    v_exp_f32 v30, v30
    v_mfma_f32_16x16x32_bf16 v[176:179], a[240:243], v[32:35], v[176:179]
    v_add_f32 v61, v61, v29
    v_cvt_pk_bf16_f32 v38, v28, v29
    v_mfma_f32_16x16x32_bf16 v[180:183], a[244:247], v[32:35], v[180:183]
    v_exp_f32 v31, v31
    v_mfma_f32_16x16x32_bf16 v[184:187], a[248:251], v[32:35], v[184:187]
    ds_read_b128 a[220:223], v2 offset:31744
    v_add_f32 v60, v60, v30
    v_mfma_f32_16x16x32_bf16 v[188:191], a[252:255], v[32:35], v[188:191]
    v_add_f32 v61, v61, v31
    v_cvt_pk_bf16_f32 v39, v30, v31
    v_add_u32 v2, s96, v1
    v_cndmask_b32_e64 v8, v7, v44, s[64:65]
    v_cndmask_b32_e64 v9, v7, v44, s[66:67]
    v_cndmask_b32_e64 v10, v7, v44, s[68:69]
    v_cndmask_b32_e64 v11, v7, v44, s[70:71]
    v_cndmask_b32_e64 v12, v7, v44, s[72:73]
    v_cndmask_b32_e64 v13, v7, v44, s[74:75]
    v_cndmask_b32_e64 v14, v7, v44, s[76:77]
    v_cndmask_b32_e64 v15, v7, v44, s[78:79]
    v_mfma_f32_16x16x32_bf16 v[24:27], a[128:131], v[80:83], v[8:11]
    v_exp_f32 v16, v16
    v_mfma_f32_16x16x32_bf16 v[24:27], a[132:135], v[84:87], v[24:27]
    s_add_u32 s62, m0, 16384
    global_load_lds_dwordx4 v1, s[14:15] offset:0 sc1
    v_exp_f32 v17, v17
    v_mfma_f32_16x16x32_bf16 v[24:27], a[136:139], v[88:91], v[24:27]
    s_and_b32 s62, s62, 0x1ffff
    ds_read_b128 a[160:163], v2 offset:0
    v_add_f32 v62, v62, v16
    v_mfma_f32_16x16x32_bf16 v[24:27], a[140:143], v[92:95], v[24:27]
    s_add_u32 s98, s62, 16384
    v_exp_f32 v18, v18
    v_mfma_f32_16x16x32_bf16 v[28:31], a[144:147], v[80:83], v[12:15]
    s_and_b32 s98, s98, 0x1ffff
    ds_read_b128 a[164:167], v2 offset:1024
    v_add_f32 v63, v63, v17
    v_cvt_pk_bf16_f32 v32, v16, v17
    v_mfma_f32_16x16x32_bf16 v[28:31], a[148:151], v[84:87], v[28:31]
    s_add_u32 s96, s96, 32768
    global_load_lds_dwordx4 v1, s[14:15] offset:1024 sc1
    v_exp_f32 v19, v19
    v_mfma_f32_16x16x32_bf16 v[28:31], a[152:155], v[88:91], v[28:31]
    s_and_b32 s96, s96, 0x1ffff
    ds_read_b128 a[168:171], v2 offset:2048
    v_add_f32 v62, v62, v18
    v_mfma_f32_16x16x32_bf16 v[28:31], a[156:159], v[92:95], v[28:31]
    s_add_u32 s18, s14, 32768
    v_exp_f32 v20, v20
    v_mfma_f32_16x16x32_bf16 v[192:195], a[224:227], v[36:39], v[192:195]
    s_addc_u32 s19, s15, 0
    v_add_f32 v63, v63, v19
    v_cvt_pk_bf16_f32 v33, v18, v19
    v_mfma_f32_16x16x32_bf16 v[196:199], a[228:231], v[36:39], v[196:199]
    s_sub_u32 s97, s97, 1
    global_load_lds_dwordx4 v1, s[14:15] offset:2048 sc1
    v_exp_f32 v21, v21
    v_mfma_f32_16x16x32_bf16 v[200:203], a[232:235], v[36:39], v[200:203]
    s_cmp_eq_u32 s97, 0
    ds_read_b128 a[172:175], v2 offset:3072
    v_add_f32 v62, v62, v20
    v_mfma_f32_16x16x32_bf16 v[204:207], a[236:239], v[36:39], v[204:207]
    s_cselect_b64 s[18:19], s[16:17], s[18:19]
    v_exp_f32 v22, v22
    v_mfma_f32_16x16x32_bf16 v[208:211], a[240:243], v[36:39], v[208:211]
    ds_read_b128 a[176:179], v2 offset:4096
    v_add_f32 v63, v63, v21
    v_cvt_pk_bf16_f32 v34, v20, v21
    v_mfma_f32_16x16x32_bf16 v[212:215], a[244:247], v[36:39], v[212:215]
    global_load_lds_dwordx4 v1, s[14:15] offset:3072 sc1
    v_exp_f32 v23, v23
    v_mfma_f32_16x16x32_bf16 v[216:219], a[248:251], v[36:39], v[216:219]
    s_mov_b32 m0, s62
    ds_read_b128 a[180:183], v2 offset:5120
    v_add_f32 v62, v62, v22
    v_mfma_f32_16x16x32_bf16 v[220:223], a[252:255], v[36:39], v[220:223]
    v_add_f32 v63, v63, v23
    v_cvt_pk_bf16_f32 v35, v22, v23
    v_mfma_f32_16x16x32_bf16 v[16:19], a[128:131], v[96:99], v[48:51]
    v_exp_f32 v24, v24
    v_mfma_f32_16x16x32_bf16 v[16:19], a[132:135], v[100:103], v[16:19]
    global_load_lds_dwordx4 v3, s[14:15] offset:0 sc1
    v_exp_f32 v25, v25
    v_mfma_f32_16x16x32_bf16 v[16:19], a[136:139], v[104:107], v[16:19]
    ds_read_b128 a[184:187], v2 offset:6144
    v_add_f32 v58, v58, v24
    v_mfma_f32_16x16x32_bf16 v[16:19], a[140:143], v[108:111], v[16:19]
    v_exp_f32 v26, v26
    v_mfma_f32_16x16x32_bf16 v[20:23], a[144:147], v[96:99], v[48:51]
    v_add_f32 v59, v59, v25
    v_cvt_pk_bf16_f32 v36, v24, v25
    v_mfma_f32_16x16x32_bf16 v[20:23], a[148:151], v[100:103], v[20:23]
    global_load_lds_dwordx4 v3, s[14:15] offset:1024 sc1
    v_exp_f32 v27, v27
    v_mfma_f32_16x16x32_bf16 v[20:23], a[152:155], v[104:107], v[20:23]
    ds_read_b128 a[188:191], v2 offset:7168
    v_add_f32 v58, v58, v26
    v_mfma_f32_16x16x32_bf16 v[20:23], a[156:159], v[108:111], v[20:23]
    s_waitcnt lgkmcnt(2)
    v_exp_f32 v28, v28
    v_mfma_f32_16x16x32_bf16 v[224:227], a[192:195], v[32:35], v[224:227]
    ds_read_b128 a[224:227], v2 offset:8192
    v_add_f32 v59, v59, v27
    v_cvt_pk_bf16_f32 v37, v26, v27
    v_mfma_f32_16x16x32_bf16 v[228:231], a[196:199], v[32:35], v[228:231]
    global_load_lds_dwordx4 v3, s[14:15] offset:2048 sc1
    v_exp_f32 v29, v29
    v_mfma_f32_16x16x32_bf16 v[232:235], a[200:203], v[32:35], v[232:235]
    ds_read_b128 a[228:231], v2 offset:9216
    v_add_f32 v58, v58, v28
    v_mfma_f32_16x16x32_bf16 v[236:239], a[204:207], v[32:35], v[236:239]
    v_exp_f32 v30, v30
    v_mfma_f32_16x16x32_bf16 v[240:243], a[208:211], v[32:35], v[240:243]
    v_add_f32 v59, v59, v29
    v_cvt_pk_bf16_f32 v38, v28, v29
    v_mfma_f32_16x16x32_bf16 v[244:247], a[212:215], v[32:35], v[244:247]
    global_load_lds_dwordx4 v3, s[14:15] offset:3072 sc1
    v_exp_f32 v31, v31
    v_mfma_f32_16x16x32_bf16 v[248:251], a[216:219], v[32:35], v[248:251]
    s_mov_b32 m0, s98
    ds_read_b128 a[232:235], v2 offset:10240
    v_add_f32 v58, v58, v30
    v_mfma_f32_16x16x32_bf16 v[252:255], a[220:223], v[32:35], v[252:255]
    s_mov_b64 s[14:15], s[18:19]
    v_add_f32 v59, v59, v31
    v_cvt_pk_bf16_f32 v39, v30, v31
    v_mfma_f32_16x16x32_bf16 v[24:27], a[160:163], v[112:115], v[52:55]
    v_exp_f32 v16, v16
    v_mfma_f32_16x16x32_bf16 v[24:27], a[164:167], v[116:119], v[24:27]
    v_exp_f32 v17, v17
    v_mfma_f32_16x16x32_bf16 v[24:27], a[168:171], v[120:123], v[24:27]
    ds_read_b128 a[236:239], v2 offset:11264
    v_add_f32 v60, v60, v16
    v_mfma_f32_16x16x32_bf16 v[24:27], a[172:175], v[124:127], v[24:27]
    v_exp_f32 v18, v18
    v_mfma_f32_16x16x32_bf16 v[28:31], a[176:179], v[112:115], v[52:55]
    v_add_f32 v61, v61, v17
    v_cvt_pk_bf16_f32 v32, v16, v17
    v_mfma_f32_16x16x32_bf16 v[28:31], a[180:183], v[116:119], v[28:31]
    s_waitcnt lgkmcnt(1)
    v_exp_f32 v19, v19
    v_mfma_f32_16x16x32_bf16 v[28:31], a[184:187], v[120:123], v[28:31]
    ds_read_b128 a[240:243], v2 offset:12288
    v_add_f32 v60, v60, v18
    v_cndmask_b32_e64 v8, v7, v44, s[80:81]
    v_mfma_f32_16x16x32_bf16 v[28:31], a[188:191], v[124:127], v[28:31]
    v_exp_f32 v20, v20
    v_cndmask_b32_e64 v9, v7, v44, s[82:83]
    v_mfma_f32_16x16x32_bf16 v[160:163], a[192:195], v[36:39], v[160:163]
    ds_read_b128 a[244:247], v2 offset:13312
    v_add_f32 v61, v61, v19
    v_cvt_pk_bf16_f32 v33, v18, v19
    v_cndmask_b32_e64 v10, v7, v44, s[84:85]
    v_mfma_f32_16x16x32_bf16 v[164:167], a[196:199], v[36:39], v[164:167]
    v_exp_f32 v21, v21
    v_cndmask_b32_e64 v11, v7, v44, s[86:87]
    v_mfma_f32_16x16x32_bf16 v[168:171], a[200:203], v[36:39], v[168:171]
    ds_read_b128 a[248:251], v2 offset:14336
    v_add_f32 v60, v60, v20
    v_cndmask_b32_e64 v12, v7, v44, s[88:89]
    v_mfma_f32_16x16x32_bf16 v[172:175], a[204:207], v[36:39], v[172:175]
    v_exp_f32 v22, v22
    v_cndmask_b32_e64 v13, v7, v44, s[90:91]
    v_mfma_f32_16x16x32_bf16 v[176:179], a[208:211], v[36:39], v[176:179]
    v_add_f32 v61, v61, v21
    v_cvt_pk_bf16_f32 v34, v20, v21
    v_cndmask_b32_e64 v14, v7, v44, s[92:93]
    v_mfma_f32_16x16x32_bf16 v[180:183], a[212:215], v[36:39], v[180:183]
    v_exp_f32 v23, v23
    v_cndmask_b32_e64 v15, v7, v44, s[94:95]
    v_mfma_f32_16x16x32_bf16 v[184:187], a[216:219], v[36:39], v[184:187]
    ds_read_b128 a[252:255], v2 offset:15360
    v_add_f32 v60, v60, v22
    v_mfma_f32_16x16x32_bf16 v[188:191], a[220:223], v[36:39], v[188:191]
    v_add_f32 v61, v61, v23
    v_cvt_pk_bf16_f32 v35, v22, v23
    v_mfma_f32_16x16x32_bf16 v[16:19], a[160:163], v[80:83], v[8:11]
    v_exp_f32 v24, v24
    v_mfma_f32_16x16x32_bf16 v[16:19], a[164:167], v[84:87], v[16:19]
    v_exp_f32 v25, v25
    v_mfma_f32_16x16x32_bf16 v[16:19], a[168:171], v[88:91], v[16:19]
    ds_read_b128 a[128:131], v2 offset:16384
    v_add_f32 v62, v62, v24
    v_mfma_f32_16x16x32_bf16 v[16:19], a[172:175], v[92:95], v[16:19]
    v_exp_f32 v26, v26
    v_mfma_f32_16x16x32_bf16 v[20:23], a[176:179], v[80:83], v[12:15]
    ds_read_b128 a[132:135], v2 offset:17408
    v_add_f32 v63, v63, v25
    v_cvt_pk_bf16_f32 v36, v24, v25
    v_mfma_f32_16x16x32_bf16 v[20:23], a[180:183], v[84:87], v[20:23]
    v_exp_f32 v27, v27
    v_mfma_f32_16x16x32_bf16 v[20:23], a[184:187], v[88:91], v[20:23]
    ds_read_b128 a[136:139], v2 offset:18432
    v_add_f32 v62, v62, v26
    v_mfma_f32_16x16x32_bf16 v[20:23], a[188:191], v[92:95], v[20:23]
    v_exp_f32 v28, v28
    v_mfma_f32_16x16x32_bf16 v[192:195], a[192:195], v[32:35], v[192:195]
    v_add_f32 v63, v63, v27
    v_cvt_pk_bf16_f32 v37, v26, v27
    v_mfma_f32_16x16x32_bf16 v[196:199], a[196:199], v[32:35], v[196:199]
    v_exp_f32 v29, v29
    v_mfma_f32_16x16x32_bf16 v[200:203], a[200:203], v[32:35], v[200:203]
    ds_read_b128 a[140:143], v2 offset:19456
    v_add_f32 v62, v62, v28
    v_mfma_f32_16x16x32_bf16 v[204:207], a[204:207], v[32:35], v[204:207]
    v_exp_f32 v30, v30
    v_mfma_f32_16x16x32_bf16 v[208:211], a[208:211], v[32:35], v[208:211]
    ds_read_b128 a[144:147], v2 offset:20480
    v_add_f32 v63, v63, v29
    v_cvt_pk_bf16_f32 v38, v28, v29
    v_mfma_f32_16x16x32_bf16 v[212:215], a[212:215], v[32:35], v[212:215]
    v_exp_f32 v31, v31
    v_mfma_f32_16x16x32_bf16 v[216:219], a[216:219], v[32:35], v[216:219]
    ds_read_b128 a[148:151], v2 offset:21504
    v_add_f32 v62, v62, v30
    v_mfma_f32_16x16x32_bf16 v[220:223], a[220:223], v[32:35], v[220:223]
    v_add_f32 v63, v63, v31
    v_cvt_pk_bf16_f32 v39, v30, v31
    v_mfma_f32_16x16x32_bf16 v[24:27], a[160:163], v[96:99], v[48:51]
    v_exp_f32 v16, v16
    v_mfma_f32_16x16x32_bf16 v[24:27], a[164:167], v[100:103], v[24:27]
    global_load_dword v4, v5, s[44:45] sc1
    v_exp_f32 v17, v17
    v_mfma_f32_16x16x32_bf16 v[24:27], a[168:171], v[104:107], v[24:27]
    ds_read_b128 a[152:155], v2 offset:22528
    v_add_f32 v58, v58, v16
    v_mfma_f32_16x16x32_bf16 v[24:27], a[172:175], v[108:111], v[24:27]
L_wk8:
    s_cbranch_execz L_wk12
    v_exp_f32 v18, v18
    v_mfma_f32_16x16x32_bf16 v[28:31], a[176:179], v[96:99], v[48:51]
    v_add_f32 v59, v59, v17
    v_cvt_pk_bf16_f32 v32, v16, v17
    v_mfma_f32_16x16x32_bf16 v[28:31], a[180:183], v[100:103], v[28:31]
    global_load_dword a4, v0, s[44:45] sc1
    v_exp_f32 v19, v19
    v_mfma_f32_16x16x32_bf16 v[28:31], a[184:187], v[104:107], v[28:31]
    ds_read_b128 a[156:159], v2 offset:23552
    v_add_f32 v58, v58, v18
    v_mfma_f32_16x16x32_bf16 v[28:31], a[188:191], v[108:111], v[28:31]
    v_exp_f32 v20, v20
    v_mfma_f32_16x16x32_bf16 v[224:227], a[224:227], v[36:39], v[224:227]
    ds_read_b128 a[192:195], v2 offset:24576
    v_add_f32 v59, v59, v19
    v_cvt_pk_bf16_f32 v33, v18, v19
    v_mfma_f32_16x16x32_bf16 v[228:231], a[228:231], v[36:39], v[228:231]
    v_exp_f32 v21, v21
    v_mfma_f32_16x16x32_bf16 v[232:235], a[232:235], v[36:39], v[232:235]
    s_waitcnt lgkmcnt(2)
    ds_read_b128 a[196:199], v2 offset:25600
    v_add_f32 v58, v58, v20
    v_mfma_f32_16x16x32_bf16 v[236:239], a[236:239], v[36:39], v[236:239]
    v_exp_f32 v22, v22
    v_mfma_f32_16x16x32_bf16 v[240:243], a[240:243], v[36:39], v[240:243]
    v_add_f32 v59, v59, v21
    v_cvt_pk_bf16_f32 v34, v20, v21
    v_mfma_f32_16x16x32_bf16 v[244:247], a[244:247], v[36:39], v[244:247]
    v_exp_f32 v23, v23
    v_mfma_f32_16x16x32_bf16 v[248:251], a[248:251], v[36:39], v[248:251]
    ds_read_b128 a[200:203], v2 offset:26624
    v_add_f32 v58, v58, v22
    v_mfma_f32_16x16x32_bf16 v[252:255], a[252:255], v[36:39], v[252:255]
    v_add_f32 v59, v59, v23
    v_cvt_pk_bf16_f32 v35, v22, v23
    v_mfma_f32_16x16x32_bf16 v[16:19], a[128:131], v[112:115], v[52:55]
    v_exp_f32 v24, v24
    v_mfma_f32_16x16x32_bf16 v[16:19], a[132:135], v[116:119], v[16:19]
    ds_read_b128 a[204:207], v2 offset:27648
    v_mfma_f32_16x16x32_bf16 v[16:19], a[136:139], v[120:123], v[16:19]
    v_exp_f32 v25, v25
    v_mfma_f32_16x16x32_bf16 v[16:19], a[140:143], v[124:127], v[16:19]
    ds_read_b128 a[208:211], v2 offset:28672
    v_cvt_pk_bf16_f32 v36, v24, v25
    v_mfma_f32_16x16x32_bf16 v[20:23], a[144:147], v[112:115], v[52:55]
    v_exp_f32 v26, v26
    v_mfma_f32_16x16x32_bf16 v[20:23], a[148:151], v[116:119], v[20:23]
    ds_read_b128 a[212:215], v2 offset:29696
    v_mfma_f32_16x16x32_bf16 v[20:23], a[152:155], v[120:123], v[20:23]
    s_waitcnt lgkmcnt(3)
    v_exp_f32 v27, v27
    v_mfma_f32_16x16x32_bf16 v[20:23], a[156:159], v[124:127], v[20:23]
    ds_read_b128 a[216:219], v2 offset:30720
    v_cvt_pk_bf16_f32 v37, v26, v27
    v_mfma_f32_16x16x32_bf16 v[160:163], a[224:227], v[32:35], v[160:163]
    s_waitcnt vmcnt(14)
    v_exp_f32 v28, v28
    v_mfma_f32_16x16x32_bf16 v[164:167], a[228:231], v[32:35], v[164:167]
    s_barrier
    ds_read_b128 a[220:223], v2 offset:31744
    v_mfma_f32_16x16x32_bf16 v[168:171], a[232:235], v[32:35], v[168:171]
    s_add_u32 s99, s99, 1
    v_exp_f32 v29, v29
    v_mfma_f32_16x16x32_bf16 v[172:175], a[236:239], v[32:35], v[172:175]
    s_bitcmp1_b64 s[4:5], s99
    v_cvt_pk_bf16_f32 v38, v28, v29
    v_mfma_f32_16x16x32_bf16 v[176:179], a[240:243], v[32:35], v[176:179]
    v_exp_f32 v30, v30
    v_mfma_f32_16x16x32_bf16 v[180:183], a[244:247], v[32:35], v[180:183]
    v_mfma_f32_16x16x32_bf16 v[184:187], a[248:251], v[32:35], v[184:187]
    v_exp_f32 v31, v31
    v_mfma_f32_16x16x32_bf16 v[188:191], a[252:255], v[32:35], v[188:191]
    v_cvt_pk_bf16_f32 v39, v30, v31
    v_add_u32 v2, s96, v1
L_att_mid:
    v_add_f32 v56, v56, v57
    v_add_f32 v58, v58, v59
    v_bfe_u32 v9, v1, 5, 3
    v_mov_b32 v57, v56
    v_mov_b32 v59, v58
    v_bfe_u32 v10, v1, 4, 1
    v_permlane32_swap_b32 v56, v57
    v_permlane32_swap_b32 v58, v59
    v_lshrrev_b32 v11, 8, v1
    v_add_f32 v56, v56, v57
    v_add_f32 v58, v58, v59
    v_lshlrev_b32 v10, 2, v10
    v_mov_b32 v57, v56
    v_mov_b32 v59, v58
    v_add_u32 v11, s58, v11
    v_permlane16_swap_b32 v56, v57
    v_permlane16_swap_b32 v58, v59
    v_lshl_add_u32 v9, v9, 7, v10
    v_add_f32 v56, v56, v57
    v_add_f32 v58, v58, v59
    v_and_b32 v11, 3, v11
    v_lshl_add_u32 v10, v11, 10, v9
    v_cmp_nlt_f32 vcc, v56, v6
    v_rcp_f32 v56, v56
    s_or_b32 s100, s100, vcc_lo
    s_or_b32 s100, s100, vcc_hi
    v_cmp_nlt_f32 vcc, v58, v6
    v_rcp_f32 v58, v58
    s_or_b32 s100, s100, vcc_lo
    s_or_b32 s100, s100, vcc_hi
    s_mul_i32 s35, s33, 1179648
    s_add_u32 s35, s35, s101
    v_pk_mul_f32 v[128:129], v[128:129], v[56:57] op_sel_hi:[1,0]
    v_pk_mul_f32 v[130:131], v[130:131], v[56:57] op_sel_hi:[1,0]
    v_pk_mul_f32 v[132:133], v[132:133], v[56:57] op_sel_hi:[1,0]
    v_pk_mul_f32 v[134:135], v[134:135], v[56:57] op_sel_hi:[1,0]
    v_cvt_pk_bf16_f32 v128, v128, v129
    v_cvt_pk_bf16_f32 v129, v130, v131
    v_cvt_pk_bf16_f32 v130, v132, v133
    v_cvt_pk_bf16_f32 v131, v134, v135
    buffer_store_dwordx4 v[128:131], v1, s[24:27], s35 offen sc1
    s_add_u32 s35, s35, 4096
    v_add_f32 v60, v60, v61
    v_add_f32 v62, v62, v63
    s_lshl_b32 s34, s32, 12
    s_add_u32 s34, s34, 61865984
    s_add_u32 s8, s60, s34
    s_addc_u32 s9, s61, 0
    v_pk_mul_f32 v[136:137], v[136:137], v[56:57] op_sel_hi:[1,0]
    v_pk_mul_f32 v[138:139], v[138:139], v[56:57] op_sel_hi:[1,0]
    v_pk_mul_f32 v[140:141], v[140:141], v[56:57] op_sel_hi:[1,0]
    v_pk_mul_f32 v[142:143], v[142:143], v[56:57] op_sel_hi:[1,0]
    v_cvt_pk_bf16_f32 v136, v136, v137
    v_cvt_pk_bf16_f32 v137, v138, v139
    v_cvt_pk_bf16_f32 v138, v140, v141
    v_cvt_pk_bf16_f32 v139, v142, v143
    buffer_store_dwordx4 v[136:139], v1, s[24:27], s35 offen sc1
    s_add_u32 s35, s35, 4096
    v_mov_b32 v61, v60
    v_mov_b32 v63, v62
    v_pk_mul_f32 v[144:145], v[144:145], v[56:57] op_sel_hi:[1,0]
    v_pk_mul_f32 v[146:147], v[146:147], v[56:57] op_sel_hi:[1,0]
    v_pk_mul_f32 v[148:149], v[148:149], v[56:57] op_sel_hi:[1,0]
    v_pk_mul_f32 v[150:151], v[150:151], v[56:57] op_sel_hi:[1,0]
    v_cvt_pk_bf16_f32 v144, v144, v145
    v_cvt_pk_bf16_f32 v145, v146, v147
    v_cvt_pk_bf16_f32 v146, v148, v149
    v_cvt_pk_bf16_f32 v147, v150, v151
    buffer_store_dwordx4 v[144:147], v1, s[24:27], s35 offen sc1
    s_add_u32 s35, s35, 4096
    v_permlane32_swap_b32 v60, v61
    v_permlane32_swap_b32 v62, v63
    v_pk_mul_f32 v[152:153], v[152:153], v[56:57] op_sel_hi:[1,0]
    v_pk_mul_f32 v[154:155], v[154:155], v[56:57] op_sel_hi:[1,0]
    v_pk_mul_f32 v[156:157], v[156:157], v[56:57] op_sel_hi:[1,0]
    v_pk_mul_f32 v[158:159], v[158:159], v[56:57] op_sel_hi:[1,0]
    v_cvt_pk_bf16_f32 v152, v152, v153
    v_cvt_pk_bf16_f32 v153, v154, v155
    v_cvt_pk_bf16_f32 v154, v156, v157
    v_cvt_pk_bf16_f32 v155, v158, v159
    buffer_store_dwordx4 v[152:155], v1, s[24:27], s35 offen sc1
    v_add_f32 v60, v60, v61
    v_add_f32 v62, v62, v63
    s_mul_i32 s35, s33, 1179648
    s_add_u32 s35, s35, s101
    s_add_u32 s35, s35, 589824
    v_pk_mul_f32 v[160:161], v[160:161], v[58:59] op_sel_hi:[1,0]
    v_pk_mul_f32 v[162:163], v[162:163], v[58:59] op_sel_hi:[1,0]
    v_pk_mul_f32 v[164:165], v[164:165], v[58:59] op_sel_hi:[1,0]
    v_pk_mul_f32 v[166:167], v[166:167], v[58:59] op_sel_hi:[1,0]
    v_cvt_pk_bf16_f32 v160, v160, v161
    v_cvt_pk_bf16_f32 v161, v162, v163
    v_cvt_pk_bf16_f32 v162, v164, v165
    v_cvt_pk_bf16_f32 v163, v166, v167
    buffer_store_dwordx4 v[160:163], v1, s[24:27], s35 offen sc1
    s_add_u32 s35, s35, 4096
    v_mov_b32 v61, v60
    v_mov_b32 v63, v62
    v_pk_mul_f32 v[168:169], v[168:169], v[58:59] op_sel_hi:[1,0]
    v_pk_mul_f32 v[170:171], v[170:171], v[58:59] op_sel_hi:[1,0]
    v_pk_mul_f32 v[172:173], v[172:173], v[58:59] op_sel_hi:[1,0]
    v_pk_mul_f32 v[174:175], v[174:175], v[58:59] op_sel_hi:[1,0]
    v_cvt_pk_bf16_f32 v168, v168, v169
    v_cvt_pk_bf16_f32 v169, v170, v171
    v_cvt_pk_bf16_f32 v170, v172, v173
    v_cvt_pk_bf16_f32 v171, v174, v175
    buffer_store_dwordx4 v[168:171], v1, s[24:27], s35 offen sc1
    s_add_u32 s35, s35, 4096
    v_permlane16_swap_b32 v60, v61
    v_permlane16_swap_b32 v62, v63
    v_pk_mul_f32 v[176:177], v[176:177], v[58:59] op_sel_hi:[1,0]
    v_pk_mul_f32 v[178:179], v[178:179], v[58:59] op_sel_hi:[1,0]
    v_pk_mul_f32 v[180:181], v[180:181], v[58:59] op_sel_hi:[1,0]
    v_pk_mul_f32 v[182:183], v[182:183], v[58:59] op_sel_hi:[1,0]
    v_cvt_pk_bf16_f32 v176, v176, v177
    v_cvt_pk_bf16_f32 v177, v178, v179
    v_cvt_pk_bf16_f32 v178, v180, v181
    v_cvt_pk_bf16_f32 v179, v182, v183
    buffer_store_dwordx4 v[176:179], v1, s[24:27], s35 offen sc1
    s_add_u32 s35, s35, 4096
    v_add_f32 v60, v60, v61
    v_add_f32 v62, v62, v63
    v_pk_mul_f32 v[184:185], v[184:185], v[58:59] op_sel_hi:[1,0]
    v_pk_mul_f32 v[186:187], v[186:187], v[58:59] op_sel_hi:[1,0]
    v_pk_mul_f32 v[188:189], v[188:189], v[58:59] op_sel_hi:[1,0]
    v_pk_mul_f32 v[190:191], v[190:191], v[58:59] op_sel_hi:[1,0]
    v_cvt_pk_bf16_f32 v184, v184, v185
    v_cvt_pk_bf16_f32 v185, v186, v187
    v_cvt_pk_bf16_f32 v186, v188, v189
    v_cvt_pk_bf16_f32 v187, v190, v191
    buffer_store_dwordx4 v[184:187], v1, s[24:27], s35 offen sc1
    v_mov_b32 v40, v60
    v_mov_b32 v41, v60
    v_mov_b32 v42, v60
    v_mov_b32 v43, v60
    v_mov_b32 v44, v62
    v_mov_b32 v45, v62
    v_mov_b32 v46, v62
    v_mov_b32 v47, v62
    s_waitcnt vmcnt(8)
    v_accvgpr_read_b32 v8, a4
    v_min_u32 v4, v4, v8
    v_cmp_gt_u32 vcc, 0x200, v4
    s_nop 1
    s_cbranch_vccnz L_ev1_slow
L_ev1_a:
    global_load_dword a8, v10, s[8:9] sc1
    s_lshl_b32 s59, s3, 12
    s_add_u32 s59, s59, 131072
    s_add_u32 s10, s16, 131072
    s_addc_u32 s11, s17, 0
    s_cmp_eq_u32 s33, 6
    s_cbranch_scc1 L_att_l2p3
    v_mfma_f32_16x16x32_bf16 v[24:27], a[128:131], v[96:99], v[48:51]
    v_exp_f32 v16, v16
    v_mfma_f32_16x16x32_bf16 v[24:27], a[132:135], v[100:103], v[24:27]
    s_add_u32 s62, m0, 16384
    ds_read_b128 a[128:131], v2 offset:0
    global_load_dwordx4 a[16:19], v1, s[6:7] offset:0 sc1
    v_mfma_f32_16x16x32_bf16 v[24:27], a[136:139], v[104:107], v[24:27]
    s_and_b32 s62, s62, 0x1ffff
    v_exp_f32 v17, v17
    v_mfma_f32_16x16x32_bf16 v[24:27], a[140:143], v[108:111], v[24:27]
    s_add_u32 s98, s62, 16384
    ds_read_b128 a[132:135], v2 offset:1024
    v_cvt_pk_bf16_f32 v32, v16, v17
    v_mfma_f32_16x16x32_bf16 v[28:31], a[144:147], v[96:99], v[48:51]
    s_and_b32 s98, s98, 0x1ffff
    v_exp_f32 v18, v18
    v_mfma_f32_16x16x32_bf16 v[28:31], a[148:151], v[100:103], v[28:31]
    s_add_u32 s96, s96, 32768
    ds_read_b128 a[136:139], v2 offset:2048
    global_load_lds_dwordx4 v1, s[14:15] offset:0 sc1
    v_mfma_f32_16x16x32_bf16 v[28:31], a[152:155], v[104:107], v[28:31]
    s_and_b32 s96, s96, 0x1ffff
    v_exp_f32 v19, v19
    v_mfma_f32_16x16x32_bf16 v[28:31], a[156:159], v[108:111], v[28:31]
    s_add_u32 s18, s14, 32768
    ds_read_b128 a[140:143], v2 offset:3072
    v_cvt_pk_bf16_f32 v33, v18, v19
    v_mfma_f32_16x16x32_bf16 v[192:195], a[224:227], v[36:39], v[192:195]
    s_addc_u32 s19, s15, 0
    v_exp_f32 v20, v20
    v_mfma_f32_16x16x32_bf16 v[196:199], a[228:231], v[36:39], v[196:199]
    s_sub_u32 s97, s97, 1
    ds_read_b128 a[144:147], v2 offset:4096
    global_load_dwordx4 a[20:23], v1, s[6:7] offset:1024 sc1
    v_mfma_f32_16x16x32_bf16 v[200:203], a[232:235], v[36:39], v[200:203]
    s_cmp_eq_u32 s97, 0
    v_exp_f32 v21, v21
    v_mfma_f32_16x16x32_bf16 v[204:207], a[236:239], v[36:39], v[204:207]
    s_cselect_b64 s[18:19], s[16:17], s[18:19]
    ds_read_b128 a[148:151], v2 offset:5120
    v_cvt_pk_bf16_f32 v34, v20, v21
    v_mfma_f32_16x16x32_bf16 v[208:211], a[240:243], v[36:39], v[208:211]
    v_exp_f32 v22, v22
    v_mfma_f32_16x16x32_bf16 v[212:215], a[244:247], v[36:39], v[212:215]
    ds_read_b128 a[152:155], v2 offset:6144
    global_load_lds_dwordx4 v1, s[14:15] offset:1024 sc1
    v_mfma_f32_16x16x32_bf16 v[216:219], a[248:251], v[36:39], v[216:219]
    v_exp_f32 v23, v23
    v_mfma_f32_16x16x32_bf16 v[220:223], a[252:255], v[36:39], v[220:223]
    ds_read_b128 a[156:159], v2 offset:7168
    v_cvt_pk_bf16_f32 v35, v22, v23
    v_mfma_f32_16x16x32_bf16 v[40:43], a[0:3], v[36:39], v[40:43]
    s_waitcnt lgkmcnt(3)
    v_mfma_f32_16x16x32_bf16 v[16:19], a[128:131], v[112:115], v[52:55]
    v_exp_f32 v24, v24
    v_mfma_f32_16x16x32_bf16 v[16:19], a[132:135], v[116:119], v[16:19]
    ds_read_b128 a[224:227], v2 offset:8192
    global_load_dwordx4 a[24:27], v1, s[6:7] offset:2048 sc1
    v_mfma_f32_16x16x32_bf16 v[16:19], a[136:139], v[120:123], v[16:19]
    s_waitcnt lgkmcnt(2)
    v_exp_f32 v25, v25
    v_mfma_f32_16x16x32_bf16 v[16:19], a[140:143], v[124:127], v[16:19]
    s_add_u32 s34, s6, 32768
    ds_read_b128 a[228:231], v2 offset:9216
    v_cvt_pk_bf16_f32 v36, v24, v25
    v_mfma_f32_16x16x32_bf16 v[20:23], a[144:147], v[112:115], v[52:55]
    s_addc_u32 s35, s7, 0
    v_exp_f32 v26, v26
    v_mfma_f32_16x16x32_bf16 v[20:23], a[148:151], v[116:119], v[20:23]
    ds_read_b128 a[232:235], v2 offset:10240
    global_load_lds_dwordx4 v1, s[14:15] offset:2048 sc1
    v_mfma_f32_16x16x32_bf16 v[20:23], a[152:155], v[120:123], v[20:23]
    s_waitcnt lgkmcnt(3)
    v_exp_f32 v27, v27
    v_mfma_f32_16x16x32_bf16 v[20:23], a[156:159], v[124:127], v[20:23]
    ds_read_b128 a[236:239], v2 offset:11264
    v_cvt_pk_bf16_f32 v37, v26, v27
    v_mfma_f32_16x16x32_bf16 v[224:227], a[192:195], v[32:35], v[224:227]
    v_exp_f32 v28, v28
    v_mfma_f32_16x16x32_bf16 v[228:231], a[196:199], v[32:35], v[228:231]
    ds_read_b128 a[240:243], v2 offset:12288
    global_load_dwordx4 a[28:31], v1, s[6:7] offset:3072 sc1
    v_mfma_f32_16x16x32_bf16 v[232:235], a[200:203], v[32:35], v[232:235]
    v_exp_f32 v29, v29
    v_mfma_f32_16x16x32_bf16 v[236:239], a[204:207], v[32:35], v[236:239]
    ds_read_b128 a[244:247], v2 offset:13312
    v_cvt_pk_bf16_f32 v38, v28, v29
    v_mfma_f32_16x16x32_bf16 v[240:243], a[208:211], v[32:35], v[240:243]
    v_exp_f32 v30, v30
    v_mfma_f32_16x16x32_bf16 v[244:247], a[212:215], v[32:35], v[244:247]
    ds_read_b128 a[248:251], v2 offset:14336
    global_load_lds_dwordx4 v1, s[14:15] offset:3072 sc1
    v_mfma_f32_16x16x32_bf16 v[248:251], a[216:219], v[32:35], v[248:251]
    s_mov_b32 m0, s62
    v_exp_f32 v31, v31
    v_mfma_f32_16x16x32_bf16 v[252:255], a[220:223], v[32:35], v[252:255]
    ds_read_b128 a[252:255], v2 offset:15360
    v_cvt_pk_bf16_f32 v39, v30, v31
    v_mfma_f32_16x16x32_bf16 v[44:47], a[0:3], v[32:35], v[44:47]
    v_mfma_f32_16x16x32_bf16 v[24:27], a[128:131], v[96:99], v[48:51]
    v_exp_f32 v16, v16
    v_mfma_f32_16x16x32_bf16 v[24:27], a[132:135], v[100:103], v[24:27]
    ds_read_b128 a[128:131], v2 offset:16384
    global_load_dwordx4 a[32:35], v3, s[6:7] offset:0 sc1
    v_mfma_f32_16x16x32_bf16 v[24:27], a[136:139], v[104:107], v[24:27]
    v_exp_f32 v17, v17
    v_mfma_f32_16x16x32_bf16 v[24:27], a[140:143], v[108:111], v[24:27]
    ds_read_b128 a[132:135], v2 offset:17408
    v_cvt_pk_bf16_f32 v32, v16, v17
    v_mfma_f32_16x16x32_bf16 v[28:31], a[144:147], v[96:99], v[48:51]
    v_exp_f32 v18, v18
    v_mfma_f32_16x16x32_bf16 v[28:31], a[148:151], v[100:103], v[28:31]
    ds_read_b128 a[136:139], v2 offset:18432
    global_load_lds_dwordx4 v3, s[14:15] offset:0 sc1
    v_mfma_f32_16x16x32_bf16 v[28:31], a[152:155], v[104:107], v[28:31]
    v_exp_f32 v19, v19
    v_mfma_f32_16x16x32_bf16 v[28:31], a[156:159], v[108:111], v[28:31]
    ds_read_b128 a[140:143], v2 offset:19456
    v_cvt_pk_bf16_f32 v33, v18, v19
    v_mfma_f32_16x16x32_bf16 v[192:195], a[192:195], v[36:39], v[192:195]
    v_exp_f32 v20, v20
    v_mfma_f32_16x16x32_bf16 v[196:199], a[196:199], v[36:39], v[196:199]
    ds_read_b128 a[144:147], v2 offset:20480
    global_load_dwordx4 a[36:39], v3, s[6:7] offset:1024 sc1
    v_mfma_f32_16x16x32_bf16 v[200:203], a[200:203], v[36:39], v[200:203]
    v_exp_f32 v21, v21
    v_mfma_f32_16x16x32_bf16 v[204:207], a[204:207], v[36:39], v[204:207]
    ds_read_b128 a[148:151], v2 offset:21504
    v_cvt_pk_bf16_f32 v34, v20, v21
    v_mfma_f32_16x16x32_bf16 v[208:211], a[208:211], v[36:39], v[208:211]
    v_exp_f32 v22, v22
    v_mfma_f32_16x16x32_bf16 v[212:215], a[212:215], v[36:39], v[212:215]
    ds_read_b128 a[152:155], v2 offset:22528
    global_load_lds_dwordx4 v3, s[14:15] offset:1024 sc1
    v_mfma_f32_16x16x32_bf16 v[216:219], a[216:219], v[36:39], v[216:219]
    v_exp_f32 v23, v23
    v_mfma_f32_16x16x32_bf16 v[220:223], a[220:223], v[36:39], v[220:223]
    ds_read_b128 a[156:159], v2 offset:23552
    v_cvt_pk_bf16_f32 v35, v22, v23
    v_mfma_f32_16x16x32_bf16 v[40:43], a[0:3], v[36:39], v[40:43]
    s_waitcnt lgkmcnt(3)
    v_mfma_f32_16x16x32_bf16 v[16:19], a[128:131], v[112:115], v[52:55]
    v_exp_f32 v24, v24
    v_mfma_f32_16x16x32_bf16 v[16:19], a[132:135], v[116:119], v[16:19]
    ds_read_b128 a[192:195], v2 offset:24576
    global_load_dwordx4 a[40:43], v3, s[6:7] offset:2048 sc1
    v_mfma_f32_16x16x32_bf16 v[16:19], a[136:139], v[120:123], v[16:19]
    v_exp_f32 v25, v25
    v_mfma_f32_16x16x32_bf16 v[16:19], a[140:143], v[124:127], v[16:19]
    ds_read_b128 a[196:199], v2 offset:25600
    v_cvt_pk_bf16_f32 v36, v24, v25
    v_mfma_f32_16x16x32_bf16 v[20:23], a[144:147], v[112:115], v[52:55]
    s_waitcnt lgkmcnt(2)
    v_exp_f32 v26, v26
    v_mfma_f32_16x16x32_bf16 v[20:23], a[148:151], v[116:119], v[20:23]
    ds_read_b128 a[200:203], v2 offset:26624
    global_load_lds_dwordx4 v3, s[14:15] offset:2048 sc1
    v_mfma_f32_16x16x32_bf16 v[20:23], a[152:155], v[120:123], v[20:23]
    v_exp_f32 v27, v27
    v_mfma_f32_16x16x32_bf16 v[20:23], a[156:159], v[124:127], v[20:23]
    ds_read_b128 a[204:207], v2 offset:27648
    v_cvt_pk_bf16_f32 v37, v26, v27
    v_mfma_f32_16x16x32_bf16 v[224:227], a[224:227], v[32:35], v[224:227]
    s_waitcnt vmcnt(18)
    v_exp_f32 v28, v28
    v_mfma_f32_16x16x32_bf16 v[228:231], a[228:231], v[32:35], v[228:231]
    s_barrier
    ds_read_b128 a[208:211], v2 offset:28672
    global_load_dwordx4 a[44:47], v3, s[6:7] offset:3072 sc1
    v_mfma_f32_16x16x32_bf16 v[232:235], a[232:235], v[32:35], v[232:235]
    s_mov_b64 s[6:7], s[34:35]
    v_exp_f32 v29, v29
    v_mfma_f32_16x16x32_bf16 v[236:239], a[236:239], v[32:35], v[236:239]
    s_add_u32 s99, s99, 1
    ds_read_b128 a[212:215], v2 offset:29696
    v_cvt_pk_bf16_f32 v38, v28, v29
    v_mfma_f32_16x16x32_bf16 v[240:243], a[240:243], v[32:35], v[240:243]
    s_bitcmp1_b64 s[4:5], s99
    v_exp_f32 v30, v30
    v_mfma_f32_16x16x32_bf16 v[244:247], a[244:247], v[32:35], v[244:247]
    ds_read_b128 a[216:219], v2 offset:30720
    global_load_lds_dwordx4 v3, s[14:15] offset:3072 sc1
    v_mfma_f32_16x16x32_bf16 v[248:251], a[248:251], v[32:35], v[248:251]
    s_mov_b32 m0, s98
    v_exp_f32 v31, v31
    v_mfma_f32_16x16x32_bf16 v[252:255], a[252:255], v[32:35], v[252:255]
    s_mov_b64 s[14:15], s[18:19]
    ds_read_b128 a[220:223], v2 offset:31744
    v_cvt_pk_bf16_f32 v39, v30, v31
    v_mfma_f32_16x16x32_bf16 v[44:47], a[0:3], v[32:35], v[44:47]
    v_add_u32 v2, s96, v1
    v_mfma_f32_16x16x32_bf16 v[24:27], a[128:131], v[96:99], v[48:51]
    v_exp_f32 v16, v16
    v_mfma_f32_16x16x32_bf16 v[24:27], a[132:135], v[100:103], v[24:27]
    s_add_u32 s62, m0, 16384
    ds_read_b128 a[128:131], v2 offset:0
    global_load_dwordx4 a[48:51], v1, s[6:7] offset:0 sc1
    v_mfma_f32_16x16x32_bf16 v[24:27], a[136:139], v[104:107], v[24:27]
    s_and_b32 s62, s62, 0x1ffff
    v_exp_f32 v17, v17
    v_mfma_f32_16x16x32_bf16 v[24:27], a[140:143], v[108:111], v[24:27]
    s_add_u32 s98, s62, 16384
    ds_read_b128 a[132:135], v2 offset:1024
    v_cvt_pk_bf16_f32 v32, v16, v17
    v_mfma_f32_16x16x32_bf16 v[28:31], a[144:147], v[96:99], v[48:51]
    s_and_b32 s98, s98, 0x1ffff
    v_exp_f32 v18, v18
    v_mfma_f32_16x16x32_bf16 v[28:31], a[148:151], v[100:103], v[28:31]
    s_add_u32 s96, s96, 32768
    ds_read_b128 a[136:139], v2 offset:2048
    global_load_lds_dwordx4 v1, s[14:15] offset:0 sc1
    v_mfma_f32_16x16x32_bf16 v[28:31], a[152:155], v[104:107], v[28:31]
    s_and_b32 s96, s96, 0x1ffff
    v_exp_f32 v19, v19
    v_mfma_f32_16x16x32_bf16 v[28:31], a[156:159], v[108:111], v[28:31]
    s_add_u32 s18, s14, 32768
    ds_read_b128 a[140:143], v2 offset:3072
    v_cvt_pk_bf16_f32 v33, v18, v19
    v_mfma_f32_16x16x32_bf16 v[192:195], a[224:227], v[36:39], v[192:195]
    s_addc_u32 s19, s15, 0
    v_exp_f32 v20, v20
    v_mfma_f32_16x16x32_bf16 v[196:199], a[228:231], v[36:39], v[196:199]
    s_sub_u32 s97, s97, 1
    ds_read_b128 a[144:147], v2 offset:4096
    global_load_dwordx4 a[52:55], v1, s[6:7] offset:1024 sc1
    v_mfma_f32_16x16x32_bf16 v[200:203], a[232:235], v[36:39], v[200:203]
    s_cmp_eq_u32 s97, 0
    v_exp_f32 v21, v21
    v_mfma_f32_16x16x32_bf16 v[204:207], a[236:239], v[36:39], v[204:207]
    s_cselect_b64 s[18:19], s[16:17], s[18:19]
    ds_read_b128 a[148:151], v2 offset:5120
    v_cvt_pk_bf16_f32 v34, v20, v21
    v_mfma_f32_16x16x32_bf16 v[208:211], a[240:243], v[36:39], v[208:211]
    v_exp_f32 v22, v22
    v_mfma_f32_16x16x32_bf16 v[212:215], a[244:247], v[36:39], v[212:215]
    ds_read_b128 a[152:155], v2 offset:6144
    global_load_lds_dwordx4 v1, s[14:15] offset:1024 sc1
    v_mfma_f32_16x16x32_bf16 v[216:219], a[248:251], v[36:39], v[216:219]
    v_exp_f32 v23, v23
    v_mfma_f32_16x16x32_bf16 v[220:223], a[252:255], v[36:39], v[220:223]
    ds_read_b128 a[156:159], v2 offset:7168
    v_cvt_pk_bf16_f32 v35, v22, v23
    v_mfma_f32_16x16x32_bf16 v[40:43], a[0:3], v[36:39], v[40:43]
    s_waitcnt lgkmcnt(3)
    v_mfma_f32_16x16x32_bf16 v[16:19], a[128:131], v[112:115], v[52:55]
    v_exp_f32 v24, v24
    v_mfma_f32_16x16x32_bf16 v[16:19], a[132:135], v[116:119], v[16:19]
    ds_read_b128 a[224:227], v2 offset:8192
    global_load_dwordx4 a[56:59], v1, s[6:7] offset:2048 sc1
    v_mfma_f32_16x16x32_bf16 v[16:19], a[136:139], v[120:123], v[16:19]
    s_waitcnt lgkmcnt(2)
    v_exp_f32 v25, v25
    v_mfma_f32_16x16x32_bf16 v[16:19], a[140:143], v[124:127], v[16:19]
    s_add_u32 s34, s6, 32768
    ds_read_b128 a[228:231], v2 offset:9216
    v_cvt_pk_bf16_f32 v36, v24, v25
    v_mfma_f32_16x16x32_bf16 v[20:23], a[144:147], v[112:115], v[52:55]
    s_addc_u32 s35, s7, 0
    v_exp_f32 v26, v26
    v_mfma_f32_16x16x32_bf16 v[20:23], a[148:151], v[116:119], v[20:23]
    ds_read_b128 a[232:235], v2 offset:10240
    global_load_lds_dwordx4 v1, s[14:15] offset:2048 sc1
    v_mfma_f32_16x16x32_bf16 v[20:23], a[152:155], v[120:123], v[20:23]
    s_waitcnt lgkmcnt(3)
    v_exp_f32 v27, v27
    v_mfma_f32_16x16x32_bf16 v[20:23], a[156:159], v[124:127], v[20:23]
    ds_read_b128 a[236:239], v2 offset:11264
    v_cvt_pk_bf16_f32 v37, v26, v27
    v_mfma_f32_16x16x32_bf16 v[224:227], a[192:195], v[32:35], v[224:227]
    v_exp_f32 v28, v28
    v_mfma_f32_16x16x32_bf16 v[228:231], a[196:199], v[32:35], v[228:231]
    ds_read_b128 a[240:243], v2 offset:12288
    global_load_dwordx4 a[60:63], v1, s[6:7] offset:3072 sc1
    v_mfma_f32_16x16x32_bf16 v[232:235], a[200:203], v[32:35], v[232:235]
    v_exp_f32 v29, v29
    v_mfma_f32_16x16x32_bf16 v[236:239], a[204:207], v[32:35], v[236:239]
    ds_read_b128 a[244:247], v2 offset:13312
    v_cvt_pk_bf16_f32 v38, v28, v29
    v_mfma_f32_16x16x32_bf16 v[240:243], a[208:211], v[32:35], v[240:243]
    v_exp_f32 v30, v30
    v_mfma_f32_16x16x32_bf16 v[244:247], a[212:215], v[32:35], v[244:247]
    ds_read_b128 a[248:251], v2 offset:14336
    global_load_lds_dwordx4 v1, s[14:15] offset:3072 sc1
    v_mfma_f32_16x16x32_bf16 v[248:251], a[216:219], v[32:35], v[248:251]
    s_mov_b32 m0, s62
    v_exp_f32 v31, v31
    v_mfma_f32_16x16x32_bf16 v[252:255], a[220:223], v[32:35], v[252:255]
    ds_read_b128 a[252:255], v2 offset:15360
    v_cvt_pk_bf16_f32 v39, v30, v31
    v_mfma_f32_16x16x32_bf16 v[44:47], a[0:3], v[32:35], v[44:47]
    v_mfma_f32_16x16x32_bf16 v[24:27], a[128:131], v[96:99], v[48:51]
    v_exp_f32 v16, v16
    v_mfma_f32_16x16x32_bf16 v[24:27], a[132:135], v[100:103], v[24:27]
    ds_read_b128 a[128:131], v2 offset:16384
    global_load_dwordx4 a[64:67], v3, s[6:7] offset:0 sc1
    v_mfma_f32_16x16x32_bf16 v[24:27], a[136:139], v[104:107], v[24:27]
    v_exp_f32 v17, v17
    v_mfma_f32_16x16x32_bf16 v[24:27], a[140:143], v[108:111], v[24:27]
    ds_read_b128 a[132:135], v2 offset:17408
    v_cvt_pk_bf16_f32 v32, v16, v17
    v_mfma_f32_16x16x32_bf16 v[28:31], a[144:147], v[96:99], v[48:51]
    v_exp_f32 v18, v18
    v_mfma_f32_16x16x32_bf16 v[28:31], a[148:151], v[100:103], v[28:31]
    ds_read_b128 a[136:139], v2 offset:18432
    global_load_lds_dwordx4 v3, s[14:15] offset:0 sc1
    v_mfma_f32_16x16x32_bf16 v[28:31], a[152:155], v[104:107], v[28:31]
    v_exp_f32 v19, v19
    v_mfma_f32_16x16x32_bf16 v[28:31], a[156:159], v[108:111], v[28:31]
    ds_read_b128 a[140:143], v2 offset:19456
    v_cvt_pk_bf16_f32 v33, v18, v19
    v_mfma_f32_16x16x32_bf16 v[192:195], a[192:195], v[36:39], v[192:195]
    v_exp_f32 v20, v20
    v_mfma_f32_16x16x32_bf16 v[196:199], a[196:199], v[36:39], v[196:199]
    ds_read_b128 a[144:147], v2 offset:20480
    global_load_dwordx4 a[68:71], v3, s[6:7] offset:1024 sc1
    v_mfma_f32_16x16x32_bf16 v[200:203], a[200:203], v[36:39], v[200:203]
    v_exp_f32 v21, v21
    v_mfma_f32_16x16x32_bf16 v[204:207], a[204:207], v[36:39], v[204:207]
    ds_read_b128 a[148:151], v2 offset:21504
    v_cvt_pk_bf16_f32 v34, v20, v21
    v_mfma_f32_16x16x32_bf16 v[208:211], a[208:211], v[36:39], v[208:211]
    v_exp_f32 v22, v22
    v_mfma_f32_16x16x32_bf16 v[212:215], a[212:215], v[36:39], v[212:215]
    ds_read_b128 a[152:155], v2 offset:22528
    global_load_lds_dwordx4 v3, s[14:15] offset:1024 sc1
    v_mfma_f32_16x16x32_bf16 v[216:219], a[216:219], v[36:39], v[216:219]
    v_exp_f32 v23, v23
    v_mfma_f32_16x16x32_bf16 v[220:223], a[220:223], v[36:39], v[220:223]
    ds_read_b128 a[156:159], v2 offset:23552
    v_cvt_pk_bf16_f32 v35, v22, v23
    v_mfma_f32_16x16x32_bf16 v[40:43], a[0:3], v[36:39], v[40:43]
    s_waitcnt lgkmcnt(3)
    v_mfma_f32_16x16x32_bf16 v[16:19], a[128:131], v[112:115], v[52:55]
    v_exp_f32 v24, v24
    v_mfma_f32_16x16x32_bf16 v[16:19], a[132:135], v[116:119], v[16:19]
    ds_read_b128 a[192:195], v2 offset:24576
    global_load_dwordx4 a[72:75], v3, s[6:7] offset:2048 sc1
    v_mfma_f32_16x16x32_bf16 v[16:19], a[136:139], v[120:123], v[16:19]
    v_exp_f32 v25, v25
    v_mfma_f32_16x16x32_bf16 v[16:19], a[140:143], v[124:127], v[16:19]
    ds_read_b128 a[196:199], v2 offset:25600
    v_cvt_pk_bf16_f32 v36, v24, v25
    v_mfma_f32_16x16x32_bf16 v[20:23], a[144:147], v[112:115], v[52:55]
    s_waitcnt lgkmcnt(2)
    v_exp_f32 v26, v26
    v_mfma_f32_16x16x32_bf16 v[20:23], a[148:151], v[116:119], v[20:23]
    ds_read_b128 a[200:203], v2 offset:26624
    global_load_lds_dwordx4 v3, s[14:15] offset:2048 sc1
    v_mfma_f32_16x16x32_bf16 v[20:23], a[152:155], v[120:123], v[20:23]
    v_exp_f32 v27, v27
    v_mfma_f32_16x16x32_bf16 v[20:23], a[156:159], v[124:127], v[20:23]
    ds_read_b128 a[204:207], v2 offset:27648
    v_cvt_pk_bf16_f32 v37, v26, v27
    v_mfma_f32_16x16x32_bf16 v[224:227], a[224:227], v[32:35], v[224:227]
    s_waitcnt vmcnt(22)
    v_exp_f32 v28, v28
    v_mfma_f32_16x16x32_bf16 v[228:231], a[228:231], v[32:35], v[228:231]
    s_barrier
    ds_read_b128 a[208:211], v2 offset:28672
    global_load_dwordx4 a[76:79], v3, s[6:7] offset:3072 sc1
    v_mfma_f32_16x16x32_bf16 v[232:235], a[232:235], v[32:35], v[232:235]
    s_mov_b64 s[6:7], s[34:35]
    v_exp_f32 v29, v29
    v_mfma_f32_16x16x32_bf16 v[236:239], a[236:239], v[32:35], v[236:239]
    s_add_u32 s99, s99, 1
    ds_read_b128 a[212:215], v2 offset:29696
    v_cvt_pk_bf16_f32 v38, v28, v29
    v_mfma_f32_16x16x32_bf16 v[240:243], a[240:243], v[32:35], v[240:243]
    s_bitcmp1_b64 s[4:5], s99
    v_exp_f32 v30, v30
    v_mfma_f32_16x16x32_bf16 v[244:247], a[244:247], v[32:35], v[244:247]
    ds_read_b128 a[216:219], v2 offset:30720
    global_load_lds_dwordx4 v3, s[14:15] offset:3072 sc1
    v_mfma_f32_16x16x32_bf16 v[248:251], a[248:251], v[32:35], v[248:251]
    s_mov_b32 m0, s98
    v_exp_f32 v31, v31
    v_mfma_f32_16x16x32_bf16 v[252:255], a[252:255], v[32:35], v[252:255]
    s_mov_b64 s[14:15], s[18:19]
    ds_read_b128 a[220:223], v2 offset:31744
    v_cvt_pk_bf16_f32 v39, v30, v31
    v_mfma_f32_16x16x32_bf16 v[44:47], a[0:3], v[32:35], v[44:47]
L_wk9:
    s_cbranch_execz L_wk13
    v_add_u32 v2, s96, v1
    v_mfma_f32_16x16x32_bf16 v[24:27], a[128:131], v[96:99], v[48:51]
    v_exp_f32 v16, v16
    v_mfma_f32_16x16x32_bf16 v[24:27], a[132:135], v[100:103], v[24:27]
    s_add_u32 s62, m0, 16384
    ds_read_b128 a[128:131], v2 offset:0
    global_load_dwordx4 a[80:83], v1, s[6:7] offset:0 sc1
    v_mfma_f32_16x16x32_bf16 v[24:27], a[136:139], v[104:107], v[24:27]
    s_and_b32 s62, s62, 0x1ffff
    v_exp_f32 v17, v17
    v_mfma_f32_16x16x32_bf16 v[24:27], a[140:143], v[108:111], v[24:27]
    s_add_u32 s98, s62, 16384
    ds_read_b128 a[132:135], v2 offset:1024
    v_cvt_pk_bf16_f32 v32, v16, v17
    v_mfma_f32_16x16x32_bf16 v[28:31], a[144:147], v[96:99], v[48:51]
    s_and_b32 s98, s98, 0x1ffff
    v_exp_f32 v18, v18
    v_mfma_f32_16x16x32_bf16 v[28:31], a[148:151], v[100:103], v[28:31]
    s_add_u32 s96, s96, 32768
    ds_read_b128 a[136:139], v2 offset:2048
    global_load_lds_dwordx4 v1, s[14:15] offset:0 sc1
    v_mfma_f32_16x16x32_bf16 v[28:31], a[152:155], v[104:107], v[28:31]
    s_and_b32 s96, s96, 0x1ffff
    v_exp_f32 v19, v19
    v_mfma_f32_16x16x32_bf16 v[28:31], a[156:159], v[108:111], v[28:31]
    s_add_u32 s18, s14, 32768
    ds_read_b128 a[140:143], v2 offset:3072
    v_cvt_pk_bf16_f32 v33, v18, v19
    v_mfma_f32_16x16x32_bf16 v[192:195], a[224:227], v[36:39], v[192:195]
    s_addc_u32 s19, s15, 0
    v_exp_f32 v20, v20
    v_mfma_f32_16x16x32_bf16 v[196:199], a[228:231], v[36:39], v[196:199]
    s_sub_u32 s97, s97, 1
    ds_read_b128 a[144:147], v2 offset:4096
    global_load_dwordx4 a[84:87], v1, s[6:7] offset:1024 sc1
    v_mfma_f32_16x16x32_bf16 v[200:203], a[232:235], v[36:39], v[200:203]
    s_cmp_eq_u32 s97, 0
    v_exp_f32 v21, v21
    v_mfma_f32_16x16x32_bf16 v[204:207], a[236:239], v[36:39], v[204:207]
    s_cselect_b64 s[18:19], s[16:17], s[18:19]
    ds_read_b128 a[148:151], v2 offset:5120
    v_cvt_pk_bf16_f32 v34, v20, v21
    v_mfma_f32_16x16x32_bf16 v[208:211], a[240:243], v[36:39], v[208:211]
    v_exp_f32 v22, v22
    v_mfma_f32_16x16x32_bf16 v[212:215], a[244:247], v[36:39], v[212:215]
    ds_read_b128 a[152:155], v2 offset:6144
    global_load_lds_dwordx4 v1, s[14:15] offset:1024 sc1
    v_mfma_f32_16x16x32_bf16 v[216:219], a[248:251], v[36:39], v[216:219]
    v_exp_f32 v23, v23
    v_mfma_f32_16x16x32_bf16 v[220:223], a[252:255], v[36:39], v[220:223]
    ds_read_b128 a[156:159], v2 offset:7168
    v_cvt_pk_bf16_f32 v35, v22, v23
    v_mfma_f32_16x16x32_bf16 v[40:43], a[0:3], v[36:39], v[40:43]
    s_waitcnt lgkmcnt(3)
    v_mfma_f32_16x16x32_bf16 v[16:19], a[128:131], v[112:115], v[52:55]
    v_exp_f32 v24, v24
    v_mfma_f32_16x16x32_bf16 v[16:19], a[132:135], v[116:119], v[16:19]
    ds_read_b128 a[224:227], v2 offset:8192
    global_load_dwordx4 a[88:91], v1, s[6:7] offset:2048 sc1
    v_mfma_f32_16x16x32_bf16 v[16:19], a[136:139], v[120:123], v[16:19]
    s_waitcnt lgkmcnt(2)
    v_exp_f32 v25, v25
    v_mfma_f32_16x16x32_bf16 v[16:19], a[140:143], v[124:127], v[16:19]
    s_add_u32 s34, s6, 32768
    ds_read_b128 a[228:231], v2 offset:9216
    v_cvt_pk_bf16_f32 v36, v24, v25
    v_mfma_f32_16x16x32_bf16 v[20:23], a[144:147], v[112:115], v[52:55]
    s_addc_u32 s35, s7, 0
    v_exp_f32 v26, v26
    v_mfma_f32_16x16x32_bf16 v[20:23], a[148:151], v[116:119], v[20:23]
    ds_read_b128 a[232:235], v2 offset:10240
    global_load_lds_dwordx4 v1, s[14:15] offset:2048 sc1
    v_mfma_f32_16x16x32_bf16 v[20:23], a[152:155], v[120:123], v[20:23]
    s_waitcnt lgkmcnt(3)
    v_exp_f32 v27, v27
    v_mfma_f32_16x16x32_bf16 v[20:23], a[156:159], v[124:127], v[20:23]
    ds_read_b128 a[236:239], v2 offset:11264
    v_cvt_pk_bf16_f32 v37, v26, v27
    v_mfma_f32_16x16x32_bf16 v[224:227], a[192:195], v[32:35], v[224:227]
    v_exp_f32 v28, v28
    v_mfma_f32_16x16x32_bf16 v[228:231], a[196:199], v[32:35], v[228:231]
    ds_read_b128 a[240:243], v2 offset:12288
    global_load_dwordx4 a[92:95], v1, s[6:7] offset:3072 sc1
    v_mfma_f32_16x16x32_bf16 v[232:235], a[200:203], v[32:35], v[232:235]
    v_exp_f32 v29, v29
    v_mfma_f32_16x16x32_bf16 v[236:239], a[204:207], v[32:35], v[236:239]
    ds_read_b128 a[244:247], v2 offset:13312
    v_cvt_pk_bf16_f32 v38, v28, v29
    v_mfma_f32_16x16x32_bf16 v[240:243], a[208:211], v[32:35], v[240:243]
    v_exp_f32 v30, v30
    v_mfma_f32_16x16x32_bf16 v[244:247], a[212:215], v[32:35], v[244:247]
    ds_read_b128 a[248:251], v2 offset:14336
    global_load_lds_dwordx4 v1, s[14:15] offset:3072 sc1
    v_mfma_f32_16x16x32_bf16 v[248:251], a[216:219], v[32:35], v[248:251]
    s_mov_b32 m0, s62
    v_exp_f32 v31, v31
    v_mfma_f32_16x16x32_bf16 v[252:255], a[220:223], v[32:35], v[252:255]
    ds_read_b128 a[252:255], v2 offset:15360
    v_cvt_pk_bf16_f32 v39, v30, v31
    v_mfma_f32_16x16x32_bf16 v[44:47], a[0:3], v[32:35], v[44:47]
    v_mfma_f32_16x16x32_bf16 v[24:27], a[128:131], v[96:99], v[48:51]
    v_exp_f32 v16, v16
    v_mfma_f32_16x16x32_bf16 v[24:27], a[132:135], v[100:103], v[24:27]
    ds_read_b128 a[128:131], v2 offset:16384
    global_load_dwordx4 a[96:99], v3, s[6:7] offset:0 sc1
    v_mfma_f32_16x16x32_bf16 v[24:27], a[136:139], v[104:107], v[24:27]
    v_exp_f32 v17, v17
    v_mfma_f32_16x16x32_bf16 v[24:27], a[140:143], v[108:111], v[24:27]
    ds_read_b128 a[132:135], v2 offset:17408
    v_cvt_pk_bf16_f32 v32, v16, v17
    v_mfma_f32_16x16x32_bf16 v[28:31], a[144:147], v[96:99], v[48:51]
    v_exp_f32 v18, v18
    v_mfma_f32_16x16x32_bf16 v[28:31], a[148:151], v[100:103], v[28:31]
    ds_read_b128 a[136:139], v2 offset:18432
    global_load_lds_dwordx4 v3, s[14:15] offset:0 sc1
    v_mfma_f32_16x16x32_bf16 v[28:31], a[152:155], v[104:107], v[28:31]
    v_exp_f32 v19, v19
    v_mfma_f32_16x16x32_bf16 v[28:31], a[156:159], v[108:111], v[28:31]
    ds_read_b128 a[140:143], v2 offset:19456
    v_cvt_pk_bf16_f32 v33, v18, v19
    v_mfma_f32_16x16x32_bf16 v[192:195], a[192:195], v[36:39], v[192:195]
    v_exp_f32 v20, v20
    v_mfma_f32_16x16x32_bf16 v[196:199], a[196:199], v[36:39], v[196:199]
    ds_read_b128 a[144:147], v2 offset:20480
    global_load_dwordx4 a[100:103], v3, s[6:7] offset:1024 sc1
    v_mfma_f32_16x16x32_bf16 v[200:203], a[200:203], v[36:39], v[200:203]
    v_exp_f32 v21, v21
    v_mfma_f32_16x16x32_bf16 v[204:207], a[204:207], v[36:39], v[204:207]
    ds_read_b128 a[148:151], v2 offset:21504
    v_cvt_pk_bf16_f32 v34, v20, v21
    v_mfma_f32_16x16x32_bf16 v[208:211], a[208:211], v[36:39], v[208:211]
    v_exp_f32 v22, v22
    v_mfma_f32_16x16x32_bf16 v[212:215], a[212:215], v[36:39], v[212:215]
    ds_read_b128 a[152:155], v2 offset:22528
    global_load_lds_dwordx4 v3, s[14:15] offset:1024 sc1
    v_mfma_f32_16x16x32_bf16 v[216:219], a[216:219], v[36:39], v[216:219]
    v_exp_f32 v23, v23
    v_mfma_f32_16x16x32_bf16 v[220:223], a[220:223], v[36:39], v[220:223]
    ds_read_b128 a[156:159], v2 offset:23552
    v_cvt_pk_bf16_f32 v35, v22, v23
    v_mfma_f32_16x16x32_bf16 v[40:43], a[0:3], v[36:39], v[40:43]
    s_waitcnt lgkmcnt(3)
    v_mfma_f32_16x16x32_bf16 v[16:19], a[128:131], v[112:115], v[52:55]
    v_exp_f32 v24, v24
    v_mfma_f32_16x16x32_bf16 v[16:19], a[132:135], v[116:119], v[16:19]
    ds_read_b128 a[192:195], v2 offset:24576
    global_load_dwordx4 a[104:107], v3, s[6:7] offset:2048 sc1
    v_mfma_f32_16x16x32_bf16 v[16:19], a[136:139], v[120:123], v[16:19]
    v_exp_f32 v25, v25
    v_mfma_f32_16x16x32_bf16 v[16:19], a[140:143], v[124:127], v[16:19]
    ds_read_b128 a[196:199], v2 offset:25600
    v_cvt_pk_bf16_f32 v36, v24, v25
    v_mfma_f32_16x16x32_bf16 v[20:23], a[144:147], v[112:115], v[52:55]
    s_waitcnt lgkmcnt(2)
    v_exp_f32 v26, v26
    v_mfma_f32_16x16x32_bf16 v[20:23], a[148:151], v[116:119], v[20:23]
    ds_read_b128 a[200:203], v2 offset:26624
    global_load_lds_dwordx4 v3, s[14:15] offset:2048 sc1
    v_mfma_f32_16x16x32_bf16 v[20:23], a[152:155], v[120:123], v[20:23]
    v_exp_f32 v27, v27
    v_mfma_f32_16x16x32_bf16 v[20:23], a[156:159], v[124:127], v[20:23]
    ds_read_b128 a[204:207], v2 offset:27648
    v_cvt_pk_bf16_f32 v37, v26, v27
    v_mfma_f32_16x16x32_bf16 v[224:227], a[224:227], v[32:35], v[224:227]
    s_waitcnt vmcnt(22)
    v_exp_f32 v28, v28
    v_mfma_f32_16x16x32_bf16 v[228:231], a[228:231], v[32:35], v[228:231]
    s_barrier
    ds_read_b128 a[208:211], v2 offset:28672
    global_load_dwordx4 a[108:111], v3, s[6:7] offset:3072 sc1
    v_mfma_f32_16x16x32_bf16 v[232:235], a[232:235], v[32:35], v[232:235]
    s_mov_b64 s[6:7], s[34:35]
    v_exp_f32 v29, v29
    v_mfma_f32_16x16x32_bf16 v[236:239], a[236:239], v[32:35], v[236:239]
    s_add_u32 s99, s99, 1
    ds_read_b128 a[212:215], v2 offset:29696
    v_cvt_pk_bf16_f32 v38, v28, v29
    v_mfma_f32_16x16x32_bf16 v[240:243], a[240:243], v[32:35], v[240:243]
    s_bitcmp1_b64 s[4:5], s99
    v_exp_f32 v30, v30
    v_mfma_f32_16x16x32_bf16 v[244:247], a[244:247], v[32:35], v[244:247]
    ds_read_b128 a[216:219], v2 offset:30720
    global_load_lds_dwordx4 v3, s[14:15] offset:3072 sc1
    v_mfma_f32_16x16x32_bf16 v[248:251], a[248:251], v[32:35], v[248:251]
    s_mov_b32 m0, s98
    v_exp_f32 v31, v31
    v_mfma_f32_16x16x32_bf16 v[252:255], a[252:255], v[32:35], v[252:255]
    s_mov_b64 s[14:15], s[18:19]
    ds_read_b128 a[220:223], v2 offset:31744
    v_cvt_pk_bf16_f32 v39, v30, v31
    v_mfma_f32_16x16x32_bf16 v[44:47], a[0:3], v[32:35], v[44:47]
    v_add_u32 v2, s96, v1
L_att_l2p3:
    v_mfma_f32_16x16x32_bf16 v[24:27], a[128:131], v[96:99], v[48:51]
    v_exp_f32 v16, v16
    v_mfma_f32_16x16x32_bf16 v[24:27], a[132:135], v[100:103], v[24:27]
    s_add_u32 s62, m0, 16384
    ds_read_b128 a[128:131], v2 offset:0
    global_load_dwordx4 a[112:115], v1, s[6:7] offset:0 sc1
    v_mfma_f32_16x16x32_bf16 v[24:27], a[136:139], v[104:107], v[24:27]
    s_and_b32 s62, s62, 0x1ffff
    v_exp_f32 v17, v17
    v_mfma_f32_16x16x32_bf16 v[24:27], a[140:143], v[108:111], v[24:27]
    s_add_u32 s98, s62, 16384
    ds_read_b128 a[132:135], v2 offset:1024
    v_cvt_pk_bf16_f32 v32, v16, v17
    v_mfma_f32_16x16x32_bf16 v[28:31], a[144:147], v[96:99], v[48:51]
    s_and_b32 s98, s98, 0x1ffff
    v_exp_f32 v18, v18
    v_mfma_f32_16x16x32_bf16 v[28:31], a[148:151], v[100:103], v[28:31]
    s_add_u32 s96, s96, 32768
    ds_read_b128 a[136:139], v2 offset:2048
    global_load_lds_dwordx4 v1, s[14:15] offset:0 sc1
    v_mfma_f32_16x16x32_bf16 v[28:31], a[152:155], v[104:107], v[28:31]
    s_and_b32 s96, s96, 0x1ffff
    v_exp_f32 v19, v19
    v_mfma_f32_16x16x32_bf16 v[28:31], a[156:159], v[108:111], v[28:31]
    s_add_u32 s18, s14, 32768
    ds_read_b128 a[140:143], v2 offset:3072
    v_cvt_pk_bf16_f32 v33, v18, v19
    v_mfma_f32_16x16x32_bf16 v[192:195], a[224:227], v[36:39], v[192:195]
    s_addc_u32 s19, s15, 0
    v_exp_f32 v20, v20
    v_mfma_f32_16x16x32_bf16 v[196:199], a[228:231], v[36:39], v[196:199]
    s_sub_u32 s97, s97, 1
    ds_read_b128 a[144:147], v2 offset:4096
    global_load_dwordx4 a[116:119], v1, s[6:7] offset:1024 sc1
    v_mfma_f32_16x16x32_bf16 v[200:203], a[232:235], v[36:39], v[200:203]
    s_cmp_eq_u32 s97, 0
    v_exp_f32 v21, v21
    v_mfma_f32_16x16x32_bf16 v[204:207], a[236:239], v[36:39], v[204:207]
    s_cselect_b64 s[18:19], s[16:17], s[18:19]
    ds_read_b128 a[148:151], v2 offset:5120
    v_cvt_pk_bf16_f32 v34, v20, v21
    v_mfma_f32_16x16x32_bf16 v[208:211], a[240:243], v[36:39], v[208:211]
    v_exp_f32 v22, v22
    v_mfma_f32_16x16x32_bf16 v[212:215], a[244:247], v[36:39], v[212:215]
    ds_read_b128 a[152:155], v2 offset:6144
    global_load_lds_dwordx4 v1, s[14:15] offset:1024 sc1
    v_mfma_f32_16x16x32_bf16 v[216:219], a[248:251], v[36:39], v[216:219]
    v_exp_f32 v23, v23
    v_mfma_f32_16x16x32_bf16 v[220:223], a[252:255], v[36:39], v[220:223]
    ds_read_b128 a[156:159], v2 offset:7168
    v_cvt_pk_bf16_f32 v35, v22, v23
    v_mfma_f32_16x16x32_bf16 v[40:43], a[0:3], v[36:39], v[40:43]
    s_waitcnt lgkmcnt(3)
    v_mfma_f32_16x16x32_bf16 v[16:19], a[128:131], v[112:115], v[52:55]
    v_exp_f32 v24, v24
    v_mfma_f32_16x16x32_bf16 v[16:19], a[132:135], v[116:119], v[16:19]
    ds_read_b128 a[224:227], v2 offset:8192
    global_load_dwordx4 a[120:123], v1, s[6:7] offset:2048 sc1
    v_mfma_f32_16x16x32_bf16 v[16:19], a[136:139], v[120:123], v[16:19]
    s_waitcnt lgkmcnt(2)
    v_exp_f32 v25, v25
    v_mfma_f32_16x16x32_bf16 v[16:19], a[140:143], v[124:127], v[16:19]
    s_add_u32 s34, s6, 32768
    ds_read_b128 a[228:231], v2 offset:9216
    v_cvt_pk_bf16_f32 v36, v24, v25
    v_mfma_f32_16x16x32_bf16 v[20:23], a[144:147], v[112:115], v[52:55]
    s_addc_u32 s35, s7, 0
    v_exp_f32 v26, v26
    v_mfma_f32_16x16x32_bf16 v[20:23], a[148:151], v[116:119], v[20:23]
    ds_read_b128 a[232:235], v2 offset:10240
    global_load_lds_dwordx4 v1, s[14:15] offset:2048 sc1
    v_mfma_f32_16x16x32_bf16 v[20:23], a[152:155], v[120:123], v[20:23]
    s_waitcnt lgkmcnt(3)
    v_exp_f32 v27, v27
    v_mfma_f32_16x16x32_bf16 v[20:23], a[156:159], v[124:127], v[20:23]
    ds_read_b128 a[236:239], v2 offset:11264
    v_cvt_pk_bf16_f32 v37, v26, v27
    v_mfma_f32_16x16x32_bf16 v[224:227], a[192:195], v[32:35], v[224:227]
    v_exp_f32 v28, v28
    v_mfma_f32_16x16x32_bf16 v[228:231], a[196:199], v[32:35], v[228:231]
    ds_read_b128 a[240:243], v2 offset:12288
    global_load_dwordx4 a[124:127], v1, s[6:7] offset:3072 sc1
    v_mfma_f32_16x16x32_bf16 v[232:235], a[200:203], v[32:35], v[232:235]
    v_exp_f32 v29, v29
    v_mfma_f32_16x16x32_bf16 v[236:239], a[204:207], v[32:35], v[236:239]
    ds_read_b128 a[244:247], v2 offset:13312
    v_cvt_pk_bf16_f32 v38, v28, v29
    v_mfma_f32_16x16x32_bf16 v[240:243], a[208:211], v[32:35], v[240:243]
    v_exp_f32 v30, v30
    v_mfma_f32_16x16x32_bf16 v[244:247], a[212:215], v[32:35], v[244:247]
    ds_read_b128 a[248:251], v2 offset:14336
    global_load_lds_dwordx4 v1, s[14:15] offset:3072 sc1
    v_mfma_f32_16x16x32_bf16 v[248:251], a[216:219], v[32:35], v[248:251]
    s_mov_b32 m0, s62
    v_exp_f32 v31, v31
    v_mfma_f32_16x16x32_bf16 v[252:255], a[220:223], v[32:35], v[252:255]
    ds_read_b128 a[252:255], v2 offset:15360
    v_cvt_pk_bf16_f32 v39, v30, v31
    v_mfma_f32_16x16x32_bf16 v[44:47], a[0:3], v[32:35], v[44:47]
    v_mfma_f32_16x16x32_bf16 v[24:27], a[128:131], v[96:99], v[48:51]
    v_exp_f32 v16, v16
    v_mfma_f32_16x16x32_bf16 v[24:27], a[132:135], v[100:103], v[24:27]
    ds_read_b128 a[128:131], v2 offset:16384
    global_load_dwordx4 v[160:163], v3, s[6:7] offset:0 sc1
    v_mfma_f32_16x16x32_bf16 v[24:27], a[136:139], v[104:107], v[24:27]
    v_exp_f32 v17, v17
    v_mfma_f32_16x16x32_bf16 v[24:27], a[140:143], v[108:111], v[24:27]
    ds_read_b128 a[132:135], v2 offset:17408
    v_cvt_pk_bf16_f32 v32, v16, v17
    v_mfma_f32_16x16x32_bf16 v[28:31], a[144:147], v[96:99], v[48:51]
    v_exp_f32 v18, v18
    v_mfma_f32_16x16x32_bf16 v[28:31], a[148:151], v[100:103], v[28:31]
    ds_read_b128 a[136:139], v2 offset:18432
    global_load_lds_dwordx4 v3, s[14:15] offset:0 sc1
    v_mfma_f32_16x16x32_bf16 v[28:31], a[152:155], v[104:107], v[28:31]
    v_exp_f32 v19, v19
    v_mfma_f32_16x16x32_bf16 v[28:31], a[156:159], v[108:111], v[28:31]
    ds_read_b128 a[140:143], v2 offset:19456
    v_cvt_pk_bf16_f32 v33, v18, v19
    v_mfma_f32_16x16x32_bf16 v[192:195], a[192:195], v[36:39], v[192:195]
    v_exp_f32 v20, v20
    v_mfma_f32_16x16x32_bf16 v[196:199], a[196:199], v[36:39], v[196:199]
    ds_read_b128 a[144:147], v2 offset:20480
    global_load_dwordx4 v[164:167], v3, s[6:7] offset:1024 sc1
    v_mfma_f32_16x16x32_bf16 v[200:203], a[200:203], v[36:39], v[200:203]
    v_exp_f32 v21, v21
    v_mfma_f32_16x16x32_bf16 v[204:207], a[204:207], v[36:39], v[204:207]
    ds_read_b128 a[148:151], v2 offset:21504
    v_cvt_pk_bf16_f32 v34, v20, v21
    v_mfma_f32_16x16x32_bf16 v[208:211], a[208:211], v[36:39], v[208:211]
    v_exp_f32 v22, v22
    v_mfma_f32_16x16x32_bf16 v[212:215], a[212:215], v[36:39], v[212:215]
    ds_read_b128 a[152:155], v2 offset:22528
    global_load_lds_dwordx4 v3, s[14:15] offset:1024 sc1
    v_mfma_f32_16x16x32_bf16 v[216:219], a[216:219], v[36:39], v[216:219]
    v_exp_f32 v23, v23
    v_mfma_f32_16x16x32_bf16 v[220:223], a[220:223], v[36:39], v[220:223]
    ds_read_b128 a[156:159], v2 offset:23552
    v_cvt_pk_bf16_f32 v35, v22, v23
    v_mfma_f32_16x16x32_bf16 v[40:43], a[0:3], v[36:39], v[40:43]
    s_waitcnt lgkmcnt(3)
    v_mfma_f32_16x16x32_bf16 v[16:19], a[128:131], v[112:115], v[52:55]
    v_exp_f32 v24, v24
    v_mfma_f32_16x16x32_bf16 v[16:19], a[132:135], v[116:119], v[16:19]
    ds_read_b128 a[192:195], v2 offset:24576
    global_load_dwordx4 v[168:171], v3, s[6:7] offset:2048 sc1
    v_mfma_f32_16x16x32_bf16 v[16:19], a[136:139], v[120:123], v[16:19]
    v_exp_f32 v25, v25
    v_mfma_f32_16x16x32_bf16 v[16:19], a[140:143], v[124:127], v[16:19]
    ds_read_b128 a[196:199], v2 offset:25600
    v_cvt_pk_bf16_f32 v36, v24, v25
    v_mfma_f32_16x16x32_bf16 v[20:23], a[144:147], v[112:115], v[52:55]
    s_waitcnt lgkmcnt(2)
    v_exp_f32 v26, v26
    v_mfma_f32_16x16x32_bf16 v[20:23], a[148:151], v[116:119], v[20:23]
    ds_read_b128 a[200:203], v2 offset:26624
    global_load_lds_dwordx4 v3, s[14:15] offset:2048 sc1
    v_mfma_f32_16x16x32_bf16 v[20:23], a[152:155], v[120:123], v[20:23]
    v_exp_f32 v27, v27
    v_mfma_f32_16x16x32_bf16 v[20:23], a[156:159], v[124:127], v[20:23]
    ds_read_b128 a[204:207], v2 offset:27648
    v_cvt_pk_bf16_f32 v37, v26, v27
    v_mfma_f32_16x16x32_bf16 v[224:227], a[224:227], v[32:35], v[224:227]
    s_waitcnt vmcnt(18)
    v_exp_f32 v28, v28
    v_mfma_f32_16x16x32_bf16 v[228:231], a[228:231], v[32:35], v[228:231]
    s_barrier
    ds_read_b128 a[208:211], v2 offset:28672
    global_load_dwordx4 v[172:175], v3, s[6:7] offset:3072 sc1
    v_mfma_f32_16x16x32_bf16 v[232:235], a[232:235], v[32:35], v[232:235]
    s_mov_b64 s[6:7], s[34:35]
    v_exp_f32 v29, v29
    v_mfma_f32_16x16x32_bf16 v[236:239], a[236:239], v[32:35], v[236:239]
    s_add_u32 s99, s99, 1
    ds_read_b128 a[212:215], v2 offset:29696
    v_cvt_pk_bf16_f32 v38, v28, v29
    v_mfma_f32_16x16x32_bf16 v[240:243], a[240:243], v[32:35], v[240:243]
    s_bitcmp1_b64 s[4:5], s99
    v_exp_f32 v30, v30
    v_mfma_f32_16x16x32_bf16 v[244:247], a[244:247], v[32:35], v[244:247]
    ds_read_b128 a[216:219], v2 offset:30720
    global_load_lds_dwordx4 v3, s[14:15] offset:3072 sc1
    v_mfma_f32_16x16x32_bf16 v[248:251], a[248:251], v[32:35], v[248:251]
    s_mov_b32 m0, s98
    v_exp_f32 v31, v31
    v_mfma_f32_16x16x32_bf16 v[252:255], a[252:255], v[32:35], v[252:255]
    s_mov_b64 s[14:15], s[18:19]
    ds_read_b128 a[220:223], v2 offset:31744
    v_cvt_pk_bf16_f32 v39, v30, v31
    v_mfma_f32_16x16x32_bf16 v[44:47], a[0:3], v[32:35], v[44:47]
    v_add_u32 v2, s96, v1
    v_mfma_f32_16x16x32_bf16 v[24:27], a[128:131], v[96:99], v[48:51]
    v_exp_f32 v16, v16
    v_mfma_f32_16x16x32_bf16 v[24:27], a[132:135], v[100:103], v[24:27]
    s_add_u32 s62, m0, 16384
    ds_read_b128 a[128:131], v2 offset:0
    global_load_dwordx4 v[176:179], v1, s[6:7] offset:0 sc1
    v_mfma_f32_16x16x32_bf16 v[24:27], a[136:139], v[104:107], v[24:27]
    s_and_b32 s62, s62, 0x1ffff
    v_exp_f32 v17, v17
    v_mfma_f32_16x16x32_bf16 v[24:27], a[140:143], v[108:111], v[24:27]
    s_add_u32 s98, s62, 16384
    ds_read_b128 a[132:135], v2 offset:1024
    v_cvt_pk_bf16_f32 v32, v16, v17
    v_mfma_f32_16x16x32_bf16 v[28:31], a[144:147], v[96:99], v[48:51]
    s_and_b32 s98, s98, 0x1ffff
    v_exp_f32 v18, v18
    v_mfma_f32_16x16x32_bf16 v[28:31], a[148:151], v[100:103], v[28:31]
    s_add_u32 s96, s96, 32768
    ds_read_b128 a[136:139], v2 offset:2048
    global_load_lds_dwordx4 v1, s[14:15] offset:0 sc1
    v_mfma_f32_16x16x32_bf16 v[28:31], a[152:155], v[104:107], v[28:31]
    s_and_b32 s96, s96, 0x1ffff
    v_exp_f32 v19, v19
    v_mfma_f32_16x16x32_bf16 v[28:31], a[156:159], v[108:111], v[28:31]
    s_add_u32 s18, s14, 32768
    ds_read_b128 a[140:143], v2 offset:3072
    v_cvt_pk_bf16_f32 v33, v18, v19
    v_mfma_f32_16x16x32_bf16 v[192:195], a[224:227], v[36:39], v[192:195]
    s_addc_u32 s19, s15, 0
    v_exp_f32 v20, v20
    v_mfma_f32_16x16x32_bf16 v[196:199], a[228:231], v[36:39], v[196:199]
    s_sub_u32 s97, s97, 1
    ds_read_b128 a[144:147], v2 offset:4096
    global_load_dwordx4 v[180:183], v1, s[6:7] offset:1024 sc1
    v_mfma_f32_16x16x32_bf16 v[200:203], a[232:235], v[36:39], v[200:203]
    s_cmp_eq_u32 s97, 0
    v_exp_f32 v21, v21
    v_mfma_f32_16x16x32_bf16 v[204:207], a[236:239], v[36:39], v[204:207]
    s_cselect_b64 s[18:19], s[16:17], s[18:19]
    ds_read_b128 a[148:151], v2 offset:5120
    v_cvt_pk_bf16_f32 v34, v20, v21
    v_mfma_f32_16x16x32_bf16 v[208:211], a[240:243], v[36:39], v[208:211]
    v_exp_f32 v22, v22
    v_mfma_f32_16x16x32_bf16 v[212:215], a[244:247], v[36:39], v[212:215]
    ds_read_b128 a[152:155], v2 offset:6144
    global_load_lds_dwordx4 v1, s[14:15] offset:1024 sc1
    v_mfma_f32_16x16x32_bf16 v[216:219], a[248:251], v[36:39], v[216:219]
    v_exp_f32 v23, v23
    v_mfma_f32_16x16x32_bf16 v[220:223], a[252:255], v[36:39], v[220:223]
    ds_read_b128 a[156:159], v2 offset:7168
    v_cvt_pk_bf16_f32 v35, v22, v23
    v_mfma_f32_16x16x32_bf16 v[40:43], a[0:3], v[36:39], v[40:43]
    s_waitcnt lgkmcnt(3)
    v_mfma_f32_16x16x32_bf16 v[16:19], a[128:131], v[112:115], v[52:55]
    v_exp_f32 v24, v24
    v_mfma_f32_16x16x32_bf16 v[16:19], a[132:135], v[116:119], v[16:19]
    ds_read_b128 a[224:227], v2 offset:8192
    global_load_dwordx4 v[184:187], v1, s[6:7] offset:2048 sc1
    v_mfma_f32_16x16x32_bf16 v[16:19], a[136:139], v[120:123], v[16:19]
    s_waitcnt lgkmcnt(2)
    v_exp_f32 v25, v25
    v_mfma_f32_16x16x32_bf16 v[16:19], a[140:143], v[124:127], v[16:19]
    s_add_u32 s34, s6, 32768
    ds_read_b128 a[228:231], v2 offset:9216
    v_cvt_pk_bf16_f32 v36, v24, v25
    v_mfma_f32_16x16x32_bf16 v[20:23], a[144:147], v[112:115], v[52:55]
    s_addc_u32 s35, s7, 0
    v_exp_f32 v26, v26
    v_mfma_f32_16x16x32_bf16 v[20:23], a[148:151], v[116:119], v[20:23]
    ds_read_b128 a[232:235], v2 offset:10240
    global_load_lds_dwordx4 v1, s[14:15] offset:2048 sc1
    v_mfma_f32_16x16x32_bf16 v[20:23], a[152:155], v[120:123], v[20:23]
    s_waitcnt lgkmcnt(3)
    v_exp_f32 v27, v27
    v_mfma_f32_16x16x32_bf16 v[20:23], a[156:159], v[124:127], v[20:23]
    ds_read_b128 a[236:239], v2 offset:11264
    v_cvt_pk_bf16_f32 v37, v26, v27
    v_mfma_f32_16x16x32_bf16 v[224:227], a[192:195], v[32:35], v[224:227]
    v_exp_f32 v28, v28
    v_mfma_f32_16x16x32_bf16 v[228:231], a[196:199], v[32:35], v[228:231]
    ds_read_b128 a[240:243], v2 offset:12288
    global_load_dwordx4 v[188:191], v1, s[6:7] offset:3072 sc1
    v_mfma_f32_16x16x32_bf16 v[232:235], a[200:203], v[32:35], v[232:235]
    v_exp_f32 v29, v29
    v_mfma_f32_16x16x32_bf16 v[236:239], a[204:207], v[32:35], v[236:239]
    ds_read_b128 a[244:247], v2 offset:13312
    v_cvt_pk_bf16_f32 v38, v28, v29
    v_mfma_f32_16x16x32_bf16 v[240:243], a[208:211], v[32:35], v[240:243]
    v_exp_f32 v30, v30
    v_mfma_f32_16x16x32_bf16 v[244:247], a[212:215], v[32:35], v[244:247]
    ds_read_b128 a[248:251], v2 offset:14336
    global_load_lds_dwordx4 v1, s[14:15] offset:3072 sc1
    v_mfma_f32_16x16x32_bf16 v[248:251], a[216:219], v[32:35], v[248:251]
    s_mov_b32 m0, s62
    v_exp_f32 v31, v31
    v_mfma_f32_16x16x32_bf16 v[252:255], a[220:223], v[32:35], v[252:255]
    ds_read_b128 a[252:255], v2 offset:15360
    v_cvt_pk_bf16_f32 v39, v30, v31
    v_mfma_f32_16x16x32_bf16 v[44:47], a[0:3], v[32:35], v[44:47]
    v_mfma_f32_16x16x32_bf16 v[24:27], a[128:131], v[96:99], v[48:51]
    v_exp_f32 v16, v16
    v_mfma_f32_16x16x32_bf16 v[24:27], a[132:135], v[100:103], v[24:27]
    ds_read_b128 a[128:131], v2 offset:16384
    global_load_dwordx4 a[160:163], v3, s[6:7] offset:0 sc1
    v_mfma_f32_16x16x32_bf16 v[24:27], a[136:139], v[104:107], v[24:27]
    v_exp_f32 v17, v17
    v_mfma_f32_16x16x32_bf16 v[24:27], a[140:143], v[108:111], v[24:27]
    ds_read_b128 a[132:135], v2 offset:17408
    v_cvt_pk_bf16_f32 v32, v16, v17
    v_mfma_f32_16x16x32_bf16 v[28:31], a[144:147], v[96:99], v[48:51]
    v_exp_f32 v18, v18
    v_mfma_f32_16x16x32_bf16 v[28:31], a[148:151], v[100:103], v[28:31]
    ds_read_b128 a[136:139], v2 offset:18432
    global_load_lds_dwordx4 v3, s[14:15] offset:0 sc1
    v_mfma_f32_16x16x32_bf16 v[28:31], a[152:155], v[104:107], v[28:31]
    v_exp_f32 v19, v19
    v_mfma_f32_16x16x32_bf16 v[28:31], a[156:159], v[108:111], v[28:31]
    ds_read_b128 a[140:143], v2 offset:19456
    v_cvt_pk_bf16_f32 v33, v18, v19
    v_mfma_f32_16x16x32_bf16 v[192:195], a[192:195], v[36:39], v[192:195]
    v_exp_f32 v20, v20
    v_mfma_f32_16x16x32_bf16 v[196:199], a[196:199], v[36:39], v[196:199]
    ds_read_b128 a[144:147], v2 offset:20480
    global_load_dwordx4 a[164:167], v3, s[6:7] offset:1024 sc1
    v_mfma_f32_16x16x32_bf16 v[200:203], a[200:203], v[36:39], v[200:203]
    v_exp_f32 v21, v21
    v_mfma_f32_16x16x32_bf16 v[204:207], a[204:207], v[36:39], v[204:207]
    ds_read_b128 a[148:151], v2 offset:21504
    v_cvt_pk_bf16_f32 v34, v20, v21
    v_mfma_f32_16x16x32_bf16 v[208:211], a[208:211], v[36:39], v[208:211]
    v_exp_f32 v22, v22
    v_mfma_f32_16x16x32_bf16 v[212:215], a[212:215], v[36:39], v[212:215]
    ds_read_b128 a[152:155], v2 offset:22528
    global_load_lds_dwordx4 v3, s[14:15] offset:1024 sc1
    v_mfma_f32_16x16x32_bf16 v[216:219], a[216:219], v[36:39], v[216:219]
    v_exp_f32 v23, v23
    v_mfma_f32_16x16x32_bf16 v[220:223], a[220:223], v[36:39], v[220:223]
    ds_read_b128 a[156:159], v2 offset:23552
    v_cvt_pk_bf16_f32 v35, v22, v23
    v_mfma_f32_16x16x32_bf16 v[40:43], a[0:3], v[36:39], v[40:43]
    s_waitcnt lgkmcnt(3)
    v_mfma_f32_16x16x32_bf16 v[16:19], a[128:131], v[112:115], v[52:55]
    v_exp_f32 v24, v24
    v_mfma_f32_16x16x32_bf16 v[16:19], a[132:135], v[116:119], v[16:19]
    ds_read_b128 a[192:195], v2 offset:24576
    global_load_dwordx4 a[168:171], v3, s[6:7] offset:2048 sc1
    v_mfma_f32_16x16x32_bf16 v[16:19], a[136:139], v[120:123], v[16:19]
    v_exp_f32 v25, v25
    v_mfma_f32_16x16x32_bf16 v[16:19], a[140:143], v[124:127], v[16:19]
    ds_read_b128 a[196:199], v2 offset:25600
    v_cvt_pk_bf16_f32 v36, v24, v25
    v_mfma_f32_16x16x32_bf16 v[20:23], a[144:147], v[112:115], v[52:55]
    s_waitcnt lgkmcnt(2)
    v_exp_f32 v26, v26
    v_mfma_f32_16x16x32_bf16 v[20:23], a[148:151], v[116:119], v[20:23]
    ds_read_b128 a[200:203], v2 offset:26624
    global_load_lds_dwordx4 v3, s[14:15] offset:2048 sc1
    v_mfma_f32_16x16x32_bf16 v[20:23], a[152:155], v[120:123], v[20:23]
    v_exp_f32 v27, v27
    v_mfma_f32_16x16x32_bf16 v[20:23], a[156:159], v[124:127], v[20:23]
    ds_read_b128 a[204:207], v2 offset:27648
    v_cvt_pk_bf16_f32 v37, v26, v27
    v_mfma_f32_16x16x32_bf16 v[224:227], a[224:227], v[32:35], v[224:227]
    s_waitcnt vmcnt(22)
    v_exp_f32 v28, v28
    v_mfma_f32_16x16x32_bf16 v[228:231], a[228:231], v[32:35], v[228:231]
    s_barrier
    ds_read_b128 a[208:211], v2 offset:28672
    global_load_dwordx4 a[172:175], v3, s[6:7] offset:3072 sc1
    v_mfma_f32_16x16x32_bf16 v[232:235], a[232:235], v[32:35], v[232:235]
    s_mov_b64 s[6:7], s[34:35]
    v_exp_f32 v29, v29
    v_mfma_f32_16x16x32_bf16 v[236:239], a[236:239], v[32:35], v[236:239]
    s_add_u32 s99, s99, 1
    ds_read_b128 a[212:215], v2 offset:29696
    v_cvt_pk_bf16_f32 v38, v28, v29
    v_mfma_f32_16x16x32_bf16 v[240:243], a[240:243], v[32:35], v[240:243]
    s_bitcmp1_b64 s[4:5], s99
    v_exp_f32 v30, v30
    v_mfma_f32_16x16x32_bf16 v[244:247], a[244:247], v[32:35], v[244:247]
    ds_read_b128 a[216:219], v2 offset:30720
    global_load_lds_dwordx4 v3, s[14:15] offset:3072 sc1
    v_mfma_f32_16x16x32_bf16 v[248:251], a[248:251], v[32:35], v[248:251]
    s_mov_b32 m0, s98
    v_exp_f32 v31, v31
    v_mfma_f32_16x16x32_bf16 v[252:255], a[252:255], v[32:35], v[252:255]
    s_mov_b64 s[14:15], s[18:19]
    ds_read_b128 a[220:223], v2 offset:31744
    v_cvt_pk_bf16_f32 v39, v30, v31
    v_mfma_f32_16x16x32_bf16 v[44:47], a[0:3], v[32:35], v[44:47]
    v_add_u32 v2, s96, v1
    v_mfma_f32_16x16x32_bf16 v[24:27], a[128:131], v[96:99], v[48:51]
    v_exp_f32 v16, v16
    v_mfma_f32_16x16x32_bf16 v[24:27], a[132:135], v[100:103], v[24:27]
    s_add_u32 s62, m0, 16384
    ds_read_b128 a[128:131], v2 offset:0
    global_load_dwordx4 a[176:179], v1, s[6:7] offset:0 sc1
    v_mfma_f32_16x16x32_bf16 v[24:27], a[136:139], v[104:107], v[24:27]
    s_and_b32 s62, s62, 0x1ffff
    v_exp_f32 v17, v17
    v_mfma_f32_16x16x32_bf16 v[24:27], a[140:143], v[108:111], v[24:27]
    s_add_u32 s98, s62, 16384
    ds_read_b128 a[132:135], v2 offset:1024
    v_cvt_pk_bf16_f32 v32, v16, v17
L_wk10:
    s_cbranch_execz L_wkret
    v_mfma_f32_16x16x32_bf16 v[28:31], a[144:147], v[96:99], v[48:51]
    s_and_b32 s98, s98, 0x1ffff
    v_exp_f32 v18, v18
    v_mfma_f32_16x16x32_bf16 v[28:31], a[148:151], v[100:103], v[28:31]
    s_add_u32 s96, s96, 32768
    ds_read_b128 a[136:139], v2 offset:2048
    global_load_lds_dwordx4 v1, s[14:15] offset:0 sc1
    v_mfma_f32_16x16x32_bf16 v[28:31], a[152:155], v[104:107], v[28:31]
    s_and_b32 s96, s96, 0x1ffff
    v_exp_f32 v19, v19
    v_mfma_f32_16x16x32_bf16 v[28:31], a[156:159], v[108:111], v[28:31]
    s_add_u32 s18, s14, 32768
    ds_read_b128 a[140:143], v2 offset:3072
    v_cvt_pk_bf16_f32 v33, v18, v19
    v_mfma_f32_16x16x32_bf16 v[192:195], a[224:227], v[36:39], v[192:195]
    s_addc_u32 s19, s15, 0
    v_exp_f32 v20, v20
    v_mfma_f32_16x16x32_bf16 v[196:199], a[228:231], v[36:39], v[196:199]
    s_sub_u32 s97, s97, 1
    ds_read_b128 a[144:147], v2 offset:4096
    global_load_dwordx4 a[180:183], v1, s[6:7] offset:1024 sc1
    v_mfma_f32_16x16x32_bf16 v[200:203], a[232:235], v[36:39], v[200:203]
    s_cmp_eq_u32 s97, 0
    v_exp_f32 v21, v21
    v_mfma_f32_16x16x32_bf16 v[204:207], a[236:239], v[36:39], v[204:207]
    s_cselect_b64 s[18:19], s[16:17], s[18:19]
    ds_read_b128 a[148:151], v2 offset:5120
    v_cvt_pk_bf16_f32 v34, v20, v21
    v_mfma_f32_16x16x32_bf16 v[208:211], a[240:243], v[36:39], v[208:211]
    v_exp_f32 v22, v22
    v_mfma_f32_16x16x32_bf16 v[212:215], a[244:247], v[36:39], v[212:215]
    ds_read_b128 a[152:155], v2 offset:6144
    global_load_lds_dwordx4 v1, s[14:15] offset:1024 sc1
    v_mfma_f32_16x16x32_bf16 v[216:219], a[248:251], v[36:39], v[216:219]
    v_exp_f32 v23, v23
    v_mfma_f32_16x16x32_bf16 v[220:223], a[252:255], v[36:39], v[220:223]
    ds_read_b128 a[156:159], v2 offset:7168
    v_cvt_pk_bf16_f32 v35, v22, v23
    v_mfma_f32_16x16x32_bf16 v[40:43], a[0:3], v[36:39], v[40:43]
    s_waitcnt lgkmcnt(3)
    v_mfma_f32_16x16x32_bf16 v[16:19], a[128:131], v[112:115], v[52:55]
    v_exp_f32 v24, v24
    v_mfma_f32_16x16x32_bf16 v[16:19], a[132:135], v[116:119], v[16:19]
    ds_read_b128 a[224:227], v2 offset:8192
    global_load_dwordx4 a[184:187], v1, s[6:7] offset:2048 sc1
    v_mfma_f32_16x16x32_bf16 v[16:19], a[136:139], v[120:123], v[16:19]
    s_waitcnt lgkmcnt(2)
    v_exp_f32 v25, v25
    v_mfma_f32_16x16x32_bf16 v[16:19], a[140:143], v[124:127], v[16:19]
    s_add_u32 s34, s6, 32768
    ds_read_b128 a[228:231], v2 offset:9216
    v_cvt_pk_bf16_f32 v36, v24, v25
    v_mfma_f32_16x16x32_bf16 v[20:23], a[144:147], v[112:115], v[52:55]
    s_addc_u32 s35, s7, 0
    v_exp_f32 v26, v26
    v_mfma_f32_16x16x32_bf16 v[20:23], a[148:151], v[116:119], v[20:23]
    ds_read_b128 a[232:235], v2 offset:10240
    global_load_lds_dwordx4 v1, s[14:15] offset:2048 sc1
    v_mfma_f32_16x16x32_bf16 v[20:23], a[152:155], v[120:123], v[20:23]
    s_waitcnt lgkmcnt(3)
    v_exp_f32 v27, v27
    v_mfma_f32_16x16x32_bf16 v[20:23], a[156:159], v[124:127], v[20:23]
    ds_read_b128 a[236:239], v2 offset:11264
    v_cvt_pk_bf16_f32 v37, v26, v27
    v_mfma_f32_16x16x32_bf16 v[224:227], a[192:195], v[32:35], v[224:227]
    v_exp_f32 v28, v28
    v_mfma_f32_16x16x32_bf16 v[228:231], a[196:199], v[32:35], v[228:231]
    ds_read_b128 a[240:243], v2 offset:12288
    global_load_dwordx4 a[188:191], v1, s[6:7] offset:3072 sc1
    v_mfma_f32_16x16x32_bf16 v[232:235], a[200:203], v[32:35], v[232:235]
    v_exp_f32 v29, v29
    v_mfma_f32_16x16x32_bf16 v[236:239], a[204:207], v[32:35], v[236:239]
    ds_read_b128 a[244:247], v2 offset:13312
    v_cvt_pk_bf16_f32 v38, v28, v29
    v_mfma_f32_16x16x32_bf16 v[240:243], a[208:211], v[32:35], v[240:243]
    v_exp_f32 v30, v30
    v_mfma_f32_16x16x32_bf16 v[244:247], a[212:215], v[32:35], v[244:247]
    ds_read_b128 a[248:251], v2 offset:14336
    global_load_lds_dwordx4 v1, s[14:15] offset:3072 sc1
    v_mfma_f32_16x16x32_bf16 v[248:251], a[216:219], v[32:35], v[248:251]
    s_mov_b32 m0, s62
    v_exp_f32 v31, v31
    v_mfma_f32_16x16x32_bf16 v[252:255], a[220:223], v[32:35], v[252:255]
    ds_read_b128 a[252:255], v2 offset:15360
    v_cvt_pk_bf16_f32 v39, v30, v31
    v_mfma_f32_16x16x32_bf16 v[44:47], a[0:3], v[32:35], v[44:47]
    v_mfma_f32_16x16x32_bf16 v[24:27], a[128:131], v[96:99], v[48:51]
    v_exp_f32 v16, v16
    v_mfma_f32_16x16x32_bf16 v[24:27], a[132:135], v[100:103], v[24:27]
    s_mov_b32 m0, s59
    ds_read_b128 a[128:131], v2 offset:16384
    global_load_lds_dwordx4 v1, s[10:11] offset:0 sc1
    v_mfma_f32_16x16x32_bf16 v[24:27], a[136:139], v[104:107], v[24:27]
    s_mov_b32 m0, s62
    v_exp_f32 v17, v17
    v_mfma_f32_16x16x32_bf16 v[24:27], a[140:143], v[108:111], v[24:27]
    ds_read_b128 a[132:135], v2 offset:17408
    v_cvt_pk_bf16_f32 v32, v16, v17
    v_mfma_f32_16x16x32_bf16 v[28:31], a[144:147], v[96:99], v[48:51]
    v_exp_f32 v18, v18
    v_mfma_f32_16x16x32_bf16 v[28:31], a[148:151], v[100:103], v[28:31]
    ds_read_b128 a[136:139], v2 offset:18432
    global_load_lds_dwordx4 v3, s[14:15] offset:0 sc1
    v_mfma_f32_16x16x32_bf16 v[28:31], a[152:155], v[104:107], v[28:31]
    v_exp_f32 v19, v19
    v_mfma_f32_16x16x32_bf16 v[28:31], a[156:159], v[108:111], v[28:31]
    ds_read_b128 a[140:143], v2 offset:19456
    v_cvt_pk_bf16_f32 v33, v18, v19
    v_mfma_f32_16x16x32_bf16 v[192:195], a[192:195], v[36:39], v[192:195]
    v_exp_f32 v20, v20
    v_mfma_f32_16x16x32_bf16 v[196:199], a[196:199], v[36:39], v[196:199]
    s_mov_b32 m0, s59
    ds_read_b128 a[144:147], v2 offset:20480
    global_load_lds_dwordx4 v1, s[10:11] offset:1024 sc1
    v_mfma_f32_16x16x32_bf16 v[200:203], a[200:203], v[36:39], v[200:203]
    s_mov_b32 m0, s62
    v_exp_f32 v21, v21
    v_mfma_f32_16x16x32_bf16 v[204:207], a[204:207], v[36:39], v[204:207]
    ds_read_b128 a[148:151], v2 offset:21504
    v_cvt_pk_bf16_f32 v34, v20, v21
    v_mfma_f32_16x16x32_bf16 v[208:211], a[208:211], v[36:39], v[208:211]
    v_exp_f32 v22, v22
    v_mfma_f32_16x16x32_bf16 v[212:215], a[212:215], v[36:39], v[212:215]
    ds_read_b128 a[152:155], v2 offset:22528
    global_load_lds_dwordx4 v3, s[14:15] offset:1024 sc1
    v_mfma_f32_16x16x32_bf16 v[216:219], a[216:219], v[36:39], v[216:219]
    v_exp_f32 v23, v23
    v_mfma_f32_16x16x32_bf16 v[220:223], a[220:223], v[36:39], v[220:223]
    ds_read_b128 a[156:159], v2 offset:23552
    v_cvt_pk_bf16_f32 v35, v22, v23
    v_mfma_f32_16x16x32_bf16 v[40:43], a[0:3], v[36:39], v[40:43]
    s_waitcnt lgkmcnt(3)
    v_mfma_f32_16x16x32_bf16 v[16:19], a[128:131], v[112:115], v[52:55]
    v_exp_f32 v24, v24
    v_mfma_f32_16x16x32_bf16 v[16:19], a[132:135], v[116:119], v[16:19]
    s_mov_b32 m0, s59
    ds_read_b128 a[192:195], v2 offset:24576
    global_load_lds_dwordx4 v1, s[10:11] offset:2048 sc1
    v_mfma_f32_16x16x32_bf16 v[16:19], a[136:139], v[120:123], v[16:19]
    s_mov_b32 m0, s62
    v_exp_f32 v25, v25
    v_mfma_f32_16x16x32_bf16 v[16:19], a[140:143], v[124:127], v[16:19]
    ds_read_b128 a[196:199], v2 offset:25600
    v_cvt_pk_bf16_f32 v36, v24, v25
    v_mfma_f32_16x16x32_bf16 v[20:23], a[144:147], v[112:115], v[52:55]
    s_waitcnt lgkmcnt(2)
    v_exp_f32 v26, v26
    v_mfma_f32_16x16x32_bf16 v[20:23], a[148:151], v[116:119], v[20:23]
    ds_read_b128 a[200:203], v2 offset:26624
    global_load_lds_dwordx4 v3, s[14:15] offset:2048 sc1
    v_mfma_f32_16x16x32_bf16 v[20:23], a[152:155], v[120:123], v[20:23]
    v_exp_f32 v27, v27
    v_mfma_f32_16x16x32_bf16 v[20:23], a[156:159], v[124:127], v[20:23]
    s_mov_b32 m0, s59
    ds_read_b128 a[204:207], v2 offset:27648
    v_cvt_pk_bf16_f32 v37, v26, v27
    v_mfma_f32_16x16x32_bf16 v[224:227], a[224:227], v[32:35], v[224:227]
    s_waitcnt vmcnt(22)
    v_exp_f32 v28, v28
    v_mfma_f32_16x16x32_bf16 v[228:231], a[228:231], v[32:35], v[228:231]
    s_barrier
    ds_read_b128 a[208:211], v2 offset:28672
    global_load_lds_dwordx4 v1, s[10:11] offset:3072 sc1
    v_mfma_f32_16x16x32_bf16 v[232:235], a[232:235], v[32:35], v[232:235]
    s_mov_b32 m0, s62
    v_exp_f32 v29, v29
    v_mfma_f32_16x16x32_bf16 v[236:239], a[236:239], v[32:35], v[236:239]
    s_add_u32 s99, s99, 1
    ds_read_b128 a[212:215], v2 offset:29696
    v_cvt_pk_bf16_f32 v38, v28, v29
    v_mfma_f32_16x16x32_bf16 v[240:243], a[240:243], v[32:35], v[240:243]
    s_bitcmp1_b64 s[4:5], s99
    v_exp_f32 v30, v30
    v_mfma_f32_16x16x32_bf16 v[244:247], a[244:247], v[32:35], v[244:247]
    s_mov_b64 s[6:7], s[34:35]
    ds_read_b128 a[216:219], v2 offset:30720
    global_load_lds_dwordx4 v3, s[14:15] offset:3072 sc1
    v_mfma_f32_16x16x32_bf16 v[248:251], a[248:251], v[32:35], v[248:251]
    s_mov_b32 m0, s98
    v_exp_f32 v31, v31
    v_mfma_f32_16x16x32_bf16 v[252:255], a[252:255], v[32:35], v[252:255]
    s_mov_b64 s[14:15], s[18:19]
    ds_read_b128 a[220:223], v2 offset:31744
    v_cvt_pk_bf16_f32 v39, v30, v31
    v_mfma_f32_16x16x32_bf16 v[44:47], a[0:3], v[32:35], v[44:47]
    v_add_u32 v2, s96, v1
.p2align 6
L_att_l2:
    v_mfma_f32_16x16x32_bf16 v[24:27], a[128:131], v[96:99], v[48:51]
    v_exp_f32 v16, v16
    v_mfma_f32_16x16x32_bf16 v[24:27], a[132:135], v[100:103], v[24:27]
    s_add_u32 s62, m0, 16384
    ds_read_b128 a[128:131], v2 offset:0
    v_mfma_f32_16x16x32_bf16 v[24:27], a[136:139], v[104:107], v[24:27]
    s_and_b32 s62, s62, 0x1ffff
    v_exp_f32 v17, v17
    v_mfma_f32_16x16x32_bf16 v[24:27], a[140:143], v[108:111], v[24:27]
    s_add_u32 s98, s62, 16384
    ds_read_b128 a[132:135], v2 offset:1024
    v_cvt_pk_bf16_f32 v32, v16, v17
    v_mfma_f32_16x16x32_bf16 v[28:31], a[144:147], v[96:99], v[48:51]
    s_and_b32 s98, s98, 0x1ffff
    v_exp_f32 v18, v18
    v_mfma_f32_16x16x32_bf16 v[28:31], a[148:151], v[100:103], v[28:31]
    s_add_u32 s96, s96, 32768
    ds_read_b128 a[136:139], v2 offset:2048
    global_load_lds_dwordx4 v1, s[14:15] offset:0 sc1
    v_mfma_f32_16x16x32_bf16 v[28:31], a[152:155], v[104:107], v[28:31]
    s_and_b32 s96, s96, 0x1ffff
    v_exp_f32 v19, v19
    v_mfma_f32_16x16x32_bf16 v[28:31], a[156:159], v[108:111], v[28:31]
    s_add_u32 s18, s14, 32768
    ds_read_b128 a[140:143], v2 offset:3072
    v_cvt_pk_bf16_f32 v33, v18, v19
    v_mfma_f32_16x16x32_bf16 v[192:195], a[224:227], v[36:39], v[192:195]
    s_addc_u32 s19, s15, 0
    v_exp_f32 v20, v20
    v_mfma_f32_16x16x32_bf16 v[196:199], a[228:231], v[36:39], v[196:199]
    s_sub_u32 s97, s97, 1
    ds_read_b128 a[144:147], v2 offset:4096
    v_mfma_f32_16x16x32_bf16 v[200:203], a[232:235], v[36:39], v[200:203]
    s_cmp_eq_u32 s97, 0
    v_exp_f32 v21, v21
    v_mfma_f32_16x16x32_bf16 v[204:207], a[236:239], v[36:39], v[204:207]
    s_cselect_b64 s[18:19], s[16:17], s[18:19]
    ds_read_b128 a[148:151], v2 offset:5120
    v_cvt_pk_bf16_f32 v34, v20, v21
    v_mfma_f32_16x16x32_bf16 v[208:211], a[240:243], v[36:39], v[208:211]
    v_exp_f32 v22, v22
    v_mfma_f32_16x16x32_bf16 v[212:215], a[244:247], v[36:39], v[212:215]
    ds_read_b128 a[152:155], v2 offset:6144
    global_load_lds_dwordx4 v1, s[14:15] offset:1024 sc1
    v_mfma_f32_16x16x32_bf16 v[216:219], a[248:251], v[36:39], v[216:219]
    v_exp_f32 v23, v23
    v_mfma_f32_16x16x32_bf16 v[220:223], a[252:255], v[36:39], v[220:223]
    ds_read_b128 a[156:159], v2 offset:7168
    v_cvt_pk_bf16_f32 v35, v22, v23
    v_mfma_f32_16x16x32_bf16 v[40:43], a[0:3], v[36:39], v[40:43]
    s_waitcnt lgkmcnt(3)
    v_mfma_f32_16x16x32_bf16 v[16:19], a[128:131], v[112:115], v[52:55]
    v_exp_f32 v24, v24
    v_mfma_f32_16x16x32_bf16 v[16:19], a[132:135], v[116:119], v[16:19]
    ds_read_b128 a[224:227], v2 offset:8192
    v_mfma_f32_16x16x32_bf16 v[16:19], a[136:139], v[120:123], v[16:19]
    v_exp_f32 v25, v25
    v_mfma_f32_16x16x32_bf16 v[16:19], a[140:143], v[124:127], v[16:19]
    ds_read_b128 a[228:231], v2 offset:9216
    v_cvt_pk_bf16_f32 v36, v24, v25
    v_mfma_f32_16x16x32_bf16 v[20:23], a[144:147], v[112:115], v[52:55]
    s_waitcnt lgkmcnt(2)
    v_exp_f32 v26, v26
    v_mfma_f32_16x16x32_bf16 v[20:23], a[148:151], v[116:119], v[20:23]
    ds_read_b128 a[232:235], v2 offset:10240
    global_load_lds_dwordx4 v1, s[14:15] offset:2048 sc1
    v_mfma_f32_16x16x32_bf16 v[20:23], a[152:155], v[120:123], v[20:23]
    v_exp_f32 v27, v27
    v_mfma_f32_16x16x32_bf16 v[20:23], a[156:159], v[124:127], v[20:23]
    ds_read_b128 a[236:239], v2 offset:11264
    v_cvt_pk_bf16_f32 v37, v26, v27
    v_mfma_f32_16x16x32_bf16 v[224:227], a[192:195], v[32:35], v[224:227]
    v_exp_f32 v28, v28
    v_mfma_f32_16x16x32_bf16 v[228:231], a[196:199], v[32:35], v[228:231]
    ds_read_b128 a[240:243], v2 offset:12288
    v_mfma_f32_16x16x32_bf16 v[232:235], a[200:203], v[32:35], v[232:235]
    v_exp_f32 v29, v29
    v_mfma_f32_16x16x32_bf16 v[236:239], a[204:207], v[32:35], v[236:239]
    ds_read_b128 a[244:247], v2 offset:13312
    v_cvt_pk_bf16_f32 v38, v28, v29
    v_mfma_f32_16x16x32_bf16 v[240:243], a[208:211], v[32:35], v[240:243]
    v_exp_f32 v30, v30
    v_mfma_f32_16x16x32_bf16 v[244:247], a[212:215], v[32:35], v[244:247]
    ds_read_b128 a[248:251], v2 offset:14336
    global_load_lds_dwordx4 v1, s[14:15] offset:3072 sc1
    v_mfma_f32_16x16x32_bf16 v[248:251], a[216:219], v[32:35], v[248:251]
    s_mov_b32 m0, s62
    v_exp_f32 v31, v31
    v_mfma_f32_16x16x32_bf16 v[252:255], a[220:223], v[32:35], v[252:255]
    ds_read_b128 a[252:255], v2 offset:15360
    v_cvt_pk_bf16_f32 v39, v30, v31
    v_mfma_f32_16x16x32_bf16 v[44:47], a[0:3], v[32:35], v[44:47]
    v_mfma_f32_16x16x32_bf16 v[24:27], a[128:131], v[96:99], v[48:51]
    v_exp_f32 v16, v16
    v_mfma_f32_16x16x32_bf16 v[24:27], a[132:135], v[100:103], v[24:27]
    ds_read_b128 a[128:131], v2 offset:16384
    v_mfma_f32_16x16x32_bf16 v[24:27], a[136:139], v[104:107], v[24:27]
    v_exp_f32 v17, v17
    v_mfma_f32_16x16x32_bf16 v[24:27], a[140:143], v[108:111], v[24:27]
    ds_read_b128 a[132:135], v2 offset:17408
    v_cvt_pk_bf16_f32 v32, v16, v17
    v_mfma_f32_16x16x32_bf16 v[28:31], a[144:147], v[96:99], v[48:51]
    v_exp_f32 v18, v18
    v_mfma_f32_16x16x32_bf16 v[28:31], a[148:151], v[100:103], v[28:31]
    ds_read_b128 a[136:139], v2 offset:18432
    global_load_lds_dwordx4 v3, s[14:15] offset:0 sc1
    v_mfma_f32_16x16x32_bf16 v[28:31], a[152:155], v[104:107], v[28:31]
    v_exp_f32 v19, v19
    v_mfma_f32_16x16x32_bf16 v[28:31], a[156:159], v[108:111], v[28:31]
    ds_read_b128 a[140:143], v2 offset:19456
    v_cvt_pk_bf16_f32 v33, v18, v19
    v_mfma_f32_16x16x32_bf16 v[192:195], a[192:195], v[36:39], v[192:195]
    v_exp_f32 v20, v20
    v_mfma_f32_16x16x32_bf16 v[196:199], a[196:199], v[36:39], v[196:199]
    ds_read_b128 a[144:147], v2 offset:20480
    v_mfma_f32_16x16x32_bf16 v[200:203], a[200:203], v[36:39], v[200:203]
    v_exp_f32 v21, v21
    v_mfma_f32_16x16x32_bf16 v[204:207], a[204:207], v[36:39], v[204:207]
    ds_read_b128 a[148:151], v2 offset:21504
    v_cvt_pk_bf16_f32 v34, v20, v21
    v_mfma_f32_16x16x32_bf16 v[208:211], a[208:211], v[36:39], v[208:211]
    v_exp_f32 v22, v22
    v_mfma_f32_16x16x32_bf16 v[212:215], a[212:215], v[36:39], v[212:215]
    ds_read_b128 a[152:155], v2 offset:22528
    global_load_lds_dwordx4 v3, s[14:15] offset:1024 sc1
    v_mfma_f32_16x16x32_bf16 v[216:219], a[216:219], v[36:39], v[216:219]
    v_exp_f32 v23, v23
    v_mfma_f32_16x16x32_bf16 v[220:223], a[220:223], v[36:39], v[220:223]
    ds_read_b128 a[156:159], v2 offset:23552
    v_cvt_pk_bf16_f32 v35, v22, v23
    v_mfma_f32_16x16x32_bf16 v[40:43], a[0:3], v[36:39], v[40:43]
    s_waitcnt lgkmcnt(3)
    v_mfma_f32_16x16x32_bf16 v[16:19], a[128:131], v[112:115], v[52:55]
    v_exp_f32 v24, v24
    v_mfma_f32_16x16x32_bf16 v[16:19], a[132:135], v[116:119], v[16:19]
    ds_read_b128 a[192:195], v2 offset:24576
    v_mfma_f32_16x16x32_bf16 v[16:19], a[136:139], v[120:123], v[16:19]
    v_exp_f32 v25, v25
    v_mfma_f32_16x16x32_bf16 v[16:19], a[140:143], v[124:127], v[16:19]
    ds_read_b128 a[196:199], v2 offset:25600
    v_cvt_pk_bf16_f32 v36, v24, v25
    v_mfma_f32_16x16x32_bf16 v[20:23], a[144:147], v[112:115], v[52:55]
    s_waitcnt lgkmcnt(2)
    v_exp_f32 v26, v26
    v_mfma_f32_16x16x32_bf16 v[20:23], a[148:151], v[116:119], v[20:23]
    ds_read_b128 a[200:203], v2 offset:26624
    global_load_lds_dwordx4 v3, s[14:15] offset:2048 sc1
    v_mfma_f32_16x16x32_bf16 v[20:23], a[152:155], v[120:123], v[20:23]
    v_exp_f32 v27, v27
    v_mfma_f32_16x16x32_bf16 v[20:23], a[156:159], v[124:127], v[20:23]
    ds_read_b128 a[204:207], v2 offset:27648
    v_cvt_pk_bf16_f32 v37, v26, v27
    v_mfma_f32_16x16x32_bf16 v[224:227], a[224:227], v[32:35], v[224:227]
    s_waitcnt vmcnt(11)
    v_exp_f32 v28, v28
    v_mfma_f32_16x16x32_bf16 v[228:231], a[228:231], v[32:35], v[228:231]
    s_barrier
    ds_read_b128 a[208:211], v2 offset:28672
    v_mfma_f32_16x16x32_bf16 v[232:235], a[232:235], v[32:35], v[232:235]
    v_exp_f32 v29, v29
    v_mfma_f32_16x16x32_bf16 v[236:239], a[236:239], v[32:35], v[236:239]
    s_add_u32 s99, s99, 1
    ds_read_b128 a[212:215], v2 offset:29696
    v_cvt_pk_bf16_f32 v38, v28, v29
    v_mfma_f32_16x16x32_bf16 v[240:243], a[240:243], v[32:35], v[240:243]
    s_bitcmp1_b64 s[4:5], s99
    v_exp_f32 v30, v30
    v_mfma_f32_16x16x32_bf16 v[244:247], a[244:247], v[32:35], v[244:247]
    ds_read_b128 a[216:219], v2 offset:30720
    global_load_lds_dwordx4 v3, s[14:15] offset:3072 sc1
    v_mfma_f32_16x16x32_bf16 v[248:251], a[248:251], v[32:35], v[248:251]
    s_mov_b32 m0, s98
    v_exp_f32 v31, v31
    v_mfma_f32_16x16x32_bf16 v[252:255], a[252:255], v[32:35], v[252:255]
    s_mov_b64 s[14:15], s[18:19]
    ds_read_b128 a[220:223], v2 offset:31744
    v_cvt_pk_bf16_f32 v39, v30, v31
    v_mfma_f32_16x16x32_bf16 v[44:47], a[0:3], v[32:35], v[44:47]
    v_add_u32 v2, s96, v1
    s_cbranch_scc0 L_att_l2
L_att_d2:
    s_add_u32 s6, s16, 147456
    s_addc_u32 s7, s17, 0
    v_cndmask_b32_e64 v8, v7, v48, s[64:65]
    v_cndmask_b32_e64 v9, v7, v48, s[66:67]
    v_cndmask_b32_e64 v10, v7, v48, s[68:69]
    v_cndmask_b32_e64 v11, v7, v48, s[70:71]
    v_cndmask_b32_e64 v12, v7, v48, s[72:73]
    v_cndmask_b32_e64 v13, v7, v48, s[74:75]
    v_cndmask_b32_e64 v14, v7, v48, s[76:77]
    v_cndmask_b32_e64 v15, v7, v48, s[78:79]
    v_mfma_f32_16x16x32_bf16 v[24:27], a[128:131], v[96:99], v[8:11]
    v_exp_f32 v16, v16
    v_mfma_f32_16x16x32_bf16 v[24:27], a[132:135], v[100:103], v[24:27]
    s_add_u32 s62, m0, 16384
    ds_read_b128 a[128:131], v2 offset:0
    global_load_dwordx4 v[128:131], v1, s[6:7] offset:0 sc1
    v_mfma_f32_16x16x32_bf16 v[24:27], a[136:139], v[104:107], v[24:27]
    s_and_b32 s62, s62, 0x1ffff
    v_exp_f32 v17, v17
    v_mfma_f32_16x16x32_bf16 v[24:27], a[140:143], v[108:111], v[24:27]
    s_add_u32 s98, s62, 16384
    ds_read_b128 a[132:135], v2 offset:1024
    v_cvt_pk_bf16_f32 v32, v16, v17
    v_mfma_f32_16x16x32_bf16 v[28:31], a[144:147], v[96:99], v[12:15]
    s_and_b32 s98, s98, 0x1ffff
    v_exp_f32 v18, v18
    v_mfma_f32_16x16x32_bf16 v[28:31], a[148:151], v[100:103], v[28:31]
    s_add_u32 s96, s96, 32768
    ds_read_b128 a[136:139], v2 offset:2048
    global_load_lds_dwordx4 v1, s[14:15] offset:0 sc1
    v_mfma_f32_16x16x32_bf16 v[28:31], a[152:155], v[104:107], v[28:31]
    s_and_b32 s96, s96, 0x1ffff
    v_exp_f32 v19, v19
    v_mfma_f32_16x16x32_bf16 v[28:31], a[156:159], v[108:111], v[28:31]
    s_add_u32 s18, s14, 32768
    ds_read_b128 a[140:143], v2 offset:3072
    v_cvt_pk_bf16_f32 v33, v18, v19
    v_mfma_f32_16x16x32_bf16 v[192:195], a[224:227], v[36:39], v[192:195]
    s_addc_u32 s19, s15, 0
    v_exp_f32 v20, v20
    v_mfma_f32_16x16x32_bf16 v[196:199], a[228:231], v[36:39], v[196:199]
    s_sub_u32 s97, s97, 1
    ds_read_b128 a[144:147], v2 offset:4096
    global_load_dwordx4 v[132:135], v1, s[6:7] offset:1024 sc1
    v_mfma_f32_16x16x32_bf16 v[200:203], a[232:235], v[36:39], v[200:203]
    s_cmp_eq_u32 s97, 0
    v_exp_f32 v21, v21
    v_mfma_f32_16x16x32_bf16 v[204:207], a[236:239], v[36:39], v[204:207]
    s_cselect_b64 s[18:19], s[16:17], s[18:19]
    ds_read_b128 a[148:151], v2 offset:5120
    v_cvt_pk_bf16_f32 v34, v20, v21
    v_mfma_f32_16x16x32_bf16 v[208:211], a[240:243], v[36:39], v[208:211]
    v_exp_f32 v22, v22
    v_mfma_f32_16x16x32_bf16 v[212:215], a[244:247], v[36:39], v[212:215]
    ds_read_b128 a[152:155], v2 offset:6144
    global_load_lds_dwordx4 v1, s[14:15] offset:1024 sc1
    v_mfma_f32_16x16x32_bf16 v[216:219], a[248:251], v[36:39], v[216:219]
    v_exp_f32 v23, v23
    v_mfma_f32_16x16x32_bf16 v[220:223], a[252:255], v[36:39], v[220:223]
    ds_read_b128 a[156:159], v2 offset:7168
    v_cvt_pk_bf16_f32 v35, v22, v23
    v_mfma_f32_16x16x32_bf16 v[40:43], a[0:3], v[36:39], v[40:43]
    s_waitcnt lgkmcnt(3)
    v_mfma_f32_16x16x32_bf16 v[16:19], a[128:131], v[112:115], v[52:55]
    v_exp_f32 v24, v24
    v_mfma_f32_16x16x32_bf16 v[16:19], a[132:135], v[116:119], v[16:19]
    ds_read_b128 a[224:227], v2 offset:8192
    global_load_dwordx4 v[136:139], v1, s[6:7] offset:2048 sc1
    v_mfma_f32_16x16x32_bf16 v[16:19], a[136:139], v[120:123], v[16:19]
    s_waitcnt lgkmcnt(2)
    v_exp_f32 v25, v25
    v_mfma_f32_16x16x32_bf16 v[16:19], a[140:143], v[124:127], v[16:19]
    s_add_u32 s34, s6, 32768
    ds_read_b128 a[228:231], v2 offset:9216
    v_cvt_pk_bf16_f32 v36, v24, v25
    v_mfma_f32_16x16x32_bf16 v[20:23], a[144:147], v[112:115], v[52:55]
    s_addc_u32 s35, s7, 0
    v_exp_f32 v26, v26
    v_mfma_f32_16x16x32_bf16 v[20:23], a[148:151], v[116:119], v[20:23]
    ds_read_b128 a[232:235], v2 offset:10240
    global_load_lds_dwordx4 v1, s[14:15] offset:2048 sc1
    v_mfma_f32_16x16x32_bf16 v[20:23], a[152:155], v[120:123], v[20:23]
    s_waitcnt lgkmcnt(3)
    v_exp_f32 v27, v27
    v_cndmask_b32_e64 v8, v7, v48, s[80:81]
    v_mfma_f32_16x16x32_bf16 v[20:23], a[156:159], v[124:127], v[20:23]
    ds_read_b128 a[236:239], v2 offset:11264
    v_cvt_pk_bf16_f32 v37, v26, v27
    v_cndmask_b32_e64 v9, v7, v48, s[82:83]
    v_mfma_f32_16x16x32_bf16 v[224:227], a[192:195], v[32:35], v[224:227]
    v_exp_f32 v28, v28
    v_cndmask_b32_e64 v10, v7, v48, s[84:85]
    v_mfma_f32_16x16x32_bf16 v[228:231], a[196:199], v[32:35], v[228:231]
    ds_read_b128 a[240:243], v2 offset:12288
    global_load_dwordx4 v[140:143], v1, s[6:7] offset:3072 sc1
    v_cndmask_b32_e64 v11, v7, v48, s[86:87]
    v_mfma_f32_16x16x32_bf16 v[232:235], a[200:203], v[32:35], v[232:235]
    v_exp_f32 v29, v29
    v_mfma_f32_16x16x32_bf16 v[236:239], a[204:207], v[32:35], v[236:239]
    ds_read_b128 a[244:247], v2 offset:13312
    v_cvt_pk_bf16_f32 v38, v28, v29
    v_cndmask_b32_e64 v12, v7, v48, s[88:89]
    v_mfma_f32_16x16x32_bf16 v[240:243], a[208:211], v[32:35], v[240:243]
    v_exp_f32 v30, v30
    v_cndmask_b32_e64 v13, v7, v48, s[90:91]
    v_mfma_f32_16x16x32_bf16 v[244:247], a[212:215], v[32:35], v[244:247]
    ds_read_b128 a[248:251], v2 offset:14336
    global_load_lds_dwordx4 v1, s[14:15] offset:3072 sc1
    v_cndmask_b32_e64 v14, v7, v48, s[92:93]
    v_mfma_f32_16x16x32_bf16 v[248:251], a[216:219], v[32:35], v[248:251]
    s_mov_b32 m0, s62
    v_exp_f32 v31, v31
    v_cndmask_b32_e64 v15, v7, v48, s[94:95]
    v_mfma_f32_16x16x32_bf16 v[252:255], a[220:223], v[32:35], v[252:255]
    ds_read_b128 a[252:255], v2 offset:15360
    v_cvt_pk_bf16_f32 v39, v30, v31
    v_mfma_f32_16x16x32_bf16 v[44:47], a[0:3], v[32:35], v[44:47]
    v_mfma_f32_16x16x32_bf16 v[24:27], a[128:131], v[96:99], v[8:11]
    v_exp_f32 v16, v16
    v_mfma_f32_16x16x32_bf16 v[24:27], a[132:135], v[100:103], v[24:27]
    ds_read_b128 a[128:131], v2 offset:16384
    global_load_dwordx4 v[144:147], v3, s[6:7] offset:0 sc1
    v_mfma_f32_16x16x32_bf16 v[24:27], a[136:139], v[104:107], v[24:27]
    v_exp_f32 v17, v17
    v_mfma_f32_16x16x32_bf16 v[24:27], a[140:143], v[108:111], v[24:27]
    ds_read_b128 a[132:135], v2 offset:17408
    v_cvt_pk_bf16_f32 v32, v16, v17
    v_mfma_f32_16x16x32_bf16 v[28:31], a[144:147], v[96:99], v[12:15]
    v_exp_f32 v18, v18
    v_mfma_f32_16x16x32_bf16 v[28:31], a[148:151], v[100:103], v[28:31]
    ds_read_b128 a[136:139], v2 offset:18432
    global_load_lds_dwordx4 v3, s[14:15] offset:0 sc1
    v_mfma_f32_16x16x32_bf16 v[28:31], a[152:155], v[104:107], v[28:31]
    v_exp_f32 v19, v19
    v_cndmask_b32_e64 v8, v7, v52, s[64:65]
    v_mfma_f32_16x16x32_bf16 v[28:31], a[156:159], v[108:111], v[28:31]
    ds_read_b128 a[140:143], v2 offset:19456
    v_cvt_pk_bf16_f32 v33, v18, v19
    v_cndmask_b32_e64 v9, v7, v52, s[66:67]
    v_mfma_f32_16x16x32_bf16 v[192:195], a[192:195], v[36:39], v[192:195]
    v_exp_f32 v20, v20
    v_cndmask_b32_e64 v10, v7, v52, s[68:69]
    v_mfma_f32_16x16x32_bf16 v[196:199], a[196:199], v[36:39], v[196:199]
    ds_read_b128 a[144:147], v2 offset:20480
    global_load_dwordx4 v[148:151], v3, s[6:7] offset:1024 sc1
    v_cndmask_b32_e64 v11, v7, v52, s[70:71]
    v_mfma_f32_16x16x32_bf16 v[200:203], a[200:203], v[36:39], v[200:203]
    v_exp_f32 v21, v21
    v_mfma_f32_16x16x32_bf16 v[204:207], a[204:207], v[36:39], v[204:207]
    ds_read_b128 a[148:151], v2 offset:21504
    v_cvt_pk_bf16_f32 v34, v20, v21
    v_cndmask_b32_e64 v12, v7, v52, s[72:73]
    v_mfma_f32_16x16x32_bf16 v[208:211], a[208:211], v[36:39], v[208:211]
    v_exp_f32 v22, v22
    v_cndmask_b32_e64 v13, v7, v52, s[74:75]
    v_mfma_f32_16x16x32_bf16 v[212:215], a[212:215], v[36:39], v[212:215]
    ds_read_b128 a[152:155], v2 offset:22528
    global_load_lds_dwordx4 v3, s[14:15] offset:1024 sc1
    v_cndmask_b32_e64 v14, v7, v52, s[76:77]
    v_mfma_f32_16x16x32_bf16 v[216:219], a[216:219], v[36:39], v[216:219]
    v_exp_f32 v23, v23
    v_cndmask_b32_e64 v15, v7, v52, s[78:79]
    v_mfma_f32_16x16x32_bf16 v[220:223], a[220:223], v[36:39], v[220:223]
    ds_read_b128 a[156:159], v2 offset:23552
    v_cvt_pk_bf16_f32 v35, v22, v23
    v_mfma_f32_16x16x32_bf16 v[40:43], a[0:3], v[36:39], v[40:43]
    s_waitcnt lgkmcnt(3)
    v_mfma_f32_16x16x32_bf16 v[16:19], a[128:131], v[112:115], v[8:11]
    v_exp_f32 v24, v24
    v_mfma_f32_16x16x32_bf16 v[16:19], a[132:135], v[116:119], v[16:19]
    ds_read_b128 a[192:195], v2 offset:24576
    global_load_dwordx4 v[152:155], v3, s[6:7] offset:2048 sc1
    v_mfma_f32_16x16x32_bf16 v[16:19], a[136:139], v[120:123], v[16:19]
    v_exp_f32 v25, v25
    v_mfma_f32_16x16x32_bf16 v[16:19], a[140:143], v[124:127], v[16:19]
    ds_read_b128 a[196:199], v2 offset:25600
    v_cvt_pk_bf16_f32 v36, v24, v25
    v_mfma_f32_16x16x32_bf16 v[20:23], a[144:147], v[112:115], v[12:15]
    s_waitcnt lgkmcnt(2)
    v_exp_f32 v26, v26
    v_mfma_f32_16x16x32_bf16 v[20:23], a[148:151], v[116:119], v[20:23]
    ds_read_b128 a[200:203], v2 offset:26624
    global_load_lds_dwordx4 v3, s[14:15] offset:2048 sc1
    v_mfma_f32_16x16x32_bf16 v[20:23], a[152:155], v[120:123], v[20:23]
    v_exp_f32 v27, v27
    v_mfma_f32_16x16x32_bf16 v[20:23], a[156:159], v[124:127], v[20:23]
    ds_read_b128 a[204:207], v2 offset:27648
    v_cvt_pk_bf16_f32 v37, v26, v27
    v_mfma_f32_16x16x32_bf16 v[224:227], a[224:227], v[32:35], v[224:227]
    s_waitcnt vmcnt(18)
    v_exp_f32 v28, v28
    v_mfma_f32_16x16x32_bf16 v[228:231], a[228:231], v[32:35], v[228:231]
    s_barrier
    ds_read_b128 a[208:211], v2 offset:28672
    global_load_dwordx4 v[156:159], v3, s[6:7] offset:3072 sc1
    v_mfma_f32_16x16x32_bf16 v[232:235], a[232:235], v[32:35], v[232:235]
    s_mov_b64 s[6:7], s[34:35]
    v_exp_f32 v29, v29
    v_mfma_f32_16x16x32_bf16 v[236:239], a[236:239], v[32:35], v[236:239]
    s_add_u32 s99, s99, 1
    ds_read_b128 a[212:215], v2 offset:29696
    v_cvt_pk_bf16_f32 v38, v28, v29
    v_mfma_f32_16x16x32_bf16 v[240:243], a[240:243], v[32:35], v[240:243]
    s_bitcmp1_b64 s[4:5], s99
    v_exp_f32 v30, v30
    v_mfma_f32_16x16x32_bf16 v[244:247], a[244:247], v[32:35], v[244:247]
    ds_read_b128 a[216:219], v2 offset:30720
    global_load_lds_dwordx4 v3, s[14:15] offset:3072 sc1
    v_mfma_f32_16x16x32_bf16 v[248:251], a[248:251], v[32:35], v[248:251]
    s_mov_b32 m0, s98
    v_exp_f32 v31, v31
    v_mfma_f32_16x16x32_bf16 v[252:255], a[252:255], v[32:35], v[252:255]
    s_mov_b64 s[14:15], s[18:19]
    ds_read_b128 a[220:223], v2 offset:31744
    v_cvt_pk_bf16_f32 v39, v30, v31
    v_mfma_f32_16x16x32_bf16 v[44:47], a[0:3], v[32:35], v[44:47]
    v_add_u32 v2, s96, v1
    ds_read_b128 a[128:131], v2 offset:0
    ds_read_b128 a[132:135], v2 offset:1024
    v_mfma_f32_16x16x32_bf16 v[192:195], a[224:227], v[36:39], v[192:195]
    ds_read_b128 a[136:139], v2 offset:2048
    v_exp_f32 v16, v16
    v_cndmask_b32_e64 v8, v7, v52, s[80:81]
    v_mfma_f32_16x16x32_bf16 v[196:199], a[228:231], v[36:39], v[196:199]
L_wk11:
    s_cbranch_execz L_wkret
    ds_read_b128 a[140:143], v2 offset:3072
    global_load_lds_dwordx4 v1, s[14:15] offset:0 sc1
    v_cndmask_b32_e64 v9, v7, v52, s[82:83]
    v_cndmask_b32_e64 v10, v7, v52, s[84:85]
    v_mfma_f32_16x16x32_bf16 v[200:203], a[232:235], v[36:39], v[200:203]
    ds_read_b128 a[144:147], v2 offset:4096
    v_exp_f32 v17, v17
    v_mfma_f32_16x16x32_bf16 v[204:207], a[236:239], v[36:39], v[204:207]
    ds_read_b128 a[148:151], v2 offset:5120
    v_cvt_pk_bf16_f32 v32, v16, v17
    v_cndmask_b32_e64 v11, v7, v52, s[86:87]
    v_mfma_f32_16x16x32_bf16 v[208:211], a[240:243], v[36:39], v[208:211]
    ds_read_b128 a[152:155], v2 offset:6144
    global_load_lds_dwordx4 v1, s[14:15] offset:1024 sc1
    v_exp_f32 v18, v18
    v_cndmask_b32_e64 v12, v7, v52, s[88:89]
    v_mfma_f32_16x16x32_bf16 v[212:215], a[244:247], v[36:39], v[212:215]
    ds_read_b128 a[156:159], v2 offset:7168
    v_cndmask_b32_e64 v13, v7, v52, s[90:91]
    v_mfma_f32_16x16x32_bf16 v[216:219], a[248:251], v[36:39], v[216:219]
    v_exp_f32 v19, v19
    v_cndmask_b32_e64 v14, v7, v52, s[92:93]
    v_mfma_f32_16x16x32_bf16 v[220:223], a[252:255], v[36:39], v[220:223]
    global_load_lds_dwordx4 v1, s[14:15] offset:2048 sc1
    v_cvt_pk_bf16_f32 v33, v18, v19
    v_cndmask_b32_e64 v15, v7, v52, s[94:95]
    v_mfma_f32_16x16x32_bf16 v[40:43], a[0:3], v[36:39], v[40:43]
    s_waitcnt lgkmcnt(3)
    v_exp_f32 v20, v20
    v_mfma_f32_16x16x32_bf16 v[24:27], a[128:131], v[112:115], v[8:11]
    ds_read_b128 a[224:227], v2 offset:8192
    v_mfma_f32_16x16x32_bf16 v[24:27], a[132:135], v[116:119], v[24:27]
    ds_read_b128 a[228:231], v2 offset:9216
    global_load_lds_dwordx4 v1, s[14:15] offset:3072 sc1
    v_exp_f32 v21, v21
    v_mfma_f32_16x16x32_bf16 v[24:27], a[136:139], v[120:123], v[24:27]
    s_add_u32 m0, m0, 16384
    ds_read_b128 a[232:235], v2 offset:10240
    v_cvt_pk_bf16_f32 v34, v20, v21
    v_mfma_f32_16x16x32_bf16 v[24:27], a[140:143], v[124:127], v[24:27]
    s_and_b32 m0, m0, 0x1ffff
    ds_read_b128 a[236:239], v2 offset:11264
    v_exp_f32 v22, v22
    v_mfma_f32_16x16x32_bf16 v[28:31], a[144:147], v[112:115], v[12:15]
    s_waitcnt lgkmcnt(4)
    ds_read_b128 a[240:243], v2 offset:12288
    v_mfma_f32_16x16x32_bf16 v[28:31], a[148:151], v[116:119], v[28:31]
    ds_read_b128 a[244:247], v2 offset:13312
    global_load_lds_dwordx4 v3, s[14:15] offset:0 sc1
    v_exp_f32 v23, v23
    v_mfma_f32_16x16x32_bf16 v[28:31], a[152:155], v[120:123], v[28:31]
    ds_read_b128 a[248:251], v2 offset:14336
    v_cvt_pk_bf16_f32 v35, v22, v23
    v_mfma_f32_16x16x32_bf16 v[28:31], a[156:159], v[124:127], v[28:31]
    s_lshl_b32 s34, s3, 2
    ds_read_b128 a[252:255], v2 offset:15360
    v_mfma_f32_16x16x32_bf16 v[224:227], a[192:195], v[32:35], v[224:227]
    global_load_lds_dwordx4 v3, s[14:15] offset:1024 sc1
    v_cmp_nlt_f32 vcc, v40, v6
    v_mov_b32 v2, 163776
    v_mfma_f32_16x16x32_bf16 v[228:231], a[196:199], v[32:35], v[228:231]
    v_rcp_f32 v40, v40
    v_mfma_f32_16x16x32_bf16 v[232:235], a[200:203], v[32:35], v[232:235]
    s_or_b32 s100, s100, vcc_lo
    v_add_u32 v20, s34, v2
    v_mfma_f32_16x16x32_bf16 v[236:239], a[204:207], v[32:35], v[236:239]
    s_or_b32 s100, s100, vcc_hi
    global_load_lds_dwordx4 v3, s[14:15] offset:2048 sc1
    v_exp_f32 v24, v24
    v_mfma_f32_16x16x32_bf16 v[240:243], a[208:211], v[32:35], v[240:243]
    s_mul_i32 s35, s33, 1179648
    v_exp_f32 v25, v25
    v_mfma_f32_16x16x32_bf16 v[244:247], a[212:215], v[32:35], v[244:247]
    s_sub_u32 s35, s101, s35
    v_exp_f32 v26, v26
    v_mfma_f32_16x16x32_bf16 v[248:251], a[216:219], v[32:35], v[248:251]
    s_add_u32 s35, s35, 17694720
    global_load_lds_dwordx4 v3, s[14:15] offset:3072 sc1
    v_exp_f32 v27, v27
    v_mfma_f32_16x16x32_bf16 v[252:255], a[220:223], v[32:35], v[252:255]
    s_add_u32 m0, m0, 16384
    v_cvt_pk_bf16_f32 v36, v24, v25
    v_cvt_pk_bf16_f32 v37, v26, v27
    v_mfma_f32_16x16x32_bf16 v[44:47], a[0:3], v[32:35], v[44:47]
    s_and_b32 m0, m0, 0x1ffff
    v_exp_f32 v28, v28
    v_exp_f32 v29, v29
    v_exp_f32 v30, v30
    v_exp_f32 v31, v31
    v_cvt_pk_bf16_f32 v38, v28, v29
    v_cvt_pk_bf16_f32 v39, v30, v31
    v_nop
    s_waitcnt lgkmcnt(0)
    v_mfma_f32_16x16x32_bf16 v[44:47], a[0:3], v[36:39], v[44:47]
    v_mul_f32 v192, v192, v40
    v_mul_f32 v193, v193, v40
    v_mul_f32 v194, v194, v40
    v_mfma_f32_16x16x32_bf16 v[224:227], a[224:227], v[36:39], v[224:227]
    v_mul_f32 v195, v195, v40
    v_mul_f32 v196, v196, v40
    v_mul_f32 v197, v197, v40
    v_mfma_f32_16x16x32_bf16 v[228:231], a[228:231], v[36:39], v[228:231]
    v_mul_f32 v198, v198, v40
    v_mul_f32 v199, v199, v40
    v_cvt_pk_bf16_f32 v192, v192, v193
    v_mfma_f32_16x16x32_bf16 v[232:235], a[232:235], v[36:39], v[232:235]
    v_cvt_pk_bf16_f32 v193, v194, v195
    v_cvt_pk_bf16_f32 v194, v196, v197
    v_cvt_pk_bf16_f32 v195, v198, v199
    v_mfma_f32_16x16x32_bf16 v[236:239], a[236:239], v[36:39], v[236:239]
    buffer_store_dwordx4 v[192:195], v1, s[24:27], s35 offen sc1
    s_add_u32 s35, s35, 4096
    v_mul_f32 v200, v200, v40
    v_mfma_f32_16x16x32_bf16 v[240:243], a[240:243], v[36:39], v[240:243]
    v_mul_f32 v201, v201, v40
    v_mul_f32 v202, v202, v40
    v_mul_f32 v203, v203, v40
    v_mfma_f32_16x16x32_bf16 v[244:247], a[244:247], v[36:39], v[244:247]
    v_mul_f32 v204, v204, v40
    v_mul_f32 v205, v205, v40
    v_mul_f32 v206, v206, v40
    v_mfma_f32_16x16x32_bf16 v[248:251], a[248:251], v[36:39], v[248:251]
    v_mul_f32 v207, v207, v40
    v_cvt_pk_bf16_f32 v200, v200, v201
    v_cvt_pk_bf16_f32 v201, v202, v203
    v_mfma_f32_16x16x32_bf16 v[252:255], a[252:255], v[36:39], v[252:255]
    v_cvt_pk_bf16_f32 v202, v204, v205
    v_cvt_pk_bf16_f32 v203, v206, v207
    buffer_store_dwordx4 v[200:203], v1, s[24:27], s35 offen sc1
    s_add_u32 s35, s35, 4096
    v_cmp_nlt_f32 vcc, v44, v6
    v_rcp_f32 v44, v44
    s_or_b32 s100, s100, vcc_lo
    s_or_b32 s100, s100, vcc_hi
    v_mov_b32 v4, s100
    ds_write_b32 v20, v4
    v_pk_mul_f32 v[208:209], v[208:209], v[40:41] op_sel_hi:[1,0]
    v_pk_mul_f32 v[210:211], v[210:211], v[40:41] op_sel_hi:[1,0]
    v_pk_mul_f32 v[212:213], v[212:213], v[40:41] op_sel_hi:[1,0]
    v_pk_mul_f32 v[214:215], v[214:215], v[40:41] op_sel_hi:[1,0]
    v_cvt_pk_bf16_f32 v208, v208, v209
    v_cvt_pk_bf16_f32 v209, v210, v211
    v_cvt_pk_bf16_f32 v210, v212, v213
    v_cvt_pk_bf16_f32 v211, v214, v215
    buffer_store_dwordx4 v[208:211], v1, s[24:27], s35 offen sc1
    s_add_u32 s35, s35, 4096
    s_lshl_b32 s34, s3, 12
    v_add_u32 v14, s34, v1
    s_lshl_b32 s18, s33, 16
    s_and_b32 s18, s18, 0x10000
    v_add_u32 v12, s18, v14
    v_pk_mul_f32 v[216:217], v[216:217], v[40:41] op_sel_hi:[1,0]
    v_pk_mul_f32 v[218:219], v[218:219], v[40:41] op_sel_hi:[1,0]
    v_pk_mul_f32 v[220:221], v[220:221], v[40:41] op_sel_hi:[1,0]
    v_pk_mul_f32 v[222:223], v[222:223], v[40:41] op_sel_hi:[1,0]
    v_cvt_pk_bf16_f32 v216, v216, v217
    v_cvt_pk_bf16_f32 v217, v218, v219
    v_cvt_pk_bf16_f32 v218, v220, v221
    v_cvt_pk_bf16_f32 v219, v222, v223
    buffer_store_dwordx4 v[216:219], v1, s[24:27], s35 offen sc1
    v_xor_b32 v13, 0x10000, v12
    v_add_u32 v14, 131072, v14
    s_add_u32 s12, s18, s34
    s_xor_b32 s13, s12, 0x1c000
    s_add_u32 s6, s16, 360448
    s_addc_u32 s7, s17, 0
    s_waitcnt lgkmcnt(0)
    s_barrier
    ds_read_b128 v[16:19], v2
    s_mul_i32 s35, s33, 1179648
    s_sub_u32 s35, s101, s35
    s_add_u32 s35, s35, 18284544
    v_pk_mul_f32 v[224:225], v[224:225], v[44:45] op_sel_hi:[1,0]
    v_pk_mul_f32 v[226:227], v[226:227], v[44:45] op_sel_hi:[1,0]
    v_pk_mul_f32 v[228:229], v[228:229], v[44:45] op_sel_hi:[1,0]
    v_pk_mul_f32 v[230:231], v[230:231], v[44:45] op_sel_hi:[1,0]
    v_cvt_pk_bf16_f32 v224, v224, v225
    v_cvt_pk_bf16_f32 v225, v226, v227
    v_cvt_pk_bf16_f32 v226, v228, v229
    v_cvt_pk_bf16_f32 v227, v230, v231
    buffer_store_dwordx4 v[224:227], v1, s[24:27], s35 offen sc1
    s_add_u32 s35, s35, 4096
    s_mul_i32 s18, s32, 589824
    s_add_u32 s18, s18, s34
    s_add_u32 s18, s18, 33554432
    s_add_u32 s8, s60, s18
    s_addc_u32 s9, s61, 0
    v_pk_mul_f32 v[232:233], v[232:233], v[44:45] op_sel_hi:[1,0]
    v_pk_mul_f32 v[234:235], v[234:235], v[44:45] op_sel_hi:[1,0]
    v_pk_mul_f32 v[236:237], v[236:237], v[44:45] op_sel_hi:[1,0]
    v_pk_mul_f32 v[238:239], v[238:239], v[44:45] op_sel_hi:[1,0]
    v_cvt_pk_bf16_f32 v232, v232, v233
    v_cvt_pk_bf16_f32 v233, v234, v235
    v_cvt_pk_bf16_f32 v234, v236, v237
    v_cvt_pk_bf16_f32 v235, v238, v239
    buffer_store_dwordx4 v[232:235], v1, s[24:27], s35 offen sc1
    s_add_u32 s35, s35, 4096
    s_add_u32 s14, s14, 32768
    s_addc_u32 s15, s15, 0
    s_lshl_b32 s18, s58, 10
    v_add_u32 v8, s18, v1
    v_add_u32 v9, 0x400, v8
    v_pk_mul_f32 v[240:241], v[240:241], v[44:45] op_sel_hi:[1,0]
    v_pk_mul_f32 v[242:243], v[242:243], v[44:45] op_sel_hi:[1,0]
    v_pk_mul_f32 v[244:245], v[244:245], v[44:45] op_sel_hi:[1,0]
    v_pk_mul_f32 v[246:247], v[246:247], v[44:45] op_sel_hi:[1,0]
    v_cvt_pk_bf16_f32 v240, v240, v241
    v_cvt_pk_bf16_f32 v241, v242, v243
    v_cvt_pk_bf16_f32 v242, v244, v245
    v_cvt_pk_bf16_f32 v243, v246, v247
    buffer_store_dwordx4 v[240:243], v1, s[24:27], s35 offen sc1
    s_add_u32 s35, s35, 4096
    v_add_u32 v10, 0x800, v8
    v_add_u32 v11, 0xc00, v8
    v_and_b32 v9, 0xfff, v9
    v_and_b32 v10, 0xfff, v10
    v_and_b32 v11, 0xfff, v11
    v_pk_mul_f32 v[248:249], v[248:249], v[44:45] op_sel_hi:[1,0]
    v_pk_mul_f32 v[250:251], v[250:251], v[44:45] op_sel_hi:[1,0]
    v_pk_mul_f32 v[252:253], v[252:253], v[44:45] op_sel_hi:[1,0]
    v_pk_mul_f32 v[254:255], v[254:255], v[44:45] op_sel_hi:[1,0]
    v_cvt_pk_bf16_f32 v248, v248, v249
    v_cvt_pk_bf16_f32 v249, v250, v251
    v_cvt_pk_bf16_f32 v250, v252, v253
    v_cvt_pk_bf16_f32 v251, v254, v255
    buffer_store_dwordx4 v[248:251], v1, s[24:27], s35 offen sc1
    s_cmp_lg_u32 s63, 0
    s_waitcnt lgkmcnt(0)
    s_cbranch_scc1 L_novote
    v_or_b32 v16, v16, v17
    v_or3_b32 v16, v16, v18, v19
    v_cmp_ne_u32 vcc, 0, v16
    s_nop 1
    s_cbranch_vccnz L_fallback
L_novote:
    ds_read_b128 v[80:83], v13 offset:49152
    ds_read_b128 v[84:87], v13 offset:50176
    ds_read_b128 v[88:91], v13 offset:51200
    ds_read_b128 v[92:95], v13 offset:52224
    global_load_dwordx4 a[128:131], v1, s[6:7] offset:0 sc1
    global_load_dwordx4 a[132:135], v1, s[6:7] offset:1024 sc1
    global_load_dwordx4 a[136:139], v1, s[6:7] offset:2048 sc1
    global_load_dwordx4 a[140:143], v1, s[6:7] offset:3072 sc1
    s_add_u32 s6, s6, 16384
    s_addc_u32 s7, s7, 0
    global_load_dwordx4 v[96:99], v8, s[8:9] sc1
    global_load_dwordx4 v[100:103], v9, s[8:9] sc1
    global_load_dwordx4 v[104:107], v10, s[8:9] sc1
    global_load_dwordx4 v[108:111], v11, s[8:9] sc1
    s_add_u32 s8, s8, 16384
    s_addc_u32 s9, s9, 0
    global_load_dwordx4 v[112:115], v8, s[8:9] sc1
    global_load_dwordx4 v[116:119], v9, s[8:9] sc1
    global_load_dwordx4 v[120:123], v10, s[8:9] sc1
    global_load_dwordx4 v[124:127], v11, s[8:9] sc1
    s_add_u32 s8, s8, 16384
    s_addc_u32 s9, s9, 0
    global_load_dwordx4 v[192:195], v8, s[8:9] sc1
    global_load_dwordx4 v[196:199], v9, s[8:9] sc1
    global_load_dwordx4 v[200:203], v10, s[8:9] sc1
    global_load_dwordx4 v[204:207], v11, s[8:9] sc1
    s_add_u32 s8, s8, 16384
    s_addc_u32 s9, s9, 0
    v_mov_b32 v2, 0x300
    s_waitcnt vmcnt(16)
    s_barrier
    buffer_store_dword v2, v1, s[48:51], 0 offen sc1
    global_load_dwordx4 v[208:211], v8, s[8:9] sc1
    global_load_dwordx4 v[212:215], v9, s[8:9] sc1
    global_load_dwordx4 v[216:219], v10, s[8:9] sc1
    global_load_dwordx4 v[220:223], v11, s[8:9] sc1
    s_add_u32 s8, s8, 16384
    s_addc_u32 s9, s9, 0
    v_accvgpr_read_b32 v4, a8
    v_accvgpr_read_b32 v6, a8
    s_nop 1
    v_permlane32_swap_b32 v4, v6
    s_nop 0
    v_mov_b32 v5, v4
    v_mov_b32 v7, v6
    s_nop 0
    v_permlane16_swap_b32 v4, v5
    v_permlane16_swap_b32 v6, v7
    s_cmp_lg_u32 s33, 7
    s_cbranch_scc1 L_havepre
    s_add_u32 s10, s16, 294912
    s_addc_u32 s11, s17, 0
    global_load_dwordx4 v[160:163], v1, s[10:11] offset:0 sc1
    global_load_dwordx4 v[164:167], v1, s[10:11] offset:1024 sc1
    global_load_dwordx4 v[168:171], v1, s[10:11] offset:2048 sc1
    global_load_dwordx4 v[172:175], v1, s[10:11] offset:3072 sc1
    s_add_u32 s10, s10, 16384
    s_addc_u32 s11, s11, 0
    global_load_dwordx4 v[176:179], v1, s[10:11] offset:0 sc1
    global_load_dwordx4 v[180:183], v1, s[10:11] offset:1024 sc1
    global_load_dwordx4 v[184:187], v1, s[10:11] offset:2048 sc1
    global_load_dwordx4 v[188:191], v1, s[10:11] offset:3072 sc1
    s_add_u32 s10, s10, 16384
    s_addc_u32 s11, s11, 0
L_havepre:
    s_waitcnt vmcnt(13) lgkmcnt(0)
    v_mfma_f32_16x16x32_bf16 v[16:19], v[80:83], v[96:99], 0
    ds_read_b128 a[0:3], v12 offset:0
    v_mfma_f32_16x16x32_bf16 v[20:23], v[84:87], v[96:99], 0
    ds_read_b128 a[4:7], v12 offset:1024
    global_load_lds_dwordx4 v1, s[14:15] offset:0 sc1
    v_mfma_f32_16x16x32_bf16 v[24:27], v[88:91], v[96:99], 0
    ds_read_b128 a[8:11], v12 offset:2048
    v_mfma_f32_16x16x32_bf16 v[28:31], v[92:95], v[96:99], 0
    ds_read_b128 a[12:15], v12 offset:3072
    v_mfma_f32_16x16x32_bf16 v[32:35], v[80:83], v[100:103], 0
    global_load_lds_dwordx4 v1, s[14:15] offset:1024 sc1
    v_mfma_f32_16x16x32_bf16 v[36:39], v[84:87], v[100:103], 0
    v_mfma_f32_16x16x32_bf16 v[40:43], v[88:91], v[100:103], 0
    v_mfma_f32_16x16x32_bf16 v[44:47], v[92:95], v[100:103], 0
    global_load_lds_dwordx4 v1, s[14:15] offset:2048 sc1
    v_mfma_f32_16x16x32_bf16 v[48:51], v[80:83], v[104:107], 0
    v_mfma_f32_16x16x32_bf16 v[52:55], v[84:87], v[104:107], 0
    v_mfma_f32_16x16x32_bf16 v[56:59], v[88:91], v[104:107], 0
    global_load_lds_dwordx4 v1, s[14:15] offset:3072 sc1
    v_mfma_f32_16x16x32_bf16 v[60:63], v[92:95], v[104:107], 0
    s_add_u32 m0, m0, 16384
    v_mfma_f32_16x16x32_bf16 v[64:67], v[80:83], v[108:111], 0
    s_and_b32 m0, m0, 0x1ffff
    v_mfma_f32_16x16x32_bf16 v[68:71], v[84:87], v[108:111], 0
    v_mfma_f32_16x16x32_bf16 v[72:75], v[88:91], v[108:111], 0
    v_mfma_f32_16x16x32_bf16 v[76:79], v[92:95], v[108:111], 0
    s_waitcnt vmcnt(13) lgkmcnt(0)
    v_mfma_f32_16x16x32_bf16 v[16:19], a[0:3], v[112:115], v[16:19]
    ds_read_b128 v[80:83], v12 offset:16384
    v_mfma_f32_16x16x32_bf16 v[20:23], a[4:7], v[112:115], v[20:23]
    ds_read_b128 v[84:87], v12 offset:17408
    global_load_lds_dwordx4 v3, s[14:15] offset:0 sc1
    v_mfma_f32_16x16x32_bf16 v[24:27], a[8:11], v[112:115], v[24:27]
    ds_read_b128 v[88:91], v12 offset:18432
    v_mfma_f32_16x16x32_bf16 v[28:31], a[12:15], v[112:115], v[28:31]
    ds_read_b128 v[92:95], v12 offset:19456
    v_mfma_f32_16x16x32_bf16 v[32:35], a[0:3], v[116:119], v[32:35]
    global_load_lds_dwordx4 v3, s[14:15] offset:1024 sc1
    v_mfma_f32_16x16x32_bf16 v[36:39], a[4:7], v[116:119], v[36:39]
    v_mfma_f32_16x16x32_bf16 v[40:43], a[8:11], v[116:119], v[40:43]
    v_mfma_f32_16x16x32_bf16 v[44:47], a[12:15], v[116:119], v[44:47]
    global_load_lds_dwordx4 v3, s[14:15] offset:2048 sc1
    v_mfma_f32_16x16x32_bf16 v[48:51], a[0:3], v[120:123], v[48:51]
    v_mfma_f32_16x16x32_bf16 v[52:55], a[4:7], v[120:123], v[52:55]
    v_mfma_f32_16x16x32_bf16 v[56:59], a[8:11], v[120:123], v[56:59]
    global_load_lds_dwordx4 v3, s[14:15] offset:3072 sc1
    v_mfma_f32_16x16x32_bf16 v[60:63], a[12:15], v[120:123], v[60:63]
    v_mfma_f32_16x16x32_bf16 v[64:67], a[0:3], v[124:127], v[64:67]
    v_mfma_f32_16x16x32_bf16 v[68:71], a[4:7], v[124:127], v[68:71]
    v_mfma_f32_16x16x32_bf16 v[72:75], a[8:11], v[124:127], v[72:75]
    v_mfma_f32_16x16x32_bf16 v[76:79], a[12:15], v[124:127], v[76:79]
    s_waitcnt vmcnt(13) lgkmcnt(0)
    v_mfma_f32_16x16x32_bf16 v[16:19], v[80:83], v[192:195], v[16:19]
    ds_read_b128 a[0:3], v12 offset:32768
    v_mfma_f32_16x16x32_bf16 v[20:23], v[84:87], v[192:195], v[20:23]
    ds_read_b128 a[4:7], v12 offset:33792
    global_load_dwordx4 a[144:147], v1, s[6:7] offset:0 sc1
    v_mfma_f32_16x16x32_bf16 v[24:27], v[88:91], v[192:195], v[24:27]
    ds_read_b128 a[8:11], v12 offset:34816
    v_mfma_f32_16x16x32_bf16 v[28:31], v[92:95], v[192:195], v[28:31]
    ds_read_b128 a[12:15], v12 offset:35840
    v_mfma_f32_16x16x32_bf16 v[32:35], v[80:83], v[196:199], v[32:35]
    global_load_dwordx4 a[148:151], v1, s[6:7] offset:1024 sc1
    v_mfma_f32_16x16x32_bf16 v[36:39], v[84:87], v[196:199], v[36:39]
    v_mfma_f32_16x16x32_bf16 v[40:43], v[88:91], v[196:199], v[40:43]
    v_mfma_f32_16x16x32_bf16 v[44:47], v[92:95], v[196:199], v[44:47]
    global_load_dwordx4 a[152:155], v1, s[6:7] offset:2048 sc1
    v_mfma_f32_16x16x32_bf16 v[48:51], v[80:83], v[200:203], v[48:51]
    v_mfma_f32_16x16x32_bf16 v[52:55], v[84:87], v[200:203], v[52:55]
    v_mfma_f32_16x16x32_bf16 v[56:59], v[88:91], v[200:203], v[56:59]
    global_load_dwordx4 a[156:159], v1, s[6:7] offset:3072 sc1
    v_mfma_f32_16x16x32_bf16 v[60:63], v[92:95], v[200:203], v[60:63]
    s_add_u32 s6, s6, 16384
    v_mfma_f32_16x16x32_bf16 v[64:67], v[80:83], v[204:207], v[64:67]
    s_addc_u32 s7, s7, 0
    v_mfma_f32_16x16x32_bf16 v[68:71], v[84:87], v[204:207], v[68:71]
    v_mfma_f32_16x16x32_bf16 v[72:75], v[88:91], v[204:207], v[72:75]
    v_mfma_f32_16x16x32_bf16 v[76:79], v[92:95], v[204:207], v[76:79]
    s_waitcnt vmcnt(12) lgkmcnt(0)
    v_mfma_f32_16x16x32_bf16 v[16:19], a[0:3], v[208:211], v[16:19]
    ds_read_b128 v[80:83], v12 offset:49152
    v_mfma_f32_16x16x32_bf16 v[20:23], a[4:7], v[208:211], v[20:23]
    ds_read_b128 v[84:87], v12 offset:50176
    global_load_dwordx4 a[192:195], v1, s[6:7] offset:0 sc1
    v_mfma_f32_16x16x32_bf16 v[24:27], a[8:11], v[208:211], v[24:27]
    ds_read_b128 v[88:91], v12 offset:51200
    v_mfma_f32_16x16x32_bf16 v[28:31], a[12:15], v[208:211], v[28:31]
    ds_read_b128 v[92:95], v12 offset:52224
    v_mfma_f32_16x16x32_bf16 v[32:35], a[0:3], v[212:215], v[32:35]
    global_load_dwordx4 a[196:199], v1, s[6:7] offset:1024 sc1
    v_mfma_f32_16x16x32_bf16 v[36:39], a[4:7], v[212:215], v[36:39]
    v_mfma_f32_16x16x32_bf16 v[40:43], a[8:11], v[212:215], v[40:43]
    v_mfma_f32_16x16x32_bf16 v[44:47], a[12:15], v[212:215], v[44:47]
    global_load_dwordx4 a[200:203], v1, s[6:7] offset:2048 sc1
    v_mfma_f32_16x16x32_bf16 v[48:51], a[0:3], v[216:219], v[48:51]
    v_mfma_f32_16x16x32_bf16 v[52:55], a[4:7], v[216:219], v[52:55]
    v_mfma_f32_16x16x32_bf16 v[56:59], a[8:11], v[216:219], v[56:59]
    global_load_dwordx4 a[204:207], v1, s[6:7] offset:3072 sc1
    v_mfma_f32_16x16x32_bf16 v[60:63], a[12:15], v[216:219], v[60:63]
    s_add_u32 s6, s6, 16384
    v_mfma_f32_16x16x32_bf16 v[64:67], a[0:3], v[220:223], v[64:67]
    s_addc_u32 s7, s7, 0
    v_mfma_f32_16x16x32_bf16 v[68:71], a[4:7], v[220:223], v[68:71]
    v_mfma_f32_16x16x32_bf16 v[72:75], a[8:11], v[220:223], v[72:75]
    v_mfma_f32_16x16x32_bf16 v[76:79], a[12:15], v[220:223], v[76:79]
    s_nop 2
    v_pk_mul_f32 v[16:17], v[16:17], v[4:5] op_sel:[0,0] op_sel_hi:[1,0]
    v_pk_mul_f32 v[18:19], v[18:19], v[4:5] op_sel:[0,0] op_sel_hi:[1,0]
    v_pk_mul_f32 v[20:21], v[20:21], v[4:5] op_sel:[0,0] op_sel_hi:[1,0]
    v_pk_mul_f32 v[22:23], v[22:23], v[4:5] op_sel:[0,0] op_sel_hi:[1,0]
    global_load_dwordx4 a[208:211], v1, s[6:7] offset:0 sc1
    v_pk_mul_f32 v[24:25], v[24:25], v[4:5] op_sel:[0,0] op_sel_hi:[1,0]
    v_pk_mul_f32 v[26:27], v[26:27], v[4:5] op_sel:[0,0] op_sel_hi:[1,0]
    v_pk_mul_f32 v[28:29], v[28:29], v[4:5] op_sel:[0,0] op_sel_hi:[1,0]
    v_pk_mul_f32 v[30:31], v[30:31], v[4:5] op_sel:[0,0] op_sel_hi:[1,0]
    v_pk_mul_f32 v[32:33], v[32:33], v[4:5] op_sel:[0,1] op_sel_hi:[1,1]
    v_pk_mul_f32 v[34:35], v[34:35], v[4:5] op_sel:[0,1] op_sel_hi:[1,1]
    v_pk_mul_f32 v[36:37], v[36:37], v[4:5] op_sel:[0,1] op_sel_hi:[1,1]
    v_pk_mul_f32 v[38:39], v[38:39], v[4:5] op_sel:[0,1] op_sel_hi:[1,1]
    global_load_dwordx4 a[212:215], v1, s[6:7] offset:1024 sc1
    v_pk_mul_f32 v[40:41], v[40:41], v[4:5] op_sel:[0,1] op_sel_hi:[1,1]
    v_pk_mul_f32 v[42:43], v[42:43], v[4:5] op_sel:[0,1] op_sel_hi:[1,1]
    v_pk_mul_f32 v[44:45], v[44:45], v[4:5] op_sel:[0,1] op_sel_hi:[1,1]
    v_pk_mul_f32 v[46:47], v[46:47], v[4:5] op_sel:[0,1] op_sel_hi:[1,1]
    v_pk_mul_f32 v[48:49], v[48:49], v[6:7] op_sel:[0,0] op_sel_hi:[1,0]
    v_pk_mul_f32 v[50:51], v[50:51], v[6:7] op_sel:[0,0] op_sel_hi:[1,0]
    v_pk_mul_f32 v[52:53], v[52:53], v[6:7] op_sel:[0,0] op_sel_hi:[1,0]
    v_pk_mul_f32 v[54:55], v[54:55], v[6:7] op_sel:[0,0] op_sel_hi:[1,0]
    global_load_dwordx4 a[216:219], v1, s[6:7] offset:2048 sc1
    v_pk_mul_f32 v[56:57], v[56:57], v[6:7] op_sel:[0,0] op_sel_hi:[1,0]
    v_pk_mul_f32 v[58:59], v[58:59], v[6:7] op_sel:[0,0] op_sel_hi:[1,0]
    v_pk_mul_f32 v[60:61], v[60:61], v[6:7] op_sel:[0,0] op_sel_hi:[1,0]
    v_pk_mul_f32 v[62:63], v[62:63], v[6:7] op_sel:[0,0] op_sel_hi:[1,0]
    v_pk_mul_f32 v[64:65], v[64:65], v[6:7] op_sel:[0,1] op_sel_hi:[1,1]
    v_pk_mul_f32 v[66:67], v[66:67], v[6:7] op_sel:[0,1] op_sel_hi:[1,1]
    v_pk_mul_f32 v[68:69], v[68:69], v[6:7] op_sel:[0,1] op_sel_hi:[1,1]
    v_pk_mul_f32 v[70:71], v[70:71], v[6:7] op_sel:[0,1] op_sel_hi:[1,1]
    global_load_dwordx4 a[220:223], v1, s[6:7] offset:3072 sc1
    s_add_u32 s6, s6, 16384
    s_addc_u32 s7, s7, 0
    v_pk_mul_f32 v[72:73], v[72:73], v[6:7] op_sel:[0,1] op_sel_hi:[1,1]
    v_pk_mul_f32 v[74:75], v[74:75], v[6:7] op_sel:[0,1] op_sel_hi:[1,1]
    v_pk_mul_f32 v[76:77], v[76:77], v[6:7] op_sel:[0,1] op_sel_hi:[1,1]
    v_pk_mul_f32 v[78:79], v[78:79], v[6:7] op_sel:[0,1] op_sel_hi:[1,1]
    global_load_dwordx4 a[224:227], v1, s[6:7] offset:0 sc1
    global_load_dwordx4 a[228:231], v1, s[6:7] offset:1024 sc1
    global_load_dwordx4 a[232:235], v1, s[6:7] offset:2048 sc1
    global_load_dwordx4 a[236:239], v1, s[6:7] offset:3072 sc1
    s_add_u32 s6, s6, 16384
    s_addc_u32 s7, s7, 0
    global_load_dwordx4 a[240:243], v1, s[6:7] offset:0 sc1
    global_load_dwordx4 a[244:247], v1, s[6:7] offset:1024 sc1
    global_load_dwordx4 a[248:251], v1, s[6:7] offset:2048 sc1
    global_load_dwordx4 a[252:255], v1, s[6:7] offset:3072 sc1
    s_add_u32 s6, s6, 16384
    s_addc_u32 s7, s7, 0
    global_load_dwordx4 v[240:243], v1, s[6:7] offset:0 sc1
    global_load_dwordx4 v[244:247], v1, s[6:7] offset:1024 sc1
    global_load_dwordx4 v[248:251], v1, s[6:7] offset:2048 sc1
    global_load_dwordx4 v[252:255], v1, s[6:7] offset:3072 sc1
    s_add_u32 s6, s6, 16384
    s_addc_u32 s7, s7, 0
    s_add_u32 s14, s16, 524288
    s_addc_u32 s15, s17, 0
    s_mov_b32 m0, s13
    s_nop 0
    global_load_dword v15, v0, s[44:45] sc1
    global_load_lds_dwordx4 v1, s[14:15] offset:0 sc1
    global_load_lds_dwordx4 v1, s[14:15] offset:1024 sc1
    global_load_lds_dwordx4 v1, s[14:15] offset:2048 sc1
    global_load_lds_dwordx4 v1, s[14:15] offset:3072 sc1
    s_add_u32 s14, s14, 16384
    s_addc_u32 s15, s15, 0
    s_add_u32 m0, s12, 0
    s_nop 0
    global_load_lds_dwordx4 v1, s[14:15] offset:0 sc1
    global_load_lds_dwordx4 v1, s[14:15] offset:1024 sc1
    global_load_lds_dwordx4 v1, s[14:15] offset:2048 sc1
    global_load_lds_dwordx4 v1, s[14:15] offset:3072 sc1
    s_add_u32 s14, s14, 16384
    s_addc_u32 s15, s15, 0
    s_add_u32 m0, s12, 16384
    s_nop 0
    global_load_lds_dwordx4 v1, s[14:15] offset:0 sc1
    global_load_lds_dwordx4 v1, s[14:15] offset:1024 sc1
    global_load_lds_dwordx4 v1, s[14:15] offset:2048 sc1
    global_load_lds_dwordx4 v1, s[14:15] offset:3072 sc1
    s_add_u32 s14, s14, 16384
    s_addc_u32 s15, s15, 0
    s_add_u32 m0, s12, 32768
    s_nop 0
    global_load_lds_dwordx4 v1, s[14:15] offset:0 sc1
    global_load_lds_dwordx4 v1, s[14:15] offset:1024 sc1
    global_load_lds_dwordx4 v1, s[14:15] offset:2048 sc1
    global_load_lds_dwordx4 v1, s[14:15] offset:3072 sc1
    s_add_u32 s14, s14, 16384
    s_addc_u32 s15, s15, 0
    s_waitcnt vmcnt(16)
    v_cmp_gt_u32 vcc, 0x300, v15
    s_nop 1
    s_cbranch_vccnz L_e3_slow
L_e3_ok:
    global_load_dwordx4 v[224:227], v8, s[8:9] sc1
    global_load_dwordx4 v[228:231], v9, s[8:9] sc1
    global_load_dwordx4 v[232:235], v10, s[8:9] sc1
    global_load_dwordx4 v[236:239], v11, s[8:9] sc1
    s_add_u32 s8, s8, 16384
    s_addc_u32 s9, s9, 0
    global_load_dwordx4 v[96:99], v8, s[8:9] sc1
    global_load_dwordx4 v[100:103], v9, s[8:9] sc1
    global_load_dwordx4 v[104:107], v10, s[8:9] sc1
    global_load_dwordx4 v[108:111], v11, s[8:9] sc1
    s_add_u32 s8, s8, 16384
    s_addc_u32 s9, s9, 0
    global_load_dwordx4 v[112:115], v8, s[8:9] sc1
    global_load_dwordx4 v[116:119], v9, s[8:9] sc1
    global_load_dwordx4 v[120:123], v10, s[8:9] sc1
    global_load_dwordx4 v[124:127], v11, s[8:9] sc1
    s_add_u32 s8, s8, 16384
    s_addc_u32 s9, s9, 0
    global_load_dwordx4 v[192:195], v8, s[8:9] sc1
    global_load_dwordx4 v[196:199], v9, s[8:9] sc1
    global_load_dwordx4 v[200:203], v10, s[8:9] sc1
    global_load_dwordx4 v[204:207], v11, s[8:9] sc1
    s_add_u32 s8, s8, 16384
    s_addc_u32 s9, s9, 0
    s_waitcnt vmcnt(12) lgkmcnt(0)
    v_mfma_f32_16x16x32_bf16 v[16:19], v[80:83], v[224:227], v[16:19]
    ds_read_b128 a[0:3], v13 offset:0
    v_mfma_f32_16x16x32_bf16 v[20:23], v[84:87], v[224:227], v[20:23]
    ds_read_b128 a[4:7], v13 offset:1024
    global_load_dwordx4 v[208:211], v8, s[8:9] sc1
    v_mfma_f32_16x16x32_bf16 v[24:27], v[88:91], v[224:227], v[24:27]
    ds_read_b128 a[8:11], v13 offset:2048
    v_mfma_f32_16x16x32_bf16 v[28:31], v[92:95], v[224:227], v[28:31]
    ds_read_b128 a[12:15], v13 offset:3072
    v_mfma_f32_16x16x32_bf16 v[32:35], v[80:83], v[228:231], v[32:35]
    v_mfma_f32_16x16x32_bf16 v[36:39], v[84:87], v[228:231], v[36:39]
    global_load_dwordx4 v[212:215], v9, s[8:9] sc1
    v_mfma_f32_16x16x32_bf16 v[40:43], v[88:91], v[228:231], v[40:43]
    v_mfma_f32_16x16x32_bf16 v[44:47], v[92:95], v[228:231], v[44:47]
    v_mfma_f32_16x16x32_bf16 v[48:51], v[80:83], v[232:235], v[48:51]
    v_mfma_f32_16x16x32_bf16 v[52:55], v[84:87], v[232:235], v[52:55]
    global_load_dwordx4 v[216:219], v10, s[8:9] sc1
    v_mfma_f32_16x16x32_bf16 v[56:59], v[88:91], v[232:235], v[56:59]
    v_mfma_f32_16x16x32_bf16 v[60:63], v[92:95], v[232:235], v[60:63]
    v_mfma_f32_16x16x32_bf16 v[64:67], v[80:83], v[236:239], v[64:67]
    v_mfma_f32_16x16x32_bf16 v[68:71], v[84:87], v[236:239], v[68:71]
    global_load_dwordx4 v[220:223], v11, s[8:9] sc1
    v_mfma_f32_16x16x32_bf16 v[72:75], v[88:91], v[236:239], v[72:75]
    s_add_u32 s8, s8, 16384
    v_mfma_f32_16x16x32_bf16 v[76:79], v[92:95], v[236:239], v[76:79]
    s_addc_u32 s9, s9, 0
    s_waitcnt vmcnt(12) lgkmcnt(0)
    v_mfma_f32_16x16x32_bf16 v[16:19], a[0:3], v[96:99], v[16:19]
    ds_read_b128 v[80:83], v13 offset:16384
    v_mfma_f32_16x16x32_bf16 v[20:23], a[4:7], v[96:99], v[20:23]
    ds_read_b128 v[84:87], v13 offset:17408
    global_load_dwordx4 v[224:227], v8, s[8:9] sc1
    v_mfma_f32_16x16x32_bf16 v[24:27], a[8:11], v[96:99], v[24:27]
    ds_read_b128 v[88:91], v13 offset:18432
    v_mfma_f32_16x16x32_bf16 v[28:31], a[12:15], v[96:99], v[28:31]
    ds_read_b128 v[92:95], v13 offset:19456
    v_mfma_f32_16x16x32_bf16 v[32:35], a[0:3], v[100:103], v[32:35]
    v_mfma_f32_16x16x32_bf16 v[36:39], a[4:7], v[100:103], v[36:39]
    global_load_dwordx4 v[228:231], v9, s[8:9] sc1
    v_mfma_f32_16x16x32_bf16 v[40:43], a[8:11], v[100:103], v[40:43]
    v_mfma_f32_16x16x32_bf16 v[44:47], a[12:15], v[100:103], v[44:47]
    v_mfma_f32_16x16x32_bf16 v[48:51], a[0:3], v[104:107], v[48:51]
    v_mfma_f32_16x16x32_bf16 v[52:55], a[4:7], v[104:107], v[52:55]
    global_load_dwordx4 v[232:235], v10, s[8:9] sc1
    v_mfma_f32_16x16x32_bf16 v[56:59], a[8:11], v[104:107], v[56:59]
    v_mfma_f32_16x16x32_bf16 v[60:63], a[12:15], v[104:107], v[60:63]
L_wk12:
    s_cbranch_execz L_wkret
    v_mfma_f32_16x16x32_bf16 v[64:67], a[0:3], v[108:111], v[64:67]
    v_mfma_f32_16x16x32_bf16 v[68:71], a[4:7], v[108:111], v[68:71]
    global_load_dwordx4 v[236:239], v11, s[8:9] sc1
    v_mfma_f32_16x16x32_bf16 v[72:75], a[8:11], v[108:111], v[72:75]
    s_add_u32 s8, s8, 16384
    v_mfma_f32_16x16x32_bf16 v[76:79], a[12:15], v[108:111], v[76:79]
    s_addc_u32 s9, s9, 0
    s_waitcnt vmcnt(12) lgkmcnt(0)
    v_mfma_f32_16x16x32_bf16 v[16:19], v[80:83], v[112:115], v[16:19]
    ds_read_b128 a[0:3], v13 offset:32768
    v_mfma_f32_16x16x32_bf16 v[20:23], v[84:87], v[112:115], v[20:23]
    ds_read_b128 a[4:7], v13 offset:33792
    global_load_dwordx4 v[96:99], v8, s[8:9] sc1
    v_mfma_f32_16x16x32_bf16 v[24:27], v[88:91], v[112:115], v[24:27]
    s_mov_b64 s[76:77], s[8:9]
    ds_read_b128 a[8:11], v13 offset:34816
    v_mfma_f32_16x16x32_bf16 v[28:31], v[92:95], v[112:115], v[28:31]
    s_add_u32 s74, s8, 16384
    ds_read_b128 a[12:15], v13 offset:35840
    v_mfma_f32_16x16x32_bf16 v[32:35], v[80:83], v[116:119], v[32:35]
    s_addc_u32 s75, s9, 0
    v_mfma_f32_16x16x32_bf16 v[36:39], v[84:87], v[116:119], v[36:39]
    global_load_dwordx4 v[104:107], v9, s[8:9] sc1
    v_mfma_f32_16x16x32_bf16 v[40:43], v[88:91], v[116:119], v[40:43]
    s_add_u32 s8, s76, 0
    v_mfma_f32_16x16x32_bf16 v[44:47], v[92:95], v[116:119], v[44:47]
    s_addc_u32 s9, s77, 0
    v_mfma_f32_16x16x32_bf16 v[48:51], v[80:83], v[120:123], v[48:51]
    v_mfma_f32_16x16x32_bf16 v[52:55], v[84:87], v[120:123], v[52:55]
    global_load_dwordx4 v[100:103], v8, s[74:75] sc1
    v_mfma_f32_16x16x32_bf16 v[56:59], v[88:91], v[120:123], v[56:59]
    v_mfma_f32_16x16x32_bf16 v[60:63], v[92:95], v[120:123], v[60:63]
    v_mfma_f32_16x16x32_bf16 v[64:67], v[80:83], v[124:127], v[64:67]
    v_mfma_f32_16x16x32_bf16 v[68:71], v[84:87], v[124:127], v[68:71]
    global_load_dwordx4 v[108:111], v9, s[74:75] sc1
    v_mfma_f32_16x16x32_bf16 v[72:75], v[88:91], v[124:127], v[72:75]
    v_mfma_f32_16x16x32_bf16 v[76:79], v[92:95], v[124:127], v[76:79]
    s_waitcnt vmcnt(12) lgkmcnt(0)
    v_mfma_f32_16x16x32_bf16 v[16:19], a[0:3], v[192:195], v[16:19]
    ds_read_b128 v[80:83], v14 offset:0
    v_mfma_f32_16x16x32_bf16 v[20:23], a[4:7], v[192:195], v[20:23]
    ds_read_b128 v[84:87], v14 offset:1024
    global_load_dwordx4 v[112:115], v10, s[8:9] sc1
    v_mfma_f32_16x16x32_bf16 v[24:27], a[8:11], v[192:195], v[24:27]
    s_add_u32 s74, s8, 16384
    ds_read_b128 v[88:91], v14 offset:2048
    v_mfma_f32_16x16x32_bf16 v[28:31], a[12:15], v[192:195], v[28:31]
    s_addc_u32 s75, s9, 0
    ds_read_b128 v[92:95], v14 offset:3072
    v_mfma_f32_16x16x32_bf16 v[32:35], a[0:3], v[196:199], v[32:35]
    v_mfma_f32_16x16x32_bf16 v[36:39], a[4:7], v[196:199], v[36:39]
    global_load_dwordx4 v[120:123], v11, s[8:9] sc1
    v_mfma_f32_16x16x32_bf16 v[40:43], a[8:11], v[196:199], v[40:43]
    s_add_u32 s8, s76, 32768
    v_mfma_f32_16x16x32_bf16 v[44:47], a[12:15], v[196:199], v[44:47]
    s_addc_u32 s9, s77, 0
    v_mfma_f32_16x16x32_bf16 v[48:51], a[0:3], v[200:203], v[48:51]
    v_mfma_f32_16x16x32_bf16 v[52:55], a[4:7], v[200:203], v[52:55]
    global_load_dwordx4 v[116:119], v10, s[74:75] sc1
    v_mfma_f32_16x16x32_bf16 v[56:59], a[8:11], v[200:203], v[56:59]
    v_mfma_f32_16x16x32_bf16 v[60:63], a[12:15], v[200:203], v[60:63]
    v_mfma_f32_16x16x32_bf16 v[64:67], a[0:3], v[204:207], v[64:67]
    v_mfma_f32_16x16x32_bf16 v[68:71], a[4:7], v[204:207], v[68:71]
    global_load_dwordx4 v[124:127], v11, s[74:75] sc1
    v_mfma_f32_16x16x32_bf16 v[72:75], a[8:11], v[204:207], v[72:75]
    v_mfma_f32_16x16x32_bf16 v[76:79], a[12:15], v[204:207], v[76:79]
    s_waitcnt vmcnt(12) lgkmcnt(0)
    v_mfma_f32_16x16x32_bf16 v[16:19], v[80:83], v[208:211], v[16:19]
    v_mfma_f32_16x16x32_bf16 v[20:23], v[84:87], v[208:211], v[20:23]
    global_load_dwordx4 v[192:195], v8, s[8:9] sc1
    v_mfma_f32_16x16x32_bf16 v[24:27], v[88:91], v[208:211], v[24:27]
    s_add_u32 s74, s8, 16384
    v_mfma_f32_16x16x32_bf16 v[28:31], v[92:95], v[208:211], v[28:31]
    s_addc_u32 s75, s9, 0
    v_mfma_f32_16x16x32_bf16 v[32:35], v[80:83], v[212:215], v[32:35]
    v_mfma_f32_16x16x32_bf16 v[36:39], v[84:87], v[212:215], v[36:39]
    global_load_dwordx4 v[200:203], v9, s[8:9] sc1
    v_mfma_f32_16x16x32_bf16 v[40:43], v[88:91], v[212:215], v[40:43]
    s_add_u32 s8, s76, 65536
    v_mfma_f32_16x16x32_bf16 v[44:47], v[92:95], v[212:215], v[44:47]
    s_addc_u32 s9, s77, 0
    v_mfma_f32_16x16x32_bf16 v[48:51], v[80:83], v[216:219], v[48:51]
    v_mfma_f32_16x16x32_bf16 v[52:55], v[84:87], v[216:219], v[52:55]
    global_load_dwordx4 v[196:199], v8, s[74:75] sc1
    v_mfma_f32_16x16x32_bf16 v[56:59], v[88:91], v[216:219], v[56:59]
    v_mfma_f32_16x16x32_bf16 v[60:63], v[92:95], v[216:219], v[60:63]
    v_mfma_f32_16x16x32_bf16 v[64:67], v[80:83], v[220:223], v[64:67]
    v_mfma_f32_16x16x32_bf16 v[68:71], v[84:87], v[220:223], v[68:71]
    global_load_dwordx4 v[204:207], v9, s[74:75] sc1
    v_mfma_f32_16x16x32_bf16 v[72:75], v[88:91], v[220:223], v[72:75]
    v_mfma_f32_16x16x32_bf16 v[76:79], v[92:95], v[220:223], v[76:79]
    s_waitcnt vmcnt(12)
    v_mfma_f32_16x16x32_bf16 v[16:19], v[128:131], v[224:227], v[16:19]
    v_mfma_f32_16x16x32_bf16 v[20:23], v[132:135], v[224:227], v[20:23]
    global_load_dwordx4 v[208:211], v8, s[8:9] sc1
    v_mfma_f32_16x16x32_bf16 v[24:27], v[136:139], v[224:227], v[24:27]
    s_add_u32 s74, s8, 16384
    v_mfma_f32_16x16x32_bf16 v[28:31], v[140:143], v[224:227], v[28:31]
    s_addc_u32 s75, s9, 0
    v_mfma_f32_16x16x32_bf16 v[32:35], v[128:131], v[228:231], v[32:35]
    v_mfma_f32_16x16x32_bf16 v[36:39], v[132:135], v[228:231], v[36:39]
    global_load_dwordx4 v[216:219], v9, s[8:9] sc1
    v_mfma_f32_16x16x32_bf16 v[40:43], v[136:139], v[228:231], v[40:43]
    s_add_u32 s8, s76, 98304
    v_mfma_f32_16x16x32_bf16 v[44:47], v[140:143], v[228:231], v[44:47]
    s_addc_u32 s9, s77, 0
    v_mfma_f32_16x16x32_bf16 v[48:51], v[128:131], v[232:235], v[48:51]
    v_mfma_f32_16x16x32_bf16 v[52:55], v[132:135], v[232:235], v[52:55]
    global_load_dwordx4 v[212:215], v8, s[74:75] sc1
    v_mfma_f32_16x16x32_bf16 v[56:59], v[136:139], v[232:235], v[56:59]
    v_mfma_f32_16x16x32_bf16 v[60:63], v[140:143], v[232:235], v[60:63]
    v_mfma_f32_16x16x32_bf16 v[64:67], v[128:131], v[236:239], v[64:67]
    v_mfma_f32_16x16x32_bf16 v[68:71], v[132:135], v[236:239], v[68:71]
    global_load_dwordx4 v[220:223], v9, s[74:75] sc1
    v_mfma_f32_16x16x32_bf16 v[72:75], v[136:139], v[236:239], v[72:75]
    v_mfma_f32_16x16x32_bf16 v[76:79], v[140:143], v[236:239], v[76:79]
    s_waitcnt vmcnt(12)
    v_mfma_f32_16x16x32_bf16 v[16:19], v[144:147], v[96:99], v[16:19]
    global_load_dwordx4 v[224:227], v8, s[8:9] sc1
    v_mfma_f32_16x16x32_bf16 v[16:19], a[16:19], v[100:103], v[16:19]
    s_add_u32 s74, s8, 16384
    v_mfma_f32_16x16x32_bf16 v[20:23], a[20:23], v[100:103], v[20:23]
    s_addc_u32 s75, s9, 0
    global_load_dwordx4 v[232:235], v9, s[8:9] sc1
    v_mfma_f32_16x16x32_bf16 v[20:23], v[148:151], v[96:99], v[20:23]
    s_add_u32 s8, s76, 131072
    v_mfma_f32_16x16x32_bf16 v[24:27], v[152:155], v[96:99], v[24:27]
    s_addc_u32 s9, s77, 0
    global_load_dwordx4 v[228:231], v8, s[74:75] sc1
    v_mfma_f32_16x16x32_bf16 v[24:27], a[24:27], v[100:103], v[24:27]
    v_mfma_f32_16x16x32_bf16 v[28:31], a[28:31], v[100:103], v[28:31]
    global_load_dwordx4 v[236:239], v9, s[74:75] sc1
    v_mfma_f32_16x16x32_bf16 v[28:31], v[156:159], v[96:99], v[28:31]
    v_mfma_f32_16x16x32_bf16 v[32:35], v[144:147], v[104:107], v[32:35]
    global_load_dwordx4 v[128:131], v1, s[6:7] offset:0 sc1
    v_mfma_f32_16x16x32_bf16 v[32:35], a[16:19], v[108:111], v[32:35]
    v_mfma_f32_16x16x32_bf16 v[36:39], a[20:23], v[108:111], v[36:39]
    global_load_dwordx4 v[132:135], v1, s[6:7] offset:1024 sc1
    v_mfma_f32_16x16x32_bf16 v[36:39], v[148:151], v[104:107], v[36:39]
    v_mfma_f32_16x16x32_bf16 v[40:43], v[152:155], v[104:107], v[40:43]
    global_load_dwordx4 v[136:139], v1, s[6:7] offset:2048 sc1
    v_mfma_f32_16x16x32_bf16 v[40:43], a[24:27], v[108:111], v[40:43]
    v_mfma_f32_16x16x32_bf16 v[44:47], a[28:31], v[108:111], v[44:47]
    global_load_dwordx4 v[140:143], v1, s[6:7] offset:3072 sc1
    v_mfma_f32_16x16x32_bf16 v[44:47], v[156:159], v[104:107], v[44:47]
    s_add_u32 s6, s6, 16384
    s_addc_u32 s7, s7, 0
    s_waitcnt vmcnt(16)
    v_mfma_f32_16x16x32_bf16 v[48:51], v[144:147], v[112:115], v[48:51]
    v_mfma_f32_16x16x32_bf16 v[48:51], a[16:19], v[116:119], v[48:51]
    global_load_dwordx4 v[96:99], v8, s[8:9] sc1
    v_mfma_f32_16x16x32_bf16 v[52:55], a[20:23], v[116:119], v[52:55]
    s_add_u32 s74, s8, 16384
    v_mfma_f32_16x16x32_bf16 v[52:55], v[148:151], v[112:115], v[52:55]
    s_addc_u32 s75, s9, 0
    v_mfma_f32_16x16x32_bf16 v[56:59], v[152:155], v[112:115], v[56:59]
    v_mfma_f32_16x16x32_bf16 v[56:59], a[24:27], v[116:119], v[56:59]
    global_load_dwordx4 v[104:107], v9, s[8:9] sc1
    v_mfma_f32_16x16x32_bf16 v[60:63], a[28:31], v[116:119], v[60:63]
    s_add_u32 s8, s76, 32768
    v_mfma_f32_16x16x32_bf16 v[60:63], v[156:159], v[112:115], v[60:63]
    s_addc_u32 s9, s77, 0
    v_mfma_f32_16x16x32_bf16 v[64:67], v[144:147], v[120:123], v[64:67]
    v_mfma_f32_16x16x32_bf16 v[64:67], a[16:19], v[124:127], v[64:67]
    global_load_dwordx4 v[100:103], v8, s[74:75] sc1
    v_mfma_f32_16x16x32_bf16 v[68:71], a[20:23], v[124:127], v[68:71]
    v_mfma_f32_16x16x32_bf16 v[68:71], v[148:151], v[120:123], v[68:71]
    v_mfma_f32_16x16x32_bf16 v[72:75], v[152:155], v[120:123], v[72:75]
    v_mfma_f32_16x16x32_bf16 v[72:75], a[24:27], v[124:127], v[72:75]
    global_load_dwordx4 v[108:111], v9, s[74:75] sc1
    v_mfma_f32_16x16x32_bf16 v[76:79], a[28:31], v[124:127], v[76:79]
    v_mfma_f32_16x16x32_bf16 v[76:79], v[156:159], v[120:123], v[76:79]
    s_waitcnt vmcnt(16)
    v_mfma_f32_16x16x32_bf16 v[16:19], a[32:35], v[192:195], v[16:19]
    global_load_dwordx4 v[112:115], v10, s[8:9] sc1
    v_mfma_f32_16x16x32_bf16 v[16:19], a[48:51], v[196:199], v[16:19]
    s_add_u32 s74, s8, 16384
    v_mfma_f32_16x16x32_bf16 v[20:23], a[52:55], v[196:199], v[20:23]
    s_addc_u32 s75, s9, 0
    global_load_dwordx4 v[120:123], v11, s[8:9] sc1
    v_mfma_f32_16x16x32_bf16 v[20:23], a[36:39], v[192:195], v[20:23]
    s_add_u32 s8, s76, 65536
    v_mfma_f32_16x16x32_bf16 v[24:27], a[40:43], v[192:195], v[24:27]
    s_addc_u32 s9, s77, 0
    global_load_dwordx4 v[116:119], v10, s[74:75] sc1
    v_mfma_f32_16x16x32_bf16 v[24:27], a[56:59], v[196:199], v[24:27]
    v_mfma_f32_16x16x32_bf16 v[28:31], a[60:63], v[196:199], v[28:31]
    global_load_dwordx4 v[124:127], v11, s[74:75] sc1
    v_mfma_f32_16x16x32_bf16 v[28:31], a[44:47], v[192:195], v[28:31]
    v_mfma_f32_16x16x32_bf16 v[32:35], a[32:35], v[200:203], v[32:35]
    global_load_dwordx4 v[144:147], v1, s[6:7] offset:0 sc1
    v_mfma_f32_16x16x32_bf16 v[32:35], a[48:51], v[204:207], v[32:35]
    v_mfma_f32_16x16x32_bf16 v[36:39], a[52:55], v[204:207], v[36:39]
    global_load_dwordx4 v[148:151], v1, s[6:7] offset:1024 sc1
    v_mfma_f32_16x16x32_bf16 v[36:39], a[36:39], v[200:203], v[36:39]
    v_mfma_f32_16x16x32_bf16 v[40:43], a[40:43], v[200:203], v[40:43]
    global_load_dwordx4 v[152:155], v1, s[6:7] offset:2048 sc1
    v_mfma_f32_16x16x32_bf16 v[40:43], a[56:59], v[204:207], v[40:43]
    v_mfma_f32_16x16x32_bf16 v[44:47], a[60:63], v[204:207], v[44:47]
    global_load_dwordx4 v[156:159], v1, s[6:7] offset:3072 sc1
    v_mfma_f32_16x16x32_bf16 v[44:47], a[44:47], v[200:203], v[44:47]
    s_add_u32 s6, s6, 16384
    s_addc_u32 s7, s7, 0
    s_waitcnt vmcnt(20)
    v_mfma_f32_16x16x32_bf16 v[16:19], a[64:67], v[208:211], v[16:19]
    v_mfma_f32_16x16x32_bf16 v[16:19], a[80:83], v[212:215], v[16:19]
    global_load_dwordx4 v[192:195], v10, s[8:9] sc1
    v_mfma_f32_16x16x32_bf16 v[20:23], a[84:87], v[212:215], v[20:23]
    s_add_u32 s74, s8, 16384
    v_mfma_f32_16x16x32_bf16 v[20:23], a[68:71], v[208:211], v[20:23]
    s_addc_u32 s75, s9, 0
    v_mfma_f32_16x16x32_bf16 v[24:27], a[72:75], v[208:211], v[24:27]
    v_mfma_f32_16x16x32_bf16 v[24:27], a[88:91], v[212:215], v[24:27]
    global_load_dwordx4 v[200:203], v11, s[8:9] sc1
    v_mfma_f32_16x16x32_bf16 v[28:31], a[92:95], v[212:215], v[28:31]
    s_add_u32 s8, s76, 98304
    v_mfma_f32_16x16x32_bf16 v[28:31], a[76:79], v[208:211], v[28:31]
    s_addc_u32 s9, s77, 0
    v_mfma_f32_16x16x32_bf16 v[32:35], a[64:67], v[216:219], v[32:35]
    v_mfma_f32_16x16x32_bf16 v[32:35], a[80:83], v[220:223], v[32:35]
    global_load_dwordx4 v[196:199], v10, s[74:75] sc1
    v_mfma_f32_16x16x32_bf16 v[36:39], a[84:87], v[220:223], v[36:39]
    v_mfma_f32_16x16x32_bf16 v[36:39], a[68:71], v[216:219], v[36:39]
    v_mfma_f32_16x16x32_bf16 v[40:43], a[72:75], v[216:219], v[40:43]
    v_mfma_f32_16x16x32_bf16 v[40:43], a[88:91], v[220:223], v[40:43]
    global_load_dwordx4 v[204:207], v11, s[74:75] sc1
    v_mfma_f32_16x16x32_bf16 v[44:47], a[92:95], v[220:223], v[44:47]
    v_mfma_f32_16x16x32_bf16 v[44:47], a[76:79], v[216:219], v[44:47]
    s_waitcnt vmcnt(20)
    v_mfma_f32_16x16x32_bf16 v[16:19], a[96:99], v[224:227], v[16:19]
    global_load_dwordx4 v[208:211], v10, s[8:9] sc1
    v_mfma_f32_16x16x32_bf16 v[16:19], a[112:115], v[228:231], v[16:19]
    s_add_u32 s74, s8, 16384
    v_mfma_f32_16x16x32_bf16 v[20:23], a[116:119], v[228:231], v[20:23]
    s_addc_u32 s75, s9, 0
    global_load_dwordx4 v[216:219], v11, s[8:9] sc1
    v_mfma_f32_16x16x32_bf16 v[20:23], a[100:103], v[224:227], v[20:23]
    s_add_u32 s8, s76, 131072
    v_mfma_f32_16x16x32_bf16 v[24:27], a[104:107], v[224:227], v[24:27]
    s_addc_u32 s9, s77, 0
    global_load_dwordx4 v[212:215], v10, s[74:75] sc1
    v_mfma_f32_16x16x32_bf16 v[24:27], a[120:123], v[228:231], v[24:27]
    v_mfma_f32_16x16x32_bf16 v[28:31], a[124:127], v[228:231], v[28:31]
    global_load_dwordx4 v[220:223], v11, s[74:75] sc1
    v_mfma_f32_16x16x32_bf16 v[28:31], a[108:111], v[224:227], v[28:31]
    v_mfma_f32_16x16x32_bf16 v[32:35], a[96:99], v[232:235], v[32:35]
    global_load_dwordx4 a[16:19], v1, s[6:7] offset:0 sc1
    v_mfma_f32_16x16x32_bf16 v[32:35], a[112:115], v[236:239], v[32:35]
    v_mfma_f32_16x16x32_bf16 v[36:39], a[116:119], v[236:239], v[36:39]
    global_load_dwordx4 a[20:23], v1, s[6:7] offset:1024 sc1
    v_mfma_f32_16x16x32_bf16 v[36:39], a[100:103], v[232:235], v[36:39]
    v_mfma_f32_16x16x32_bf16 v[40:43], a[104:107], v[232:235], v[40:43]
    global_load_dwordx4 a[24:27], v1, s[6:7] offset:2048 sc1
    v_mfma_f32_16x16x32_bf16 v[40:43], a[120:123], v[236:239], v[40:43]
    v_mfma_f32_16x16x32_bf16 v[44:47], a[124:127], v[236:239], v[44:47]
    global_load_dwordx4 a[28:31], v1, s[6:7] offset:3072 sc1
    v_mfma_f32_16x16x32_bf16 v[44:47], a[108:111], v[232:235], v[44:47]
    s_add_u32 s6, s6, 16384
    s_addc_u32 s7, s7, 0
    s_waitcnt vmcnt(20)
    v_mfma_f32_16x16x32_bf16 v[16:19], v[160:163], v[96:99], v[16:19]
    v_mfma_f32_16x16x32_bf16 v[16:19], v[176:179], v[100:103], v[16:19]
    global_load_dwordx4 v[224:227], v10, s[8:9] sc1
    v_mfma_f32_16x16x32_bf16 v[20:23], v[180:183], v[100:103], v[20:23]
    s_add_u32 s74, s8, 16384
    v_mfma_f32_16x16x32_bf16 v[20:23], v[164:167], v[96:99], v[20:23]
    s_addc_u32 s75, s9, 0
    v_mfma_f32_16x16x32_bf16 v[24:27], v[168:171], v[96:99], v[24:27]
    v_mfma_f32_16x16x32_bf16 v[24:27], v[184:187], v[100:103], v[24:27]
    global_load_dwordx4 v[232:235], v11, s[8:9] sc1
    v_mfma_f32_16x16x32_bf16 v[28:31], v[188:191], v[100:103], v[28:31]
    s_add_u32 s8, s76, 163840
    v_mfma_f32_16x16x32_bf16 v[28:31], v[172:175], v[96:99], v[28:31]
    s_addc_u32 s9, s77, 0
    v_mfma_f32_16x16x32_bf16 v[32:35], v[160:163], v[104:107], v[32:35]
    v_mfma_f32_16x16x32_bf16 v[32:35], v[176:179], v[108:111], v[32:35]
    global_load_dwordx4 v[228:231], v10, s[74:75] sc1
    v_mfma_f32_16x16x32_bf16 v[36:39], v[180:183], v[108:111], v[36:39]
    v_mfma_f32_16x16x32_bf16 v[36:39], v[164:167], v[104:107], v[36:39]
    v_mfma_f32_16x16x32_bf16 v[40:43], v[168:171], v[104:107], v[40:43]
    v_mfma_f32_16x16x32_bf16 v[40:43], v[184:187], v[108:111], v[40:43]
    global_load_dwordx4 v[236:239], v11, s[74:75] sc1
    v_mfma_f32_16x16x32_bf16 v[44:47], v[188:191], v[108:111], v[44:47]
    v_mfma_f32_16x16x32_bf16 v[44:47], v[172:175], v[104:107], v[44:47]
    s_waitcnt vmcnt(20)
    v_mfma_f32_16x16x32_bf16 v[48:51], a[32:35], v[112:115], v[48:51]
    v_mfma_f32_16x16x32_bf16 v[48:51], a[48:51], v[116:119], v[48:51]
    global_load_dwordx4 v[96:99], v8, s[8:9] sc1
    v_mfma_f32_16x16x32_bf16 v[52:55], a[52:55], v[116:119], v[52:55]
    s_add_u32 s74, s8, 16384
    v_mfma_f32_16x16x32_bf16 v[52:55], a[36:39], v[112:115], v[52:55]
    s_addc_u32 s75, s9, 0
    v_mfma_f32_16x16x32_bf16 v[56:59], a[40:43], v[112:115], v[56:59]
    v_mfma_f32_16x16x32_bf16 v[56:59], a[56:59], v[116:119], v[56:59]
    global_load_dwordx4 v[104:107], v9, s[8:9] sc1
    v_mfma_f32_16x16x32_bf16 v[60:63], a[60:63], v[116:119], v[60:63]
    s_add_u32 s8, s76, 196608
    v_mfma_f32_16x16x32_bf16 v[60:63], a[44:47], v[112:115], v[60:63]
    s_addc_u32 s9, s77, 0
    v_mfma_f32_16x16x32_bf16 v[64:67], a[32:35], v[120:123], v[64:67]
    v_mfma_f32_16x16x32_bf16 v[64:67], a[48:51], v[124:127], v[64:67]
    global_load_dwordx4 v[100:103], v8, s[74:75] sc1
    v_mfma_f32_16x16x32_bf16 v[68:71], a[52:55], v[124:127], v[68:71]
    v_mfma_f32_16x16x32_bf16 v[68:71], a[36:39], v[120:123], v[68:71]
    v_mfma_f32_16x16x32_bf16 v[72:75], a[40:43], v[120:123], v[72:75]
    v_mfma_f32_16x16x32_bf16 v[72:75], a[56:59], v[124:127], v[72:75]
    global_load_dwordx4 v[108:111], v9, s[74:75] sc1
    v_mfma_f32_16x16x32_bf16 v[76:79], a[60:63], v[124:127], v[76:79]
    v_mfma_f32_16x16x32_bf16 v[76:79], a[44:47], v[120:123], v[76:79]
    s_waitcnt vmcnt(16)
    v_mfma_f32_16x16x32_bf16 v[48:51], a[64:67], v[192:195], v[48:51]
    v_mfma_f32_16x16x32_bf16 v[48:51], a[80:83], v[196:199], v[48:51]
    global_load_dwordx4 v[112:115], v8, s[8:9] sc1
    v_mfma_f32_16x16x32_bf16 v[52:55], a[84:87], v[196:199], v[52:55]
    s_add_u32 s74, s8, 16384
    v_mfma_f32_16x16x32_bf16 v[52:55], a[68:71], v[192:195], v[52:55]
    s_addc_u32 s75, s9, 0
    v_mfma_f32_16x16x32_bf16 v[56:59], a[72:75], v[192:195], v[56:59]
    v_mfma_f32_16x16x32_bf16 v[56:59], a[88:91], v[196:199], v[56:59]
    global_load_dwordx4 v[120:123], v9, s[8:9] sc1
    v_mfma_f32_16x16x32_bf16 v[60:63], a[92:95], v[196:199], v[60:63]
    s_add_u32 s8, s76, 229376
    v_mfma_f32_16x16x32_bf16 v[60:63], a[76:79], v[192:195], v[60:63]
    s_addc_u32 s9, s77, 0
    v_mfma_f32_16x16x32_bf16 v[64:67], a[64:67], v[200:203], v[64:67]
    v_mfma_f32_16x16x32_bf16 v[64:67], a[80:83], v[204:207], v[64:67]
    global_load_dwordx4 v[116:119], v8, s[74:75] sc1
    v_mfma_f32_16x16x32_bf16 v[68:71], a[84:87], v[204:207], v[68:71]
    v_mfma_f32_16x16x32_bf16 v[68:71], a[68:71], v[200:203], v[68:71]
    v_mfma_f32_16x16x32_bf16 v[72:75], a[72:75], v[200:203], v[72:75]
    v_mfma_f32_16x16x32_bf16 v[72:75], a[88:91], v[204:207], v[72:75]
    global_load_dwordx4 v[124:127], v9, s[74:75] sc1
    v_mfma_f32_16x16x32_bf16 v[76:79], a[92:95], v[204:207], v[76:79]
    v_mfma_f32_16x16x32_bf16 v[76:79], a[76:79], v[200:203], v[76:79]
    s_waitcnt vmcnt(16)
    v_mfma_f32_16x16x32_bf16 v[48:51], a[96:99], v[208:211], v[48:51]
    v_mfma_f32_16x16x32_bf16 v[48:51], a[112:115], v[212:215], v[48:51]
    global_load_dwordx4 v[192:195], v8, s[8:9] sc1
    v_mfma_f32_16x16x32_bf16 v[52:55], a[116:119], v[212:215], v[52:55]
    s_add_u32 s74, s8, 16384
    v_mfma_f32_16x16x32_bf16 v[52:55], a[100:103], v[208:211], v[52:55]
    s_addc_u32 s75, s9, 0
    v_mfma_f32_16x16x32_bf16 v[56:59], a[104:107], v[208:211], v[56:59]
    v_mfma_f32_16x16x32_bf16 v[56:59], a[120:123], v[212:215], v[56:59]
    global_load_dwordx4 v[200:203], v9, s[8:9] sc1
    v_mfma_f32_16x16x32_bf16 v[60:63], a[124:127], v[212:215], v[60:63]
    s_add_u32 s8, s76, 262144
    v_mfma_f32_16x16x32_bf16 v[60:63], a[108:111], v[208:211], v[60:63]
    s_addc_u32 s9, s77, 0
    v_mfma_f32_16x16x32_bf16 v[64:67], a[96:99], v[216:219], v[64:67]
    v_mfma_f32_16x16x32_bf16 v[64:67], a[112:115], v[220:223], v[64:67]
    global_load_dwordx4 v[196:199], v8, s[74:75] sc1
    v_mfma_f32_16x16x32_bf16 v[68:71], a[116:119], v[220:223], v[68:71]
    v_mfma_f32_16x16x32_bf16 v[68:71], a[100:103], v[216:219], v[68:71]
    v_mfma_f32_16x16x32_bf16 v[72:75], a[104:107], v[216:219], v[72:75]
    v_mfma_f32_16x16x32_bf16 v[72:75], a[120:123], v[220:223], v[72:75]
    global_load_dwordx4 v[204:207], v9, s[74:75] sc1
    v_mfma_f32_16x16x32_bf16 v[76:79], a[124:127], v[220:223], v[76:79]
    v_mfma_f32_16x16x32_bf16 v[76:79], a[108:111], v[216:219], v[76:79]
    s_waitcnt vmcnt(12)
    v_mfma_f32_16x16x32_bf16 v[48:51], v[160:163], v[224:227], v[48:51]
    v_mfma_f32_16x16x32_bf16 v[48:51], v[176:179], v[228:231], v[48:51]
    global_load_dwordx4 v[208:211], v8, s[8:9] sc1
    v_mfma_f32_16x16x32_bf16 v[52:55], v[180:183], v[228:231], v[52:55]
    s_add_u32 s74, s8, 16384
    v_mfma_f32_16x16x32_bf16 v[52:55], v[164:167], v[224:227], v[52:55]
    s_addc_u32 s75, s9, 0
    v_mfma_f32_16x16x32_bf16 v[56:59], v[168:171], v[224:227], v[56:59]
    v_mfma_f32_16x16x32_bf16 v[56:59], v[184:187], v[228:231], v[56:59]
    global_load_dwordx4 v[216:219], v9, s[8:9] sc1
    v_mfma_f32_16x16x32_bf16 v[60:63], v[188:191], v[228:231], v[60:63]
    s_add_u32 s8, s76, 163840
    v_mfma_f32_16x16x32_bf16 v[60:63], v[172:175], v[224:227], v[60:63]
    s_addc_u32 s9, s77, 0
    v_mfma_f32_16x16x32_bf16 v[64:67], v[160:163], v[232:235], v[64:67]
    v_mfma_f32_16x16x32_bf16 v[64:67], v[176:179], v[236:239], v[64:67]
    global_load_dwordx4 v[212:215], v8, s[74:75] sc1
    v_mfma_f32_16x16x32_bf16 v[68:71], v[180:183], v[236:239], v[68:71]
    v_mfma_f32_16x16x32_bf16 v[68:71], v[164:167], v[232:235], v[68:71]
    v_mfma_f32_16x16x32_bf16 v[72:75], v[168:171], v[232:235], v[72:75]
    v_mfma_f32_16x16x32_bf16 v[72:75], v[184:187], v[236:239], v[72:75]
    global_load_dwordx4 v[220:223], v9, s[74:75] sc1
    v_mfma_f32_16x16x32_bf16 v[76:79], v[188:191], v[236:239], v[76:79]
    v_mfma_f32_16x16x32_bf16 v[76:79], v[172:175], v[232:235], v[76:79]
    s_waitcnt vmcnt(12)
    v_mfma_f32_16x16x32_bf16 v[16:19], a[160:163], v[96:99], v[16:19]
    v_mfma_f32_16x16x32_bf16 v[16:19], a[176:179], v[100:103], v[16:19]
    global_load_dwordx4 v[224:227], v10, s[8:9] sc1
    v_mfma_f32_16x16x32_bf16 v[20:23], a[180:183], v[100:103], v[20:23]
    s_add_u32 s74, s8, 16384
    v_mfma_f32_16x16x32_bf16 v[20:23], a[164:167], v[96:99], v[20:23]
    s_addc_u32 s75, s9, 0
    v_mfma_f32_16x16x32_bf16 v[24:27], a[168:171], v[96:99], v[24:27]
    v_mfma_f32_16x16x32_bf16 v[24:27], a[184:187], v[100:103], v[24:27]
    global_load_dwordx4 v[232:235], v11, s[8:9] sc1
    v_mfma_f32_16x16x32_bf16 v[28:31], a[188:191], v[100:103], v[28:31]
    s_add_u32 s8, s76, 196608
    v_mfma_f32_16x16x32_bf16 v[28:31], a[172:175], v[96:99], v[28:31]
    s_addc_u32 s9, s77, 0
    v_mfma_f32_16x16x32_bf16 v[32:35], a[160:163], v[104:107], v[32:35]
    v_mfma_f32_16x16x32_bf16 v[32:35], a[176:179], v[108:111], v[32:35]
    global_load_dwordx4 v[228:231], v10, s[74:75] sc1
    v_mfma_f32_16x16x32_bf16 v[36:39], a[180:183], v[108:111], v[36:39]
    v_mfma_f32_16x16x32_bf16 v[36:39], a[164:167], v[104:107], v[36:39]
    v_mfma_f32_16x16x32_bf16 v[40:43], a[168:171], v[104:107], v[40:43]
    v_mfma_f32_16x16x32_bf16 v[40:43], a[184:187], v[108:111], v[40:43]
    global_load_dwordx4 v[236:239], v11, s[74:75] sc1
    v_mfma_f32_16x16x32_bf16 v[44:47], a[188:191], v[108:111], v[44:47]
    v_mfma_f32_16x16x32_bf16 v[44:47], a[172:175], v[104:107], v[44:47]
    s_waitcnt vmcnt(12)
    v_mfma_f32_16x16x32_bf16 v[16:19], a[128:131], v[112:115], v[16:19]
    v_mfma_f32_16x16x32_bf16 v[16:19], a[144:147], v[116:119], v[16:19]
    global_load_dwordx4 v[96:99], v10, s[8:9] sc1
    v_mfma_f32_16x16x32_bf16 v[20:23], a[148:151], v[116:119], v[20:23]
    s_add_u32 s74, s8, 16384
    v_mfma_f32_16x16x32_bf16 v[20:23], a[132:135], v[112:115], v[20:23]
    s_addc_u32 s75, s9, 0
    v_mfma_f32_16x16x32_bf16 v[24:27], a[136:139], v[112:115], v[24:27]
    v_mfma_f32_16x16x32_bf16 v[24:27], a[152:155], v[116:119], v[24:27]
    global_load_dwordx4 v[104:107], v11, s[8:9] sc1
    v_mfma_f32_16x16x32_bf16 v[28:31], a[156:159], v[116:119], v[28:31]
    s_add_u32 s8, s76, 229376
    v_mfma_f32_16x16x32_bf16 v[28:31], a[140:143], v[112:115], v[28:31]
    s_addc_u32 s9, s77, 0
    v_mfma_f32_16x16x32_bf16 v[32:35], a[128:131], v[120:123], v[32:35]
    v_mfma_f32_16x16x32_bf16 v[32:35], a[144:147], v[124:127], v[32:35]
    global_load_dwordx4 v[100:103], v10, s[74:75] sc1
    v_mfma_f32_16x16x32_bf16 v[36:39], a[148:151], v[124:127], v[36:39]
    v_mfma_f32_16x16x32_bf16 v[36:39], a[132:135], v[120:123], v[36:39]
    v_mfma_f32_16x16x32_bf16 v[40:43], a[136:139], v[120:123], v[40:43]
    v_mfma_f32_16x16x32_bf16 v[40:43], a[152:155], v[124:127], v[40:43]
    global_load_dwordx4 v[108:111], v11, s[74:75] sc1
    v_mfma_f32_16x16x32_bf16 v[44:47], a[156:159], v[124:127], v[44:47]
    v_mfma_f32_16x16x32_bf16 v[44:47], a[140:143], v[120:123], v[44:47]
    s_waitcnt vmcnt(12)
    v_mfma_f32_16x16x32_bf16 v[16:19], a[192:195], v[192:195], v[16:19]
    v_mfma_f32_16x16x32_bf16 v[16:19], a[208:211], v[196:199], v[16:19]
    global_load_dwordx4 v[112:115], v10, s[8:9] sc1
    v_mfma_f32_16x16x32_bf16 v[20:23], a[212:215], v[196:199], v[20:23]
    s_add_u32 s74, s8, 16384
    v_mfma_f32_16x16x32_bf16 v[20:23], a[196:199], v[192:195], v[20:23]
    s_addc_u32 s75, s9, 0
    v_mfma_f32_16x16x32_bf16 v[24:27], a[200:203], v[192:195], v[24:27]
    v_mfma_f32_16x16x32_bf16 v[24:27], a[216:219], v[196:199], v[24:27]
    global_load_dwordx4 v[120:123], v11, s[8:9] sc1
    v_mfma_f32_16x16x32_bf16 v[28:31], a[220:223], v[196:199], v[28:31]
    s_add_u32 s8, s76, 262144
    v_mfma_f32_16x16x32_bf16 v[28:31], a[204:207], v[192:195], v[28:31]
    s_addc_u32 s9, s77, 0
    v_mfma_f32_16x16x32_bf16 v[32:35], a[192:195], v[200:203], v[32:35]
    v_mfma_f32_16x16x32_bf16 v[32:35], a[208:211], v[204:207], v[32:35]
    global_load_dwordx4 v[116:119], v10, s[74:75] sc1
    v_mfma_f32_16x16x32_bf16 v[36:39], a[212:215], v[204:207], v[36:39]
    v_mfma_f32_16x16x32_bf16 v[36:39], a[196:199], v[200:203], v[36:39]
    v_mfma_f32_16x16x32_bf16 v[40:43], a[200:203], v[200:203], v[40:43]
    v_mfma_f32_16x16x32_bf16 v[40:43], a[216:219], v[204:207], v[40:43]
    global_load_dwordx4 v[124:127], v11, s[74:75] sc1
    v_mfma_f32_16x16x32_bf16 v[44:47], a[220:223], v[204:207], v[44:47]
    v_mfma_f32_16x16x32_bf16 v[44:47], a[204:207], v[200:203], v[44:47]
    s_waitcnt vmcnt(12)
    v_mfma_f32_16x16x32_bf16 v[16:19], a[224:227], v[208:211], v[16:19]
    s_barrier
    v_mfma_f32_16x16x32_bf16 v[16:19], a[240:243], v[212:215], v[16:19]
    s_and_b32 s14, s13, 0x10000
    global_load_dwordx4 v[192:195], v10, s[8:9] sc1
    v_mfma_f32_16x16x32_bf16 v[20:23], a[244:247], v[212:215], v[20:23]
    s_mov_b32 s28, s56
    v_mfma_f32_16x16x32_bf16 v[20:23], a[228:231], v[208:211], v[20:23]
    s_mov_b32 s29, s57
    v_mfma_f32_16x16x32_bf16 v[24:27], a[232:235], v[208:211], v[24:27]
    s_mov_b32 s30, 2097152
    v_mfma_f32_16x16x32_bf16 v[24:27], a[248:251], v[212:215], v[24:27]
    s_mov_b32 s31, 0x20000
    v_mfma_f32_16x16x32_bf16 v[28:31], a[252:255], v[212:215], v[28:31]
    s_lshl_b32 s34, s32, 2
    v_mfma_f32_16x16x32_bf16 v[28:31], a[236:239], v[208:211], v[28:31]
    s_add_u32 s34, s34, s58
    v_mfma_f32_16x16x32_bf16 v[32:35], a[224:227], v[216:219], v[32:35]
    s_lshl_b32 s34, s34, 14
    v_mfma_f32_16x16x32_bf16 v[32:35], a[240:243], v[220:223], v[32:35]
    s_lshl_b32 s35, s33, 7
    v_mfma_f32_16x16x32_bf16 v[36:39], a[244:247], v[220:223], v[36:39]
    s_add_u32 s34, s34, s35
    v_mfma_f32_16x16x32_bf16 v[36:39], a[228:231], v[216:219], v[36:39]
    s_add_u32 s74, s8, 16384
    v_mfma_f32_16x16x32_bf16 v[40:43], a[232:235], v[216:219], v[40:43]
    s_addc_u32 s75, s9, 0
    global_load_dwordx4 v[200:203], v11, s[8:9] sc1
    v_mfma_f32_16x16x32_bf16 v[40:43], a[248:251], v[220:223], v[40:43]
    s_add_u32 s8, s76, 294912
    v_mfma_f32_16x16x32_bf16 v[44:47], a[252:255], v[220:223], v[44:47]
    s_addc_u32 s9, s77, 0
    v_mfma_f32_16x16x32_bf16 v[44:47], a[236:239], v[216:219], v[44:47]
    global_load_dwordx4 v[196:199], v10, s[74:75] sc1
    global_load_dwordx4 v[204:207], v11, s[74:75] sc1
    s_waitcnt vmcnt(12)
    v_mfma_f32_16x16x32_bf16 v[48:51], a[160:163], v[224:227], v[48:51]
    v_mfma_f32_16x16x32_bf16 v[48:51], a[176:179], v[228:231], v[48:51]
    global_load_dwordx4 v[208:211], v8, s[8:9] sc1
    v_mfma_f32_16x16x32_bf16 v[52:55], a[180:183], v[228:231], v[52:55]
    s_add_u32 s74, s8, 16384
    v_mfma_f32_16x16x32_bf16 v[52:55], a[164:167], v[224:227], v[52:55]
    s_addc_u32 s75, s9, 0
    v_mfma_f32_16x16x32_bf16 v[56:59], a[168:171], v[224:227], v[56:59]
    v_mfma_f32_16x16x32_bf16 v[56:59], a[184:187], v[228:231], v[56:59]
    global_load_dwordx4 v[216:219], v9, s[8:9] sc1
    v_mfma_f32_16x16x32_bf16 v[60:63], a[188:191], v[228:231], v[60:63]
    s_add_u32 s8, s76, 327680
    v_mfma_f32_16x16x32_bf16 v[60:63], a[172:175], v[224:227], v[60:63]
    s_addc_u32 s9, s77, 0
    v_mfma_f32_16x16x32_bf16 v[64:67], a[160:163], v[232:235], v[64:67]
    v_mfma_f32_16x16x32_bf16 v[64:67], a[176:179], v[236:239], v[64:67]
    global_load_dwordx4 v[212:215], v8, s[74:75] sc1
    v_mfma_f32_16x16x32_bf16 v[68:71], a[180:183], v[236:239], v[68:71]
    v_mfma_f32_16x16x32_bf16 v[68:71], a[164:167], v[232:235], v[68:71]
    v_mfma_f32_16x16x32_bf16 v[72:75], a[168:171], v[232:235], v[72:75]
    v_mfma_f32_16x16x32_bf16 v[72:75], a[184:187], v[236:239], v[72:75]
    global_load_dwordx4 v[220:223], v9, s[74:75] sc1
    v_mfma_f32_16x16x32_bf16 v[76:79], a[188:191], v[236:239], v[76:79]
    v_mfma_f32_16x16x32_bf16 v[76:79], a[172:175], v[232:235], v[76:79]
    s_waitcnt vmcnt(12)
    v_mfma_f32_16x16x32_bf16 v[48:51], a[128:131], v[96:99], v[48:51]
    v_add_f32 v4, 1.0, v4
    v_bfe_u32 v3, v1, 4, 4
    v_mfma_f32_16x16x32_bf16 v[48:51], a[144:147], v[100:103], v[48:51]
    global_load_dwordx4 v[224:227], v8, s[8:9] sc1
    v_rcp_f32 v4, v4
    v_mfma_f32_16x16x32_bf16 v[52:55], a[148:151], v[100:103], v[52:55]
    s_add_u32 s74, s8, 16384
    v_lshrrev_b32 v5, 8, v1
    v_lshlrev_b32 v5, 4, v5
    v_mfma_f32_16x16x32_bf16 v[52:55], a[132:135], v[96:99], v[52:55]
    s_addc_u32 s75, s9, 0
    v_lshl_add_u32 v15, v3, 10, v5
    v_mul_u32_u24 v3, 11, v1
    v_mfma_f32_16x16x32_bf16 v[56:59], a[136:139], v[96:99], v[56:59]
    v_subrev_u32 v3, s14, v3
    v_mul_u32_u24 v80, 12, v8
    v_mfma_f32_16x16x32_bf16 v[56:59], a[152:155], v[100:103], v[56:59]
    global_load_dwordx4 v[232:235], v9, s[8:9] sc1
    v_sub_u32 v80, v80, v3
    v_mul_u32_u24 v81, 12, v9
    v_mfma_f32_16x16x32_bf16 v[60:63], a[156:159], v[100:103], v[60:63]
    s_add_u32 s8, s76, 294912
    v_sub_u32 v81, v81, v3
    v_mul_u32_u24 v82, 12, v10
    v_mfma_f32_16x16x32_bf16 v[60:63], a[140:143], v[96:99], v[60:63]
    s_addc_u32 s9, s77, 0
    v_sub_u32 v82, v82, v3
    v_mul_u32_u24 v83, 12, v11
    v_mfma_f32_16x16x32_bf16 v[64:67], a[128:131], v[104:107], v[64:67]
    v_sub_u32 v83, v83, v3
    v_mfma_f32_16x16x32_bf16 v[64:67], a[144:147], v[108:111], v[64:67]
    global_load_dwordx4 v[228:231], v8, s[74:75] sc1
    v_mfma_f32_16x16x32_bf16 v[68:71], a[148:151], v[108:111], v[68:71]
    v_mfma_f32_16x16x32_bf16 v[68:71], a[132:135], v[104:107], v[68:71]
L_wk13:
    s_cbranch_execz L_wkret
    v_mfma_f32_16x16x32_bf16 v[72:75], a[136:139], v[104:107], v[72:75]
    v_mfma_f32_16x16x32_bf16 v[72:75], a[152:155], v[108:111], v[72:75]
    global_load_dwordx4 v[236:239], v9, s[74:75] sc1
    v_mfma_f32_16x16x32_bf16 v[76:79], a[156:159], v[108:111], v[76:79]
    v_mfma_f32_16x16x32_bf16 v[76:79], a[140:143], v[104:107], v[76:79]
    s_waitcnt vmcnt(12)
    v_mfma_f32_16x16x32_bf16 v[48:51], a[192:195], v[112:115], v[48:51]
    v_mfma_f32_16x16x32_bf16 v[48:51], a[208:211], v[116:119], v[48:51]
    global_load_dwordx4 v[96:99], v10, s[8:9] sc1
    v_mfma_f32_16x16x32_bf16 v[52:55], a[212:215], v[116:119], v[52:55]
    s_add_u32 s74, s8, 16384
    ds_read_b128 a[64:67], v13 offset:49152
    v_mfma_f32_16x16x32_bf16 v[52:55], a[196:199], v[112:115], v[52:55]
    s_addc_u32 s75, s9, 0
    v_mfma_f32_16x16x32_bf16 v[56:59], a[200:203], v[112:115], v[56:59]
    v_mfma_f32_16x16x32_bf16 v[56:59], a[216:219], v[116:119], v[56:59]
    ds_read_b128 a[68:71], v13 offset:50176
    global_load_dwordx4 v[104:107], v11, s[8:9] sc1
    v_mfma_f32_16x16x32_bf16 v[60:63], a[220:223], v[116:119], v[60:63]
    s_add_u32 s8, s76, 327680
    v_mfma_f32_16x16x32_bf16 v[60:63], a[204:207], v[112:115], v[60:63]
    s_addc_u32 s9, s77, 0
    v_mfma_f32_16x16x32_bf16 v[64:67], a[192:195], v[120:123], v[64:67]
    v_mfma_f32_16x16x32_bf16 v[64:67], a[208:211], v[124:127], v[64:67]
    ds_read_b128 a[72:75], v13 offset:51200
    global_load_dwordx4 v[100:103], v10, s[74:75] sc1
    v_mfma_f32_16x16x32_bf16 v[68:71], a[212:215], v[124:127], v[68:71]
    v_mfma_f32_16x16x32_bf16 v[68:71], a[196:199], v[120:123], v[68:71]
    v_mfma_f32_16x16x32_bf16 v[72:75], a[200:203], v[120:123], v[72:75]
    ds_read_b128 a[76:79], v13 offset:52224
    v_mfma_f32_16x16x32_bf16 v[72:75], a[216:219], v[124:127], v[72:75]
    global_load_dwordx4 v[108:111], v11, s[74:75] sc1
    v_mfma_f32_16x16x32_bf16 v[76:79], a[220:223], v[124:127], v[76:79]
    v_mfma_f32_16x16x32_bf16 v[76:79], a[204:207], v[120:123], v[76:79]
    s_waitcnt vmcnt(12)
    v_mfma_f32_16x16x32_bf16 v[48:51], a[224:227], v[192:195], v[48:51]
    v_mfma_f32_16x16x32_bf16 v[48:51], a[240:243], v[196:199], v[48:51]
    global_load_dwordx4 v[112:115], v10, s[8:9] sc1
    v_mfma_f32_16x16x32_bf16 v[52:55], a[244:247], v[196:199], v[52:55]
    s_add_u32 s74, s8, 16384
    ds_read_b128 a[80:83], v12 offset:0
    v_mfma_f32_16x16x32_bf16 v[52:55], a[228:231], v[192:195], v[52:55]
    s_addc_u32 s75, s9, 0
    v_mfma_f32_16x16x32_bf16 v[56:59], a[232:235], v[192:195], v[56:59]
    v_mfma_f32_16x16x32_bf16 v[56:59], a[248:251], v[196:199], v[56:59]
    ds_read_b128 a[84:87], v12 offset:1024
    global_load_dwordx4 v[120:123], v11, s[8:9] sc1
    v_mfma_f32_16x16x32_bf16 v[60:63], a[252:255], v[196:199], v[60:63]
    s_add_u32 s8, s76, 360448
    v_mfma_f32_16x16x32_bf16 v[60:63], a[236:239], v[192:195], v[60:63]
    s_addc_u32 s9, s77, 0
    v_mfma_f32_16x16x32_bf16 v[64:67], a[224:227], v[200:203], v[64:67]
    v_mfma_f32_16x16x32_bf16 v[64:67], a[240:243], v[204:207], v[64:67]
    ds_read_b128 a[88:91], v12 offset:2048
    global_load_dwordx4 v[116:119], v10, s[74:75] sc1
    v_mfma_f32_16x16x32_bf16 v[68:71], a[244:247], v[204:207], v[68:71]
    v_mfma_f32_16x16x32_bf16 v[68:71], a[228:231], v[200:203], v[68:71]
    v_mfma_f32_16x16x32_bf16 v[72:75], a[232:235], v[200:203], v[72:75]
    ds_read_b128 a[92:95], v12 offset:3072
    v_mfma_f32_16x16x32_bf16 v[72:75], a[248:251], v[204:207], v[72:75]
    global_load_dwordx4 v[124:127], v11, s[74:75] sc1
    v_mfma_f32_16x16x32_bf16 v[76:79], a[252:255], v[204:207], v[76:79]
    v_mfma_f32_16x16x32_bf16 v[76:79], a[236:239], v[200:203], v[76:79]
    s_waitcnt vmcnt(12)
    v_mfma_f32_16x16x32_bf16 v[16:19], v[240:243], v[208:211], v[16:19]
    v_mfma_f32_16x16x32_bf16 v[16:19], v[128:131], v[212:215], v[16:19]
    global_load_dwordx4 v[192:195], v9, s[8:9] sc1
    v_mfma_f32_16x16x32_bf16 v[20:23], v[132:135], v[212:215], v[20:23]
    s_add_u32 s68, s8, 16384
    ds_read_b128 a[96:99], v12 offset:16384
    v_mfma_f32_16x16x32_bf16 v[20:23], v[244:247], v[208:211], v[20:23]
    s_addc_u32 s69, s9, 0
    v_mfma_f32_16x16x32_bf16 v[24:27], v[248:251], v[208:211], v[24:27]
    v_mfma_f32_16x16x32_bf16 v[24:27], v[136:139], v[212:215], v[24:27]
    ds_read_b128 a[100:103], v12 offset:17408
    global_load_dwordx4 v[196:199], v9, s[68:69] sc1
    v_mfma_f32_16x16x32_bf16 v[28:31], v[140:143], v[212:215], v[28:31]
    s_add_u32 s70, s8, 32768
    v_mfma_f32_16x16x32_bf16 v[28:31], v[252:255], v[208:211], v[28:31]
    s_addc_u32 s71, s9, 0
    v_mfma_f32_16x16x32_bf16 v[32:35], v[240:243], v[216:219], v[32:35]
    v_mfma_f32_16x16x32_bf16 v[32:35], v[128:131], v[220:223], v[32:35]
    ds_read_b128 a[104:107], v12 offset:18432
    global_load_dwordx4 v[200:203], v9, s[70:71] sc1
    v_mfma_f32_16x16x32_bf16 v[36:39], v[132:135], v[220:223], v[36:39]
    s_add_u32 s72, s8, 49152
    v_mfma_f32_16x16x32_bf16 v[36:39], v[244:247], v[216:219], v[36:39]
    s_addc_u32 s73, s9, 0
    v_mfma_f32_16x16x32_bf16 v[40:43], v[248:251], v[216:219], v[40:43]
    ds_read_b128 a[108:111], v12 offset:19456
    v_mfma_f32_16x16x32_bf16 v[40:43], v[136:139], v[220:223], v[40:43]
    global_load_dwordx4 v[204:207], v9, s[72:73] sc1
    v_mfma_f32_16x16x32_bf16 v[44:47], v[140:143], v[220:223], v[44:47]
    v_mfma_f32_16x16x32_bf16 v[44:47], v[252:255], v[216:219], v[44:47]
    s_waitcnt vmcnt(12)
    v_mfma_f32_16x16x32_bf16 v[16:19], v[144:147], v[224:227], v[16:19]
    v_mfma_f32_16x16x32_bf16 v[16:19], a[16:19], v[228:231], v[16:19]
    global_load_dwordx4 v[208:211], v10, s[8:9] sc1
    v_mfma_f32_16x16x32_bf16 v[20:23], a[20:23], v[228:231], v[20:23]
    ds_read_b128 a[112:115], v12 offset:32768
    v_mfma_f32_16x16x32_bf16 v[20:23], v[148:151], v[224:227], v[20:23]
    v_mfma_f32_16x16x32_bf16 v[24:27], v[152:155], v[224:227], v[24:27]
    v_mfma_f32_16x16x32_bf16 v[24:27], a[24:27], v[228:231], v[24:27]
    ds_read_b128 a[116:119], v12 offset:33792
    global_load_dwordx4 v[212:215], v10, s[68:69] sc1
    v_mfma_f32_16x16x32_bf16 v[28:31], a[28:31], v[228:231], v[28:31]
    v_mfma_f32_16x16x32_bf16 v[28:31], v[156:159], v[224:227], v[28:31]
    v_mfma_f32_16x16x32_bf16 v[32:35], v[144:147], v[232:235], v[32:35]
    v_mfma_f32_16x16x32_bf16 v[32:35], a[16:19], v[236:239], v[32:35]
    ds_read_b128 a[120:123], v12 offset:34816
    global_load_dwordx4 v[216:219], v10, s[70:71] sc1
    v_mfma_f32_16x16x32_bf16 v[36:39], a[20:23], v[236:239], v[36:39]
    v_mfma_f32_16x16x32_bf16 v[36:39], v[148:151], v[232:235], v[36:39]
    v_mfma_f32_16x16x32_bf16 v[40:43], v[152:155], v[232:235], v[40:43]
    ds_read_b128 a[124:127], v12 offset:35840
    v_mfma_f32_16x16x32_bf16 v[40:43], a[24:27], v[236:239], v[40:43]
    global_load_dwordx4 v[220:223], v10, s[72:73] sc1
    v_mfma_f32_16x16x32_bf16 v[44:47], a[28:31], v[236:239], v[44:47]
    v_mfma_f32_16x16x32_bf16 v[44:47], v[156:159], v[232:235], v[44:47]
    s_waitcnt vmcnt(12)
    v_mfma_f32_16x16x32_bf16 v[48:51], v[240:243], v[96:99], v[48:51]
    v_mfma_f32_16x16x32_bf16 v[48:51], v[128:131], v[100:103], v[48:51]
    global_load_dwordx4 v[224:227], v11, s[8:9] sc1
    v_mfma_f32_16x16x32_bf16 v[52:55], v[132:135], v[100:103], v[52:55]
    v_mfma_f32_16x16x32_bf16 v[52:55], v[244:247], v[96:99], v[52:55]
    v_mfma_f32_16x16x32_bf16 v[56:59], v[248:251], v[96:99], v[56:59]
    v_mfma_f32_16x16x32_bf16 v[56:59], v[136:139], v[100:103], v[56:59]
    global_load_dwordx4 v[228:231], v11, s[68:69] sc1
    v_mfma_f32_16x16x32_bf16 v[60:63], v[140:143], v[100:103], v[60:63]
    v_mfma_f32_16x16x32_bf16 v[60:63], v[252:255], v[96:99], v[60:63]
    v_mfma_f32_16x16x32_bf16 v[64:67], v[240:243], v[104:107], v[64:67]
    v_mfma_f32_16x16x32_bf16 v[64:67], v[128:131], v[108:111], v[64:67]
    global_load_dwordx4 v[232:235], v11, s[70:71] sc1
    v_mfma_f32_16x16x32_bf16 v[68:71], v[132:135], v[108:111], v[68:71]
    v_mfma_f32_16x16x32_bf16 v[68:71], v[244:247], v[104:107], v[68:71]
    v_mfma_f32_16x16x32_bf16 v[72:75], v[248:251], v[104:107], v[72:75]
    v_mfma_f32_16x16x32_bf16 v[72:75], v[136:139], v[108:111], v[72:75]
    global_load_dwordx4 v[236:239], v11, s[72:73] sc1
    v_mfma_f32_16x16x32_bf16 v[76:79], v[140:143], v[108:111], v[76:79]
    v_mfma_f32_16x16x32_bf16 v[76:79], v[252:255], v[104:107], v[76:79]
    s_waitcnt vmcnt(12)
    v_mfma_f32_16x16x32_bf16 v[48:51], v[144:147], v[112:115], v[48:51]
    v_mfma_f32_16x16x32_bf16 v[48:51], a[16:19], v[116:119], v[48:51]
    global_load_dwordx4 v[96:99], v8, s[8:9] sc1
    v_mfma_f32_16x16x32_bf16 v[52:55], a[20:23], v[116:119], v[52:55]
    v_mfma_f32_16x16x32_bf16 v[52:55], v[148:151], v[112:115], v[52:55]
    v_mfma_f32_16x16x32_bf16 v[56:59], v[152:155], v[112:115], v[56:59]
    v_mfma_f32_16x16x32_bf16 v[56:59], a[24:27], v[116:119], v[56:59]
    global_load_dwordx4 v[100:103], v8, s[68:69] sc1
    v_mfma_f32_16x16x32_bf16 v[60:63], a[28:31], v[116:119], v[60:63]
    v_mfma_f32_16x16x32_bf16 v[60:63], v[156:159], v[112:115], v[60:63]
    v_mfma_f32_16x16x32_bf16 v[64:67], v[144:147], v[120:123], v[64:67]
    v_mfma_f32_16x16x32_bf16 v[64:67], a[16:19], v[124:127], v[64:67]
    global_load_dwordx4 v[104:107], v8, s[70:71] sc1
    v_mfma_f32_16x16x32_bf16 v[68:71], a[20:23], v[124:127], v[68:71]
    v_mfma_f32_16x16x32_bf16 v[68:71], v[148:151], v[120:123], v[68:71]
    v_mfma_f32_16x16x32_bf16 v[72:75], v[152:155], v[120:123], v[72:75]
    v_mfma_f32_16x16x32_bf16 v[72:75], a[24:27], v[124:127], v[72:75]
    global_load_dwordx4 v[108:111], v8, s[72:73] sc1
    v_mfma_f32_16x16x32_bf16 v[76:79], a[28:31], v[124:127], v[76:79]
    v_mfma_f32_16x16x32_bf16 v[76:79], v[156:159], v[120:123], v[76:79]
    s_waitcnt vmcnt(12) lgkmcnt(0)
    v_mfma_f32_16x16x32_bf16 v[32:35], a[64:67], v[192:195], v[32:35]
    v_mfma_f32_16x16x32_bf16 v[32:35], a[80:83], v[196:199], v[32:35]
    v_mfma_f32_16x16x32_bf16 v[32:35], a[96:99], v[200:203], v[32:35]
    v_mfma_f32_16x16x32_bf16 v[32:35], a[112:115], v[204:207], v[32:35]
    v_mfma_f32_16x16x32_bf16 v[36:39], a[68:71], v[192:195], v[36:39]
    v_mfma_f32_16x16x32_bf16 v[36:39], a[84:87], v[196:199], v[36:39]
    v_mfma_f32_16x16x32_bf16 v[36:39], a[100:103], v[200:203], v[36:39]
    v_mfma_f32_16x16x32_bf16 v[36:39], a[116:119], v[204:207], v[36:39]
    v_mfma_f32_16x16x32_bf16 v[40:43], a[72:75], v[192:195], v[40:43]
    v_mfma_f32_16x16x32_bf16 v[40:43], a[88:91], v[196:199], v[40:43]
    v_mfma_f32_16x16x32_bf16 v[40:43], a[104:107], v[200:203], v[40:43]
    v_mfma_f32_16x16x32_bf16 v[40:43], a[120:123], v[204:207], v[40:43]
    v_mfma_f32_16x16x32_bf16 v[44:47], a[76:79], v[192:195], v[44:47]
    v_mfma_f32_16x16x32_bf16 v[44:47], a[92:95], v[196:199], v[44:47]
    v_mfma_f32_16x16x32_bf16 v[44:47], a[108:111], v[200:203], v[44:47]
    v_mfma_f32_16x16x32_bf16 v[44:47], a[124:127], v[204:207], v[44:47]
    s_waitcnt vmcnt(8)
    v_mfma_f32_16x16x32_bf16 v[48:51], a[64:67], v[208:211], v[48:51]
    v_mfma_f32_16x16x32_bf16 v[48:51], a[80:83], v[212:215], v[48:51]
    ds_write_b128 v81, v[32:35] offset:0
    v_mfma_f32_16x16x32_bf16 v[48:51], a[96:99], v[216:219], v[48:51]
    v_mfma_f32_16x16x32_bf16 v[48:51], a[112:115], v[220:223], v[48:51]
    v_mfma_f32_16x16x32_bf16 v[52:55], a[68:71], v[208:211], v[52:55]
    v_mfma_f32_16x16x32_bf16 v[52:55], a[84:87], v[212:215], v[52:55]
    ds_write_b128 v81, v[36:39] offset:1024
    v_mfma_f32_16x16x32_bf16 v[52:55], a[100:103], v[216:219], v[52:55]
    v_mfma_f32_16x16x32_bf16 v[52:55], a[116:119], v[220:223], v[52:55]
    v_mfma_f32_16x16x32_bf16 v[56:59], a[72:75], v[208:211], v[56:59]
    v_mfma_f32_16x16x32_bf16 v[56:59], a[88:91], v[212:215], v[56:59]
    ds_write_b128 v81, v[40:43] offset:2048
    v_mfma_f32_16x16x32_bf16 v[56:59], a[104:107], v[216:219], v[56:59]
    v_mfma_f32_16x16x32_bf16 v[56:59], a[120:123], v[220:223], v[56:59]
    v_mfma_f32_16x16x32_bf16 v[60:63], a[76:79], v[208:211], v[60:63]
    v_mfma_f32_16x16x32_bf16 v[60:63], a[92:95], v[212:215], v[60:63]
    ds_write_b128 v81, v[44:47] offset:3072
    v_mfma_f32_16x16x32_bf16 v[60:63], a[108:111], v[216:219], v[60:63]
    v_mfma_f32_16x16x32_bf16 v[60:63], a[124:127], v[220:223], v[60:63]
    s_waitcnt vmcnt(4)
    v_mfma_f32_16x16x32_bf16 v[64:67], a[64:67], v[224:227], v[64:67]
    v_mfma_f32_16x16x32_bf16 v[64:67], a[80:83], v[228:231], v[64:67]
    ds_write_b128 v82, v[48:51] offset:4096
    v_mfma_f32_16x16x32_bf16 v[64:67], a[96:99], v[232:235], v[64:67]
    v_mfma_f32_16x16x32_bf16 v[64:67], a[112:115], v[236:239], v[64:67]
    v_mfma_f32_16x16x32_bf16 v[68:71], a[68:71], v[224:227], v[68:71]
    v_mfma_f32_16x16x32_bf16 v[68:71], a[84:87], v[228:231], v[68:71]
    ds_write_b128 v82, v[52:55] offset:5120
    v_mfma_f32_16x16x32_bf16 v[68:71], a[100:103], v[232:235], v[68:71]
    v_mfma_f32_16x16x32_bf16 v[68:71], a[116:119], v[236:239], v[68:71]
    v_mfma_f32_16x16x32_bf16 v[72:75], a[72:75], v[224:227], v[72:75]
    v_mfma_f32_16x16x32_bf16 v[72:75], a[88:91], v[228:231], v[72:75]
    ds_write_b128 v82, v[56:59] offset:6144
    v_mfma_f32_16x16x32_bf16 v[72:75], a[104:107], v[232:235], v[72:75]
    v_mfma_f32_16x16x32_bf16 v[72:75], a[120:123], v[236:239], v[72:75]
    v_mfma_f32_16x16x32_bf16 v[76:79], a[76:79], v[224:227], v[76:79]
    v_mfma_f32_16x16x32_bf16 v[76:79], a[92:95], v[228:231], v[76:79]
    ds_write_b128 v82, v[60:63] offset:7168
    v_mfma_f32_16x16x32_bf16 v[76:79], a[108:111], v[232:235], v[76:79]
    v_mfma_f32_16x16x32_bf16 v[76:79], a[124:127], v[236:239], v[76:79]
    s_waitcnt vmcnt(0)
    v_mfma_f32_16x16x32_bf16 v[16:19], a[64:67], v[96:99], v[16:19]
    ds_write_b128 v83, v[64:67] offset:8192
    v_mfma_f32_16x16x32_bf16 v[16:19], a[80:83], v[100:103], v[16:19]
    v_mfma_f32_16x16x32_bf16 v[16:19], a[96:99], v[104:107], v[16:19]
    ds_write_b128 v83, v[68:71] offset:9216
    v_mfma_f32_16x16x32_bf16 v[16:19], a[112:115], v[108:111], v[16:19]
    v_mfma_f32_16x16x32_bf16 v[20:23], a[68:71], v[96:99], v[20:23]
    ds_write_b128 v83, v[72:75] offset:10240
    v_mfma_f32_16x16x32_bf16 v[20:23], a[84:87], v[100:103], v[20:23]
    s_waitcnt lgkmcnt(3)
    v_mfma_f32_16x16x32_bf16 v[20:23], a[100:103], v[104:107], v[20:23]
    s_barrier
    v_mfma_f32_16x16x32_bf16 v[20:23], a[116:119], v[108:111], v[20:23]
    ds_write_b128 v83, v[76:79] offset:11264
    v_mfma_f32_16x16x32_bf16 v[24:27], a[72:75], v[96:99], v[24:27]
    ds_read_b128 v[32:35], v80 offset:0
    v_mfma_f32_16x16x32_bf16 v[24:27], a[88:91], v[100:103], v[24:27]
    ds_read_b128 v[36:39], v80 offset:1024
    v_mfma_f32_16x16x32_bf16 v[24:27], a[104:107], v[104:107], v[24:27]
    ds_read_b128 v[40:43], v80 offset:2048
    v_mfma_f32_16x16x32_bf16 v[24:27], a[120:123], v[108:111], v[24:27]
    ds_read_b128 v[44:47], v80 offset:3072
    v_mfma_f32_16x16x32_bf16 v[28:31], a[76:79], v[96:99], v[28:31]
    ds_read_b128 v[48:51], v80 offset:4096
    v_mfma_f32_16x16x32_bf16 v[28:31], a[92:95], v[100:103], v[28:31]
    ds_read_b128 v[52:55], v80 offset:5120
    v_mfma_f32_16x16x32_bf16 v[28:31], a[108:111], v[104:107], v[28:31]
    ds_read_b128 v[56:59], v80 offset:6144
    v_mfma_f32_16x16x32_bf16 v[28:31], a[124:127], v[108:111], v[28:31]
    ds_read_b128 v[60:63], v80 offset:7168
    s_waitcnt lgkmcnt(8)
    s_barrier
    ds_read_b128 v[64:67], v80 offset:8192
    ds_read_b128 v[68:71], v80 offset:9216
    ds_read_b128 v[72:75], v80 offset:10240
    ds_read_b128 v[76:79], v80 offset:11264
    s_waitcnt lgkmcnt(4)
    v_pk_add_f32 v[32:33], v[32:33], v[48:49]
    v_pk_add_f32 v[34:35], v[34:35], v[50:51]
    v_pk_add_f32 v[36:37], v[36:37], v[52:53]
    v_pk_add_f32 v[38:39], v[38:39], v[54:55]
    v_pk_add_f32 v[40:41], v[40:41], v[56:57]
    v_pk_add_f32 v[42:43], v[42:43], v[58:59]
    v_pk_add_f32 v[44:45], v[44:45], v[60:61]
    v_pk_add_f32 v[46:47], v[46:47], v[62:63]
    v_pk_add_f32 v[16:17], v[16:17], v[32:33]
    v_pk_add_f32 v[18:19], v[18:19], v[34:35]
    v_pk_add_f32 v[20:21], v[20:21], v[36:37]
    v_pk_add_f32 v[22:23], v[22:23], v[38:39]
    v_pk_add_f32 v[24:25], v[24:25], v[40:41]
    v_pk_add_f32 v[26:27], v[26:27], v[42:43]
    v_pk_add_f32 v[28:29], v[28:29], v[44:45]
    v_pk_add_f32 v[30:31], v[30:31], v[46:47]
    s_waitcnt lgkmcnt(2)
    v_pk_add_f32 v[16:17], v[16:17], v[64:65]
    v_pk_add_f32 v[18:19], v[18:19], v[66:67]
    v_pk_add_f32 v[20:21], v[20:21], v[68:69]
    v_pk_add_f32 v[22:23], v[22:23], v[70:71]
    v_pk_mul_f32 v[16:17], v[16:17], v[4:5] op_sel_hi:[1,0]
    v_pk_mul_f32 v[18:19], v[18:19], v[4:5] op_sel_hi:[1,0]
    v_pk_mul_f32 v[20:21], v[20:21], v[4:5] op_sel_hi:[1,0]
    v_pk_mul_f32 v[22:23], v[22:23], v[4:5] op_sel_hi:[1,0]
    v_cvt_pk_bf16_f32 v16, v16, v17
    v_cvt_pk_bf16_f32 v17, v18, v19
    v_cvt_pk_bf16_f32 v18, v20, v21
    v_cvt_pk_bf16_f32 v19, v22, v23
    buffer_store_dwordx4 v[16:19], v15, s[28:31], s34 offen offset:0
    s_waitcnt lgkmcnt(0)
    v_pk_add_f32 v[24:25], v[24:25], v[72:73]
    v_pk_add_f32 v[26:27], v[26:27], v[74:75]
    v_pk_add_f32 v[28:29], v[28:29], v[76:77]
    v_pk_add_f32 v[30:31], v[30:31], v[78:79]
    v_pk_mul_f32 v[24:25], v[24:25], v[4:5] op_sel_hi:[1,0]
    v_pk_mul_f32 v[26:27], v[26:27], v[4:5] op_sel_hi:[1,0]
    v_pk_mul_f32 v[28:29], v[28:29], v[4:5] op_sel_hi:[1,0]
    v_pk_mul_f32 v[30:31], v[30:31], v[4:5] op_sel_hi:[1,0]
    v_cvt_pk_bf16_f32 v24, v24, v25
    v_cvt_pk_bf16_f32 v25, v26, v27
    v_cvt_pk_bf16_f32 v26, v28, v29
    v_cvt_pk_bf16_f32 v27, v30, v31
    buffer_store_dwordx4 v[24:27], v15, s[28:31], s34 offen offset:64
L_A_end:
    s_endpgm
L_e0_slow:
    s_mov_b32 s35, 0
L_e0_lp:
    s_mov_b64 exec, vcc
    buffer_load_dword v23, off, s[28:31], 0 sc1
    s_add_u32 s35, s35, 1
    s_cmp_ge_u32 s35, 0x40000
    s_waitcnt vmcnt(0)
    s_cbranch_scc1 L_e0_out
    v_cmp_gt_u32 vcc, 0x100, v23
    s_nop 1
    s_cbranch_vccnz L_e0_lp
L_e0_out:
    s_mov_b64 exec, -1
    s_nop 3
    s_branch L_e0_ok
L_e1_slow:
    s_mov_b32 s35, 0
L_e1_lp:
    s_mov_b64 exec, vcc
    global_load_dword v19, v18, s[44:45] sc1
    s_add_u32 s35, s35, 1
    s_cmp_ge_u32 s35, 0x40000
    s_waitcnt vmcnt(0)
    s_cbranch_scc1 L_e1_out
    v_cmp_gt_u32 vcc, 0x100, v19
    s_nop 1
    s_cbranch_vccnz L_e1_lp
L_e1_out:
    s_mov_b64 exec, -1
    s_nop 3
    s_branch L_e1_ok
L_s1_wb:
    buffer_wbl2 sc1
    s_waitcnt vmcnt(0)
    s_branch L_s1_pub
L_s2_wb:
    buffer_wbl2 sc1
    s_waitcnt vmcnt(0)
    s_branch L_s2_pub
L_ev0_slow:
    s_mov_b32 s35, 0
L_ev0_lp:
    global_load_dword v4, v5, s[44:45] sc1
    global_load_dword v9, v0, s[44:45] sc1
    s_add_u32 s35, s35, 1
    s_cmp_ge_u32 s35, 0x40000
    s_waitcnt vmcnt(0)
    s_cbranch_scc1 L_ev0_a
    v_min_u32 v4, v4, v9
    v_cmp_gt_u32 vcc, 0x200, v4
    s_nop 1
    s_cbranch_vccnz L_ev0_lp
    s_branch L_ev0_a
L_ev1_slow:
    s_mov_b32 s35, 0
L_ev1_lp:
    global_load_dword v4, v5, s[44:45] sc1
    global_load_dword v9, v0, s[44:45] sc1
    s_add_u32 s35, s35, 1
    s_cmp_ge_u32 s35, 0x40000
    s_waitcnt vmcnt(0)
    s_cbranch_scc1 L_ev1_a
    v_min_u32 v4, v4, v9
    v_cmp_gt_u32 vcc, 0x200, v4
    s_nop 1
    s_cbranch_vccnz L_ev1_lp
    s_branch L_ev1_a
L_att_d0p:
    s_lshl_b32 s59, s3, 12
    s_add_u32 s59, s59, 131072
    s_add_u32 s10, s16, 131072
    s_addc_u32 s11, s17, 0
    v_cndmask_b32_e64 v8, v7, v40, s[64:65]
    v_cndmask_b32_e64 v9, v7, v40, s[66:67]
    v_cndmask_b32_e64 v10, v7, v40, s[68:69]
    v_cndmask_b32_e64 v11, v7, v40, s[70:71]
    v_cndmask_b32_e64 v12, v7, v40, s[72:73]
    v_cndmask_b32_e64 v13, v7, v40, s[74:75]
    v_cndmask_b32_e64 v14, v7, v40, s[76:77]
    v_cndmask_b32_e64 v15, v7, v40, s[78:79]
    v_mfma_f32_16x16x32_bf16 v[24:27], a[128:131], v[64:67], v[8:11]
    v_exp_f32 v16, v16
    v_mfma_f32_16x16x32_bf16 v[24:27], a[132:135], v[68:71], v[24:27]
    s_add_u32 s62, m0, 16384
    global_load_lds_dwordx4 v1, s[14:15] offset:0 sc1
    v_exp_f32 v17, v17
    v_mfma_f32_16x16x32_bf16 v[24:27], a[136:139], v[72:75], v[24:27]
    s_and_b32 s62, s62, 0x1ffff
    ds_read_b128 a[160:163], v2 offset:0
    v_add_f32 v62, v62, v16
    v_mfma_f32_16x16x32_bf16 v[24:27], a[140:143], v[76:79], v[24:27]
    s_add_u32 s98, s62, 16384
    v_exp_f32 v18, v18
    v_mfma_f32_16x16x32_bf16 v[28:31], a[144:147], v[64:67], v[12:15]
    s_and_b32 s98, s98, 0x1ffff
    v_add_f32 v63, v63, v17
    v_cvt_pk_bf16_f32 v32, v16, v17
    v_mfma_f32_16x16x32_bf16 v[28:31], a[148:151], v[68:71], v[28:31]
    s_add_u32 s96, s96, 32768
    global_load_lds_dwordx4 v1, s[14:15] offset:1024 sc1
    v_exp_f32 v19, v19
    v_mfma_f32_16x16x32_bf16 v[28:31], a[152:155], v[72:75], v[28:31]
    s_and_b32 s96, s96, 0x1ffff
    ds_read_b128 a[164:167], v2 offset:1024
    v_add_f32 v62, v62, v18
    v_mfma_f32_16x16x32_bf16 v[28:31], a[156:159], v[76:79], v[28:31]
    s_add_u32 s18, s14, 32768
    v_exp_f32 v20, v20
    v_mfma_f32_16x16x32_bf16 v[192:195], a[224:227], v[36:39], v[192:195]
    s_addc_u32 s19, s15, 0
    v_add_f32 v63, v63, v19
    v_cvt_pk_bf16_f32 v33, v18, v19
    v_mfma_f32_16x16x32_bf16 v[196:199], a[228:231], v[36:39], v[196:199]
    s_sub_u32 s97, s97, 1
    global_load_lds_dwordx4 v1, s[14:15] offset:2048 sc1
    v_exp_f32 v21, v21
    v_mfma_f32_16x16x32_bf16 v[200:203], a[232:235], v[36:39], v[200:203]
    s_cmp_eq_u32 s97, 0
    ds_read_b128 a[168:171], v2 offset:2048
    v_add_f32 v62, v62, v20
    v_mfma_f32_16x16x32_bf16 v[204:207], a[236:239], v[36:39], v[204:207]
    s_cselect_b64 s[18:19], s[16:17], s[18:19]
    v_exp_f32 v22, v22
    v_mfma_f32_16x16x32_bf16 v[208:211], a[240:243], v[36:39], v[208:211]
    v_add_f32 v63, v63, v21
    v_cvt_pk_bf16_f32 v34, v20, v21
    v_mfma_f32_16x16x32_bf16 v[212:215], a[244:247], v[36:39], v[212:215]
    global_load_lds_dwordx4 v1, s[14:15] offset:3072 sc1
    v_exp_f32 v23, v23
    v_mfma_f32_16x16x32_bf16 v[216:219], a[248:251], v[36:39], v[216:219]
    s_mov_b32 m0, s62
    ds_read_b128 a[172:175], v2 offset:3072
    v_add_f32 v62, v62, v22
    v_mfma_f32_16x16x32_bf16 v[220:223], a[252:255], v[36:39], v[220:223]
    v_add_f32 v63, v63, v23
    v_cvt_pk_bf16_f32 v35, v22, v23
    v_mfma_f32_16x16x32_bf16 v[16:19], a[128:131], v[80:83], v[44:47]
    v_exp_f32 v24, v24
    v_mfma_f32_16x16x32_bf16 v[16:19], a[132:135], v[84:87], v[16:19]
    global_load_lds_dwordx4 v3, s[14:15] offset:0 sc1
    v_exp_f32 v25, v25
    v_mfma_f32_16x16x32_bf16 v[16:19], a[136:139], v[88:91], v[16:19]
    ds_read_b128 a[176:179], v2 offset:4096
    v_add_f32 v56, v56, v24
    v_mfma_f32_16x16x32_bf16 v[16:19], a[140:143], v[92:95], v[16:19]
    v_exp_f32 v26, v26
    v_mfma_f32_16x16x32_bf16 v[20:23], a[144:147], v[80:83], v[44:47]
    v_add_f32 v57, v57, v25
    v_cvt_pk_bf16_f32 v36, v24, v25
    v_mfma_f32_16x16x32_bf16 v[20:23], a[148:151], v[84:87], v[20:23]
    global_load_lds_dwordx4 v3, s[14:15] offset:1024 sc1
    v_exp_f32 v27, v27
    v_mfma_f32_16x16x32_bf16 v[20:23], a[152:155], v[88:91], v[20:23]
    ds_read_b128 a[180:183], v2 offset:5120
    v_add_f32 v56, v56, v26
    v_mfma_f32_16x16x32_bf16 v[20:23], a[156:159], v[92:95], v[20:23]
    s_waitcnt lgkmcnt(2)
    v_exp_f32 v28, v28
    v_mfma_f32_16x16x32_bf16 v[224:227], a[192:195], v[32:35], v[224:227]
    v_add_f32 v57, v57, v27
    v_cvt_pk_bf16_f32 v37, v26, v27
    v_mfma_f32_16x16x32_bf16 v[228:231], a[196:199], v[32:35], v[228:231]
    global_load_lds_dwordx4 v3, s[14:15] offset:2048 sc1
    v_exp_f32 v29, v29
    v_mfma_f32_16x16x32_bf16 v[232:235], a[200:203], v[32:35], v[232:235]
    ds_read_b128 a[184:187], v2 offset:6144
    v_add_f32 v56, v56, v28
    v_mfma_f32_16x16x32_bf16 v[236:239], a[204:207], v[32:35], v[236:239]
    v_exp_f32 v30, v30
    v_mfma_f32_16x16x32_bf16 v[240:243], a[208:211], v[32:35], v[240:243]
    v_add_f32 v57, v57, v29
    v_cvt_pk_bf16_f32 v38, v28, v29
    v_mfma_f32_16x16x32_bf16 v[244:247], a[212:215], v[32:35], v[244:247]
    global_load_lds_dwordx4 v3, s[14:15] offset:3072 sc1
    v_exp_f32 v31, v31
    v_mfma_f32_16x16x32_bf16 v[248:251], a[216:219], v[32:35], v[248:251]
    s_mov_b32 m0, s98
    ds_read_b128 a[188:191], v2 offset:7168
    v_add_f32 v56, v56, v30
    v_mfma_f32_16x16x32_bf16 v[252:255], a[220:223], v[32:35], v[252:255]
    s_mov_b64 s[14:15], s[18:19]
    v_add_f32 v57, v57, v31
    v_cvt_pk_bf16_f32 v39, v30, v31
    v_mfma_f32_16x16x32_bf16 v[24:27], a[128:131], v[96:99], v[48:51]
    v_exp_f32 v16, v16
    v_mfma_f32_16x16x32_bf16 v[24:27], a[132:135], v[100:103], v[24:27]
    global_load_dwordx4 a[16:19], v1, s[6:7] offset:0 sc1
    v_exp_f32 v17, v17
    v_mfma_f32_16x16x32_bf16 v[24:27], a[136:139], v[104:107], v[24:27]
    ds_read_b128 a[224:227], v2 offset:8192
    v_add_f32 v58, v58, v16
    v_mfma_f32_16x16x32_bf16 v[24:27], a[140:143], v[108:111], v[24:27]
    v_exp_f32 v18, v18
    v_mfma_f32_16x16x32_bf16 v[28:31], a[144:147], v[96:99], v[48:51]
    v_add_f32 v59, v59, v17
    v_cvt_pk_bf16_f32 v32, v16, v17
    v_mfma_f32_16x16x32_bf16 v[28:31], a[148:151], v[100:103], v[28:31]
    global_load_dwordx4 a[20:23], v1, s[6:7] offset:1024 sc1
    v_exp_f32 v19, v19
    v_mfma_f32_16x16x32_bf16 v[28:31], a[152:155], v[104:107], v[28:31]
    ds_read_b128 a[228:231], v2 offset:9216
    v_add_f32 v58, v58, v18
    v_mfma_f32_16x16x32_bf16 v[28:31], a[156:159], v[108:111], v[28:31]
    v_exp_f32 v20, v20
    v_mfma_f32_16x16x32_bf16 v[128:131], a[192:195], v[36:39], v[128:131]
    v_add_f32 v59, v59, v19
    v_cvt_pk_bf16_f32 v33, v18, v19
    v_mfma_f32_16x16x32_bf16 v[132:135], a[196:199], v[36:39], v[132:135]
    global_load_dwordx4 a[24:27], v1, s[6:7] offset:2048 sc1
    v_exp_f32 v21, v21
    v_mfma_f32_16x16x32_bf16 v[136:139], a[200:203], v[36:39], v[136:139]
    ds_read_b128 a[232:235], v2 offset:10240
    v_add_f32 v58, v58, v20
    v_mfma_f32_16x16x32_bf16 v[140:143], a[204:207], v[36:39], v[140:143]
    v_exp_f32 v22, v22
    v_mfma_f32_16x16x32_bf16 v[144:147], a[208:211], v[36:39], v[144:147]
    v_add_f32 v59, v59, v21
    v_cvt_pk_bf16_f32 v34, v20, v21
    v_mfma_f32_16x16x32_bf16 v[148:151], a[212:215], v[36:39], v[148:151]
    global_load_dwordx4 a[28:31], v1, s[6:7] offset:3072 sc1
    v_exp_f32 v23, v23
    v_mfma_f32_16x16x32_bf16 v[152:155], a[216:219], v[36:39], v[152:155]
    ds_read_b128 a[236:239], v2 offset:11264
    v_add_f32 v58, v58, v22
    v_mfma_f32_16x16x32_bf16 v[156:159], a[220:223], v[36:39], v[156:159]
    v_add_f32 v59, v59, v23
    v_cvt_pk_bf16_f32 v35, v22, v23
    v_mfma_f32_16x16x32_bf16 v[16:19], a[160:163], v[112:115], v[52:55]
    v_exp_f32 v24, v24
    v_mfma_f32_16x16x32_bf16 v[16:19], a[164:167], v[116:119], v[16:19]
    global_load_dwordx4 a[32:35], v3, s[6:7] offset:0 sc1
    v_exp_f32 v25, v25
    v_mfma_f32_16x16x32_bf16 v[16:19], a[168:171], v[120:123], v[16:19]
    ds_read_b128 a[240:243], v2 offset:12288
    v_add_f32 v60, v60, v24
    v_mfma_f32_16x16x32_bf16 v[16:19], a[172:175], v[124:127], v[16:19]
    s_waitcnt lgkmcnt(2)
    v_exp_f32 v26, v26
    v_mfma_f32_16x16x32_bf16 v[20:23], a[176:179], v[112:115], v[52:55]
    v_add_f32 v61, v61, v25
    v_cvt_pk_bf16_f32 v36, v24, v25
    v_mfma_f32_16x16x32_bf16 v[20:23], a[180:183], v[116:119], v[20:23]
    global_load_dwordx4 a[36:39], v3, s[6:7] offset:1024 sc1
    v_exp_f32 v27, v27
    v_mfma_f32_16x16x32_bf16 v[20:23], a[184:187], v[120:123], v[20:23]
    ds_read_b128 a[244:247], v2 offset:13312
    v_add_f32 v60, v60, v26
    v_cndmask_b32_e64 v8, v7, v40, s[80:81]
    v_mfma_f32_16x16x32_bf16 v[20:23], a[188:191], v[124:127], v[20:23]
    v_exp_f32 v28, v28
    v_cndmask_b32_e64 v9, v7, v40, s[82:83]
    v_mfma_f32_16x16x32_bf16 v[160:163], a[192:195], v[32:35], v[160:163]
    v_add_f32 v61, v61, v27
    v_cvt_pk_bf16_f32 v37, v26, v27
    v_cndmask_b32_e64 v10, v7, v40, s[84:85]
    v_mfma_f32_16x16x32_bf16 v[164:167], a[196:199], v[32:35], v[164:167]
    global_load_dwordx4 a[40:43], v3, s[6:7] offset:2048 sc1
    v_exp_f32 v29, v29
    v_cndmask_b32_e64 v11, v7, v40, s[86:87]
    v_mfma_f32_16x16x32_bf16 v[168:171], a[200:203], v[32:35], v[168:171]
    ds_read_b128 a[248:251], v2 offset:14336
    v_add_f32 v60, v60, v28
    v_cndmask_b32_e64 v12, v7, v40, s[88:89]
    v_mfma_f32_16x16x32_bf16 v[172:175], a[204:207], v[32:35], v[172:175]
    v_exp_f32 v30, v30
    v_cndmask_b32_e64 v13, v7, v40, s[90:91]
    v_mfma_f32_16x16x32_bf16 v[176:179], a[208:211], v[32:35], v[176:179]
    v_add_f32 v61, v61, v29
    v_cvt_pk_bf16_f32 v38, v28, v29
    v_cndmask_b32_e64 v14, v7, v40, s[92:93]
    v_mfma_f32_16x16x32_bf16 v[180:183], a[212:215], v[32:35], v[180:183]
    global_load_dwordx4 a[44:47], v3, s[6:7] offset:3072 sc1
    v_exp_f32 v31, v31
    v_cndmask_b32_e64 v15, v7, v40, s[94:95]
    v_mfma_f32_16x16x32_bf16 v[184:187], a[216:219], v[32:35], v[184:187]
    s_add_u32 s6, s6, 32768
    ds_read_b128 a[252:255], v2 offset:15360
    v_add_f32 v60, v60, v30
    v_mfma_f32_16x16x32_bf16 v[188:191], a[220:223], v[32:35], v[188:191]
    s_addc_u32 s7, s7, 0
    v_add_f32 v61, v61, v31
    v_cvt_pk_bf16_f32 v39, v30, v31
    v_mfma_f32_16x16x32_bf16 v[24:27], a[160:163], v[64:67], v[8:11]
    v_exp_f32 v16, v16
    v_mfma_f32_16x16x32_bf16 v[24:27], a[164:167], v[68:71], v[24:27]
    global_load_dwordx4 a[48:51], v1, s[6:7] offset:0 sc1
    v_exp_f32 v17, v17
    v_mfma_f32_16x16x32_bf16 v[24:27], a[168:171], v[72:75], v[24:27]
    ds_read_b128 a[128:131], v2 offset:16384
    v_add_f32 v62, v62, v16
    v_mfma_f32_16x16x32_bf16 v[24:27], a[172:175], v[76:79], v[24:27]
    v_exp_f32 v18, v18
    v_mfma_f32_16x16x32_bf16 v[28:31], a[176:179], v[64:67], v[12:15]
    v_add_f32 v63, v63, v17
    v_cvt_pk_bf16_f32 v32, v16, v17
    v_mfma_f32_16x16x32_bf16 v[28:31], a[180:183], v[68:71], v[28:31]
    global_load_dwordx4 a[52:55], v1, s[6:7] offset:1024 sc1
    v_exp_f32 v19, v19
    v_mfma_f32_16x16x32_bf16 v[28:31], a[184:187], v[72:75], v[28:31]
    ds_read_b128 a[132:135], v2 offset:17408
    v_add_f32 v62, v62, v18
    v_mfma_f32_16x16x32_bf16 v[28:31], a[188:191], v[76:79], v[28:31]
    v_exp_f32 v20, v20
    v_mfma_f32_16x16x32_bf16 v[192:195], a[192:195], v[36:39], v[192:195]
    v_add_f32 v63, v63, v19
    v_cvt_pk_bf16_f32 v33, v18, v19
    v_mfma_f32_16x16x32_bf16 v[196:199], a[196:199], v[36:39], v[196:199]
    global_load_dwordx4 a[56:59], v1, s[6:7] offset:2048 sc1
    v_exp_f32 v21, v21
    v_mfma_f32_16x16x32_bf16 v[200:203], a[200:203], v[36:39], v[200:203]
    ds_read_b128 a[136:139], v2 offset:18432
    v_add_f32 v62, v62, v20
    v_mfma_f32_16x16x32_bf16 v[204:207], a[204:207], v[36:39], v[204:207]
    v_exp_f32 v22, v22
    v_mfma_f32_16x16x32_bf16 v[208:211], a[208:211], v[36:39], v[208:211]
    v_add_f32 v63, v63, v21
    v_cvt_pk_bf16_f32 v34, v20, v21
    v_mfma_f32_16x16x32_bf16 v[212:215], a[212:215], v[36:39], v[212:215]
    global_load_dwordx4 a[60:63], v1, s[6:7] offset:3072 sc1
    v_exp_f32 v23, v23
    v_mfma_f32_16x16x32_bf16 v[216:219], a[216:219], v[36:39], v[216:219]
    ds_read_b128 a[140:143], v2 offset:19456
    v_add_f32 v62, v62, v22
    v_mfma_f32_16x16x32_bf16 v[220:223], a[220:223], v[36:39], v[220:223]
    v_add_f32 v63, v63, v23
    v_cvt_pk_bf16_f32 v35, v22, v23
    v_mfma_f32_16x16x32_bf16 v[16:19], a[160:163], v[80:83], v[44:47]
    v_exp_f32 v24, v24
    v_mfma_f32_16x16x32_bf16 v[16:19], a[164:167], v[84:87], v[16:19]
    global_load_dwordx4 a[64:67], v3, s[6:7] offset:0 sc1
    v_exp_f32 v25, v25
    v_mfma_f32_16x16x32_bf16 v[16:19], a[168:171], v[88:91], v[16:19]
    ds_read_b128 a[144:147], v2 offset:20480
    v_add_f32 v56, v56, v24
    v_mfma_f32_16x16x32_bf16 v[16:19], a[172:175], v[92:95], v[16:19]
    v_exp_f32 v26, v26
    v_mfma_f32_16x16x32_bf16 v[20:23], a[176:179], v[80:83], v[44:47]
    v_add_f32 v57, v57, v25
    v_cvt_pk_bf16_f32 v36, v24, v25
    v_mfma_f32_16x16x32_bf16 v[20:23], a[180:183], v[84:87], v[20:23]
    global_load_dwordx4 a[68:71], v3, s[6:7] offset:1024 sc1
    v_exp_f32 v27, v27
    v_mfma_f32_16x16x32_bf16 v[20:23], a[184:187], v[88:91], v[20:23]
    ds_read_b128 a[148:151], v2 offset:21504
    v_add_f32 v56, v56, v26
    v_mfma_f32_16x16x32_bf16 v[20:23], a[188:191], v[92:95], v[20:23]
    v_exp_f32 v28, v28
    v_mfma_f32_16x16x32_bf16 v[224:227], a[224:227], v[32:35], v[224:227]
    v_add_f32 v57, v57, v27
    v_cvt_pk_bf16_f32 v37, v26, v27
    v_mfma_f32_16x16x32_bf16 v[228:231], a[228:231], v[32:35], v[228:231]
    global_load_dwordx4 a[72:75], v3, s[6:7] offset:2048 sc1
    v_exp_f32 v29, v29
    v_mfma_f32_16x16x32_bf16 v[232:235], a[232:235], v[32:35], v[232:235]
    s_waitcnt lgkmcnt(1)
    ds_read_b128 a[152:155], v2 offset:22528
    v_add_f32 v56, v56, v28
    v_mfma_f32_16x16x32_bf16 v[236:239], a[236:239], v[32:35], v[236:239]
    v_exp_f32 v30, v30
    v_mfma_f32_16x16x32_bf16 v[240:243], a[240:243], v[32:35], v[240:243]
    v_add_f32 v57, v57, v29
    v_cvt_pk_bf16_f32 v38, v28, v29
    v_mfma_f32_16x16x32_bf16 v[244:247], a[244:247], v[32:35], v[244:247]
    global_load_dwordx4 a[76:79], v3, s[6:7] offset:3072 sc1
    v_exp_f32 v31, v31
    v_mfma_f32_16x16x32_bf16 v[248:251], a[248:251], v[32:35], v[248:251]
    s_add_u32 s6, s6, 32768
    ds_read_b128 a[156:159], v2 offset:23552
    v_add_f32 v56, v56, v30
    v_mfma_f32_16x16x32_bf16 v[252:255], a[252:255], v[32:35], v[252:255]
    s_addc_u32 s7, s7, 0
    v_add_f32 v57, v57, v31
    v_cvt_pk_bf16_f32 v39, v30, v31
    v_mfma_f32_16x16x32_bf16 v[24:27], a[160:163], v[96:99], v[48:51]
    s_mov_b32 m0, s59
    v_exp_f32 v16, v16
    v_mfma_f32_16x16x32_bf16 v[24:27], a[164:167], v[100:103], v[24:27]
    global_load_lds_dwordx4 v1, s[10:11] offset:0 sc1
    v_exp_f32 v17, v17
    v_mfma_f32_16x16x32_bf16 v[24:27], a[168:171], v[104:107], v[24:27]
    ds_read_b128 a[192:195], v2 offset:24576
    v_add_f32 v58, v58, v16
    v_mfma_f32_16x16x32_bf16 v[24:27], a[172:175], v[108:111], v[24:27]
    v_exp_f32 v18, v18
    v_mfma_f32_16x16x32_bf16 v[28:31], a[176:179], v[96:99], v[48:51]
    v_add_f32 v59, v59, v17
    v_cvt_pk_bf16_f32 v32, v16, v17
    v_mfma_f32_16x16x32_bf16 v[28:31], a[180:183], v[100:103], v[28:31]
    global_load_lds_dwordx4 v1, s[10:11] offset:1024 sc1
    v_exp_f32 v19, v19
    v_mfma_f32_16x16x32_bf16 v[28:31], a[184:187], v[104:107], v[28:31]
    ds_read_b128 a[196:199], v2 offset:25600
    v_add_f32 v58, v58, v18
    v_mfma_f32_16x16x32_bf16 v[28:31], a[188:191], v[108:111], v[28:31]
    v_exp_f32 v20, v20
    v_mfma_f32_16x16x32_bf16 v[128:131], a[224:227], v[36:39], v[128:131]
    v_add_f32 v59, v59, v19
    v_cvt_pk_bf16_f32 v33, v18, v19
    v_mfma_f32_16x16x32_bf16 v[132:135], a[228:231], v[36:39], v[132:135]
    global_load_lds_dwordx4 v1, s[10:11] offset:2048 sc1
    v_exp_f32 v21, v21
    v_mfma_f32_16x16x32_bf16 v[136:139], a[232:235], v[36:39], v[136:139]
    ds_read_b128 a[200:203], v2 offset:26624
    v_add_f32 v58, v58, v20
    v_mfma_f32_16x16x32_bf16 v[140:143], a[236:239], v[36:39], v[140:143]
    v_exp_f32 v22, v22
    v_mfma_f32_16x16x32_bf16 v[144:147], a[240:243], v[36:39], v[144:147]
    v_add_f32 v59, v59, v21
    v_cvt_pk_bf16_f32 v34, v20, v21
    v_mfma_f32_16x16x32_bf16 v[148:151], a[244:247], v[36:39], v[148:151]
    global_load_lds_dwordx4 v1, s[10:11] offset:3072 sc1
    v_exp_f32 v23, v23
    v_mfma_f32_16x16x32_bf16 v[152:155], a[248:251], v[36:39], v[152:155]
    s_mov_b32 m0, s98
    ds_read_b128 a[204:207], v2 offset:27648
    v_add_f32 v58, v58, v22
    v_mfma_f32_16x16x32_bf16 v[156:159], a[252:255], v[36:39], v[156:159]
    v_add_f32 v59, v59, v23
    v_cvt_pk_bf16_f32 v35, v22, v23
    v_mfma_f32_16x16x32_bf16 v[16:19], a[128:131], v[112:115], v[52:55]
    v_exp_f32 v24, v24
    v_mfma_f32_16x16x32_bf16 v[16:19], a[132:135], v[116:119], v[16:19]
    v_exp_f32 v25, v25
    v_mfma_f32_16x16x32_bf16 v[16:19], a[136:139], v[120:123], v[16:19]
    ds_read_b128 a[208:211], v2 offset:28672
    v_add_f32 v60, v60, v24
    v_mfma_f32_16x16x32_bf16 v[16:19], a[140:143], v[124:127], v[16:19]
    v_exp_f32 v26, v26
    v_mfma_f32_16x16x32_bf16 v[20:23], a[144:147], v[112:115], v[52:55]
    s_waitcnt lgkmcnt(1)
    v_add_f32 v61, v61, v25
    v_cvt_pk_bf16_f32 v36, v24, v25
    v_mfma_f32_16x16x32_bf16 v[20:23], a[148:151], v[116:119], v[20:23]
    v_exp_f32 v27, v27
    v_mfma_f32_16x16x32_bf16 v[20:23], a[152:155], v[120:123], v[20:23]
    ds_read_b128 a[212:215], v2 offset:29696
    v_add_f32 v60, v60, v26
    v_mfma_f32_16x16x32_bf16 v[20:23], a[156:159], v[124:127], v[20:23]
    v_exp_f32 v28, v28
    v_mfma_f32_16x16x32_bf16 v[160:163], a[224:227], v[32:35], v[160:163]
    s_waitcnt vmcnt(32)
    v_add_f32 v61, v61, v27
    v_cvt_pk_bf16_f32 v37, v26, v27
    v_mfma_f32_16x16x32_bf16 v[164:167], a[228:231], v[32:35], v[164:167]
    s_barrier
    v_exp_f32 v29, v29
    v_mfma_f32_16x16x32_bf16 v[168:171], a[232:235], v[32:35], v[168:171]
    s_add_u32 s99, s99, 1
    ds_read_b128 a[216:219], v2 offset:30720
    v_add_f32 v60, v60, v28
    v_mfma_f32_16x16x32_bf16 v[172:175], a[236:239], v[32:35], v[172:175]
    s_bitcmp1_b64 s[4:5], s99
    v_exp_f32 v30, v30
    v_mfma_f32_16x16x32_bf16 v[176:179], a[240:243], v[32:35], v[176:179]
    v_add_f32 v61, v61, v29
    v_cvt_pk_bf16_f32 v38, v28, v29
    v_mfma_f32_16x16x32_bf16 v[180:183], a[244:247], v[32:35], v[180:183]
    v_exp_f32 v31, v31
    v_mfma_f32_16x16x32_bf16 v[184:187], a[248:251], v[32:35], v[184:187]
    ds_read_b128 a[220:223], v2 offset:31744
    v_add_f32 v60, v60, v30
    v_mfma_f32_16x16x32_bf16 v[188:191], a[252:255], v[32:35], v[188:191]
    v_add_f32 v61, v61, v31
    v_cvt_pk_bf16_f32 v39, v30, v31
    v_add_u32 v2, s96, v1
    v_cndmask_b32_e64 v8, v7, v44, s[64:65]
    v_cndmask_b32_e64 v9, v7, v44, s[66:67]
    v_cndmask_b32_e64 v10, v7, v44, s[68:69]
    v_cndmask_b32_e64 v11, v7, v44, s[70:71]
    v_cndmask_b32_e64 v12, v7, v44, s[72:73]
    v_cndmask_b32_e64 v13, v7, v44, s[74:75]
    v_cndmask_b32_e64 v14, v7, v44, s[76:77]
    v_cndmask_b32_e64 v15, v7, v44, s[78:79]
    v_mfma_f32_16x16x32_bf16 v[24:27], a[128:131], v[80:83], v[8:11]
    v_exp_f32 v16, v16
    v_mfma_f32_16x16x32_bf16 v[24:27], a[132:135], v[84:87], v[24:27]
    s_add_u32 s62, m0, 16384
    global_load_lds_dwordx4 v1, s[14:15] offset:0 sc1
    v_exp_f32 v17, v17
    v_mfma_f32_16x16x32_bf16 v[24:27], a[136:139], v[88:91], v[24:27]
    s_and_b32 s62, s62, 0x1ffff
    ds_read_b128 a[160:163], v2 offset:0
    v_add_f32 v62, v62, v16
    v_mfma_f32_16x16x32_bf16 v[24:27], a[140:143], v[92:95], v[24:27]
    s_add_u32 s98, s62, 16384
    v_exp_f32 v18, v18
    v_mfma_f32_16x16x32_bf16 v[28:31], a[144:147], v[80:83], v[12:15]
    s_and_b32 s98, s98, 0x1ffff
    ds_read_b128 a[164:167], v2 offset:1024
    v_add_f32 v63, v63, v17
    v_cvt_pk_bf16_f32 v32, v16, v17
    v_mfma_f32_16x16x32_bf16 v[28:31], a[148:151], v[84:87], v[28:31]
    s_add_u32 s96, s96, 32768
    global_load_lds_dwordx4 v1, s[14:15] offset:1024 sc1
    v_exp_f32 v19, v19
    v_mfma_f32_16x16x32_bf16 v[28:31], a[152:155], v[88:91], v[28:31]
    s_and_b32 s96, s96, 0x1ffff
    ds_read_b128 a[168:171], v2 offset:2048
    v_add_f32 v62, v62, v18
    v_mfma_f32_16x16x32_bf16 v[28:31], a[156:159], v[92:95], v[28:31]
    s_add_u32 s18, s14, 32768
    v_exp_f32 v20, v20
    v_mfma_f32_16x16x32_bf16 v[192:195], a[224:227], v[36:39], v[192:195]
    s_addc_u32 s19, s15, 0
    v_add_f32 v63, v63, v19
    v_cvt_pk_bf16_f32 v33, v18, v19
    v_mfma_f32_16x16x32_bf16 v[196:199], a[228:231], v[36:39], v[196:199]
    s_sub_u32 s97, s97, 1
    global_load_lds_dwordx4 v1, s[14:15] offset:2048 sc1
    v_exp_f32 v21, v21
    v_mfma_f32_16x16x32_bf16 v[200:203], a[232:235], v[36:39], v[200:203]
    s_cmp_eq_u32 s97, 0
    ds_read_b128 a[172:175], v2 offset:3072
    v_add_f32 v62, v62, v20
    v_mfma_f32_16x16x32_bf16 v[204:207], a[236:239], v[36:39], v[204:207]
    s_cselect_b64 s[18:19], s[16:17], s[18:19]
    v_exp_f32 v22, v22
    v_mfma_f32_16x16x32_bf16 v[208:211], a[240:243], v[36:39], v[208:211]
    ds_read_b128 a[176:179], v2 offset:4096
    v_add_f32 v63, v63, v21
    v_cvt_pk_bf16_f32 v34, v20, v21
    v_mfma_f32_16x16x32_bf16 v[212:215], a[244:247], v[36:39], v[212:215]
    global_load_lds_dwordx4 v1, s[14:15] offset:3072 sc1
    v_exp_f32 v23, v23
    v_mfma_f32_16x16x32_bf16 v[216:219], a[248:251], v[36:39], v[216:219]
    s_mov_b32 m0, s62
    ds_read_b128 a[180:183], v2 offset:5120
    v_add_f32 v62, v62, v22
    v_mfma_f32_16x16x32_bf16 v[220:223], a[252:255], v[36:39], v[220:223]
    v_add_f32 v63, v63, v23
    v_cvt_pk_bf16_f32 v35, v22, v23
    v_mfma_f32_16x16x32_bf16 v[16:19], a[128:131], v[96:99], v[48:51]
    v_exp_f32 v24, v24
    v_mfma_f32_16x16x32_bf16 v[16:19], a[132:135], v[100:103], v[16:19]
    global_load_lds_dwordx4 v3, s[14:15] offset:0 sc1
    v_exp_f32 v25, v25
    v_mfma_f32_16x16x32_bf16 v[16:19], a[136:139], v[104:107], v[16:19]
    ds_read_b128 a[184:187], v2 offset:6144
    v_add_f32 v58, v58, v24
    v_mfma_f32_16x16x32_bf16 v[16:19], a[140:143], v[108:111], v[16:19]
    v_exp_f32 v26, v26
    v_mfma_f32_16x16x32_bf16 v[20:23], a[144:147], v[96:99], v[48:51]
    v_add_f32 v59, v59, v25
    v_cvt_pk_bf16_f32 v36, v24, v25
    v_mfma_f32_16x16x32_bf16 v[20:23], a[148:151], v[100:103], v[20:23]
    global_load_lds_dwordx4 v3, s[14:15] offset:1024 sc1
    v_exp_f32 v27, v27
    v_mfma_f32_16x16x32_bf16 v[20:23], a[152:155], v[104:107], v[20:23]
    ds_read_b128 a[188:191], v2 offset:7168
    v_add_f32 v58, v58, v26
    v_mfma_f32_16x16x32_bf16 v[20:23], a[156:159], v[108:111], v[20:23]
    s_waitcnt lgkmcnt(2)
    v_exp_f32 v28, v28
    v_mfma_f32_16x16x32_bf16 v[224:227], a[192:195], v[32:35], v[224:227]
    ds_read_b128 a[224:227], v2 offset:8192
    v_add_f32 v59, v59, v27
    v_cvt_pk_bf16_f32 v37, v26, v27
    v_mfma_f32_16x16x32_bf16 v[228:231], a[196:199], v[32:35], v[228:231]
    global_load_lds_dwordx4 v3, s[14:15] offset:2048 sc1
    v_exp_f32 v29, v29
    v_mfma_f32_16x16x32_bf16 v[232:235], a[200:203], v[32:35], v[232:235]
    ds_read_b128 a[228:231], v2 offset:9216
    v_add_f32 v58, v58, v28
    v_mfma_f32_16x16x32_bf16 v[236:239], a[204:207], v[32:35], v[236:239]
    v_exp_f32 v30, v30
    v_mfma_f32_16x16x32_bf16 v[240:243], a[208:211], v[32:35], v[240:243]
    v_add_f32 v59, v59, v29
    v_cvt_pk_bf16_f32 v38, v28, v29
    v_mfma_f32_16x16x32_bf16 v[244:247], a[212:215], v[32:35], v[244:247]
    global_load_lds_dwordx4 v3, s[14:15] offset:3072 sc1
    v_exp_f32 v31, v31
    v_mfma_f32_16x16x32_bf16 v[248:251], a[216:219], v[32:35], v[248:251]
    s_mov_b32 m0, s98
    ds_read_b128 a[232:235], v2 offset:10240
    v_add_f32 v58, v58, v30
    v_mfma_f32_16x16x32_bf16 v[252:255], a[220:223], v[32:35], v[252:255]
    s_mov_b64 s[14:15], s[18:19]
    v_add_f32 v59, v59, v31
    v_cvt_pk_bf16_f32 v39, v30, v31
    v_mfma_f32_16x16x32_bf16 v[24:27], a[160:163], v[112:115], v[52:55]
    v_exp_f32 v16, v16
    v_mfma_f32_16x16x32_bf16 v[24:27], a[164:167], v[116:119], v[24:27]
    global_load_dwordx4 a[80:83], v1, s[6:7] offset:0 sc1
    v_exp_f32 v17, v17
    v_mfma_f32_16x16x32_bf16 v[24:27], a[168:171], v[120:123], v[24:27]
    ds_read_b128 a[236:239], v2 offset:11264
    v_add_f32 v60, v60, v16
    v_mfma_f32_16x16x32_bf16 v[24:27], a[172:175], v[124:127], v[24:27]
    v_exp_f32 v18, v18
    v_mfma_f32_16x16x32_bf16 v[28:31], a[176:179], v[112:115], v[52:55]
    v_add_f32 v61, v61, v17
    v_cvt_pk_bf16_f32 v32, v16, v17
    v_mfma_f32_16x16x32_bf16 v[28:31], a[180:183], v[116:119], v[28:31]
    s_waitcnt lgkmcnt(1)
    global_load_dwordx4 a[84:87], v1, s[6:7] offset:1024 sc1
    v_exp_f32 v19, v19
    v_mfma_f32_16x16x32_bf16 v[28:31], a[184:187], v[120:123], v[28:31]
    ds_read_b128 a[240:243], v2 offset:12288
    v_add_f32 v60, v60, v18
    v_cndmask_b32_e64 v8, v7, v44, s[80:81]
    v_mfma_f32_16x16x32_bf16 v[28:31], a[188:191], v[124:127], v[28:31]
    v_exp_f32 v20, v20
    v_cndmask_b32_e64 v9, v7, v44, s[82:83]
    v_mfma_f32_16x16x32_bf16 v[160:163], a[192:195], v[36:39], v[160:163]
    ds_read_b128 a[244:247], v2 offset:13312
    v_add_f32 v61, v61, v19
    v_cvt_pk_bf16_f32 v33, v18, v19
    v_cndmask_b32_e64 v10, v7, v44, s[84:85]
    v_mfma_f32_16x16x32_bf16 v[164:167], a[196:199], v[36:39], v[164:167]
    global_load_dwordx4 a[88:91], v1, s[6:7] offset:2048 sc1
    v_exp_f32 v21, v21
    v_cndmask_b32_e64 v11, v7, v44, s[86:87]
    v_mfma_f32_16x16x32_bf16 v[168:171], a[200:203], v[36:39], v[168:171]
    ds_read_b128 a[248:251], v2 offset:14336
    v_add_f32 v60, v60, v20
    v_cndmask_b32_e64 v12, v7, v44, s[88:89]
    v_mfma_f32_16x16x32_bf16 v[172:175], a[204:207], v[36:39], v[172:175]
    v_exp_f32 v22, v22
    v_cndmask_b32_e64 v13, v7, v44, s[90:91]
    v_mfma_f32_16x16x32_bf16 v[176:179], a[208:211], v[36:39], v[176:179]
    v_add_f32 v61, v61, v21
    v_cvt_pk_bf16_f32 v34, v20, v21
    v_cndmask_b32_e64 v14, v7, v44, s[92:93]
    v_mfma_f32_16x16x32_bf16 v[180:183], a[212:215], v[36:39], v[180:183]
    global_load_dwordx4 a[92:95], v1, s[6:7] offset:3072 sc1
    v_exp_f32 v23, v23
    v_cndmask_b32_e64 v15, v7, v44, s[94:95]
    v_mfma_f32_16x16x32_bf16 v[184:187], a[216:219], v[36:39], v[184:187]
    ds_read_b128 a[252:255], v2 offset:15360
    v_add_f32 v60, v60, v22
    v_mfma_f32_16x16x32_bf16 v[188:191], a[220:223], v[36:39], v[188:191]
    v_add_f32 v61, v61, v23
    v_cvt_pk_bf16_f32 v35, v22, v23
    v_mfma_f32_16x16x32_bf16 v[16:19], a[160:163], v[80:83], v[8:11]
    v_exp_f32 v24, v24
    v_mfma_f32_16x16x32_bf16 v[16:19], a[164:167], v[84:87], v[16:19]
    global_load_dwordx4 a[96:99], v3, s[6:7] offset:0 sc1
    v_exp_f32 v25, v25
    v_mfma_f32_16x16x32_bf16 v[16:19], a[168:171], v[88:91], v[16:19]
    ds_read_b128 a[128:131], v2 offset:16384
    v_add_f32 v62, v62, v24
    v_mfma_f32_16x16x32_bf16 v[16:19], a[172:175], v[92:95], v[16:19]
    v_exp_f32 v26, v26
    v_mfma_f32_16x16x32_bf16 v[20:23], a[176:179], v[80:83], v[12:15]
    ds_read_b128 a[132:135], v2 offset:17408
    v_add_f32 v63, v63, v25
    v_cvt_pk_bf16_f32 v36, v24, v25
    v_mfma_f32_16x16x32_bf16 v[20:23], a[180:183], v[84:87], v[20:23]
    global_load_dwordx4 a[100:103], v3, s[6:7] offset:1024 sc1
    v_exp_f32 v27, v27
    v_mfma_f32_16x16x32_bf16 v[20:23], a[184:187], v[88:91], v[20:23]
    ds_read_b128 a[136:139], v2 offset:18432
    v_add_f32 v62, v62, v26
    v_mfma_f32_16x16x32_bf16 v[20:23], a[188:191], v[92:95], v[20:23]
    v_exp_f32 v28, v28
    v_mfma_f32_16x16x32_bf16 v[192:195], a[192:195], v[32:35], v[192:195]
    v_add_f32 v63, v63, v27
    v_cvt_pk_bf16_f32 v37, v26, v27
    v_mfma_f32_16x16x32_bf16 v[196:199], a[196:199], v[32:35], v[196:199]
    global_load_dwordx4 a[104:107], v3, s[6:7] offset:2048 sc1
    v_exp_f32 v29, v29
    v_mfma_f32_16x16x32_bf16 v[200:203], a[200:203], v[32:35], v[200:203]
    ds_read_b128 a[140:143], v2 offset:19456
    v_add_f32 v62, v62, v28
    v_mfma_f32_16x16x32_bf16 v[204:207], a[204:207], v[32:35], v[204:207]
    v_exp_f32 v30, v30
    v_mfma_f32_16x16x32_bf16 v[208:211], a[208:211], v[32:35], v[208:211]
    ds_read_b128 a[144:147], v2 offset:20480
    v_add_f32 v63, v63, v29
    v_cvt_pk_bf16_f32 v38, v28, v29
    v_mfma_f32_16x16x32_bf16 v[212:215], a[212:215], v[32:35], v[212:215]
    global_load_dwordx4 a[108:111], v3, s[6:7] offset:3072 sc1
    v_exp_f32 v31, v31
    v_mfma_f32_16x16x32_bf16 v[216:219], a[216:219], v[32:35], v[216:219]
    s_add_u32 s6, s6, 32768
    ds_read_b128 a[148:151], v2 offset:21504
    v_add_f32 v62, v62, v30
    v_mfma_f32_16x16x32_bf16 v[220:223], a[220:223], v[32:35], v[220:223]
    s_addc_u32 s7, s7, 0
    v_add_f32 v63, v63, v31
    v_cvt_pk_bf16_f32 v39, v30, v31
    v_mfma_f32_16x16x32_bf16 v[24:27], a[160:163], v[96:99], v[48:51]
    v_exp_f32 v16, v16
    v_mfma_f32_16x16x32_bf16 v[24:27], a[164:167], v[100:103], v[24:27]
    global_load_dwordx4 a[112:115], v1, s[6:7] offset:0 sc1
    v_exp_f32 v17, v17
    v_mfma_f32_16x16x32_bf16 v[24:27], a[168:171], v[104:107], v[24:27]
    ds_read_b128 a[152:155], v2 offset:22528
    v_add_f32 v58, v58, v16
    v_mfma_f32_16x16x32_bf16 v[24:27], a[172:175], v[108:111], v[24:27]
    v_exp_f32 v18, v18
    v_mfma_f32_16x16x32_bf16 v[28:31], a[176:179], v[96:99], v[48:51]
    v_add_f32 v59, v59, v17
    v_cvt_pk_bf16_f32 v32, v16, v17
    v_mfma_f32_16x16x32_bf16 v[28:31], a[180:183], v[100:103], v[28:31]
    global_load_dwordx4 a[116:119], v1, s[6:7] offset:1024 sc1
    v_exp_f32 v19, v19
    v_mfma_f32_16x16x32_bf16 v[28:31], a[184:187], v[104:107], v[28:31]
    ds_read_b128 a[156:159], v2 offset:23552
    v_add_f32 v58, v58, v18
    v_mfma_f32_16x16x32_bf16 v[28:31], a[188:191], v[108:111], v[28:31]
    v_exp_f32 v20, v20
    v_mfma_f32_16x16x32_bf16 v[224:227], a[224:227], v[36:39], v[224:227]
    ds_read_b128 a[192:195], v2 offset:24576
    v_add_f32 v59, v59, v19
    v_cvt_pk_bf16_f32 v33, v18, v19
    v_mfma_f32_16x16x32_bf16 v[228:231], a[228:231], v[36:39], v[228:231]
    global_load_dwordx4 a[120:123], v1, s[6:7] offset:2048 sc1
    v_exp_f32 v21, v21
    v_mfma_f32_16x16x32_bf16 v[232:235], a[232:235], v[36:39], v[232:235]
    s_waitcnt lgkmcnt(2)
    ds_read_b128 a[196:199], v2 offset:25600
    v_add_f32 v58, v58, v20
    v_mfma_f32_16x16x32_bf16 v[236:239], a[236:239], v[36:39], v[236:239]
    v_exp_f32 v22, v22
    v_mfma_f32_16x16x32_bf16 v[240:243], a[240:243], v[36:39], v[240:243]
    v_add_f32 v59, v59, v21
    v_cvt_pk_bf16_f32 v34, v20, v21
    v_mfma_f32_16x16x32_bf16 v[244:247], a[244:247], v[36:39], v[244:247]
    global_load_dwordx4 a[124:127], v1, s[6:7] offset:3072 sc1
    v_exp_f32 v23, v23
    v_mfma_f32_16x16x32_bf16 v[248:251], a[248:251], v[36:39], v[248:251]
    ds_read_b128 a[200:203], v2 offset:26624
    v_add_f32 v58, v58, v22
    v_mfma_f32_16x16x32_bf16 v[252:255], a[252:255], v[36:39], v[252:255]
    v_add_f32 v59, v59, v23
    v_cvt_pk_bf16_f32 v35, v22, v23
    v_mfma_f32_16x16x32_bf16 v[16:19], a[128:131], v[112:115], v[52:55]
    v_exp_f32 v24, v24
    v_mfma_f32_16x16x32_bf16 v[16:19], a[132:135], v[116:119], v[16:19]
    ds_read_b128 a[204:207], v2 offset:27648
    v_mfma_f32_16x16x32_bf16 v[16:19], a[136:139], v[120:123], v[16:19]
    v_exp_f32 v25, v25
    v_mfma_f32_16x16x32_bf16 v[16:19], a[140:143], v[124:127], v[16:19]
    ds_read_b128 a[208:211], v2 offset:28672
    v_cvt_pk_bf16_f32 v36, v24, v25
    v_mfma_f32_16x16x32_bf16 v[20:23], a[144:147], v[112:115], v[52:55]
    v_exp_f32 v26, v26
    v_mfma_f32_16x16x32_bf16 v[20:23], a[148:151], v[116:119], v[20:23]
    ds_read_b128 a[212:215], v2 offset:29696
    v_mfma_f32_16x16x32_bf16 v[20:23], a[152:155], v[120:123], v[20:23]
    s_waitcnt lgkmcnt(3)
    v_exp_f32 v27, v27
    v_mfma_f32_16x16x32_bf16 v[20:23], a[156:159], v[124:127], v[20:23]
    ds_read_b128 a[216:219], v2 offset:30720
    v_cvt_pk_bf16_f32 v37, v26, v27
    v_mfma_f32_16x16x32_bf16 v[160:163], a[224:227], v[32:35], v[160:163]
    s_waitcnt vmcnt(44)
    v_exp_f32 v28, v28
    v_mfma_f32_16x16x32_bf16 v[164:167], a[228:231], v[32:35], v[164:167]
    s_barrier
    ds_read_b128 a[220:223], v2 offset:31744
    v_mfma_f32_16x16x32_bf16 v[168:171], a[232:235], v[32:35], v[168:171]
    s_add_u32 s99, s99, 1
    v_exp_f32 v29, v29
    v_mfma_f32_16x16x32_bf16 v[172:175], a[236:239], v[32:35], v[172:175]
    s_bitcmp1_b64 s[4:5], s99
    v_cvt_pk_bf16_f32 v38, v28, v29
    v_mfma_f32_16x16x32_bf16 v[176:179], a[240:243], v[32:35], v[176:179]
    v_exp_f32 v30, v30
    v_mfma_f32_16x16x32_bf16 v[180:183], a[244:247], v[32:35], v[180:183]
    v_mfma_f32_16x16x32_bf16 v[184:187], a[248:251], v[32:35], v[184:187]
    v_exp_f32 v31, v31
    v_mfma_f32_16x16x32_bf16 v[188:191], a[252:255], v[32:35], v[188:191]
    v_cvt_pk_bf16_f32 v39, v30, v31
    v_add_u32 v2, s96, v1
    s_cmp_lg_u32 s33, 7
    s_cbranch_scc1 L_att_mid
    s_add_u32 s6, s16, 327680
    s_addc_u32 s7, s17, 0
    global_load_dwordx4 a[160:163], v1, s[6:7] offset:0 sc1
    v_add_f32 v56, v56, v57
    v_add_f32 v58, v58, v59
    v_bfe_u32 v9, v1, 5, 3
    v_mov_b32 v57, v56
    v_mov_b32 v59, v58
    v_bfe_u32 v10, v1, 4, 1
    v_permlane32_swap_b32 v56, v57
    v_permlane32_swap_b32 v58, v59
    v_lshrrev_b32 v11, 8, v1
    v_add_f32 v56, v56, v57
    v_add_f32 v58, v58, v59
    v_lshlrev_b32 v10, 2, v10
    global_load_dwordx4 a[164:167], v1, s[6:7] offset:1024 sc1
    v_mov_b32 v57, v56
    v_mov_b32 v59, v58
    v_add_u32 v11, s58, v11
    v_permlane16_swap_b32 v56, v57
    v_permlane16_swap_b32 v58, v59
    v_lshl_add_u32 v9, v9, 7, v10
    v_add_f32 v56, v56, v57
    v_add_f32 v58, v58, v59
    v_and_b32 v11, 3, v11
    v_lshl_add_u32 v10, v11, 10, v9
    v_cmp_nlt_f32 vcc, v56, v6
    v_rcp_f32 v56, v56
    global_load_dwordx4 a[168:171], v1, s[6:7] offset:2048 sc1
    s_or_b32 s100, s100, vcc_lo
    s_or_b32 s100, s100, vcc_hi
    v_cmp_nlt_f32 vcc, v58, v6
    v_rcp_f32 v58, v58
    s_or_b32 s100, s100, vcc_lo
    s_or_b32 s100, s100, vcc_hi
    s_mul_i32 s35, s33, 1179648
    s_add_u32 s35, s35, s101
    v_pk_mul_f32 v[128:129], v[128:129], v[56:57] op_sel_hi:[1,0]
    v_pk_mul_f32 v[130:131], v[130:131], v[56:57] op_sel_hi:[1,0]
    v_pk_mul_f32 v[132:133], v[132:133], v[56:57] op_sel_hi:[1,0]
    v_pk_mul_f32 v[134:135], v[134:135], v[56:57] op_sel_hi:[1,0]
    global_load_dwordx4 a[172:175], v1, s[6:7] offset:3072 sc1
    v_cvt_pk_bf16_f32 v128, v128, v129
    v_cvt_pk_bf16_f32 v129, v130, v131
    v_cvt_pk_bf16_f32 v130, v132, v133
    v_cvt_pk_bf16_f32 v131, v134, v135
    buffer_store_dwordx4 v[128:131], v1, s[24:27], s35 offen sc1
    s_add_u32 s35, s35, 4096
    v_add_f32 v60, v60, v61
    v_add_f32 v62, v62, v63
    s_lshl_b32 s34, s32, 12
    s_add_u32 s34, s34, 61865984
    s_add_u32 s8, s60, s34
    s_addc_u32 s9, s61, 0
    v_pk_mul_f32 v[136:137], v[136:137], v[56:57] op_sel_hi:[1,0]
    v_pk_mul_f32 v[138:139], v[138:139], v[56:57] op_sel_hi:[1,0]
    v_pk_mul_f32 v[140:141], v[140:141], v[56:57] op_sel_hi:[1,0]
    v_pk_mul_f32 v[142:143], v[142:143], v[56:57] op_sel_hi:[1,0]
    v_cvt_pk_bf16_f32 v136, v136, v137
    v_cvt_pk_bf16_f32 v137, v138, v139
    v_cvt_pk_bf16_f32 v138, v140, v141
    v_cvt_pk_bf16_f32 v139, v142, v143
    buffer_store_dwordx4 v[136:139], v1, s[24:27], s35 offen sc1
    s_add_u32 s35, s35, 4096
    v_mov_b32 v61, v60
    v_mov_b32 v63, v62
    v_pk_mul_f32 v[144:145], v[144:145], v[56:57] op_sel_hi:[1,0]
    v_pk_mul_f32 v[146:147], v[146:147], v[56:57] op_sel_hi:[1,0]
    v_pk_mul_f32 v[148:149], v[148:149], v[56:57] op_sel_hi:[1,0]
    v_pk_mul_f32 v[150:151], v[150:151], v[56:57] op_sel_hi:[1,0]
    global_load_dwordx4 a[176:179], v3, s[6:7] offset:0 sc1
    v_cvt_pk_bf16_f32 v144, v144, v145
    v_cvt_pk_bf16_f32 v145, v146, v147
    v_cvt_pk_bf16_f32 v146, v148, v149
    v_cvt_pk_bf16_f32 v147, v150, v151
    buffer_store_dwordx4 v[144:147], v1, s[24:27], s35 offen sc1
    s_add_u32 s35, s35, 4096
    v_permlane32_swap_b32 v60, v61
    v_permlane32_swap_b32 v62, v63
    v_pk_mul_f32 v[152:153], v[152:153], v[56:57] op_sel_hi:[1,0]
    v_pk_mul_f32 v[154:155], v[154:155], v[56:57] op_sel_hi:[1,0]
    v_pk_mul_f32 v[156:157], v[156:157], v[56:57] op_sel_hi:[1,0]
    v_pk_mul_f32 v[158:159], v[158:159], v[56:57] op_sel_hi:[1,0]
    v_cvt_pk_bf16_f32 v152, v152, v153
    v_cvt_pk_bf16_f32 v153, v154, v155
    v_cvt_pk_bf16_f32 v154, v156, v157
    v_cvt_pk_bf16_f32 v155, v158, v159
    buffer_store_dwordx4 v[152:155], v1, s[24:27], s35 offen sc1
    v_add_f32 v60, v60, v61
    v_add_f32 v62, v62, v63
    s_mul_i32 s35, s33, 1179648
    s_add_u32 s35, s35, s101
    s_add_u32 s35, s35, 589824
    v_pk_mul_f32 v[160:161], v[160:161], v[58:59] op_sel_hi:[1,0]
    v_pk_mul_f32 v[162:163], v[162:163], v[58:59] op_sel_hi:[1,0]
    global_load_dwordx4 a[180:183], v3, s[6:7] offset:1024 sc1
    v_pk_mul_f32 v[164:165], v[164:165], v[58:59] op_sel_hi:[1,0]
    v_pk_mul_f32 v[166:167], v[166:167], v[58:59] op_sel_hi:[1,0]
    v_cvt_pk_bf16_f32 v160, v160, v161
    v_cvt_pk_bf16_f32 v161, v162, v163
    v_cvt_pk_bf16_f32 v162, v164, v165
    v_cvt_pk_bf16_f32 v163, v166, v167
    buffer_store_dwordx4 v[160:163], v1, s[24:27], s35 offen sc1
    s_add_u32 s35, s35, 4096
    v_mov_b32 v61, v60
    v_mov_b32 v63, v62
    v_pk_mul_f32 v[168:169], v[168:169], v[58:59] op_sel_hi:[1,0]
    v_pk_mul_f32 v[170:171], v[170:171], v[58:59] op_sel_hi:[1,0]
    v_pk_mul_f32 v[172:173], v[172:173], v[58:59] op_sel_hi:[1,0]
    v_pk_mul_f32 v[174:175], v[174:175], v[58:59] op_sel_hi:[1,0]
    v_cvt_pk_bf16_f32 v168, v168, v169
    v_cvt_pk_bf16_f32 v169, v170, v171
    v_cvt_pk_bf16_f32 v170, v172, v173
    v_cvt_pk_bf16_f32 v171, v174, v175
    buffer_store_dwordx4 v[168:171], v1, s[24:27], s35 offen sc1
    s_add_u32 s35, s35, 4096
    v_permlane16_swap_b32 v60, v61
    v_permlane16_swap_b32 v62, v63
    v_pk_mul_f32 v[176:177], v[176:177], v[58:59] op_sel_hi:[1,0]
    v_pk_mul_f32 v[178:179], v[178:179], v[58:59] op_sel_hi:[1,0]
    global_load_dwordx4 a[184:187], v3, s[6:7] offset:2048 sc1
    v_pk_mul_f32 v[180:181], v[180:181], v[58:59] op_sel_hi:[1,0]
    v_pk_mul_f32 v[182:183], v[182:183], v[58:59] op_sel_hi:[1,0]
    v_cvt_pk_bf16_f32 v176, v176, v177
    v_cvt_pk_bf16_f32 v177, v178, v179
    v_cvt_pk_bf16_f32 v178, v180, v181
    v_cvt_pk_bf16_f32 v179, v182, v183
    buffer_store_dwordx4 v[176:179], v1, s[24:27], s35 offen sc1
    s_add_u32 s35, s35, 4096
    v_add_f32 v60, v60, v61
    v_add_f32 v62, v62, v63
    v_pk_mul_f32 v[184:185], v[184:185], v[58:59] op_sel_hi:[1,0]
    v_pk_mul_f32 v[186:187], v[186:187], v[58:59] op_sel_hi:[1,0]
    v_pk_mul_f32 v[188:189], v[188:189], v[58:59] op_sel_hi:[1,0]
    v_pk_mul_f32 v[190:191], v[190:191], v[58:59] op_sel_hi:[1,0]
    v_cvt_pk_bf16_f32 v184, v184, v185
    v_cvt_pk_bf16_f32 v185, v186, v187
    v_cvt_pk_bf16_f32 v186, v188, v189
    v_cvt_pk_bf16_f32 v187, v190, v191
    buffer_store_dwordx4 v[184:187], v1, s[24:27], s35 offen sc1
    v_mov_b32 v40, v60
    v_mov_b32 v41, v60
    v_mov_b32 v42, v60
    global_load_dwordx4 a[188:191], v3, s[6:7] offset:3072 sc1
    v_mov_b32 v43, v60
    v_mov_b32 v44, v62
    v_mov_b32 v45, v62
    v_mov_b32 v46, v62
    v_mov_b32 v47, v62
    global_load_dword a8, v10, s[8:9] sc1
    s_branch L_att_d2
L_e3_slow:
    s_mov_b32 s35, 0
L_e3_lp:
    s_mov_b64 exec, vcc
    global_load_dword v15, v0, s[44:45] sc1
    s_add_u32 s35, s35, 1
    s_cmp_ge_u32 s35, 0x40000
    s_waitcnt vmcnt(0)
    s_cbranch_scc1 L_e3_out
    v_cmp_gt_u32 vcc, 0x300, v15
    s_nop 1
    s_cbranch_vccnz L_e3_lp
L_e3_out:
    s_mov_b64 exec, -1
    s_nop 3
    s_branch L_e3_ok
L_fallback:
    s_mov_b32 s63, 1
    s_waitcnt vmcnt(0)
    s_lshl_b32 s34, s3, 4
    v_bfe_u32 v2, v1, 4, 4
    v_add_u32 v2, s34, v2
    v_lshrrev_b32 v4, 8, v1
    v_lshlrev_b32 v4, 2, v4
    v_sub_u32 v2, v2, v4
    s_lshl_b32 s34, s33, 16
    s_sub_u32 s99, 0x100000, s34
    s_lshl_b32 s34, s33, 7
    v_add_u32 v8, s34, v2
    v_add_u32 v9, 64, v8
    s_sub_u32 s34, 1920, s34
    v_add_u32 v10, s34, v2
    v_add_u32 v11, 64, v10
    v_mov_b32 v12, v7
    v_mov_b32 v13, v7
    v_mov_b32 v14, v7
    v_mov_b32 v15, v7
    s_mov_b32 s98, 0
L_fb_loop:
    s_add_u32 s35, s98, 4096
    buffer_load_dwordx4 a[128:131], v1, s[20:23], s98 offen offset:0 sc1
    buffer_load_dwordx4 a[132:135], v1, s[20:23], s98 offen offset:1024 sc1
    buffer_load_dwordx4 a[136:139], v1, s[20:23], s98 offen offset:2048 sc1
    buffer_load_dwordx4 a[140:143], v1, s[20:23], s98 offen offset:3072 sc1
    buffer_load_dwordx4 a[144:147], v1, s[20:23], s35 offen offset:0 sc1
    buffer_load_dwordx4 a[148:151], v1, s[20:23], s35 offen offset:1024 sc1
    buffer_load_dwordx4 a[152:155], v1, s[20:23], s35 offen offset:2048 sc1
    buffer_load_dwordx4 a[156:159], v1, s[20:23], s35 offen offset:3072 sc1
    s_waitcnt vmcnt(0)
    v_mfma_f32_16x16x32_bf16 v[16:19], a[128:131], v[64:67], 0
    v_mfma_f32_16x16x32_bf16 v[16:19], a[132:135], v[68:71], v[16:19]
    v_mfma_f32_16x16x32_bf16 v[16:19], a[136:139], v[72:75], v[16:19]
    v_mfma_f32_16x16x32_bf16 v[16:19], a[140:143], v[76:79], v[16:19]
    v_mfma_f32_16x16x32_bf16 v[20:23], a[144:147], v[64:67], 0
    v_mfma_f32_16x16x32_bf16 v[20:23], a[148:151], v[68:71], v[20:23]
    v_mfma_f32_16x16x32_bf16 v[20:23], a[152:155], v[72:75], v[20:23]
    v_mfma_f32_16x16x32_bf16 v[20:23], a[156:159], v[76:79], v[20:23]
    v_mfma_f32_16x16x32_bf16 v[24:27], a[128:131], v[80:83], 0
    v_mfma_f32_16x16x32_bf16 v[24:27], a[132:135], v[84:87], v[24:27]
    v_mfma_f32_16x16x32_bf16 v[24:27], a[136:139], v[88:91], v[24:27]
    v_mfma_f32_16x16x32_bf16 v[24:27], a[140:143], v[92:95], v[24:27]
    v_mfma_f32_16x16x32_bf16 v[28:31], a[144:147], v[80:83], 0
    v_mfma_f32_16x16x32_bf16 v[28:31], a[148:151], v[84:87], v[28:31]
    v_mfma_f32_16x16x32_bf16 v[28:31], a[152:155], v[88:91], v[28:31]
    v_mfma_f32_16x16x32_bf16 v[28:31], a[156:159], v[92:95], v[28:31]
    v_mfma_f32_16x16x32_bf16 v[32:35], a[128:131], v[96:99], 0
    v_mfma_f32_16x16x32_bf16 v[32:35], a[132:135], v[100:103], v[32:35]
    v_mfma_f32_16x16x32_bf16 v[32:35], a[136:139], v[104:107], v[32:35]
    v_mfma_f32_16x16x32_bf16 v[32:35], a[140:143], v[108:111], v[32:35]
    v_mfma_f32_16x16x32_bf16 v[36:39], a[144:147], v[96:99], 0
    v_mfma_f32_16x16x32_bf16 v[36:39], a[148:151], v[100:103], v[36:39]
    v_mfma_f32_16x16x32_bf16 v[36:39], a[152:155], v[104:107], v[36:39]
    v_mfma_f32_16x16x32_bf16 v[36:39], a[156:159], v[108:111], v[36:39]
    v_mfma_f32_16x16x32_bf16 v[40:43], a[128:131], v[112:115], 0
    v_mfma_f32_16x16x32_bf16 v[40:43], a[132:135], v[116:119], v[40:43]
    v_mfma_f32_16x16x32_bf16 v[40:43], a[136:139], v[120:123], v[40:43]
    v_mfma_f32_16x16x32_bf16 v[40:43], a[140:143], v[124:127], v[40:43]
    v_mfma_f32_16x16x32_bf16 v[44:47], a[144:147], v[112:115], 0
    v_mfma_f32_16x16x32_bf16 v[44:47], a[148:151], v[116:119], v[44:47]
    v_mfma_f32_16x16x32_bf16 v[44:47], a[152:155], v[120:123], v[44:47]
    v_mfma_f32_16x16x32_bf16 v[44:47], a[156:159], v[124:127], v[44:47]
    s_nop 7
    v_cmp_le_i32 vcc, 0, v8
    s_nop 1
    v_cndmask_b32 v4, v7, v16, vcc
    v_max_f32 v12, v12, v4
    v_cmp_le_i32 vcc, 1, v8
    s_nop 1
    v_cndmask_b32 v4, v7, v17, vcc
    v_max_f32 v12, v12, v4
    v_cmp_le_i32 vcc, 2, v8
    s_nop 1
    v_cndmask_b32 v4, v7, v18, vcc
    v_max_f32 v12, v12, v4
    v_cmp_le_i32 vcc, 3, v8
    s_nop 1
    v_cndmask_b32 v4, v7, v19, vcc
    v_max_f32 v12, v12, v4
    v_cmp_le_i32 vcc, 16, v8
    s_nop 1
    v_cndmask_b32 v4, v7, v20, vcc
    v_max_f32 v12, v12, v4
    v_cmp_le_i32 vcc, 17, v8
    s_nop 1
    v_cndmask_b32 v4, v7, v21, vcc
    v_max_f32 v12, v12, v4
    v_cmp_le_i32 vcc, 18, v8
    s_nop 1
    v_cndmask_b32 v4, v7, v22, vcc
    v_max_f32 v12, v12, v4
    v_cmp_le_i32 vcc, 19, v8
    s_nop 1
    v_cndmask_b32 v4, v7, v23, vcc
    v_max_f32 v12, v12, v4
    v_subrev_u32 v8, 32, v8
    v_cmp_le_i32 vcc, 0, v9
    s_nop 1
    v_cndmask_b32 v4, v7, v24, vcc
    v_max_f32 v13, v13, v4
    v_cmp_le_i32 vcc, 1, v9
    s_nop 1
    v_cndmask_b32 v4, v7, v25, vcc
    v_max_f32 v13, v13, v4
    v_cmp_le_i32 vcc, 2, v9
    s_nop 1
    v_cndmask_b32 v4, v7, v26, vcc
    v_max_f32 v13, v13, v4
    v_cmp_le_i32 vcc, 3, v9
    s_nop 1
    v_cndmask_b32 v4, v7, v27, vcc
    v_max_f32 v13, v13, v4
    v_cmp_le_i32 vcc, 16, v9
    s_nop 1
    v_cndmask_b32 v4, v7, v28, vcc
    v_max_f32 v13, v13, v4
    v_cmp_le_i32 vcc, 17, v9
    s_nop 1
    v_cndmask_b32 v4, v7, v29, vcc
    v_max_f32 v13, v13, v4
    v_cmp_le_i32 vcc, 18, v9
    s_nop 1
    v_cndmask_b32 v4, v7, v30, vcc
    v_max_f32 v13, v13, v4
    v_cmp_le_i32 vcc, 19, v9
    s_nop 1
    v_cndmask_b32 v4, v7, v31, vcc
    v_max_f32 v13, v13, v4
    v_subrev_u32 v9, 32, v9
    v_cmp_le_i32 vcc, 0, v10
    s_nop 1
    v_cndmask_b32 v4, v7, v32, vcc
    v_max_f32 v14, v14, v4
    v_cmp_le_i32 vcc, 1, v10
    s_nop 1
    v_cndmask_b32 v4, v7, v33, vcc
    v_max_f32 v14, v14, v4
    v_cmp_le_i32 vcc, 2, v10
    s_nop 1
    v_cndmask_b32 v4, v7, v34, vcc
    v_max_f32 v14, v14, v4
    v_cmp_le_i32 vcc, 3, v10
    s_nop 1
    v_cndmask_b32 v4, v7, v35, vcc
    v_max_f32 v14, v14, v4
    v_cmp_le_i32 vcc, 16, v10
    s_nop 1
    v_cndmask_b32 v4, v7, v36, vcc
    v_max_f32 v14, v14, v4
    v_cmp_le_i32 vcc, 17, v10
    s_nop 1
    v_cndmask_b32 v4, v7, v37, vcc
    v_max_f32 v14, v14, v4
    v_cmp_le_i32 vcc, 18, v10
    s_nop 1
    v_cndmask_b32 v4, v7, v38, vcc
    v_max_f32 v14, v14, v4
    v_cmp_le_i32 vcc, 19, v10
    s_nop 1
    v_cndmask_b32 v4, v7, v39, vcc
    v_max_f32 v14, v14, v4
    v_subrev_u32 v10, 32, v10
    v_cmp_le_i32 vcc, 0, v11
    s_nop 1
    v_cndmask_b32 v4, v7, v40, vcc
    v_max_f32 v15, v15, v4
    v_cmp_le_i32 vcc, 1, v11
    s_nop 1
    v_cndmask_b32 v4, v7, v41, vcc
    v_max_f32 v15, v15, v4
    v_cmp_le_i32 vcc, 2, v11
    s_nop 1
    v_cndmask_b32 v4, v7, v42, vcc
    v_max_f32 v15, v15, v4
    v_cmp_le_i32 vcc, 3, v11
    s_nop 1
    v_cndmask_b32 v4, v7, v43, vcc
    v_max_f32 v15, v15, v4
    v_cmp_le_i32 vcc, 16, v11
    s_nop 1
    v_cndmask_b32 v4, v7, v44, vcc
    v_max_f32 v15, v15, v4
    v_cmp_le_i32 vcc, 17, v11
    s_nop 1
    v_cndmask_b32 v4, v7, v45, vcc
    v_max_f32 v15, v15, v4
    v_cmp_le_i32 vcc, 18, v11
    s_nop 1
    v_cndmask_b32 v4, v7, v46, vcc
    v_max_f32 v15, v15, v4
    v_cmp_le_i32 vcc, 19, v11
    s_nop 1
    v_cndmask_b32 v4, v7, v47, vcc
    v_max_f32 v15, v15, v4
    v_subrev_u32 v11, 32, v11
    s_add_u32 s98, s98, 16384
    s_cmp_lt_u32 s98, s99
    s_cbranch_scc1 L_fb_loop
    v_mov_b32 v8, v12
    v_mov_b32 v9, v13
    v_mov_b32 v10, v14
    v_mov_b32 v11, v15
    v_permlane32_swap_b32 v12, v8
    v_permlane32_swap_b32 v13, v9
    v_permlane32_swap_b32 v14, v10
    v_permlane32_swap_b32 v15, v11
    v_max_f32 v12, v12, v8
    v_max_f32 v13, v13, v9
    v_max_f32 v14, v14, v10
    v_max_f32 v15, v15, v11
    v_mov_b32 v8, v12
    v_mov_b32 v9, v13
    v_mov_b32 v10, v14
    v_mov_b32 v11, v15
    v_permlane16_swap_b32 v12, v8
    v_permlane16_swap_b32 v13, v9
    v_permlane16_swap_b32 v14, v10
    v_permlane16_swap_b32 v15, v11
    v_max_f32 v12, v12, v8
    v_max_f32 v13, v13, v9
    v_max_f32 v14, v14, v10
    v_max_f32 v15, v15, v11
    v_mov_b32 v8, v12
    v_mov_b32 v10, v13
    v_mov_b32 v12, v14
    v_sub_f32 v52, 0, v15
    v_sub_f32 v53, 0, v15
    v_sub_f32 v54, 0, v15
    v_sub_f32 v55, 0, v15
    v_mov_b32 v56, 0
    v_mov_b32 v57, 0
    v_mov_b32 v58, 0
    v_mov_b32 v59, 0
    v_mov_b32 v60, 0
    v_mov_b32 v61, 0
    v_mov_b32 v62, 0
    v_mov_b32 v63, 0
    s_lshl_b32 s34, s3, 12
    s_add_u32 s14, s20, s34
    s_addc_u32 s15, s21, 0
    s_add_u32 s10, s14, 32768
    s_addc_u32 s11, s15, 0
    s_add_u32 s12, s14, 65536
    s_addc_u32 s13, s15, 0
    s_add_u32 s38, s34, 0
    s_add_u32 s39, s34, 16384
    s_add_u32 s40, s34, 32768
    s_add_u32 s41, s34, 49152
    s_add_u32 s46, s34, 65536
    s_add_u32 s47, s34, 81920
    s_add_u32 m0, s34, 114688
    s_lshl_b32 s97, s33, 1
    s_sub_u32 s97, 29, s97
    global_load_lds_dwordx4 v1, s[14:15] offset:0 sc1
    global_load_lds_dwordx4 v1, s[14:15] offset:1024 sc1
    global_load_lds_dwordx4 v1, s[14:15] offset:2048 sc1
    global_load_lds_dwordx4 v1, s[14:15] offset:3072 sc1
    s_mov_b32 m0, s38
    s_nop 0
    global_load_lds_dwordx4 v3, s[14:15] offset:0 sc1
    global_load_lds_dwordx4 v3, s[14:15] offset:1024 sc1
    global_load_lds_dwordx4 v3, s[14:15] offset:2048 sc1
    global_load_lds_dwordx4 v3, s[14:15] offset:3072 sc1
    s_mov_b32 m0, s39
    s_nop 0
    global_load_lds_dwordx4 v1, s[10:11] offset:0 sc1
    global_load_lds_dwordx4 v1, s[10:11] offset:1024 sc1
    global_load_lds_dwordx4 v1, s[10:11] offset:2048 sc1
    global_load_lds_dwordx4 v1, s[10:11] offset:3072 sc1
    s_mov_b32 m0, s40
    s_nop 0
    global_load_lds_dwordx4 v3, s[10:11] offset:0 sc1
    global_load_lds_dwordx4 v3, s[10:11] offset:1024 sc1
    global_load_lds_dwordx4 v3, s[10:11] offset:2048 sc1
    global_load_lds_dwordx4 v3, s[10:11] offset:3072 sc1
    s_mov_b32 m0, s41
    s_nop 0
    global_load_lds_dwordx4 v1, s[12:13] offset:0 sc1
    global_load_lds_dwordx4 v1, s[12:13] offset:1024 sc1
    global_load_lds_dwordx4 v1, s[12:13] offset:2048 sc1
    global_load_lds_dwordx4 v1, s[12:13] offset:3072 sc1
    s_mov_b32 m0, s46
    s_nop 0
    global_load_lds_dwordx4 v3, s[12:13] offset:0 sc1
    global_load_lds_dwordx4 v3, s[12:13] offset:1024 sc1
    global_load_lds_dwordx4 v3, s[12:13] offset:2048 sc1
    global_load_lds_dwordx4 v3, s[12:13] offset:3072 sc1
    s_mov_b32 m0, s47
    s_nop 0
    s_add_u32 s14, s14, 98304
    s_addc_u32 s15, s15, 0
    s_add_u32 s6, s16, 180224
    s_addc_u32 s7, s17, 0
    s_mov_b32 s96, 0
    s_mov_b32 s99, 0
    v_mfma_f32_32x32x16_bf16 v[128:143], v[56:59], v[56:59], 0
    v_mfma_f32_32x32x16_bf16 v[144:159], v[56:59], v[56:59], 0
    v_mfma_f32_32x32x16_bf16 v[160:175], v[56:59], v[56:59], 0
    v_mfma_f32_32x32x16_bf16 v[176:191], v[56:59], v[56:59], 0
    v_mfma_f32_32x32x16_bf16 v[192:207], v[56:59], v[56:59], 0
    v_mfma_f32_32x32x16_bf16 v[208:223], v[56:59], v[56:59], 0
    v_mfma_f32_32x32x16_bf16 v[224:239], v[56:59], v[56:59], 0
    v_mfma_f32_32x32x16_bf16 v[240:255], v[56:59], v[56:59], 0
    v_add_u32 v2, 114688, v1
    s_waitcnt vmcnt(0)
    s_barrier
    ds_read_b128 a[128:131], v2 offset:0
    ds_read_b128 a[132:135], v2 offset:1024
    ds_read_b128 a[136:139], v2 offset:2048
    ds_read_b128 a[140:143], v2 offset:3072
    ds_read_b128 a[144:147], v2 offset:4096
    ds_read_b128 a[148:151], v2 offset:5120
    ds_read_b128 a[152:155], v2 offset:6144
    ds_read_b128 a[156:159], v2 offset:7168
    s_waitcnt lgkmcnt(0)
    ds_read_b128 a[192:195], v2 offset:8192
    ds_read_b128 a[196:199], v2 offset:9216
    ds_read_b128 a[200:203], v2 offset:10240
    ds_read_b128 a[204:207], v2 offset:11264
    ds_read_b128 a[208:211], v2 offset:12288
    ds_read_b128 a[212:215], v2 offset:13312
    ds_read_b128 a[216:219], v2 offset:14336
    ds_read_b128 a[220:223], v2 offset:15360
    s_branch L_att_go
L_code_end:
.section .rodata,"a"
.p2align 6
.amdhsa_kernel gated_mix__sliding_local_dilated__compressed_kv_cla__prompt_kernel
  .amdhsa_next_free_vgpr 512
  .amdhsa_next_free_sgpr 102
  .amdhsa_accum_offset 256
  .amdhsa_group_segment_fixed_size 0
  .amdhsa_kernarg_size 104
  .amdhsa_user_sgpr_count 2
  .amdhsa_user_sgpr_kernarg_segment_ptr 1
  .amdhsa_system_sgpr_workgroup_id_x 1
.end_amdhsa_kernel
```
